```python
import torch

def _softmax(x, axis=-1):
    return torch.softmax(x, dim=axis)
def _gelu(x):
    return torch.nn.functional.gelu(x, approximate="tanh")
def _silu(x):
    return torch.nn.functional.silu(x)
def _sigmoid(x):
    return torch.sigmoid(x)
def _layernorm(x, axis=-1, eps=1e-5):
    m = x.mean(dim=axis, keepdim=True)
    v = x.var(dim=axis, keepdim=True, unbiased=False)
    return (x - m) / torch.sqrt(v + eps)
def _scatter_add(tgt, idx, src, axis=0):
    return tgt.clone().index_add_(axis, idx, src)
def _segment_sum(src, seg, n):
    out = torch.zeros((n,) + src.shape[1:], dtype=src.dtype)
    return out.index_add_(0, seg, src)
def _pad(x, pw):
    flat = tuple(v for pair in reversed(pw) for v in pair)
    return torch.nn.functional.pad(x, flat)

kernel_name = 'recurrent_scan__ssm_conv_s5__glu_gated_geglu__prompt'

def setup_inputs():

    _w = (lambda a: (lambda t: t.to(torch.bfloat16) if t.is_floating_point() else t)(torch.as_tensor(a)))
    def _A_setup():
        B, S, D = 1, 2048, 1024
        P = D
        Lambda_re = -0.5 * (lambda _x: torch.exp(torch.as_tensor(_x)))((lambda *s: torch.randn(*s, dtype=torch.bfloat16) * 0.8)(P))
        Lambda_im = (lambda *s: torch.randn(*s, dtype=torch.bfloat16) * 0.8)(P) * 1.0
        B_re = (lambda *s: torch.randn(*s, dtype=torch.bfloat16) * 1.6)(P, D) * (D ** -0.5)
        B_im = (lambda *s: torch.randn(*s, dtype=torch.bfloat16) * 1.6)(P, D) * (D ** -0.5)
        C_re = (lambda *s: torch.randn(*s, dtype=torch.bfloat16) * 1.6)(D, P) * (P ** -0.5)
        C_im = (lambda *s: torch.randn(*s, dtype=torch.bfloat16) * 1.6)(D, P) * (P ** -0.5)
        log_dt = (lambda *s: torch.randn(*s, dtype=torch.bfloat16) * 0.8)(P) * 0.3 - 2.0
        Dskip = (lambda *s: torch.randn(*s, dtype=torch.bfloat16) * 0.8)(D)
        return {
            "x": _w((lambda *s: torch.randn(*s, dtype=torch.bfloat16) * 0.05)(B, S, D)),
            "Lambda_re": _w(Lambda_re),
            "Lambda_im": _w(Lambda_im),
            "B_re": _w(B_re),
            "B_im": _w(B_im),
            "C_re": _w(C_re),
            "C_im": _w(C_im),
            "log_dt": _w(log_dt),
            "Dskip": _w(Dskip),
        }
    _A_in = _A_setup()

    def _B_setup():
        B, S, Dm, Df = 1, 2048, 1024, 3584
        return {
            "x": _w((lambda *s: torch.randn(*s, dtype=torch.bfloat16) * 0.05)(B, S, Dm)),
            "w_gate": _w((lambda *s: torch.randn(*s, dtype=torch.bfloat16) * 0.2)(Dm, Df) * (Dm ** -0.5)),
            "w_up": _w((lambda *s: torch.randn(*s, dtype=torch.bfloat16) * 0.2)(Dm, Df) * (Dm ** -0.5)),
            "w_down": _w((lambda *s: torch.randn(*s, dtype=torch.bfloat16) * 0.2)(Df, Dm) * (Df ** -0.5)),
        }
    _B_in = _B_setup()

    return {
        "A_x": _A_in["x"],
        "A_Lambda_re": _A_in["Lambda_re"],
        "A_Lambda_im": _A_in["Lambda_im"],
        "A_B_re": _A_in["B_re"],
        "A_B_im": _A_in["B_im"],
        "A_C_re": _A_in["C_re"],
        "A_C_im": _A_in["C_im"],
        "A_log_dt": _A_in["log_dt"],
        "A_Dskip": _A_in["Dskip"],
        "B_x": _B_in["x"],
        "B_w_gate": _B_in["w_gate"],
        "B_w_up": _B_in["w_up"],
        "B_w_down": _B_in["w_down"],
    }

def reference(A_x, A_Lambda_re, A_Lambda_im, A_B_re, A_B_im, A_C_re, A_C_im, A_log_dt, A_Dskip, B_x, B_w_gate, B_w_up, B_w_down):
    def _A_ref(x, Lambda_re, Lambda_im, B_re, B_im, C_re, C_im, log_dt, Dskip):
        Bsz, L, H = x.shape
        Lam = Lambda_re + 1j * Lambda_im
        Bmat = B_re + 1j * B_im
        Cmat = C_re + 1j * C_im
        dt = torch.exp(log_dt)
        Lam_bar = torch.exp(dt * Lam)
        B_bar = ((Lam_bar - 1.0) / Lam)[:, None] * Bmat
        Bu = torch.einsum("bld,pd->blp", x + 0j, B_bar)
        h = torch.zeros_like(Bu[:, 0, :])
        hs = []
        for t in range(L):
            h = Lam_bar[None, :] * h + Bu[:, t, :]
            hs.append(h)
        hseq = torch.stack(hs, 1)
        y = 2.0 * torch.einsum("blp,dp->bld", hseq, Cmat).real + x * Dskip[None, None, :]
        return y

    def _B_ref(x, w_gate, w_up, w_down):
        g = torch.einsum("bsd,df->bsf", x, w_gate)
        u = torch.einsum("bsd,df->bsf", x, w_up)
        h = _gelu(g) * u
        return torch.einsum("bsf,fd->bsd", h, w_down)

    x = A_x
    xn = _layernorm(x, axis=-1)
    s = _A_ref(xn, A_Lambda_re, A_Lambda_im, A_B_re, A_B_im, A_C_re, A_C_im, A_log_dt, A_Dskip)
    g = _silu(_B_ref(xn, B_w_gate, B_w_up, B_w_down))
    return x + s * g
```

```asm
; @launch grid=(256,1,1) block=(256,1,1) lds=163840
.amdgcn_target "amdgcn-amd-amdhsa--gfx950"
.text
.globl recurrent_scan__ssm_conv_s5__glu_gated_geglu__prompt_kernel
.p2align 8
.type recurrent_scan__ssm_conv_s5__glu_gated_geglu__prompt_kernel,@function
recurrent_scan__ssm_conv_s5__glu_gated_geglu__prompt_kernel:
    s_cmp_ge_u32 s2, 256
    s_cbranch_scc1 L_end
    s_load_dwordx2 s[60:61], s[0:1], 0
    s_load_dwordx4 s[48:51], s[0:1], 112
    s_load_dwordx4 s[40:43], s[0:1], 80
    s_load_dwordx4 s[44:47], s[0:1], 24
    s_load_dwordx4 s[64:67], s[0:1], 8
    s_load_dwordx2 s[62:63], s[0:1], 56
    s_load_dwordx4 s[52:55], s[0:1], 40
    s_load_dwordx2 s[56:57], s[0:1], 96
    s_getpc_b64 s[58:59]
L_pc1:
    s_add_u32 s58, s58, L_noclr-L_pc1
    s_addc_u32 s59, s59, 0
    v_and_b32 v21, 63, v0
    v_min_u32_e64 v21, 24, v21
    s_lshr_b32 s3, s2, 3
    s_mul_i32 s3, s3, 25
    v_add_lshl_u32 v21, v21, s3, 7
    v_min_u32 v21, L_text_end-L_noclr-4, v21
    global_load_dword a237, v21, s[58:59]
    v_and_b32 v29, 7, v0
    v_lshrrev_b32_e64 v30, 3, v0
    s_lshr_b32 s68, s2, 3
    s_bfe_u32 s69, s2, 0x10002
    s_and_b32 s70, s2, 3
    s_lshl_b32 s71, s68, 6
    s_lshl_b32 s3, s69, 5
    s_add_u32 s71, s71, s3
    s_lshl_b32 s3, s70, 2
    s_add_u32 s71, s71, s3
    v_lshrrev_b32 v19, 7, v0
    v_lshlrev_b32 v19, 4, v19
    v_bfe_u32 v20, v0, 5, 2
    v_add3_u32 v19, v19, v20, s71
    v_lshlrev_b32 v19, 11, v19
    v_and_b32 v31, 31, v0
    v_lshl_add_u32 v19, v31, 4, v19
    s_waitcnt lgkmcnt(0)
    s_mov_b32 s20, s50
    s_mov_b32 s21, s51
    s_mov_b32 s22, 45088768
    s_mov_b32 s23, 0x00020000
    s_mov_b32 s3, 36175872
    buffer_load_dwordx2 v[62:63], off, s[20:23], s3 sc1
L_noclr:
    global_load_dwordx4 v[40:43], v19, s[60:61] offset:0
    global_load_dwordx4 v[44:47], v19, s[60:61] offset:512
    global_load_dwordx4 v[48:51], v19, s[60:61] offset:1024
    global_load_dwordx4 v[52:55], v19, s[60:61] offset:1536
    v_lshrrev_b32 v17, 6, v0
    v_and_b32 v18, 63, v0
    s_and_b32 s3, s2, 7
    s_bfe_u32 s25, s2, 0x20003
    s_lshr_b32 s24, s2, 5
    v_readfirstlane_b32 s26, v17
    s_lshr_b32 s4, s3, 1
    s_lshl_b32 s6, s4, 2
    s_add_u32 s6, s6, s25
    s_lshl_b32 s4, s4, 1
    s_and_b32 s7, s25, 1
    s_add_u32 s4, s4, s7
    s_add_u32 s7, s4, 16
    s_bitcmp1_b32 s2, 0
    s_cselect_b32 s6, s7, s6
    s_cselect_b32 s25, s25, 0
    s_or_b32 s25, s25, 1
    s_lshl_b32 s37, s6, 7
    s_lshl_b32 s38, s6, 4
    s_lshl_b32 s6, s4, 6
    s_add_u32 s6, s6, 3072
    s_mul_i32 s7, s4, 80
    s_add_u32 s7, s7, 384
    s_cmp_eq_u32 s25, 3
    s_cselect_b32 s37, s6, s37
    s_cselect_b32 s38, s7, s38
    s_lshr_b32 s6, s37, 10
    s_lshl_b32 s6, s6, 9
    s_add_u32 s6, s6, s37
    s_add_u32 s6, s6, 512
    s_lshr_b32 s7, s4, 2
    s_mul_i32 s7, s7, 1536
    s_and_b32 s4, s4, 3
    s_lshl_b32 s4, s4, 7
    s_add_u32 s7, s7, s4
    s_cmp_lt_u32 s37, 3072
    s_cselect_b32 s7, s7, s37
    s_cmp_lt_u32 s37, 2048
    s_cselect_b32 s37, s6, s7
    s_movk_i32 s73, 64
    v_lshlrev_b32_e64 v10, 4, v18
    s_lshl_b32 s36, s24, 2
    s_add_u32 s36, s36, s26
    s_lshl_b32 s29, s36, 17
    s_mov_b32 s27, 0
    s_mov_b32 s28, 0
    s_mov_b32 s34, 75776
    s_mov_b32 s10, 7340032
    s_mov_b32 s11, 0x00020000
    s_mov_b32 s14, 2097152
    s_mov_b32 s15, 0x00020000
    s_and_b32 s5, s26, 1
    s_mul_i32 s6, s5, 229376
    s_lshl_b32 s7, s37, 1
    s_add_u32 s6, s6, s7
    s_movk_i32 s7, 7168
    s_cmp_eq_u32 s25, 3
    s_cselect_b32 s3, 79, 15
    s_cselect_b32 s4, 127, 63
    v_and_b32 v28, s4, v0
    v_min_u32_e64 v28, s3, v28
    v_add_lshl_u32 v20, v28, s38, 1
    v_lshlrev_b32_e64 v28, 3, v28
    s_cmp_lt_u32 s26, 2
    s_cselect_b32 s8, s40, s42
    s_cselect_b32 s9, s41, s43
    s_cselect_b32 s12, s44, s46
    s_cselect_b32 s13, s45, s47
    s_cselect_b32 s52, s52, s54
    s_cselect_b32 s53, s53, s55
    s_lshl_b32 s45, s73, 1
    global_load_ushort v56, v20, s[64:65]
    global_load_ushort v57, v20, s[66:67]
    global_load_ushort v58, v20, s[62:63]
    v_mov_b32 v32, 0
    v_lshrrev_b32 v33, 5, v0
    v_lshlrev_b32_e64 v33, 15, v33
    v_lshl_add_u32 v33, v31, 2, v33
    s_lshl_b32 s3, s2, 7
    s_add_u32 s3, s3, 35913728
    buffer_store_dword v32, v33, s[20:23], s3 offen sc1
    s_cmp_eq_u32 s25, 3
    s_cselect_b32 s3, 0, 1
    s_cselect_b32 s4, 10, 2
    v_lshrrev_b32 v21, 1, v18
    v_min_u32 v21, 7, v21
    v_mul_u32_u24 v21, s7, v21
    v_and_b32 v22, s3, v18
    v_mad_u32_u24 v21, v22, s45, v21
    s_lshl_b32 s3, s24, 1
    s_add_u32 s3, s3, s5
    s_mul_i32 s3, s3, 57344
    s_lshl_b32 s71, s37, 1
    s_add_u32 s72, s3, s71
    buffer_load_dword a236, v21, s[8:11], s72 offen
    s_mul_i32 s3, s24, s4
    s_add_u32 s3, s3, s38
    s_lshl_b32 s3, s3, 11
    s_sub_u32 s4, s4, 1
    s_mul_i32 s71, s5, 128
    s_add_u32 s3, s3, s71
    v_lshrrev_b32 v34, 2, v18
    v_min_u32 v34, s4, v34
    v_lshlrev_b32 v34, 11, v34
    v_and_b32 v22, 3, v18
    v_min_u32 v22, 0, v22
    v_lshl_add_u32 v34, v22, 7, v34
    buffer_load_dword a236, v34, s[12:15], s3 offen
    s_lshl_b32 s71, s68, 17
    s_lshl_b32 s3, s70, 10
    s_add_u32 s71, s71, s3
    s_lshl_b32 s3, s69, 7
    s_add_u32 s71, s71, s3
    v_lshrrev_b32 v25, 2, v30
    v_lshlrev_b32 v25, 12, v25
    v_and_b32 v21, 3, v30
    v_lshlrev_b32_e64 v21, 8, v21
    v_add3_u32 v25, v25, v21, s71
    v_lshl_add_u32 v25, v29, 4, v25
    v_lshrrev_b32 v21, 5, v0
    v_xor_b32 v21, v21, v29
    v_lshlrev_b32_e64 v21, 4, v21
    v_lshl_add_u32 v26, v31, 7, v21
    v_add_u32 v26, 113664, v26
    v_and_b32 v21, 7, v30
    v_xor_b32 v21, v21, v29
    v_lshlrev_b32_e64 v21, 4, v21
    v_lshl_add_u32 v27, v30, 7, v21
    v_add_u32 v27, 113664, v27
    s_cmp_eq_u32 s25, 3
    s_cbranch_scc1 L_k2_B
    v_bfe_u32 v19, v18, 4, 1
    v_bfe_u32 v20, v18, 5, 1
    v_lshlrev_b32_e64 v19, 2, v19
    v_lshl_or_b32 v19, v20, 4, v19
    v_and_b32 v20, 7, v18
    v_mul_u32_u24 v19, s7, v19
    v_lshl_add_u32 v19, v20, 4, v19
    v_bfe_u32 v20, v18, 3, 1
    v_mad_u32_u24 v19, v20, s45, v19
    v_add_u32_e64 v1, s6, v19
    v_add_u32 v2, 6112, v1
    v_add_u32 v3, 12224, v1
    v_add_u32 v4, 18336, v1
    v_add_u32 v5, 57344, v1
    v_add_u32 v6, 63456, v1
    v_add_u32 v7, 69568, v1
    v_add_u32 v8, 75680, v1
    s_mul_i32 s3, s5, 8
    s_add_u32 s3, s3, s38
    s_lshl_b32 s3, s3, 11
    s_lshl_b32 s4, s5, 2
    v_lshrrev_b32 v19, 4, v18
    v_and_b32 v20, 7, v18
    v_xor_b32 v20, v20, v19
    v_xor_b32 v20, s4, v20
    v_lshrrev_b32 v21, 3, v18
    v_lshlrev_b32 v21, 11, v21
    v_add_u32_e64 v21, s3, v21
    v_lshl_add_u32 v9, v20, 4, v21
    s_mul_i32 s30, s26, 8448
    s_add_u32 s31, s30, 37888
    s_mul_i32 s32, s26, 1024
    s_add_u32 s32, s32, 33792
    s_add_u32 s33, s32, 37888
    s_mov_b32 s16, s50
    s_mov_b32 s17, s51
    s_mov_b32 s18, 4194304
    s_mov_b32 s19, 0x00020000
    s_mov_b32 s50, s60
    s_mov_b32 s51, s61
    v_accvgpr_write_b32 a0, 0
    v_accvgpr_write_b32 a1, 0
    v_accvgpr_write_b32 a2, 0
    v_accvgpr_write_b32 a3, 0
    v_accvgpr_write_b32 a4, 0
    v_accvgpr_write_b32 a5, 0
    v_accvgpr_write_b32 a6, 0
    v_accvgpr_write_b32 a7, 0
    v_accvgpr_write_b32 a8, 0
    v_accvgpr_write_b32 a9, 0
    v_accvgpr_write_b32 a10, 0
    v_accvgpr_write_b32 a11, 0
    v_accvgpr_write_b32 a12, 0
    v_accvgpr_write_b32 a13, 0
    v_accvgpr_write_b32 a14, 0
    v_accvgpr_write_b32 a15, 0
    v_accvgpr_write_b32 a16, 0
    v_accvgpr_write_b32 a17, 0
    v_accvgpr_write_b32 a18, 0
    v_accvgpr_write_b32 a19, 0
    v_accvgpr_write_b32 a20, 0
    v_accvgpr_write_b32 a21, 0
    v_accvgpr_write_b32 a22, 0
    v_accvgpr_write_b32 a23, 0
    v_accvgpr_write_b32 a24, 0
    v_accvgpr_write_b32 a25, 0
    v_accvgpr_write_b32 a26, 0
    v_accvgpr_write_b32 a27, 0
    v_accvgpr_write_b32 a28, 0
    v_accvgpr_write_b32 a29, 0
    v_accvgpr_write_b32 a30, 0
    v_accvgpr_write_b32 a31, 0
    v_accvgpr_write_b32 a32, 0
    v_accvgpr_write_b32 a33, 0
    v_accvgpr_write_b32 a34, 0
    v_accvgpr_write_b32 a35, 0
    v_accvgpr_write_b32 a36, 0
    v_accvgpr_write_b32 a37, 0
    v_accvgpr_write_b32 a38, 0
    v_accvgpr_write_b32 a39, 0
    v_accvgpr_write_b32 a40, 0
    v_accvgpr_write_b32 a41, 0
    v_accvgpr_write_b32 a42, 0
    v_accvgpr_write_b32 a43, 0
    v_accvgpr_write_b32 a44, 0
    v_accvgpr_write_b32 a45, 0
    v_accvgpr_write_b32 a46, 0
    v_accvgpr_write_b32 a47, 0
    v_accvgpr_write_b32 a48, 0
    v_accvgpr_write_b32 a49, 0
    v_accvgpr_write_b32 a50, 0
    v_accvgpr_write_b32 a51, 0
    v_accvgpr_write_b32 a52, 0
    v_accvgpr_write_b32 a53, 0
    v_accvgpr_write_b32 a54, 0
    v_accvgpr_write_b32 a55, 0
    v_accvgpr_write_b32 a56, 0
    v_accvgpr_write_b32 a57, 0
    v_accvgpr_write_b32 a58, 0
    v_accvgpr_write_b32 a59, 0
    v_accvgpr_write_b32 a60, 0
    v_accvgpr_write_b32 a61, 0
    v_accvgpr_write_b32 a62, 0
    v_accvgpr_write_b32 a63, 0
    v_bfe_u32 v19, v18, 2, 3
    v_mul_u32_u24 v19, 1056, v19
    v_bfe_u32 v20, v18, 5, 1
    v_lshl_add_u32 v19, v20, 9, v19
    v_and_b32_e64 v20, 3, v18
    v_lshl_add_u32 v11, v20, 3, v19
    v_add_u32 v12, 37888, v11
    v_and_b32 v19, 15, v18
    v_lshrrev_b32 v20, 1, v19
    v_lshrrev_b32 v21, 4, v18
    v_xor_b32 v20, v20, v21
    v_lshlrev_b32_e64 v20, 4, v20
    v_lshl_add_u32 v19, v19, 7, v20
    v_xor_b32_e64 v20, 64, v19
    v_add_u32 v13, 33792, v19
    v_add_u32 v14, 33792, v20
    v_add_u32 v15, 37888, v13
    v_add_u32 v16, 37888, v14
    s_lshl_b32 s3, s2, 2
    s_add_u32 s3, s3, s26
    s_lshl_b32 s4, s3, 3
    v_and_b32 v19, 7, v18
    v_add_lshl_u32 v23, v19, s4, 7
    s_lshl_b32 s3, s2, 1
    s_add_u32 s3, s3, s5
    s_lshl_b32 s3, s3, 2
    v_and_b32 v19, 3, v18
    v_add_lshl_u32 v24, v19, s3, 7
    v_mov_b32 v104, 0
    v_mov_b32 v105, 0
    v_mov_b32 v106, 0
    v_mov_b32 v107, 0
    v_mov_b32 v108, 0
    v_mov_b32 v109, 0
    v_mov_b32 v110, 0
    v_mov_b32 v111, 0
    v_mov_b32 v112, 0
    v_mov_b32 v113, 0
    v_mov_b32 v114, 0
    v_mov_b32 v115, 0
    v_mov_b32 v116, 0
    v_mov_b32 v117, 0
    v_mov_b32 v118, 0
    v_mov_b32 v119, 0
    v_mov_b32 v120, 0
    v_mov_b32 v121, 0
    v_mov_b32 v122, 0
    v_mov_b32 v123, 0
    v_mov_b32 v124, 0
    v_mov_b32 v125, 0
    v_mov_b32 v126, 0
    v_mov_b32 v127, 0
    v_mov_b32 v128, 0
    v_mov_b32 v129, 0
    v_mov_b32 v130, 0
    v_mov_b32 v131, 0
    v_mov_b32 v132, 0
    v_mov_b32 v133, 0
    v_mov_b32 v134, 0
    v_mov_b32 v135, 0
    v_mov_b32 v136, 0
    v_mov_b32 v137, 0
    v_mov_b32 v138, 0
    v_mov_b32 v139, 0
    v_mov_b32 v140, 0
    v_mov_b32 v141, 0
    v_mov_b32 v142, 0
    v_mov_b32 v143, 0
    v_mov_b32 v144, 0
    v_mov_b32 v145, 0
    v_mov_b32 v146, 0
    v_mov_b32 v147, 0
    v_mov_b32 v148, 0
    v_mov_b32 v149, 0
    v_mov_b32 v150, 0
    v_mov_b32 v151, 0
    v_mov_b32 v152, 0
    v_mov_b32 v153, 0
    v_mov_b32 v154, 0
    v_mov_b32 v155, 0
    v_mov_b32 v156, 0
    v_mov_b32 v157, 0
    v_mov_b32 v158, 0
    v_mov_b32 v159, 0
    v_mov_b32 v160, 0
    v_mov_b32 v161, 0
    v_mov_b32 v162, 0
    v_mov_b32 v163, 0
    v_mov_b32 v164, 0
    v_mov_b32 v165, 0
    v_mov_b32 v166, 0
    v_mov_b32 v167, 0
    v_mov_b32 v168, 0
    v_mov_b32 v169, 0
    v_mov_b32 v170, 0
    v_mov_b32 v171, 0
    v_mov_b32 v172, 0
    v_mov_b32 v173, 0
    v_mov_b32 v174, 0
    v_mov_b32 v175, 0
    v_mov_b32 v176, 0
    v_mov_b32 v177, 0
    v_mov_b32 v178, 0
    v_mov_b32 v179, 0
    v_mov_b32 v180, 0
    v_mov_b32 v181, 0
    v_mov_b32 v182, 0
    v_mov_b32 v183, 0
    v_mov_b32 v184, 0
    v_mov_b32 v185, 0
    v_mov_b32 v186, 0
    v_mov_b32 v187, 0
    v_mov_b32 v188, 0
    v_mov_b32 v189, 0
    v_mov_b32 v190, 0
    v_mov_b32 v191, 0
    v_mov_b32 v192, 0
    v_mov_b32 v193, 0
    v_mov_b32 v194, 0
    v_mov_b32 v195, 0
    v_mov_b32 v196, 0
    v_mov_b32 v197, 0
    v_mov_b32 v198, 0
    v_mov_b32 v199, 0
    v_mov_b32 v200, 0
    v_mov_b32 v201, 0
    v_mov_b32 v202, 0
    v_mov_b32 v203, 0
    v_mov_b32 v204, 0
    v_mov_b32 v205, 0
    v_mov_b32 v206, 0
    v_mov_b32 v207, 0
    v_mov_b32 v208, 0
    v_mov_b32 v209, 0
    v_mov_b32 v210, 0
    v_mov_b32 v211, 0
    v_mov_b32 v212, 0
    v_mov_b32 v213, 0
    v_mov_b32 v214, 0
    v_mov_b32 v215, 0
    v_mov_b32 v216, 0
    v_mov_b32 v217, 0
    v_mov_b32 v218, 0
    v_mov_b32 v219, 0
    v_mov_b32 v220, 0
    v_mov_b32 v221, 0
    v_mov_b32 v222, 0
    v_mov_b32 v223, 0
    v_mov_b32 v224, 0
    v_mov_b32 v225, 0
    v_mov_b32 v226, 0
    v_mov_b32 v227, 0
    v_mov_b32 v228, 0
    v_mov_b32 v229, 0
    v_mov_b32 v230, 0
    v_mov_b32 v231, 0
    v_mov_b32 v232, 0
    v_mov_b32 v233, 0
    v_mov_b32 v234, 0
    v_mov_b32 v235, 0
    v_mov_b32 v236, 0
    v_mov_b32 v237, 0
    v_mov_b32 v238, 0
    v_mov_b32 v239, 0
    v_mov_b32 v240, 0
    v_mov_b32 v241, 0
    v_mov_b32 v242, 0
    v_mov_b32 v243, 0
    v_mov_b32 v244, 0
    v_mov_b32 v245, 0
    v_mov_b32 v246, 0
    v_mov_b32 v247, 0
    v_mov_b32 v248, 0
    v_mov_b32 v249, 0
    v_mov_b32 v250, 0
    v_mov_b32 v251, 0
    v_mov_b32 v252, 0
    v_mov_b32 v253, 0
    v_mov_b32 v254, 0
    v_mov_b32_e64 v255, 0
    s_and_b32 s64, s2, 1
    s_xor_b32 s64, s64, 1
    s_lshr_b32 s4, s2, 5
    s_bfe_u32 s6, s2, 0x20003
    s_bfe_u32 s3, s2, 0x10002
    s_lshl_b32 s3, s3, 3
    s_add_u32 s60, s3, s4
    s_bfe_u32 s3, s2, 0x10001
    s_lshl_b32 s3, s3, 2
    s_add_u32 s61, s3, s6
    s_add_u32 s79, s4, s6
    s_and_b32 s79, s79, 3
    s_lshr_b32 s62, s26, 1
    s_and_b32 s63, s26, 1
    s_lshl_b32 s65, s60, 1
    s_add_u32 s65, s65, s63
    s_lshl_b32 s76, s62, 16
    s_lshl_b32 s3, s63, 13
    s_add_u32 s76, s76, s3
    s_mov_b32 s71, 0x00020000
    s_mov_b32 s72, 0
    s_mov_b32 s73, 262144
    s_mov_b32 s74, 524288
    s_mov_b32 s75, 786432
    s_lshl_b32 s54, s79, 18
    s_lshl_b32 s3, s63, 16
    s_lshl_b32 s4, s61, 8
    s_add_u32 s3, s3, s4
    v_lshrrev_b32_e64 v19, 4, v18
    v_bfe_u32 v20, v18, 1, 3
    v_xor_b32 v20, v20, v19
    v_and_b32 v21, 1, v18
    v_lshlrev_b32_e64 v21, 4, v21
    v_lshl_add_u32 v21, v19, 11, v21
    v_add_u32_e64 v21, s3, v21
    v_lshl_add_u32 v19, v20, 5, v21
    v_xor_b32_e64 v20, 4, v20
    v_lshl_add_u32 v20, v20, 5, v21
    v_add_u32_e64 v21, 0, v19
    v_accvgpr_write_b32 a240, v21
    v_add_u32 v21, 7168, v19
    v_accvgpr_write_b32 a241, v21
    v_add_u32 v21, 14336, v20
    v_accvgpr_write_b32 a242, v21
    v_add_u32 v21, 21504, v20
    v_accvgpr_write_b32 a243, v21
    v_add_u32 v21, 32768, v19
    v_accvgpr_write_b32 a244, v21
    v_add_u32 v21, 39936, v19
    v_accvgpr_write_b32 a245, v21
    v_add_u32 v21, 47104, v20
    v_accvgpr_write_b32 a246, v21
    v_add_u32 v21, 54272, v20
    v_accvgpr_write_b32 a247, v21
    s_mul_i32 s77, s62, 3145728
    s_lshl_b32 s3, s64, 20
    s_add_u32 s77, s77, s3
    s_mov_b32 s68, s56
    s_mov_b32 s69, s57
    s_mov_b32 s70, 7340032
    s_waitcnt vmcnt(6)
    v_readfirstlane_b32 s48, v62
    v_readfirstlane_b32 s49, v63
    s_add_u32 s48, s48, 1
    s_addc_u32 s49, s49, 0
    s_max_u32 s48, s48, 1
    v_accvgpr_write_b32 a248, s48
    v_accvgpr_write_b32 a249, s49
    v_lshlrev_b32_e64 v64, 16, v40
    v_and_b32 v65, 0xffff0000, v40
    v_lshlrev_b32_e64 v66, 16, v41
    v_and_b32 v67, 0xffff0000, v41
    v_lshlrev_b32_e64 v68, 16, v42
    v_and_b32 v69, 0xffff0000, v42
    v_lshlrev_b32_e64 v70, 16, v43
    v_and_b32 v71, 0xffff0000, v43
    v_lshlrev_b32_e64 v72, 16, v44
    v_and_b32 v73, 0xffff0000, v44
    v_lshlrev_b32_e64 v74, 16, v45
    v_and_b32 v75, 0xffff0000, v45
    v_lshlrev_b32_e64 v76, 16, v46
    v_and_b32 v77, 0xffff0000, v46
    v_lshlrev_b32_e64 v78, 16, v47
    v_and_b32 v79, 0xffff0000, v47
    v_lshlrev_b32_e64 v80, 16, v48
    v_and_b32 v81, 0xffff0000, v48
    v_lshlrev_b32_e64 v82, 16, v49
    v_and_b32 v83, 0xffff0000, v49
    v_lshlrev_b32_e64 v84, 16, v50
    v_and_b32 v85, 0xffff0000, v50
    v_lshlrev_b32_e64 v86, 16, v51
    v_and_b32 v87, 0xffff0000, v51
    v_lshlrev_b32_e64 v88, 16, v52
    v_and_b32 v89, 0xffff0000, v52
    v_lshlrev_b32_e64 v90, 16, v53
    v_and_b32 v91, 0xffff0000, v53
    v_lshlrev_b32_e64 v92, 16, v54
    v_and_b32 v93, 0xffff0000, v54
    v_lshlrev_b32_e64 v94, 16, v55
    v_and_b32 v95, 0xffff0000, v55
    v_pk_add_f32 v[32:33], v[64:65], v[66:67]
    v_pk_add_f32 v[34:35], v[68:69], v[70:71]
    v_pk_add_f32 v[32:33], v[32:33], v[72:73]
    v_pk_add_f32 v[34:35], v[34:35], v[74:75]
    v_pk_add_f32 v[32:33], v[32:33], v[76:77]
    v_pk_add_f32 v[34:35], v[34:35], v[78:79]
    v_pk_add_f32 v[32:33], v[32:33], v[80:81]
    v_pk_add_f32 v[34:35], v[34:35], v[82:83]
    v_pk_add_f32 v[32:33], v[32:33], v[84:85]
    v_pk_add_f32 v[34:35], v[34:35], v[86:87]
    v_pk_add_f32 v[32:33], v[32:33], v[88:89]
    v_pk_add_f32 v[34:35], v[34:35], v[90:91]
    v_pk_add_f32 v[32:33], v[32:33], v[92:93]
    v_pk_add_f32 v[34:35], v[34:35], v[94:95]
    v_pk_add_f32 v[32:33], v[32:33], v[34:35]
    v_add_f32 v32, v32, v33
    s_nop 1
    v_add_f32_dpp v32, v32, v32 quad_perm:[1,0,3,2] row_mask:0xf bank_mask:0xf
    s_nop 1
    v_add_f32_dpp v32, v32, v32 quad_perm:[2,3,0,1] row_mask:0xf bank_mask:0xf
    s_nop 1
    v_add_f32_dpp v32, v32, v32 row_half_mirror row_mask:0xf bank_mask:0xf
    s_nop 1
    v_add_f32_dpp v32, v32, v32 row_mirror row_mask:0xf bank_mask:0xf
    v_mov_b32 v33, v32
    s_nop 1
    v_permlane16_swap_b32 v32, v33
    s_nop 1
    v_add_f32 v32, v32, v33
    v_mul_f32 v38, 0xba800000, v32
    v_pk_add_f32 v[96:97], v[64:65], v[38:39] op_sel_hi:[1,0]
    v_pk_mul_f32 v[32:33], v[96:97], v[96:97]
    v_pk_add_f32 v[98:99], v[66:67], v[38:39] op_sel_hi:[1,0]
    v_pk_mul_f32 v[34:35], v[98:99], v[98:99]
    v_pk_add_f32 v[100:101], v[68:69], v[38:39] op_sel_hi:[1,0]
    v_pk_fma_f32 v[32:33], v[100:101], v[100:101], v[32:33]
    v_pk_add_f32 v[102:103], v[70:71], v[38:39] op_sel_hi:[1,0]
    v_pk_fma_f32 v[34:35], v[102:103], v[102:103], v[34:35]
    v_pk_add_f32 v[96:97], v[72:73], v[38:39] op_sel_hi:[1,0]
    v_pk_fma_f32 v[32:33], v[96:97], v[96:97], v[32:33]
    v_pk_add_f32 v[98:99], v[74:75], v[38:39] op_sel_hi:[1,0]
    v_pk_fma_f32 v[34:35], v[98:99], v[98:99], v[34:35]
    v_pk_add_f32 v[100:101], v[76:77], v[38:39] op_sel_hi:[1,0]
    v_pk_fma_f32 v[32:33], v[100:101], v[100:101], v[32:33]
    v_pk_add_f32 v[102:103], v[78:79], v[38:39] op_sel_hi:[1,0]
    v_pk_fma_f32 v[34:35], v[102:103], v[102:103], v[34:35]
    v_pk_add_f32 v[96:97], v[80:81], v[38:39] op_sel_hi:[1,0]
    v_pk_fma_f32 v[32:33], v[96:97], v[96:97], v[32:33]
    v_pk_add_f32 v[98:99], v[82:83], v[38:39] op_sel_hi:[1,0]
    v_pk_fma_f32 v[34:35], v[98:99], v[98:99], v[34:35]
    v_pk_add_f32 v[100:101], v[84:85], v[38:39] op_sel_hi:[1,0]
    v_pk_fma_f32 v[32:33], v[100:101], v[100:101], v[32:33]
    v_pk_add_f32 v[102:103], v[86:87], v[38:39] op_sel_hi:[1,0]
    v_pk_fma_f32 v[34:35], v[102:103], v[102:103], v[34:35]
    v_pk_add_f32 v[96:97], v[88:89], v[38:39] op_sel_hi:[1,0]
    v_pk_fma_f32 v[32:33], v[96:97], v[96:97], v[32:33]
    v_pk_add_f32 v[98:99], v[90:91], v[38:39] op_sel_hi:[1,0]
    v_pk_fma_f32 v[34:35], v[98:99], v[98:99], v[34:35]
    v_pk_add_f32 v[100:101], v[92:93], v[38:39] op_sel_hi:[1,0]
    v_pk_fma_f32 v[32:33], v[100:101], v[100:101], v[32:33]
    v_pk_add_f32 v[102:103], v[94:95], v[38:39] op_sel_hi:[1,0]
    v_pk_fma_f32 v[34:35], v[102:103], v[102:103], v[34:35]
    v_pk_add_f32 v[32:33], v[32:33], v[34:35]
    v_add_f32 v32, v32, v33
    s_nop 1
    v_add_f32_dpp v32, v32, v32 quad_perm:[1,0,3,2] row_mask:0xf bank_mask:0xf
    s_nop 1
    v_add_f32_dpp v32, v32, v32 quad_perm:[2,3,0,1] row_mask:0xf bank_mask:0xf
    s_nop 1
    v_add_f32_dpp v32, v32, v32 row_half_mirror row_mask:0xf bank_mask:0xf
    s_nop 1
    v_add_f32_dpp v32, v32, v32 row_mirror row_mask:0xf bank_mask:0xf
    v_mov_b32 v33, v32
    s_nop 1
    v_permlane16_swap_b32 v32, v33
    s_nop 1
    v_add_f32 v32, v32, v33
    v_mul_f32 v39, 0x3a800000, v32
    v_cvt_pk_bf16_f32 v36, v38, v39
    v_lshlrev_b32_e64 v38, 16, v36
    v_and_b32 v36, 0xffff0000, v36
    v_add_f32 v36, 0x3727c5ac, v36
    v_cvt_pk_bf16_f32 v36, v36, v36
    v_lshlrev_b32 v36, 16, v36
    v_sqrt_f32_e64 v36, v36
    s_nop 0
    v_cvt_pk_bf16_f32 v36, v36, v36
    v_lshlrev_b32 v36, 16, v36
    v_rcp_f32 v36, v36
    v_pk_add_f32 v[64:65], v[64:65], v[38:39] op_sel_hi:[1,0]
    v_pk_add_f32 v[66:67], v[66:67], v[38:39] op_sel_hi:[1,0]
    v_pk_add_f32 v[68:69], v[68:69], v[38:39] op_sel_hi:[1,0]
    v_pk_add_f32 v[70:71], v[70:71], v[38:39] op_sel_hi:[1,0]
    v_cvt_pk_bf16_f32 v40, v64, v65
    v_cvt_pk_bf16_f32 v41, v66, v67
    v_cvt_pk_bf16_f32 v42, v68, v69
    v_cvt_pk_bf16_f32 v43, v70, v71
    v_lshlrev_b32_e64 v64, 16, v40
    v_and_b32 v65, 0xffff0000, v40
    v_lshlrev_b32_e64 v66, 16, v41
    v_and_b32 v67, 0xffff0000, v41
    v_lshlrev_b32_e64 v68, 16, v42
    v_and_b32 v69, 0xffff0000, v42
    v_lshlrev_b32_e64 v70, 16, v43
    v_and_b32 v71, 0xffff0000, v43
    v_pk_mul_f32 v[64:65], v[64:65], v[36:37] op_sel_hi:[1,0]
    v_pk_mul_f32 v[66:67], v[66:67], v[36:37] op_sel_hi:[1,0]
    v_pk_mul_f32 v[68:69], v[68:69], v[36:37] op_sel_hi:[1,0]
    v_pk_mul_f32 v[70:71], v[70:71], v[36:37] op_sel_hi:[1,0]
    v_cvt_pk_bf16_f32 v40, v64, v65
    v_cvt_pk_bf16_f32 v41, v66, v67
    v_cvt_pk_bf16_f32 v42, v68, v69
    v_cvt_pk_bf16_f32 v43, v70, v71
    ds_write_b128 v26, v[40:43] offset:0
    v_pk_add_f32 v[72:73], v[72:73], v[38:39] op_sel_hi:[1,0]
    v_pk_add_f32 v[74:75], v[74:75], v[38:39] op_sel_hi:[1,0]
    v_pk_add_f32 v[76:77], v[76:77], v[38:39] op_sel_hi:[1,0]
    v_pk_add_f32 v[78:79], v[78:79], v[38:39] op_sel_hi:[1,0]
    v_cvt_pk_bf16_f32 v44, v72, v73
    v_cvt_pk_bf16_f32 v45, v74, v75
    v_cvt_pk_bf16_f32 v46, v76, v77
    v_cvt_pk_bf16_f32 v47, v78, v79
    v_lshlrev_b32_e64 v72, 16, v44
    v_and_b32 v73, 0xffff0000, v44
    v_lshlrev_b32_e64 v74, 16, v45
    v_and_b32 v75, 0xffff0000, v45
    v_lshlrev_b32_e64 v76, 16, v46
    v_and_b32 v77, 0xffff0000, v46
    v_lshlrev_b32_e64 v78, 16, v47
    v_and_b32 v79, 0xffff0000, v47
    v_pk_mul_f32 v[72:73], v[72:73], v[36:37] op_sel_hi:[1,0]
    v_pk_mul_f32 v[74:75], v[74:75], v[36:37] op_sel_hi:[1,0]
    v_pk_mul_f32 v[76:77], v[76:77], v[36:37] op_sel_hi:[1,0]
    v_pk_mul_f32 v[78:79], v[78:79], v[36:37] op_sel_hi:[1,0]
    v_cvt_pk_bf16_f32 v44, v72, v73
    v_cvt_pk_bf16_f32 v45, v74, v75
    v_cvt_pk_bf16_f32 v46, v76, v77
    v_cvt_pk_bf16_f32 v47, v78, v79
    ds_write_b128 v26, v[44:47] offset:4096
    v_pk_add_f32 v[80:81], v[80:81], v[38:39] op_sel_hi:[1,0]
    v_pk_add_f32 v[82:83], v[82:83], v[38:39] op_sel_hi:[1,0]
    v_pk_add_f32 v[84:85], v[84:85], v[38:39] op_sel_hi:[1,0]
    v_pk_add_f32 v[86:87], v[86:87], v[38:39] op_sel_hi:[1,0]
    v_cvt_pk_bf16_f32 v48, v80, v81
    v_cvt_pk_bf16_f32 v49, v82, v83
    v_cvt_pk_bf16_f32 v50, v84, v85
    v_cvt_pk_bf16_f32 v51, v86, v87
    v_lshlrev_b32_e64 v80, 16, v48
    v_and_b32 v81, 0xffff0000, v48
    v_lshlrev_b32_e64 v82, 16, v49
    v_and_b32 v83, 0xffff0000, v49
    v_lshlrev_b32_e64 v84, 16, v50
    v_and_b32 v85, 0xffff0000, v50
    v_lshlrev_b32_e64 v86, 16, v51
    v_and_b32 v87, 0xffff0000, v51
    v_pk_mul_f32 v[80:81], v[80:81], v[36:37] op_sel_hi:[1,0]
    v_pk_mul_f32 v[82:83], v[82:83], v[36:37] op_sel_hi:[1,0]
    v_pk_mul_f32 v[84:85], v[84:85], v[36:37] op_sel_hi:[1,0]
    v_pk_mul_f32 v[86:87], v[86:87], v[36:37] op_sel_hi:[1,0]
    v_cvt_pk_bf16_f32 v48, v80, v81
    v_cvt_pk_bf16_f32 v49, v82, v83
    v_cvt_pk_bf16_f32 v50, v84, v85
    v_cvt_pk_bf16_f32 v51, v86, v87
    ds_write_b128 v26, v[48:51] offset:8192
    v_pk_add_f32 v[88:89], v[88:89], v[38:39] op_sel_hi:[1,0]
    v_pk_add_f32 v[90:91], v[90:91], v[38:39] op_sel_hi:[1,0]
    v_pk_add_f32 v[92:93], v[92:93], v[38:39] op_sel_hi:[1,0]
    v_pk_add_f32 v[94:95], v[94:95], v[38:39] op_sel_hi:[1,0]
    v_cvt_pk_bf16_f32 v52, v88, v89
    v_cvt_pk_bf16_f32 v53, v90, v91
    v_cvt_pk_bf16_f32 v54, v92, v93
    v_cvt_pk_bf16_f32 v55, v94, v95
    v_lshlrev_b32_e64 v88, 16, v52
    v_and_b32 v89, 0xffff0000, v52
    v_lshlrev_b32_e64 v90, 16, v53
    v_and_b32 v91, 0xffff0000, v53
    v_lshlrev_b32_e64 v92, 16, v54
    v_and_b32 v93, 0xffff0000, v54
    v_lshlrev_b32_e64 v94, 16, v55
    v_and_b32 v95, 0xffff0000, v55
    v_pk_mul_f32 v[88:89], v[88:89], v[36:37] op_sel_hi:[1,0]
    v_pk_mul_f32 v[90:91], v[90:91], v[36:37] op_sel_hi:[1,0]
    v_pk_mul_f32 v[92:93], v[92:93], v[36:37] op_sel_hi:[1,0]
    v_pk_mul_f32 v[94:95], v[94:95], v[36:37] op_sel_hi:[1,0]
    v_cvt_pk_bf16_f32 v52, v88, v89
    v_cvt_pk_bf16_f32 v53, v90, v91
    v_cvt_pk_bf16_f32 v54, v92, v93
    v_cvt_pk_bf16_f32 v55, v94, v95
    ds_write_b128 v26, v[52:55] offset:12288
    s_waitcnt lgkmcnt(0)
    s_barrier
    ds_read_b128 v[40:43], v27 offset:0
    ds_read_b128 v[44:47], v27 offset:4096
    ds_read_b128 v[48:51], v27 offset:8192
    ds_read_b128 v[52:55], v27 offset:12288
    s_mov_b32 s3, 0
    s_waitcnt lgkmcnt(3)
    buffer_store_dwordx4 v[40:43], v25, s[20:23], s3 offen sc1
    s_mov_b32 s3, 32768
    s_waitcnt lgkmcnt(2)
    buffer_store_dwordx4 v[44:47], v25, s[20:23], s3 offen sc1
    s_mov_b32 s3, 65536
    s_waitcnt lgkmcnt(1)
    buffer_store_dwordx4 v[48:51], v25, s[20:23], s3 offen sc1
    s_mov_b32 s3, 98304
    s_waitcnt lgkmcnt(0)
    buffer_store_dwordx4 v[52:55], v25, s[20:23], s3 offen sc1
    s_waitcnt vmcnt(4)
    s_mov_b32 s3, 0x3fb8aa3b
    s_mov_b32 s4, 0x3e22f983
    s_mov_b32 s6, 0x31dc9c88
    s_cmp_ge_u32 s26, 2
    s_cbranch_scc1 L_noparA
    v_lshlrev_b32 v56, 16, v56
    v_lshlrev_b32 v57, 16, v57
    v_lshlrev_b32 v58, 16, v58
    v_mul_f32 v68, s3, v58
    v_exp_f32_e64 v68, v68
    s_nop 0
    v_cvt_pk_bf16_f32 v68, v68, v68
    v_lshlrev_b32 v68, 16, v68
    v_mul_f32 v69, v68, v56
    v_mul_f32 v70, v68, v57
    v_mul_f32 v73, s3, v69
    v_exp_f32 v73, v73
    v_mul_f32 v71, s4, v70
    v_fma_f32 v72, v70, s4, -v71
    v_fma_f32 v72, v70, s6, v72
    v_rndne_f32 v64, v71
    v_sub_f32 v71, v71, v64
    v_add_f32 v71, v71, v72
    v_cos_f32 v64, v71
    v_sin_f32 v65, v71
    s_nop 0
    v_mul_f32 v64, v64, v73
    v_mul_f32 v65, v65, v73
    v_add_f32 v68, -1.0, v64
    v_mul_f32 v69, v56, v56
    v_fmac_f32 v69, v57, v57
    v_rcp_f32 v69, v69
    v_mul_f32 v66, v68, v56
    v_fmac_f32 v66, v65, v57
    v_mul_f32_e64 v67, v65, v56
    v_fma_f32 v67, -v68, v57, v67
    v_mul_f32 v66, v66, v69
    v_mul_f32 v67, v67, v69
    v_lshlrev_b32_e64 v74, 1, v28
    v_add_u32 v74, 151552, v74
    v_add_u32 v75, 152832, v28
    v_cmp_gt_u32 vcc, 16, v0
    s_nop 1
    s_mov_b64 exec, vcc
    ds_write_b128 v74, v[64:67]
    s_mov_b64 exec, -1
    v_pk_mul_f32 v[76:77], v[64:65], v[64:65] op_sel_hi:[1,0]
    v_pk_fma_f32 v[76:77], v[64:65], v[64:65], v[76:77] op_sel:[1,1,0] op_sel_hi:[0,1,1] neg_lo:[0,1,0]
    v_pk_mul_f32 v[78:79], v[76:77], v[76:77] op_sel_hi:[1,0]
    v_pk_fma_f32 v[78:79], v[76:77], v[76:77], v[78:79] op_sel:[1,1,0] op_sel_hi:[0,1,1] neg_lo:[0,1,0]
    v_pk_mul_f32 v[76:77], v[78:79], v[78:79] op_sel_hi:[1,0]
    v_pk_fma_f32 v[76:77], v[78:79], v[78:79], v[76:77] op_sel:[1,1,0] op_sel_hi:[0,1,1] neg_lo:[0,1,0]
    v_pk_mul_f32 v[78:79], v[76:77], v[76:77] op_sel_hi:[1,0]
    v_pk_fma_f32 v[78:79], v[76:77], v[76:77], v[78:79] op_sel:[1,1,0] op_sel_hi:[0,1,1] neg_lo:[0,1,0]
    v_mov_b32 v80, 1.0
    v_mov_b32_e64 v81, 0
    s_mov_b64 exec, vcc
    ds_write_b64 v75, v[80:81]
    ds_write_b64 v75, v[78:79] offset:640
    s_mov_b64 exec, -1
    v_pk_mul_f32 v[84:85], v[78:79], v[78:79] op_sel_hi:[1,0]
    v_pk_fma_f32 v[84:85], v[78:79], v[78:79], v[84:85] op_sel:[1,1,0] op_sel_hi:[0,1,1] neg_lo:[0,1,0]
    s_mov_b64 exec, vcc
    ds_write_b64 v75, v[84:85] offset:1280
    s_mov_b64 exec, -1
    v_pk_mul_f32 v[86:87], v[84:85], v[78:79] op_sel_hi:[1,0]
    v_pk_fma_f32 v[86:87], v[84:85], v[78:79], v[86:87] op_sel:[1,1,0] op_sel_hi:[0,1,1] neg_lo:[0,1,0]
    s_mov_b64 exec, vcc
    ds_write_b64 v75, v[86:87] offset:1920
    s_mov_b64 exec, -1
    v_pk_mul_f32 v[80:81], v[86:87], v[78:79] op_sel_hi:[1,0]
    v_pk_fma_f32 v[80:81], v[86:87], v[78:79], v[80:81] op_sel:[1,1,0] op_sel_hi:[0,1,1] neg_lo:[0,1,0]
    s_mov_b64 exec, vcc
    ds_write_b64 v75, v[80:81] offset:2560
    s_mov_b64 exec, -1
    v_pk_mul_f32 v[82:83], v[80:81], v[78:79] op_sel_hi:[1,0]
    v_pk_fma_f32 v[82:83], v[80:81], v[78:79], v[82:83] op_sel:[1,1,0] op_sel_hi:[0,1,1] neg_lo:[0,1,0]
    s_mov_b64 exec, vcc
    ds_write_b64 v75, v[82:83] offset:3200
    s_mov_b64 exec, -1
    v_pk_mul_f32 v[84:85], v[82:83], v[78:79] op_sel_hi:[1,0]
    v_pk_fma_f32 v[84:85], v[82:83], v[78:79], v[84:85] op_sel:[1,1,0] op_sel_hi:[0,1,1] neg_lo:[0,1,0]
    s_mov_b64 exec, vcc
    ds_write_b64 v75, v[84:85] offset:3840
    s_mov_b64 exec, -1
    v_pk_mul_f32 v[86:87], v[84:85], v[78:79] op_sel_hi:[1,0]
    v_pk_fma_f32 v[86:87], v[84:85], v[78:79], v[86:87] op_sel:[1,1,0] op_sel_hi:[0,1,1] neg_lo:[0,1,0]
    s_mov_b64 exec, vcc
    ds_write_b64 v75, v[86:87] offset:4480
    s_mov_b64 exec, -1
    v_pk_mul_f32 v[80:81], v[86:87], v[78:79] op_sel_hi:[1,0]
    v_pk_fma_f32 v[80:81], v[86:87], v[78:79], v[80:81] op_sel:[1,1,0] op_sel_hi:[0,1,1] neg_lo:[0,1,0]
    s_mov_b64 exec, vcc
    ds_write_b64 v75, v[80:81] offset:5120
    s_mov_b64 exec, -1
    v_pk_mul_f32 v[82:83], v[80:81], v[78:79] op_sel_hi:[1,0]
    v_pk_fma_f32 v[82:83], v[80:81], v[78:79], v[82:83] op_sel:[1,1,0] op_sel_hi:[0,1,1] neg_lo:[0,1,0]
    s_mov_b64 exec, vcc
    ds_write_b64 v75, v[82:83] offset:5760
    s_mov_b64 exec, -1
    v_pk_mul_f32 v[84:85], v[82:83], v[78:79] op_sel_hi:[1,0]
    v_pk_fma_f32 v[84:85], v[82:83], v[78:79], v[84:85] op_sel:[1,1,0] op_sel_hi:[0,1,1] neg_lo:[0,1,0]
    s_mov_b64 exec, vcc
    ds_write_b64 v75, v[84:85] offset:6400
    s_mov_b64 exec, -1
    v_pk_mul_f32 v[86:87], v[84:85], v[78:79] op_sel_hi:[1,0]
    v_pk_fma_f32 v[86:87], v[84:85], v[78:79], v[86:87] op_sel:[1,1,0] op_sel_hi:[0,1,1] neg_lo:[0,1,0]
    s_mov_b64 exec, vcc
    ds_write_b64 v75, v[86:87] offset:7040
    s_mov_b64 exec, -1
    v_pk_mul_f32 v[80:81], v[86:87], v[78:79] op_sel_hi:[1,0]
    v_pk_fma_f32 v[80:81], v[86:87], v[78:79], v[80:81] op_sel:[1,1,0] op_sel_hi:[0,1,1] neg_lo:[0,1,0]
    s_mov_b64 exec, vcc
    ds_write_b64 v75, v[80:81] offset:7680
    s_mov_b64 exec, -1
    v_pk_mul_f32 v[82:83], v[80:81], v[78:79] op_sel_hi:[1,0]
    v_pk_fma_f32 v[82:83], v[80:81], v[78:79], v[82:83] op_sel:[1,1,0] op_sel_hi:[0,1,1] neg_lo:[0,1,0]
    s_mov_b64 exec, vcc
    ds_write_b64 v75, v[82:83] offset:8320
    s_mov_b64 exec, -1
    v_pk_mul_f32 v[84:85], v[82:83], v[78:79] op_sel_hi:[1,0]
    v_pk_fma_f32 v[84:85], v[82:83], v[78:79], v[84:85] op_sel:[1,1,0] op_sel_hi:[0,1,1] neg_lo:[0,1,0]
    s_mov_b64 exec, vcc
    ds_write_b64 v75, v[84:85] offset:8960
    s_mov_b64 exec, -1
    v_pk_mul_f32 v[86:87], v[84:85], v[78:79] op_sel_hi:[1,0]
    v_pk_fma_f32 v[86:87], v[84:85], v[78:79], v[86:87] op_sel:[1,1,0] op_sel_hi:[0,1,1] neg_lo:[0,1,0]
    s_mov_b64 exec, vcc
    ds_write_b64 v75, v[86:87] offset:9600
    s_mov_b64 exec, -1
    v_pk_mul_f32 v[80:81], v[86:87], v[78:79] op_sel_hi:[1,0]
    v_pk_fma_f32 v[80:81], v[86:87], v[78:79], v[80:81] op_sel:[1,1,0] op_sel_hi:[0,1,1] neg_lo:[0,1,0]
    v_accvgpr_write_b32 a230, v78
    v_accvgpr_write_b32 a231, v79
    v_accvgpr_write_b32 a232, v80
    v_accvgpr_write_b32 a233, v81
L_noparA:
    s_waitcnt vmcnt(0) lgkmcnt(0)
    s_barrier
    s_cmp_lg_u32 s26, 0
    s_cbranch_scc1 L_sigxA
    s_lshl_b32 s3, s2, 7
    s_add_u32 s3, s3, 35913728
    s_mov_b64 exec, 1
    buffer_store_dwordx2 a[248:249], off, s[20:23], s3 sc1
    s_mov_b64 exec, -1
L_sigxA:
    s_mov_b32 m0, s30
    s_nop 0
    buffer_load_dwordx4 v1, s[8:11], s27 offen offset:0 nt lds
    buffer_load_dwordx4 v2, s[8:11], s27 offen offset:1056 nt lds
    buffer_load_dwordx4 v3, s[8:11], s27 offen offset:2112 nt lds
    buffer_load_dwordx4 v4, s[8:11], s27 offen offset:3168 nt lds
    s_add_u32 m0, s30, 4224
    s_nop 0
    buffer_load_dwordx4 v5, s[8:11], s27 offen offset:0 nt lds
    buffer_load_dwordx4 v6, s[8:11], s27 offen offset:1056 nt lds
    buffer_load_dwordx4 v7, s[8:11], s27 offen offset:2112 nt lds
    buffer_load_dwordx4 v8, s[8:11], s27 offen offset:3168 nt lds
    s_mov_b32 m0, s32
    s_add_u32 s27, s27, 458752
    buffer_load_dwordx4 v9, s[12:15], s28 offen offset:0 nt lds
    s_add_u32 s28, s28, 128
    s_add_u32 s30, s30, s34
    s_add_u32 s32, s32, s34
    s_mov_b32 m0, s31
    s_nop 0
    buffer_load_dwordx4 v1, s[8:11], s27 offen offset:0 nt lds
    buffer_load_dwordx4 v2, s[8:11], s27 offen offset:1056 nt lds
    buffer_load_dwordx4 v3, s[8:11], s27 offen offset:2112 nt lds
    buffer_load_dwordx4 v4, s[8:11], s27 offen offset:3168 nt lds
    s_add_u32 m0, s31, 4224
    s_nop 0
    buffer_load_dwordx4 v5, s[8:11], s27 offen offset:0 nt lds
    buffer_load_dwordx4 v6, s[8:11], s27 offen offset:1056 nt lds
    buffer_load_dwordx4 v7, s[8:11], s27 offen offset:2112 nt lds
    buffer_load_dwordx4 v8, s[8:11], s27 offen offset:3168 nt lds
    s_mov_b32 m0, s33
    s_add_u32 s27, s27, 458752
    buffer_load_dwordx4 v9, s[12:15], s28 offen offset:0 nt lds
    s_add_u32 s28, s28, 128
    s_add_u32 s31, s31, s34
    s_add_u32 s33, s33, s34
    v_mov_b32 v32, 0
    v_mov_b32 v33, 0
    v_mov_b32 v34, 0
    v_mov_b32 v35, 0
    v_mov_b32 v36, 0
    v_mov_b32 v37, 0
    v_mov_b32 v38, 0
    v_mov_b32 v39, 0
    v_mov_b32 v40, 0
    v_mov_b32 v41, 0
    v_mov_b32 v42, 0
    v_mov_b32 v43, 0
    v_mov_b32 v44, 0
    v_mov_b32 v45, 0
    v_mov_b32 v46, 0
    v_mov_b32 v47, 0
    v_mov_b32 v48, 0
    v_mov_b32 v49, 0
    v_mov_b32 v50, 0
    v_mov_b32 v51, 0
    v_mov_b32 v52, 0
    v_mov_b32 v53, 0
    v_mov_b32 v54, 0
    v_mov_b32 v55, 0
    v_mov_b32 v56, 0
    v_mov_b32 v57, 0
    v_mov_b32 v58, 0
    v_mov_b32 v59, 0
    v_mov_b32 v60, 0
    v_mov_b32 v61, 0
    v_mov_b32 v62, 0
    v_mov_b32 v63, 0
    v_mov_b32 v64, 0
    v_mov_b32 v65, 0
    v_mov_b32 v66, 0
    v_mov_b32 v67, 0
    v_mov_b32 v68, 0
    v_mov_b32 v69, 0
    v_mov_b32 v70, 0
    v_mov_b32 v71, 0
    v_mov_b32 v72, 0
    v_mov_b32 v73, 0
    v_mov_b32 v74, 0
    v_mov_b32 v75, 0
    v_mov_b32 v76, 0
    v_mov_b32 v77, 0
    v_mov_b32 v78, 0
    v_mov_b32 v79, 0
    v_mov_b32 v80, 0
    v_mov_b32 v81, 0
    v_mov_b32 v82, 0
    v_mov_b32 v83, 0
    v_mov_b32 v84, 0
    v_mov_b32 v85, 0
    v_mov_b32 v86, 0
    v_mov_b32 v87, 0
    v_mov_b32 v88, 0
    v_mov_b32 v89, 0
    v_mov_b32 v90, 0
    v_mov_b32 v91, 0
    v_mov_b32 v92, 0
    v_mov_b32 v93, 0
    v_mov_b32 v94, 0
    v_mov_b32 v95, 0
    v_mov_b32 v96, 0
    v_mov_b32 v97, 0
    v_mov_b32 v98, 0
    v_mov_b32 v99, 0
    v_mov_b32 v100, 0
    v_mov_b32 v101, 0
    v_mov_b32 v102, 0
    v_mov_b32 v103, 0
    v_and_b32 v26, 31, v0
    v_lshlrev_b32_e64 v26, 7, v26
    s_lshl_b32 s58, s24, 12
    s_add_u32 s58, s58, 35913728
    buffer_load_dwordx2 v[30:31], v26, s[20:23], s58 offen sc1
    s_waitcnt vmcnt(10) lgkmcnt(0)
    s_barrier
    v_and_b32 v19, 15, v18
    v_lshlrev_b32 v20, 4, v19
    v_add_u32 v20, 151552, v20
    v_lshrrev_b32_e64 v21, 4, v0
    v_mul_u32_u24 v21, 640, v21
    v_lshl_add_u32 v21, v19, 3, v21
    v_add_u32 v21, 152832, v21
    ds_read_b128 a[200:203], v20 offset:0
    ds_read_b64 a[204:205], v21 offset:0
    ds_read_b64_tr_b16 a[64:65], v11 offset:0
    ds_read_b64_tr_b16 a[66:67], v11 offset:256
    ds_read_b64_tr_b16 a[68:69], v11 offset:8448
    ds_read_b64_tr_b16 a[70:71], v11 offset:8704
    ds_read_b64_tr_b16 a[72:73], v11 offset:16896
    ds_read_b64_tr_b16 a[74:75], v11 offset:17152
    ds_read_b64_tr_b16 a[76:77], v11 offset:25344
    ds_read_b64_tr_b16 a[78:79], v11 offset:25600
    ds_read_b64_tr_b16 a[80:81], v11 offset:32
    ds_read_b64_tr_b16 a[82:83], v11 offset:288
    ds_read_b64_tr_b16 a[84:85], v11 offset:8480
    ds_read_b64_tr_b16 a[86:87], v11 offset:8736
    ds_read_b64_tr_b16 a[88:89], v11 offset:16928
    ds_read_b64_tr_b16 a[90:91], v11 offset:17184
    ds_read_b64_tr_b16 a[92:93], v11 offset:25376
    ds_read_b64_tr_b16 a[94:95], v11 offset:25632
    ds_read_b64_tr_b16 a[96:97], v11 offset:64
    ds_read_b64_tr_b16 a[98:99], v11 offset:320
    ds_read_b64_tr_b16 a[100:101], v11 offset:8512
    ds_read_b64_tr_b16 a[102:103], v11 offset:8768
    ds_read_b64_tr_b16 a[104:105], v11 offset:16960
    ds_read_b64_tr_b16 a[106:107], v11 offset:17216
    ds_read_b64_tr_b16 a[108:109], v11 offset:25408
    ds_read_b64_tr_b16 a[110:111], v11 offset:25664
    ds_read_b64_tr_b16 a[112:113], v11 offset:96
    ds_read_b64_tr_b16 a[114:115], v11 offset:352
    ds_read_b64_tr_b16 a[116:117], v11 offset:8544
    ds_read_b64_tr_b16 a[118:119], v11 offset:8800
    ds_read_b64_tr_b16 a[120:121], v11 offset:16992
    ds_read_b64_tr_b16 a[122:123], v11 offset:17248
    ds_read_b64_tr_b16 a[124:125], v11 offset:25440
    ds_read_b64_tr_b16 a[126:127], v11 offset:25696
    ds_read_b64_tr_b16 a[128:129], v11 offset:128
    ds_read_b64_tr_b16 a[130:131], v11 offset:384
    ds_read_b64_tr_b16 a[132:133], v11 offset:8576
    ds_read_b64_tr_b16 a[134:135], v11 offset:8832
    s_mov_b32 s55, 0x40000
    s_waitcnt vmcnt(0)
L_wxA:
    v_cmp_ne_u64 vcc, s[48:49], v[30:31]
    s_cbranch_vccz L_gxA
    s_sleep 1
    buffer_load_dwordx2 v[30:31], v26, s[20:23], s58 offen sc1
    s_waitcnt vmcnt(0)
    s_sub_u32 s55, s55, 1
    s_cmp_lg_u32 s55, 0
    s_cbranch_scc1 L_wxA
L_gxA:
    buffer_load_dwordx4 a[136:139], v10, s[16:19], s29 offen offset:0 sc1
    buffer_load_dwordx4 a[140:143], v10, s[16:19], s29 offen offset:1024 sc1
    buffer_load_dwordx4 a[144:147], v10, s[16:19], s29 offen offset:2048 sc1
    buffer_load_dwordx4 a[148:151], v10, s[16:19], s29 offen offset:3072 sc1
    s_add_u32 s29, s29, 4096
    buffer_load_dwordx4 a[152:155], v10, s[16:19], s29 offen offset:0 sc1
    buffer_load_dwordx4 a[156:159], v10, s[16:19], s29 offen offset:1024 sc1
    buffer_load_dwordx4 a[160:163], v10, s[16:19], s29 offen offset:2048 sc1
    buffer_load_dwordx4 a[164:167], v10, s[16:19], s29 offen offset:3072 sc1
    s_add_u32 s29, s29, 4096
    s_mov_b32 m0, s30
    s_nop 0
    buffer_load_dwordx4 v1, s[8:11], s27 offen offset:0 nt lds
    buffer_load_dwordx4 v2, s[8:11], s27 offen offset:1056 nt lds
    buffer_load_dwordx4 v3, s[8:11], s27 offen offset:2112 nt lds
    buffer_load_dwordx4 v4, s[8:11], s27 offen offset:3168 nt lds
    s_add_u32 m0, s30, 4224
    s_nop 0
    buffer_load_dwordx4 v5, s[8:11], s27 offen offset:0 nt lds
    buffer_load_dwordx4 v6, s[8:11], s27 offen offset:1056 nt lds
    global_load_dword a236, v24, s[52:53]
    v_add_u32 v24, 262144, v24
    s_mov_b32 s34, 0xfffed800
    s_mov_b32 s35, 0
    s_waitcnt vmcnt(7) lgkmcnt(0)
    .p2align 6
L_k2_loopA:
    s_waitcnt vmcnt(10) lgkmcnt(6)
    v_mfma_f32_16x16x32_bf16 v[32:35], a[64:67], a[136:139], v[32:35]
    v_mfma_f32_16x16x32_bf16 v[32:35], a[68:71], a[152:155], v[32:35]
    buffer_load_dwordx4 a[168:171], v10, s[16:19], s29 offen offset:0 sc1
    v_mfma_f32_16x16x32_bf16 v[36:39], a[68:71], a[156:159], v[36:39]
    v_mfma_f32_16x16x32_bf16 v[36:39], a[64:67], a[140:143], v[36:39]
    v_mfma_f32_16x16x32_bf16 v[40:43], a[64:67], a[144:147], v[40:43]
    buffer_load_dwordx4 a[172:175], v10, s[16:19], s29 offen offset:1024 sc1
    v_mfma_f32_16x16x32_bf16 v[40:43], a[68:71], a[160:163], v[40:43]
    v_mfma_f32_16x16x32_bf16 v[44:47], a[68:71], a[164:167], v[44:47]
    ds_read_b64_tr_b16 a[68:69], v11 offset:25472
    v_mfma_f32_16x16x32_bf16 v[44:47], a[64:67], a[148:151], v[44:47]
    ds_read_b64_tr_b16 a[70:71], v11 offset:25728
    v_mfma_f32_16x16x32_bf16 v[60:63], a[72:75], a[148:151], v[60:63]
    ds_read_b64_tr_b16 a[64:65], v11 offset:17024
    v_mfma_f32_16x16x32_bf16 v[60:63], a[76:79], a[164:167], v[60:63]
    ds_read_b64_tr_b16 a[66:67], v11 offset:17280
    v_mfma_f32_16x16x32_bf16 v[56:59], a[76:79], a[160:163], v[56:59]
    buffer_load_dwordx4 a[176:179], v10, s[16:19], s29 offen offset:2048 sc1
    v_mfma_f32_16x16x32_bf16 v[56:59], a[72:75], a[144:147], v[56:59]
    v_mfma_f32_16x16x32_bf16 v[52:55], a[72:75], a[140:143], v[52:55]
    buffer_load_dwordx4 a[180:183], v10, s[16:19], s29 offen offset:3072 sc1
    v_mfma_f32_16x16x32_bf16 v[52:55], a[76:79], a[156:159], v[52:55]
    v_mfma_f32_16x16x32_bf16 v[48:51], a[76:79], a[152:155], v[48:51]
    ds_read_b64_tr_b16 a[76:77], v11 offset:8608
    v_mfma_f32_16x16x32_bf16 v[48:51], a[72:75], a[136:139], v[48:51]
    ds_read_b64_tr_b16 a[78:79], v11 offset:8864
    v_mfma_f32_16x16x32_bf16 v[64:67], a[80:83], a[136:139], v[64:67]
    ds_read_b64_tr_b16 a[72:73], v11 offset:160
    v_mfma_f32_16x16x32_bf16 v[64:67], a[84:87], a[152:155], v[64:67]
    ds_read_b64_tr_b16 a[74:75], v11 offset:416
    v_mfma_f32_16x16x32_bf16 v[68:71], a[84:87], a[156:159], v[68:71]
    s_add_u32 s29, s29, 4096
    v_mfma_f32_16x16x32_bf16 v[68:71], a[80:83], a[140:143], v[68:71]
    buffer_load_dwordx4 a[184:187], v10, s[16:19], s29 offen offset:0 sc1
    v_mfma_f32_16x16x32_bf16 v[72:75], a[80:83], a[144:147], v[72:75]
    v_mfma_f32_16x16x32_bf16 v[72:75], a[84:87], a[160:163], v[72:75]
    v_mfma_f32_16x16x32_bf16 v[76:79], a[84:87], a[164:167], v[76:79]
    ds_read_b64_tr_b16 a[84:85], v11 offset:25504
    v_mfma_f32_16x16x32_bf16 v[76:79], a[80:83], a[148:151], v[76:79]
    ds_read_b64_tr_b16 a[86:87], v11 offset:25760
    v_mfma_f32_16x16x32_bf16 v[92:95], a[88:91], a[148:151], v[92:95]
    ds_read_b64_tr_b16 a[80:81], v11 offset:17056
    v_mfma_f32_16x16x32_bf16 v[92:95], a[92:95], a[164:167], v[92:95]
    ds_read_b64_tr_b16 a[82:83], v11 offset:17312
    v_mfma_f32_16x16x32_bf16 v[88:91], a[92:95], a[160:163], v[88:91]
    buffer_load_dwordx4 a[188:191], v10, s[16:19], s29 offen offset:1024 sc1
    v_mfma_f32_16x16x32_bf16 v[88:91], a[88:91], a[144:147], v[88:91]
    buffer_load_dwordx4 a[192:195], v10, s[16:19], s29 offen offset:2048 sc1
    v_mfma_f32_16x16x32_bf16 v[84:87], a[88:91], a[140:143], v[84:87]
    v_mfma_f32_16x16x32_bf16 v[84:87], a[92:95], a[156:159], v[84:87]
    v_mfma_f32_16x16x32_bf16 v[80:83], a[92:95], a[152:155], v[80:83]
    ds_read_b64_tr_b16 a[92:93], v11 offset:8640
    v_mfma_f32_16x16x32_bf16 v[80:83], a[88:91], a[136:139], v[80:83]
    ds_read_b64_tr_b16 a[94:95], v11 offset:8896
    v_mfma_f32_16x16x32_bf16 v[96:99], a[96:99], a[136:139], v[96:99]
    ds_read_b64_tr_b16 a[88:89], v11 offset:192
    v_mfma_f32_16x16x32_bf16 v[96:99], a[100:103], a[152:155], v[96:99]
    ds_read_b64_tr_b16 a[90:91], v11 offset:448
    v_mfma_f32_16x16x32_bf16 v[100:103], a[100:103], a[156:159], v[100:103]
    buffer_load_dwordx4 a[196:199], v10, s[16:19], s29 offen offset:3072 sc1
    v_mfma_f32_16x16x32_bf16 v[100:103], a[96:99], a[140:143], v[100:103]
    s_add_u32 s29, s29, 4096
    v_mfma_f32_16x16x32_bf16 v[104:107], a[96:99], a[144:147], v[104:107]
    v_mfma_f32_16x16x32_bf16 v[104:107], a[100:103], a[160:163], v[104:107]
    v_mfma_f32_16x16x32_bf16 v[108:111], a[100:103], a[164:167], v[108:111]
    ds_read_b64_tr_b16 a[100:101], v11 offset:25536
    v_mfma_f32_16x16x32_bf16 v[108:111], a[96:99], a[148:151], v[108:111]
    ds_read_b64_tr_b16 a[102:103], v11 offset:25792
    v_mfma_f32_16x16x32_bf16 v[124:127], a[104:107], a[148:151], v[124:127]
    ds_read_b64_tr_b16 a[96:97], v11 offset:17088
    v_mfma_f32_16x16x32_bf16 v[124:127], a[108:111], a[164:167], v[124:127]
    ds_read_b64_tr_b16 a[98:99], v11 offset:17344
    v_mfma_f32_16x16x32_bf16 v[120:123], a[108:111], a[160:163], v[120:123]
    buffer_load_dwordx4 v7, s[8:11], s27 offen offset:2112 nt lds
    v_mfma_f32_16x16x32_bf16 v[120:123], a[104:107], a[144:147], v[120:123]
    buffer_load_dwordx4 v8, s[8:11], s27 offen offset:3168 nt lds
    v_mfma_f32_16x16x32_bf16 v[116:119], a[104:107], a[140:143], v[116:119]
    v_mfma_f32_16x16x32_bf16 v[116:119], a[108:111], a[156:159], v[116:119]
    v_mfma_f32_16x16x32_bf16 v[112:115], a[108:111], a[152:155], v[112:115]
    ds_read_b64_tr_b16 a[108:109], v11 offset:8672
    v_mfma_f32_16x16x32_bf16 v[112:115], a[104:107], a[136:139], v[112:115]
    ds_read_b64_tr_b16 a[110:111], v11 offset:8928
    v_mfma_f32_16x16x32_bf16 v[128:131], a[112:115], a[136:139], v[128:131]
    ds_read_b64_tr_b16 a[104:105], v11 offset:224
    v_mfma_f32_16x16x32_bf16 v[128:131], a[116:119], a[152:155], v[128:131]
    ds_read_b64_tr_b16 a[106:107], v11 offset:480
    v_mfma_f32_16x16x32_bf16 v[132:135], a[116:119], a[156:159], v[132:135]
    s_mov_b32 m0, s32
    v_mfma_f32_16x16x32_bf16 v[132:135], a[112:115], a[140:143], v[132:135]
    s_add_u32 s27, s27, 458752
    v_mfma_f32_16x16x32_bf16 v[136:139], a[112:115], a[144:147], v[136:139]
    v_mfma_f32_16x16x32_bf16 v[136:139], a[116:119], a[160:163], v[136:139]
    buffer_load_dwordx4 v9, s[12:15], s28 offen offset:0 nt lds
    v_mfma_f32_16x16x32_bf16 v[140:143], a[116:119], a[164:167], v[140:143]
    ds_read_b64_tr_b16 a[116:117], v11 offset:25568
    v_mfma_f32_16x16x32_bf16 v[140:143], a[112:115], a[148:151], v[140:143]
    ds_read_b64_tr_b16 a[118:119], v11 offset:25824
    s_waitcnt lgkmcnt(6)
    v_mfma_f32_16x16x32_bf16 v[156:159], a[120:123], a[148:151], v[156:159]
    ds_read_b64_tr_b16 a[112:113], v11 offset:17120
    v_mfma_f32_16x16x32_bf16 v[156:159], a[124:127], a[164:167], v[156:159]
    ds_read_b64_tr_b16 a[114:115], v11 offset:17376
    v_mfma_f32_16x16x32_bf16 v[152:155], a[124:127], a[160:163], v[152:155]
    s_add_u32 s28, s28, 128
    v_mfma_f32_16x16x32_bf16 v[152:155], a[120:123], a[144:147], v[152:155]
    v_mfma_f32_16x16x32_bf16 v[148:151], a[120:123], a[140:143], v[148:151]
    v_mfma_f32_16x16x32_bf16 v[148:151], a[124:127], a[156:159], v[148:151]
    s_add_u32 s30, s30, s34
    v_mfma_f32_16x16x32_bf16 v[144:147], a[124:127], a[152:155], v[144:147]
    ds_read_b128 a[124:127], v14 offset:0
    v_mfma_f32_16x16x32_bf16 v[144:147], a[120:123], a[136:139], v[144:147]
    ds_read_b128 a[120:123], v13 offset:0
    v_mfma_f32_16x16x32_bf16 v[160:163], a[128:131], a[136:139], v[160:163]
    v_mfma_f32_16x16x32_bf16 v[160:163], a[132:135], a[152:155], v[160:163]
    s_add_u32 s32, s32, s34
    v_mfma_f32_16x16x32_bf16 v[164:167], a[132:135], a[156:159], v[164:167]
    v_mfma_f32_16x16x32_bf16 v[164:167], a[128:131], a[140:143], v[164:167]
    v_mfma_f32_16x16x32_bf16 v[168:171], a[128:131], a[144:147], v[168:171]
    v_mfma_f32_16x16x32_bf16 v[168:171], a[132:135], a[160:163], v[168:171]
    v_mfma_f32_16x16x32_bf16 v[172:175], a[132:135], a[164:167], v[172:175]
    ds_read_b128 a[132:135], v14 offset:2048
    v_mfma_f32_16x16x32_bf16 v[172:175], a[128:131], a[148:151], v[172:175]
    ds_read_b128 a[128:131], v13 offset:2048
    v_mfma_f32_16x16x32_bf16 v[176:179], a[64:67], a[136:139], v[176:179]
    v_mfma_f32_16x16x32_bf16 v[176:179], a[68:71], a[152:155], v[176:179]
    s_mov_b32 m0, s31
    v_mfma_f32_16x16x32_bf16 v[180:183], a[68:71], a[156:159], v[180:183]
    v_mfma_f32_16x16x32_bf16 v[180:183], a[64:67], a[140:143], v[180:183]
    v_mfma_f32_16x16x32_bf16 v[184:187], a[64:67], a[144:147], v[184:187]
    v_mfma_f32_16x16x32_bf16 v[184:187], a[68:71], a[160:163], v[184:187]
    v_mfma_f32_16x16x32_bf16 v[188:191], a[68:71], a[164:167], v[188:191]
    v_mfma_f32_16x16x32_bf16 v[188:191], a[64:67], a[148:151], v[188:191]
    buffer_load_dwordx4 v1, s[8:11], s27 offen offset:0 nt lds
    v_mfma_f32_16x16x32_bf16 v[204:207], a[72:75], a[148:151], v[204:207]
    v_mfma_f32_16x16x32_bf16 v[204:207], a[76:79], a[164:167], v[204:207]
    v_mfma_f32_16x16x32_bf16 v[200:203], a[76:79], a[160:163], v[200:203]
    v_mfma_f32_16x16x32_bf16 v[200:203], a[72:75], a[144:147], v[200:203]
    s_waitcnt vmcnt(19)
    s_waitcnt lgkmcnt(0)
    s_barrier
    ds_read_b64_tr_b16 a[68:69], v12 offset:8448
    v_mfma_f32_16x16x32_bf16 v[196:199], a[72:75], a[140:143], v[196:199]
    ds_read_b64_tr_b16 a[70:71], v12 offset:8704
    v_mfma_f32_16x16x32_bf16 v[196:199], a[76:79], a[156:159], v[196:199]
    ds_read_b64_tr_b16 a[64:65], v12 offset:0
    v_mfma_f32_16x16x32_bf16 v[192:195], a[76:79], a[152:155], v[192:195]
    ds_read_b64_tr_b16 a[66:67], v12 offset:256
    v_mfma_f32_16x16x32_bf16 v[192:195], a[72:75], a[136:139], v[192:195]
    ds_read_b64_tr_b16 a[76:77], v12 offset:25344
    v_mfma_f32_16x16x32_bf16 v[208:211], a[80:83], a[136:139], v[208:211]
    ds_read_b64_tr_b16 a[78:79], v12 offset:25600
    v_mfma_f32_16x16x32_bf16 v[208:211], a[84:87], a[152:155], v[208:211]
    ds_read_b64_tr_b16 a[72:73], v12 offset:16896
    v_mfma_f32_16x16x32_bf16 v[212:215], a[84:87], a[156:159], v[212:215]
    ds_read_b64_tr_b16 a[74:75], v12 offset:17152
    v_mfma_f32_16x16x32_bf16 v[212:215], a[80:83], a[140:143], v[212:215]
    buffer_load_dwordx4 v2, s[8:11], s27 offen offset:1056 nt lds
    v_mfma_f32_16x16x32_bf16 v[216:219], a[80:83], a[144:147], v[216:219]
    v_mfma_f32_16x16x32_bf16 v[216:219], a[84:87], a[160:163], v[216:219]
    buffer_load_dwordx4 v3, s[8:11], s27 offen offset:2112 nt lds
    v_mfma_f32_16x16x32_bf16 v[220:223], a[84:87], a[164:167], v[220:223]
    ds_read_b64_tr_b16 a[84:85], v12 offset:8480
    v_mfma_f32_16x16x32_bf16 v[220:223], a[80:83], a[148:151], v[220:223]
    ds_read_b64_tr_b16 a[86:87], v12 offset:8736
    v_mfma_f32_16x16x32_bf16 v[236:239], a[88:91], a[148:151], v[236:239]
    ds_read_b64_tr_b16 a[80:81], v12 offset:32
    v_mfma_f32_16x16x32_bf16 v[236:239], a[92:95], a[164:167], v[236:239]
    ds_read_b64_tr_b16 a[82:83], v12 offset:288
    v_mfma_f32_16x16x32_bf16 v[232:235], a[92:95], a[160:163], v[232:235]
    v_mfma_f32_16x16x32_bf16 v[232:235], a[88:91], a[144:147], v[232:235]
    v_mfma_f32_16x16x32_bf16 v[228:231], a[88:91], a[140:143], v[228:231]
    buffer_load_dwordx4 v4, s[8:11], s27 offen offset:3168 nt lds
    v_mfma_f32_16x16x32_bf16 v[228:231], a[92:95], a[156:159], v[228:231]
    v_mfma_f32_16x16x32_bf16 v[224:227], a[92:95], a[152:155], v[224:227]
    ds_read_b64_tr_b16 a[92:93], v12 offset:25376
    v_mfma_f32_16x16x32_bf16 v[224:227], a[88:91], a[136:139], v[224:227]
    ds_read_b64_tr_b16 a[94:95], v12 offset:25632
    v_mfma_f32_16x16x32_bf16 v[240:243], a[96:99], a[136:139], v[240:243]
    ds_read_b64_tr_b16 a[88:89], v12 offset:16928
    v_mfma_f32_16x16x32_bf16 v[240:243], a[100:103], a[152:155], v[240:243]
    ds_read_b64_tr_b16 a[90:91], v12 offset:17184
    v_mfma_f32_16x16x32_bf16 v[244:247], a[100:103], a[156:159], v[244:247]
    v_mfma_f32_16x16x32_bf16 v[244:247], a[96:99], a[140:143], v[244:247]
    s_add_u32 m0, s31, 4224
    v_mfma_f32_16x16x32_bf16 v[248:251], a[96:99], a[144:147], v[248:251]
    v_mfma_f32_16x16x32_bf16 v[248:251], a[100:103], a[160:163], v[248:251]
    v_mfma_f32_16x16x32_bf16 v[252:255], a[100:103], a[164:167], v[252:255]
    ds_read_b64_tr_b16 a[100:101], v12 offset:8512
    v_mfma_f32_16x16x32_bf16 v[252:255], a[96:99], a[148:151], v[252:255]
    ds_read_b64_tr_b16 a[102:103], v12 offset:8768
    v_mfma_f32_16x16x32_bf16 a[12:15], a[104:107], a[148:151], a[12:15]
    ds_read_b64_tr_b16 a[96:97], v12 offset:64
    v_mfma_f32_16x16x32_bf16 a[12:15], a[108:111], a[164:167], a[12:15]
    ds_read_b64_tr_b16 a[98:99], v12 offset:320
    v_mfma_f32_16x16x32_bf16 a[8:11], a[108:111], a[160:163], a[8:11]
    buffer_load_dwordx4 v5, s[8:11], s27 offen offset:0 nt lds
    v_mfma_f32_16x16x32_bf16 a[8:11], a[104:107], a[144:147], a[8:11]
    v_mfma_f32_16x16x32_bf16 a[4:7], a[104:107], a[140:143], a[4:7]
    v_mfma_f32_16x16x32_bf16 a[4:7], a[108:111], a[156:159], a[4:7]
    v_mfma_f32_16x16x32_bf16 a[0:3], a[108:111], a[152:155], a[0:3]
    ds_read_b64_tr_b16 a[108:109], v12 offset:25408
    v_mfma_f32_16x16x32_bf16 a[0:3], a[104:107], a[136:139], a[0:3]
    ds_read_b64_tr_b16 a[110:111], v12 offset:25664
    v_mfma_f32_16x16x32_bf16 a[16:19], a[112:115], a[136:139], a[16:19]
    ds_read_b64_tr_b16 a[104:105], v12 offset:16960
    v_mfma_f32_16x16x32_bf16 a[16:19], a[116:119], a[152:155], a[16:19]
    ds_read_b64_tr_b16 a[106:107], v12 offset:17216
    v_mfma_f32_16x16x32_bf16 a[20:23], a[116:119], a[156:159], a[20:23]
    buffer_load_dwordx4 v6, s[8:11], s27 offen offset:1056 nt lds
    v_mfma_f32_16x16x32_bf16 a[20:23], a[112:115], a[140:143], a[20:23]
    v_mfma_f32_16x16x32_bf16 a[24:27], a[112:115], a[144:147], a[24:27]
    v_mfma_f32_16x16x32_bf16 a[24:27], a[116:119], a[160:163], a[24:27]
    v_mfma_f32_16x16x32_bf16 a[28:31], a[116:119], a[164:167], a[28:31]
    ds_read_b64_tr_b16 a[116:117], v12 offset:8544
    v_mfma_f32_16x16x32_bf16 a[28:31], a[112:115], a[148:151], a[28:31]
    ds_read_b64_tr_b16 a[118:119], v12 offset:8800
    v_mfma_f32_16x16x32_bf16 a[44:47], a[148:151], a[120:123], a[44:47]
    ds_read_b64_tr_b16 a[112:113], v12 offset:96
    v_mfma_f32_16x16x32_bf16 a[44:47], a[164:167], a[124:127], a[44:47]
    ds_read_b64_tr_b16 a[114:115], v12 offset:352
    v_mfma_f32_16x16x32_bf16 a[40:43], a[160:163], a[124:127], a[40:43]
    global_load_dword a236, v23, s[56:57]
    v_mfma_f32_16x16x32_bf16 a[40:43], a[144:147], a[120:123], a[40:43]
    v_mfma_f32_16x16x32_bf16 a[36:39], a[140:143], a[120:123], a[36:39]
    v_mfma_f32_16x16x32_bf16 a[36:39], a[156:159], a[124:127], a[36:39]
    v_mfma_f32_16x16x32_bf16 a[32:35], a[152:155], a[124:127], a[32:35]
    ds_read_b64_tr_b16 a[124:125], v12 offset:25440
    v_mfma_f32_16x16x32_bf16 a[32:35], a[136:139], a[120:123], a[32:35]
    ds_read_b64_tr_b16 a[126:127], v12 offset:25696
    v_mfma_f32_16x16x32_bf16 a[48:51], a[136:139], a[128:131], a[48:51]
    ds_read_b64_tr_b16 a[120:121], v12 offset:16992
    v_mfma_f32_16x16x32_bf16 a[48:51], a[152:155], a[132:135], a[48:51]
    ds_read_b64_tr_b16 a[122:123], v12 offset:17248
    v_mfma_f32_16x16x32_bf16 a[52:55], a[156:159], a[132:135], a[52:55]
    v_add_u32 v23, 1048576, v23
    v_mfma_f32_16x16x32_bf16 a[52:55], a[140:143], a[128:131], a[52:55]
    v_mfma_f32_16x16x32_bf16 a[56:59], a[144:147], a[128:131], a[56:59]
    v_mfma_f32_16x16x32_bf16 a[56:59], a[160:163], a[132:135], a[56:59]
    v_mfma_f32_16x16x32_bf16 a[60:63], a[164:167], a[132:135], a[60:63]
    ds_read_b64_tr_b16 a[132:133], v12 offset:8576
    v_mfma_f32_16x16x32_bf16 a[60:63], a[148:151], a[128:131], a[60:63]
    ds_read_b64_tr_b16 a[134:135], v12 offset:8832
    ds_read_b64_tr_b16 a[128:129], v12 offset:128
    ds_read_b64_tr_b16 a[130:131], v12 offset:384
    s_waitcnt vmcnt(10) lgkmcnt(6)
    v_mfma_f32_16x16x32_bf16 v[32:35], a[64:67], a[168:171], v[32:35]
    v_mfma_f32_16x16x32_bf16 v[32:35], a[68:71], a[184:187], v[32:35]
    buffer_load_dwordx4 a[136:139], v10, s[16:19], s29 offen offset:0 sc1
    v_mfma_f32_16x16x32_bf16 v[36:39], a[68:71], a[188:191], v[36:39]
    v_mfma_f32_16x16x32_bf16 v[36:39], a[64:67], a[172:175], v[36:39]
    v_mfma_f32_16x16x32_bf16 v[40:43], a[64:67], a[176:179], v[40:43]
    buffer_load_dwordx4 a[140:143], v10, s[16:19], s29 offen offset:1024 sc1
    v_mfma_f32_16x16x32_bf16 v[40:43], a[68:71], a[192:195], v[40:43]
    v_mfma_f32_16x16x32_bf16 v[44:47], a[68:71], a[196:199], v[44:47]
    ds_read_b64_tr_b16 a[68:69], v12 offset:25472
    v_mfma_f32_16x16x32_bf16 v[44:47], a[64:67], a[180:183], v[44:47]
    ds_read_b64_tr_b16 a[70:71], v12 offset:25728
    v_mfma_f32_16x16x32_bf16 v[60:63], a[72:75], a[180:183], v[60:63]
    ds_read_b64_tr_b16 a[64:65], v12 offset:17024
    v_mfma_f32_16x16x32_bf16 v[60:63], a[76:79], a[196:199], v[60:63]
    ds_read_b64_tr_b16 a[66:67], v12 offset:17280
    v_mfma_f32_16x16x32_bf16 v[56:59], a[76:79], a[192:195], v[56:59]
    buffer_load_dwordx4 a[144:147], v10, s[16:19], s29 offen offset:2048 sc1
    v_mfma_f32_16x16x32_bf16 v[56:59], a[72:75], a[176:179], v[56:59]
    v_mfma_f32_16x16x32_bf16 v[52:55], a[72:75], a[172:175], v[52:55]
    buffer_load_dwordx4 a[148:151], v10, s[16:19], s29 offen offset:3072 sc1
    v_mfma_f32_16x16x32_bf16 v[52:55], a[76:79], a[188:191], v[52:55]
    v_mfma_f32_16x16x32_bf16 v[48:51], a[76:79], a[184:187], v[48:51]
    ds_read_b64_tr_b16 a[76:77], v12 offset:8608
    v_mfma_f32_16x16x32_bf16 v[48:51], a[72:75], a[168:171], v[48:51]
    ds_read_b64_tr_b16 a[78:79], v12 offset:8864
    v_mfma_f32_16x16x32_bf16 v[64:67], a[80:83], a[168:171], v[64:67]
    ds_read_b64_tr_b16 a[72:73], v12 offset:160
    v_mfma_f32_16x16x32_bf16 v[64:67], a[84:87], a[184:187], v[64:67]
    ds_read_b64_tr_b16 a[74:75], v12 offset:416
    v_mfma_f32_16x16x32_bf16 v[68:71], a[84:87], a[188:191], v[68:71]
    s_add_u32 s29, s29, 4096
    v_mfma_f32_16x16x32_bf16 v[68:71], a[80:83], a[172:175], v[68:71]
    buffer_load_dwordx4 a[152:155], v10, s[16:19], s29 offen offset:0 sc1
    v_mfma_f32_16x16x32_bf16 v[72:75], a[80:83], a[176:179], v[72:75]
    v_mfma_f32_16x16x32_bf16 v[72:75], a[84:87], a[192:195], v[72:75]
    v_mfma_f32_16x16x32_bf16 v[76:79], a[84:87], a[196:199], v[76:79]
    ds_read_b64_tr_b16 a[84:85], v12 offset:25504
    v_mfma_f32_16x16x32_bf16 v[76:79], a[80:83], a[180:183], v[76:79]
    ds_read_b64_tr_b16 a[86:87], v12 offset:25760
    v_mfma_f32_16x16x32_bf16 v[92:95], a[88:91], a[180:183], v[92:95]
    ds_read_b64_tr_b16 a[80:81], v12 offset:17056
    v_mfma_f32_16x16x32_bf16 v[92:95], a[92:95], a[196:199], v[92:95]
    ds_read_b64_tr_b16 a[82:83], v12 offset:17312
    v_mfma_f32_16x16x32_bf16 v[88:91], a[92:95], a[192:195], v[88:91]
    buffer_load_dwordx4 a[156:159], v10, s[16:19], s29 offen offset:1024 sc1
    v_mfma_f32_16x16x32_bf16 v[88:91], a[88:91], a[176:179], v[88:91]
    buffer_load_dwordx4 a[160:163], v10, s[16:19], s29 offen offset:2048 sc1
    v_mfma_f32_16x16x32_bf16 v[84:87], a[88:91], a[172:175], v[84:87]
    v_mfma_f32_16x16x32_bf16 v[84:87], a[92:95], a[188:191], v[84:87]
    v_mfma_f32_16x16x32_bf16 v[80:83], a[92:95], a[184:187], v[80:83]
    ds_read_b64_tr_b16 a[92:93], v12 offset:8640
    v_mfma_f32_16x16x32_bf16 v[80:83], a[88:91], a[168:171], v[80:83]
    ds_read_b64_tr_b16 a[94:95], v12 offset:8896
    v_mfma_f32_16x16x32_bf16 v[96:99], a[96:99], a[168:171], v[96:99]
    ds_read_b64_tr_b16 a[88:89], v12 offset:192
    v_mfma_f32_16x16x32_bf16 v[96:99], a[100:103], a[184:187], v[96:99]
    ds_read_b64_tr_b16 a[90:91], v12 offset:448
    v_mfma_f32_16x16x32_bf16 v[100:103], a[100:103], a[188:191], v[100:103]
    buffer_load_dwordx4 a[164:167], v10, s[16:19], s29 offen offset:3072 sc1
    v_mfma_f32_16x16x32_bf16 v[100:103], a[96:99], a[172:175], v[100:103]
    s_add_u32 s29, s29, 4096
    v_mfma_f32_16x16x32_bf16 v[104:107], a[96:99], a[176:179], v[104:107]
    v_mfma_f32_16x16x32_bf16 v[104:107], a[100:103], a[192:195], v[104:107]
    v_mfma_f32_16x16x32_bf16 v[108:111], a[100:103], a[196:199], v[108:111]
    ds_read_b64_tr_b16 a[100:101], v12 offset:25536
    v_mfma_f32_16x16x32_bf16 v[108:111], a[96:99], a[180:183], v[108:111]
    ds_read_b64_tr_b16 a[102:103], v12 offset:25792
    v_mfma_f32_16x16x32_bf16 v[124:127], a[104:107], a[180:183], v[124:127]
    ds_read_b64_tr_b16 a[96:97], v12 offset:17088
    v_mfma_f32_16x16x32_bf16 v[124:127], a[108:111], a[196:199], v[124:127]
    ds_read_b64_tr_b16 a[98:99], v12 offset:17344
    v_mfma_f32_16x16x32_bf16 v[120:123], a[108:111], a[192:195], v[120:123]
    buffer_load_dwordx4 v7, s[8:11], s27 offen offset:2112 nt lds
    v_mfma_f32_16x16x32_bf16 v[120:123], a[104:107], a[176:179], v[120:123]
    buffer_load_dwordx4 v8, s[8:11], s27 offen offset:3168 nt lds
    v_mfma_f32_16x16x32_bf16 v[116:119], a[104:107], a[172:175], v[116:119]
    v_subrev_u32_e64 v11, s34, v11
    v_mfma_f32_16x16x32_bf16 v[116:119], a[108:111], a[188:191], v[116:119]
    v_subrev_u32_e64 v13, s34, v13
    v_mfma_f32_16x16x32_bf16 v[112:115], a[108:111], a[184:187], v[112:115]
    ds_read_b64_tr_b16 a[108:109], v12 offset:8672
    v_mfma_f32_16x16x32_bf16 v[112:115], a[104:107], a[168:171], v[112:115]
    ds_read_b64_tr_b16 a[110:111], v12 offset:8928
    v_mfma_f32_16x16x32_bf16 v[128:131], a[112:115], a[168:171], v[128:131]
    ds_read_b64_tr_b16 a[104:105], v12 offset:224
    v_mfma_f32_16x16x32_bf16 v[128:131], a[116:119], a[184:187], v[128:131]
    ds_read_b64_tr_b16 a[106:107], v12 offset:480
    v_mfma_f32_16x16x32_bf16 v[132:135], a[116:119], a[188:191], v[132:135]
    s_mov_b32 m0, s33
    v_mfma_f32_16x16x32_bf16 v[132:135], a[112:115], a[172:175], v[132:135]
    s_add_u32 s27, s27, 458752
    v_mfma_f32_16x16x32_bf16 v[136:139], a[112:115], a[176:179], v[136:139]
    v_subrev_u32 v14, s34, v14
    v_mfma_f32_16x16x32_bf16 v[136:139], a[116:119], a[192:195], v[136:139]
    buffer_load_dwordx4 v9, s[12:15], s28 offen offset:0 nt lds
    v_mfma_f32_16x16x32_bf16 v[140:143], a[116:119], a[196:199], v[140:143]
    ds_read_b64_tr_b16 a[116:117], v12 offset:25568
    v_mfma_f32_16x16x32_bf16 v[140:143], a[112:115], a[180:183], v[140:143]
    ds_read_b64_tr_b16 a[118:119], v12 offset:25824
    s_waitcnt lgkmcnt(6)
    v_mfma_f32_16x16x32_bf16 v[156:159], a[120:123], a[180:183], v[156:159]
    ds_read_b64_tr_b16 a[112:113], v12 offset:17120
    v_mfma_f32_16x16x32_bf16 v[156:159], a[124:127], a[196:199], v[156:159]
    ds_read_b64_tr_b16 a[114:115], v12 offset:17376
    v_mfma_f32_16x16x32_bf16 v[152:155], a[124:127], a[192:195], v[152:155]
    s_add_u32 s28, s28, 128
    v_mfma_f32_16x16x32_bf16 v[152:155], a[120:123], a[176:179], v[152:155]
    v_mfma_f32_16x16x32_bf16 v[148:151], a[120:123], a[172:175], v[148:151]
    v_mfma_f32_16x16x32_bf16 v[148:151], a[124:127], a[188:191], v[148:151]
    s_add_u32 s31, s31, s34
    v_mfma_f32_16x16x32_bf16 v[144:147], a[124:127], a[184:187], v[144:147]
    ds_read_b128 a[124:127], v16 offset:0
    v_mfma_f32_16x16x32_bf16 v[144:147], a[120:123], a[168:171], v[144:147]
    ds_read_b128 a[120:123], v15 offset:0
    v_mfma_f32_16x16x32_bf16 v[160:163], a[128:131], a[168:171], v[160:163]
    v_mfma_f32_16x16x32_bf16 v[160:163], a[132:135], a[184:187], v[160:163]
    s_add_u32 s33, s33, s34
    v_mfma_f32_16x16x32_bf16 v[164:167], a[132:135], a[188:191], v[164:167]
    v_mfma_f32_16x16x32_bf16 v[164:167], a[128:131], a[172:175], v[164:167]
    v_mfma_f32_16x16x32_bf16 v[168:171], a[128:131], a[176:179], v[168:171]
    v_mfma_f32_16x16x32_bf16 v[168:171], a[132:135], a[192:195], v[168:171]
    v_mfma_f32_16x16x32_bf16 v[172:175], a[132:135], a[196:199], v[172:175]
    ds_read_b128 a[132:135], v16 offset:2048
    v_mfma_f32_16x16x32_bf16 v[172:175], a[128:131], a[180:183], v[172:175]
    ds_read_b128 a[128:131], v15 offset:2048
    v_mfma_f32_16x16x32_bf16 v[176:179], a[64:67], a[168:171], v[176:179]
    v_mfma_f32_16x16x32_bf16 v[176:179], a[68:71], a[184:187], v[176:179]
    s_mov_b32 m0, s30
    v_mfma_f32_16x16x32_bf16 v[180:183], a[68:71], a[188:191], v[180:183]
    v_subrev_u32_e64 v12, s34, v12
    v_mfma_f32_16x16x32_bf16 v[180:183], a[64:67], a[172:175], v[180:183]
    v_subrev_u32_e64 v15, s34, v15
    v_mfma_f32_16x16x32_bf16 v[184:187], a[64:67], a[176:179], v[184:187]
    v_subrev_u32_e64 v16, s34, v16
    v_mfma_f32_16x16x32_bf16 v[184:187], a[68:71], a[192:195], v[184:187]
    v_mfma_f32_16x16x32_bf16 v[188:191], a[68:71], a[196:199], v[188:191]
    v_mfma_f32_16x16x32_bf16 v[188:191], a[64:67], a[180:183], v[188:191]
    buffer_load_dwordx4 v1, s[8:11], s27 offen offset:0 nt lds
    v_mfma_f32_16x16x32_bf16 v[204:207], a[72:75], a[180:183], v[204:207]
    v_mfma_f32_16x16x32_bf16 v[204:207], a[76:79], a[196:199], v[204:207]
    v_mfma_f32_16x16x32_bf16 v[200:203], a[76:79], a[192:195], v[200:203]
    v_mfma_f32_16x16x32_bf16 v[200:203], a[72:75], a[176:179], v[200:203]
    s_waitcnt vmcnt(19)
    s_waitcnt lgkmcnt(0)
    s_barrier
    ds_read_b64_tr_b16 a[68:69], v11 offset:8448
    v_mfma_f32_16x16x32_bf16 v[196:199], a[72:75], a[172:175], v[196:199]
    ds_read_b64_tr_b16 a[70:71], v11 offset:8704
    v_mfma_f32_16x16x32_bf16 v[196:199], a[76:79], a[188:191], v[196:199]
    ds_read_b64_tr_b16 a[64:65], v11 offset:0
    v_mfma_f32_16x16x32_bf16 v[192:195], a[76:79], a[184:187], v[192:195]
    ds_read_b64_tr_b16 a[66:67], v11 offset:256
    v_mfma_f32_16x16x32_bf16 v[192:195], a[72:75], a[168:171], v[192:195]
    ds_read_b64_tr_b16 a[76:77], v11 offset:25344
    v_mfma_f32_16x16x32_bf16 v[208:211], a[80:83], a[168:171], v[208:211]
    ds_read_b64_tr_b16 a[78:79], v11 offset:25600
    v_mfma_f32_16x16x32_bf16 v[208:211], a[84:87], a[184:187], v[208:211]
    ds_read_b64_tr_b16 a[72:73], v11 offset:16896
    v_mfma_f32_16x16x32_bf16 v[212:215], a[84:87], a[188:191], v[212:215]
    ds_read_b64_tr_b16 a[74:75], v11 offset:17152
    v_mfma_f32_16x16x32_bf16 v[212:215], a[80:83], a[172:175], v[212:215]
    buffer_load_dwordx4 v2, s[8:11], s27 offen offset:1056 nt lds
    v_mfma_f32_16x16x32_bf16 v[216:219], a[80:83], a[176:179], v[216:219]
    v_mfma_f32_16x16x32_bf16 v[216:219], a[84:87], a[192:195], v[216:219]
    buffer_load_dwordx4 v3, s[8:11], s27 offen offset:2112 nt lds
    v_mfma_f32_16x16x32_bf16 v[220:223], a[84:87], a[196:199], v[220:223]
    ds_read_b64_tr_b16 a[84:85], v11 offset:8480
    v_mfma_f32_16x16x32_bf16 v[220:223], a[80:83], a[180:183], v[220:223]
    ds_read_b64_tr_b16 a[86:87], v11 offset:8736
    v_mfma_f32_16x16x32_bf16 v[236:239], a[88:91], a[180:183], v[236:239]
    ds_read_b64_tr_b16 a[80:81], v11 offset:32
    v_mfma_f32_16x16x32_bf16 v[236:239], a[92:95], a[196:199], v[236:239]
    ds_read_b64_tr_b16 a[82:83], v11 offset:288
    v_mfma_f32_16x16x32_bf16 v[232:235], a[92:95], a[192:195], v[232:235]
    v_mfma_f32_16x16x32_bf16 v[232:235], a[88:91], a[176:179], v[232:235]
    v_mfma_f32_16x16x32_bf16 v[228:231], a[88:91], a[172:175], v[228:231]
    buffer_load_dwordx4 v4, s[8:11], s27 offen offset:3168 nt lds
    v_mfma_f32_16x16x32_bf16 v[228:231], a[92:95], a[188:191], v[228:231]
    v_mfma_f32_16x16x32_bf16 v[224:227], a[92:95], a[184:187], v[224:227]
    ds_read_b64_tr_b16 a[92:93], v11 offset:25376
    v_mfma_f32_16x16x32_bf16 v[224:227], a[88:91], a[168:171], v[224:227]
    ds_read_b64_tr_b16 a[94:95], v11 offset:25632
    v_mfma_f32_16x16x32_bf16 v[240:243], a[96:99], a[168:171], v[240:243]
    ds_read_b64_tr_b16 a[88:89], v11 offset:16928
    v_mfma_f32_16x16x32_bf16 v[240:243], a[100:103], a[184:187], v[240:243]
    ds_read_b64_tr_b16 a[90:91], v11 offset:17184
    v_mfma_f32_16x16x32_bf16 v[244:247], a[100:103], a[188:191], v[244:247]
    v_mfma_f32_16x16x32_bf16 v[244:247], a[96:99], a[172:175], v[244:247]
    s_add_u32 m0, s30, 4224
    v_mfma_f32_16x16x32_bf16 v[248:251], a[96:99], a[176:179], v[248:251]
    v_mfma_f32_16x16x32_bf16 v[248:251], a[100:103], a[192:195], v[248:251]
    v_mfma_f32_16x16x32_bf16 v[252:255], a[100:103], a[196:199], v[252:255]
    ds_read_b64_tr_b16 a[100:101], v11 offset:8512
    v_mfma_f32_16x16x32_bf16 v[252:255], a[96:99], a[180:183], v[252:255]
    ds_read_b64_tr_b16 a[102:103], v11 offset:8768
    v_mfma_f32_16x16x32_bf16 a[12:15], a[104:107], a[180:183], a[12:15]
    ds_read_b64_tr_b16 a[96:97], v11 offset:64
    v_mfma_f32_16x16x32_bf16 a[12:15], a[108:111], a[196:199], a[12:15]
    ds_read_b64_tr_b16 a[98:99], v11 offset:320
    v_mfma_f32_16x16x32_bf16 a[8:11], a[108:111], a[192:195], a[8:11]
    buffer_load_dwordx4 v5, s[8:11], s27 offen offset:0 nt lds
    v_mfma_f32_16x16x32_bf16 a[8:11], a[104:107], a[176:179], a[8:11]
    v_mfma_f32_16x16x32_bf16 a[4:7], a[104:107], a[172:175], a[4:7]
    v_mfma_f32_16x16x32_bf16 a[4:7], a[108:111], a[188:191], a[4:7]
    v_mfma_f32_16x16x32_bf16 a[0:3], a[108:111], a[184:187], a[0:3]
    ds_read_b64_tr_b16 a[108:109], v11 offset:25408
    v_mfma_f32_16x16x32_bf16 a[0:3], a[104:107], a[168:171], a[0:3]
    ds_read_b64_tr_b16 a[110:111], v11 offset:25664
    v_mfma_f32_16x16x32_bf16 a[16:19], a[112:115], a[168:171], a[16:19]
    ds_read_b64_tr_b16 a[104:105], v11 offset:16960
    v_mfma_f32_16x16x32_bf16 a[16:19], a[116:119], a[184:187], a[16:19]
    ds_read_b64_tr_b16 a[106:107], v11 offset:17216
    v_mfma_f32_16x16x32_bf16 a[20:23], a[116:119], a[188:191], a[20:23]
    buffer_load_dwordx4 v6, s[8:11], s27 offen offset:1056 nt lds
    v_mfma_f32_16x16x32_bf16 a[20:23], a[112:115], a[172:175], a[20:23]
    v_mfma_f32_16x16x32_bf16 a[24:27], a[112:115], a[176:179], a[24:27]
    v_mfma_f32_16x16x32_bf16 a[24:27], a[116:119], a[192:195], a[24:27]
    v_mfma_f32_16x16x32_bf16 a[28:31], a[116:119], a[196:199], a[28:31]
    ds_read_b64_tr_b16 a[116:117], v11 offset:8544
    v_mfma_f32_16x16x32_bf16 a[28:31], a[112:115], a[180:183], a[28:31]
    ds_read_b64_tr_b16 a[118:119], v11 offset:8800
    v_mfma_f32_16x16x32_bf16 a[44:47], a[180:183], a[120:123], a[44:47]
    ds_read_b64_tr_b16 a[112:113], v11 offset:96
    v_mfma_f32_16x16x32_bf16 a[44:47], a[196:199], a[124:127], a[44:47]
    ds_read_b64_tr_b16 a[114:115], v11 offset:352
    v_mfma_f32_16x16x32_bf16 a[40:43], a[192:195], a[124:127], a[40:43]
    global_load_dword a236, v24, s[52:53]
    v_mfma_f32_16x16x32_bf16 a[40:43], a[176:179], a[120:123], a[40:43]
    v_mfma_f32_16x16x32_bf16 a[36:39], a[172:175], a[120:123], a[36:39]
    s_sub_u32 s34, 0, s34
    v_mfma_f32_16x16x32_bf16 a[36:39], a[188:191], a[124:127], a[36:39]
    v_mfma_f32_16x16x32_bf16 a[32:35], a[184:187], a[124:127], a[32:35]
    ds_read_b64_tr_b16 a[124:125], v11 offset:25440
    v_mfma_f32_16x16x32_bf16 a[32:35], a[168:171], a[120:123], a[32:35]
    ds_read_b64_tr_b16 a[126:127], v11 offset:25696
    v_mfma_f32_16x16x32_bf16 a[48:51], a[168:171], a[128:131], a[48:51]
    ds_read_b64_tr_b16 a[120:121], v11 offset:16992
    v_mfma_f32_16x16x32_bf16 a[48:51], a[184:187], a[132:135], a[48:51]
    ds_read_b64_tr_b16 a[122:123], v11 offset:17248
    v_mfma_f32_16x16x32_bf16 a[52:55], a[188:191], a[132:135], a[52:55]
    v_add_u32 v24, 262144, v24
    v_mfma_f32_16x16x32_bf16 a[52:55], a[172:175], a[128:131], a[52:55]
    v_mfma_f32_16x16x32_bf16 a[56:59], a[176:179], a[128:131], a[56:59]
    v_mfma_f32_16x16x32_bf16 a[56:59], a[192:195], a[132:135], a[56:59]
    v_mfma_f32_16x16x32_bf16 a[60:63], a[196:199], a[132:135], a[60:63]
    ds_read_b64_tr_b16 a[132:133], v11 offset:8576
    v_mfma_f32_16x16x32_bf16 a[60:63], a[180:183], a[128:131], a[60:63]
    ds_read_b64_tr_b16 a[134:135], v11 offset:8832
    ds_read_b64_tr_b16 a[128:129], v11 offset:128
    ds_read_b64_tr_b16 a[130:131], v11 offset:384
    s_add_u32 s35, s35, 1
    s_cmp_lt_u32 s35, 6
    s_cbranch_scc1 L_k2_loopA
    s_waitcnt vmcnt(10) lgkmcnt(6)
    v_mfma_f32_16x16x32_bf16 v[32:35], a[64:67], a[136:139], v[32:35]
    v_mfma_f32_16x16x32_bf16 v[32:35], a[68:71], a[152:155], v[32:35]
    buffer_load_dwordx4 a[168:171], v10, s[16:19], s29 offen offset:0 sc1
    v_mfma_f32_16x16x32_bf16 v[36:39], a[68:71], a[156:159], v[36:39]
    v_mfma_f32_16x16x32_bf16 v[36:39], a[64:67], a[140:143], v[36:39]
    v_mfma_f32_16x16x32_bf16 v[40:43], a[64:67], a[144:147], v[40:43]
    buffer_load_dwordx4 a[172:175], v10, s[16:19], s29 offen offset:1024 sc1
    v_mfma_f32_16x16x32_bf16 v[40:43], a[68:71], a[160:163], v[40:43]
    v_mfma_f32_16x16x32_bf16 v[44:47], a[68:71], a[164:167], v[44:47]
    ds_read_b64_tr_b16 a[68:69], v11 offset:25472
    v_mfma_f32_16x16x32_bf16 v[44:47], a[64:67], a[148:151], v[44:47]
    ds_read_b64_tr_b16 a[70:71], v11 offset:25728
    v_mfma_f32_16x16x32_bf16 v[60:63], a[72:75], a[148:151], v[60:63]
    ds_read_b64_tr_b16 a[64:65], v11 offset:17024
    v_mfma_f32_16x16x32_bf16 v[60:63], a[76:79], a[164:167], v[60:63]
    ds_read_b64_tr_b16 a[66:67], v11 offset:17280
    v_mfma_f32_16x16x32_bf16 v[56:59], a[76:79], a[160:163], v[56:59]
    buffer_load_dwordx4 a[176:179], v10, s[16:19], s29 offen offset:2048 sc1
    v_mfma_f32_16x16x32_bf16 v[56:59], a[72:75], a[144:147], v[56:59]
    v_mfma_f32_16x16x32_bf16 v[52:55], a[72:75], a[140:143], v[52:55]
    buffer_load_dwordx4 a[180:183], v10, s[16:19], s29 offen offset:3072 sc1
    v_mfma_f32_16x16x32_bf16 v[52:55], a[76:79], a[156:159], v[52:55]
    v_mfma_f32_16x16x32_bf16 v[48:51], a[76:79], a[152:155], v[48:51]
    ds_read_b64_tr_b16 a[76:77], v11 offset:8608
    v_mfma_f32_16x16x32_bf16 v[48:51], a[72:75], a[136:139], v[48:51]
    ds_read_b64_tr_b16 a[78:79], v11 offset:8864
    v_mfma_f32_16x16x32_bf16 v[64:67], a[80:83], a[136:139], v[64:67]
    ds_read_b64_tr_b16 a[72:73], v11 offset:160
    v_mfma_f32_16x16x32_bf16 v[64:67], a[84:87], a[152:155], v[64:67]
    ds_read_b64_tr_b16 a[74:75], v11 offset:416
    v_mfma_f32_16x16x32_bf16 v[68:71], a[84:87], a[156:159], v[68:71]
    s_add_u32 s29, s29, 4096
    v_mfma_f32_16x16x32_bf16 v[68:71], a[80:83], a[140:143], v[68:71]
    buffer_load_dwordx4 a[184:187], v10, s[16:19], s29 offen offset:0 sc1
    v_mfma_f32_16x16x32_bf16 v[72:75], a[80:83], a[144:147], v[72:75]
    v_mfma_f32_16x16x32_bf16 v[72:75], a[84:87], a[160:163], v[72:75]
    v_mfma_f32_16x16x32_bf16 v[76:79], a[84:87], a[164:167], v[76:79]
    ds_read_b64_tr_b16 a[84:85], v11 offset:25504
    v_mfma_f32_16x16x32_bf16 v[76:79], a[80:83], a[148:151], v[76:79]
    ds_read_b64_tr_b16 a[86:87], v11 offset:25760
    v_mfma_f32_16x16x32_bf16 v[92:95], a[88:91], a[148:151], v[92:95]
    ds_read_b64_tr_b16 a[80:81], v11 offset:17056
    v_mfma_f32_16x16x32_bf16 v[92:95], a[92:95], a[164:167], v[92:95]
    ds_read_b64_tr_b16 a[82:83], v11 offset:17312
    v_mfma_f32_16x16x32_bf16 v[88:91], a[92:95], a[160:163], v[88:91]
    buffer_load_dwordx4 a[188:191], v10, s[16:19], s29 offen offset:1024 sc1
    v_mfma_f32_16x16x32_bf16 v[88:91], a[88:91], a[144:147], v[88:91]
    buffer_load_dwordx4 a[192:195], v10, s[16:19], s29 offen offset:2048 sc1
    v_mfma_f32_16x16x32_bf16 v[84:87], a[88:91], a[140:143], v[84:87]
    v_mfma_f32_16x16x32_bf16 v[84:87], a[92:95], a[156:159], v[84:87]
    v_mfma_f32_16x16x32_bf16 v[80:83], a[92:95], a[152:155], v[80:83]
    ds_read_b64_tr_b16 a[92:93], v11 offset:8640
    v_mfma_f32_16x16x32_bf16 v[80:83], a[88:91], a[136:139], v[80:83]
    ds_read_b64_tr_b16 a[94:95], v11 offset:8896
    v_mfma_f32_16x16x32_bf16 v[96:99], a[96:99], a[136:139], v[96:99]
    ds_read_b64_tr_b16 a[88:89], v11 offset:192
    v_mfma_f32_16x16x32_bf16 v[96:99], a[100:103], a[152:155], v[96:99]
    ds_read_b64_tr_b16 a[90:91], v11 offset:448
    v_mfma_f32_16x16x32_bf16 v[100:103], a[100:103], a[156:159], v[100:103]
    buffer_load_dwordx4 a[196:199], v10, s[16:19], s29 offen offset:3072 sc1
    v_mfma_f32_16x16x32_bf16 v[100:103], a[96:99], a[140:143], v[100:103]
    s_add_u32 s29, s29, 4096
    v_mfma_f32_16x16x32_bf16 v[104:107], a[96:99], a[144:147], v[104:107]
    v_mfma_f32_16x16x32_bf16 v[104:107], a[100:103], a[160:163], v[104:107]
    v_mfma_f32_16x16x32_bf16 v[108:111], a[100:103], a[164:167], v[108:111]
    ds_read_b64_tr_b16 a[100:101], v11 offset:25536
    v_mfma_f32_16x16x32_bf16 v[108:111], a[96:99], a[148:151], v[108:111]
    ds_read_b64_tr_b16 a[102:103], v11 offset:25792
    v_mfma_f32_16x16x32_bf16 v[124:127], a[104:107], a[148:151], v[124:127]
    ds_read_b64_tr_b16 a[96:97], v11 offset:17088
    v_mfma_f32_16x16x32_bf16 v[124:127], a[108:111], a[164:167], v[124:127]
    ds_read_b64_tr_b16 a[98:99], v11 offset:17344
    v_mfma_f32_16x16x32_bf16 v[120:123], a[108:111], a[160:163], v[120:123]
    buffer_load_dwordx4 v7, s[8:11], s27 offen offset:2112 nt lds
    v_mfma_f32_16x16x32_bf16 v[120:123], a[104:107], a[144:147], v[120:123]
    buffer_load_dwordx4 v8, s[8:11], s27 offen offset:3168 nt lds
    v_mfma_f32_16x16x32_bf16 v[116:119], a[104:107], a[140:143], v[116:119]
    v_mfma_f32_16x16x32_bf16 v[116:119], a[108:111], a[156:159], v[116:119]
    v_mfma_f32_16x16x32_bf16 v[112:115], a[108:111], a[152:155], v[112:115]
    ds_read_b64_tr_b16 a[108:109], v11 offset:8672
    v_mfma_f32_16x16x32_bf16 v[112:115], a[104:107], a[136:139], v[112:115]
    ds_read_b64_tr_b16 a[110:111], v11 offset:8928
    v_mfma_f32_16x16x32_bf16 v[128:131], a[112:115], a[136:139], v[128:131]
    ds_read_b64_tr_b16 a[104:105], v11 offset:224
    v_mfma_f32_16x16x32_bf16 v[128:131], a[116:119], a[152:155], v[128:131]
    ds_read_b64_tr_b16 a[106:107], v11 offset:480
    v_mfma_f32_16x16x32_bf16 v[132:135], a[116:119], a[156:159], v[132:135]
    s_mov_b32 m0, s32
    v_mfma_f32_16x16x32_bf16 v[132:135], a[112:115], a[140:143], v[132:135]
    s_add_u32 s27, s27, 458752
    v_mfma_f32_16x16x32_bf16 v[136:139], a[112:115], a[144:147], v[136:139]
    v_mfma_f32_16x16x32_bf16 v[136:139], a[116:119], a[160:163], v[136:139]
    buffer_load_dwordx4 v9, s[12:15], s28 offen offset:0 nt lds
    v_mfma_f32_16x16x32_bf16 v[140:143], a[116:119], a[164:167], v[140:143]
    ds_read_b64_tr_b16 a[116:117], v11 offset:25568
    v_mfma_f32_16x16x32_bf16 v[140:143], a[112:115], a[148:151], v[140:143]
    ds_read_b64_tr_b16 a[118:119], v11 offset:25824
    s_waitcnt lgkmcnt(6)
    v_mfma_f32_16x16x32_bf16 v[156:159], a[120:123], a[148:151], v[156:159]
    ds_read_b64_tr_b16 a[112:113], v11 offset:17120
    v_mfma_f32_16x16x32_bf16 v[156:159], a[124:127], a[164:167], v[156:159]
    ds_read_b64_tr_b16 a[114:115], v11 offset:17376
    v_mfma_f32_16x16x32_bf16 v[152:155], a[124:127], a[160:163], v[152:155]
    s_add_u32 s28, s28, 128
    v_mfma_f32_16x16x32_bf16 v[152:155], a[120:123], a[144:147], v[152:155]
    v_mfma_f32_16x16x32_bf16 v[148:151], a[120:123], a[140:143], v[148:151]
    v_mfma_f32_16x16x32_bf16 v[148:151], a[124:127], a[156:159], v[148:151]
    s_add_u32 s30, s30, s34
    v_mfma_f32_16x16x32_bf16 v[144:147], a[124:127], a[152:155], v[144:147]
    ds_read_b128 a[124:127], v14 offset:0
    v_mfma_f32_16x16x32_bf16 v[144:147], a[120:123], a[136:139], v[144:147]
    ds_read_b128 a[120:123], v13 offset:0
    v_mfma_f32_16x16x32_bf16 v[160:163], a[128:131], a[136:139], v[160:163]
    v_mfma_f32_16x16x32_bf16 v[160:163], a[132:135], a[152:155], v[160:163]
    s_add_u32 s32, s32, s34
    v_mfma_f32_16x16x32_bf16 v[164:167], a[132:135], a[156:159], v[164:167]
    v_mfma_f32_16x16x32_bf16 v[164:167], a[128:131], a[140:143], v[164:167]
    v_mfma_f32_16x16x32_bf16 v[168:171], a[128:131], a[144:147], v[168:171]
    v_mfma_f32_16x16x32_bf16 v[168:171], a[132:135], a[160:163], v[168:171]
    v_mfma_f32_16x16x32_bf16 v[172:175], a[132:135], a[164:167], v[172:175]
    ds_read_b128 a[132:135], v14 offset:2048
    v_mfma_f32_16x16x32_bf16 v[172:175], a[128:131], a[148:151], v[172:175]
    ds_read_b128 a[128:131], v13 offset:2048
    v_mfma_f32_16x16x32_bf16 v[176:179], a[64:67], a[136:139], v[176:179]
    v_mfma_f32_16x16x32_bf16 v[176:179], a[68:71], a[152:155], v[176:179]
    s_mov_b32 m0, s31
    v_mfma_f32_16x16x32_bf16 v[180:183], a[68:71], a[156:159], v[180:183]
    v_mfma_f32_16x16x32_bf16 v[180:183], a[64:67], a[140:143], v[180:183]
    v_mfma_f32_16x16x32_bf16 v[184:187], a[64:67], a[144:147], v[184:187]
    v_mfma_f32_16x16x32_bf16 v[184:187], a[68:71], a[160:163], v[184:187]
    v_mfma_f32_16x16x32_bf16 v[188:191], a[68:71], a[164:167], v[188:191]
    v_mfma_f32_16x16x32_bf16 v[188:191], a[64:67], a[148:151], v[188:191]
    buffer_load_dwordx4 v1, s[8:11], s27 offen offset:0 nt lds
    v_mfma_f32_16x16x32_bf16 v[204:207], a[72:75], a[148:151], v[204:207]
    v_mfma_f32_16x16x32_bf16 v[204:207], a[76:79], a[164:167], v[204:207]
    v_mfma_f32_16x16x32_bf16 v[200:203], a[76:79], a[160:163], v[200:203]
    v_mfma_f32_16x16x32_bf16 v[200:203], a[72:75], a[144:147], v[200:203]
    s_waitcnt vmcnt(19)
    s_waitcnt lgkmcnt(0)
    s_barrier
    ds_read_b64_tr_b16 a[68:69], v12 offset:8448
    v_mfma_f32_16x16x32_bf16 v[196:199], a[72:75], a[140:143], v[196:199]
    ds_read_b64_tr_b16 a[70:71], v12 offset:8704
    v_mfma_f32_16x16x32_bf16 v[196:199], a[76:79], a[156:159], v[196:199]
    ds_read_b64_tr_b16 a[64:65], v12 offset:0
    v_mfma_f32_16x16x32_bf16 v[192:195], a[76:79], a[152:155], v[192:195]
    ds_read_b64_tr_b16 a[66:67], v12 offset:256
    v_mfma_f32_16x16x32_bf16 v[192:195], a[72:75], a[136:139], v[192:195]
    ds_read_b64_tr_b16 a[76:77], v12 offset:25344
    v_mfma_f32_16x16x32_bf16 v[208:211], a[80:83], a[136:139], v[208:211]
    ds_read_b64_tr_b16 a[78:79], v12 offset:25600
    v_mfma_f32_16x16x32_bf16 v[208:211], a[84:87], a[152:155], v[208:211]
    ds_read_b64_tr_b16 a[72:73], v12 offset:16896
    v_mfma_f32_16x16x32_bf16 v[212:215], a[84:87], a[156:159], v[212:215]
    ds_read_b64_tr_b16 a[74:75], v12 offset:17152
    v_mfma_f32_16x16x32_bf16 v[212:215], a[80:83], a[140:143], v[212:215]
    buffer_load_dwordx4 v2, s[8:11], s27 offen offset:1056 nt lds
    v_mfma_f32_16x16x32_bf16 v[216:219], a[80:83], a[144:147], v[216:219]
    v_mfma_f32_16x16x32_bf16 v[216:219], a[84:87], a[160:163], v[216:219]
    buffer_load_dwordx4 v3, s[8:11], s27 offen offset:2112 nt lds
    v_mfma_f32_16x16x32_bf16 v[220:223], a[84:87], a[164:167], v[220:223]
    ds_read_b64_tr_b16 a[84:85], v12 offset:8480
    v_mfma_f32_16x16x32_bf16 v[220:223], a[80:83], a[148:151], v[220:223]
    ds_read_b64_tr_b16 a[86:87], v12 offset:8736
    v_mfma_f32_16x16x32_bf16 v[236:239], a[88:91], a[148:151], v[236:239]
    ds_read_b64_tr_b16 a[80:81], v12 offset:32
    v_mfma_f32_16x16x32_bf16 v[236:239], a[92:95], a[164:167], v[236:239]
    ds_read_b64_tr_b16 a[82:83], v12 offset:288
    v_mfma_f32_16x16x32_bf16 v[232:235], a[92:95], a[160:163], v[232:235]
    v_mfma_f32_16x16x32_bf16 v[232:235], a[88:91], a[144:147], v[232:235]
    v_mfma_f32_16x16x32_bf16 v[228:231], a[88:91], a[140:143], v[228:231]
    buffer_load_dwordx4 v4, s[8:11], s27 offen offset:3168 nt lds
    v_mfma_f32_16x16x32_bf16 v[228:231], a[92:95], a[156:159], v[228:231]
    v_mfma_f32_16x16x32_bf16 v[224:227], a[92:95], a[152:155], v[224:227]
    ds_read_b64_tr_b16 a[92:93], v12 offset:25376
    v_mfma_f32_16x16x32_bf16 v[224:227], a[88:91], a[136:139], v[224:227]
    ds_read_b64_tr_b16 a[94:95], v12 offset:25632
    v_mfma_f32_16x16x32_bf16 v[240:243], a[96:99], a[136:139], v[240:243]
    ds_read_b64_tr_b16 a[88:89], v12 offset:16928
    v_mfma_f32_16x16x32_bf16 v[240:243], a[100:103], a[152:155], v[240:243]
    ds_read_b64_tr_b16 a[90:91], v12 offset:17184
    v_mfma_f32_16x16x32_bf16 v[244:247], a[100:103], a[156:159], v[244:247]
    v_mfma_f32_16x16x32_bf16 v[244:247], a[96:99], a[140:143], v[244:247]
    s_add_u32 m0, s31, 4224
    v_mfma_f32_16x16x32_bf16 v[248:251], a[96:99], a[144:147], v[248:251]
    v_mfma_f32_16x16x32_bf16 v[248:251], a[100:103], a[160:163], v[248:251]
    v_mfma_f32_16x16x32_bf16 v[252:255], a[100:103], a[164:167], v[252:255]
    ds_read_b64_tr_b16 a[100:101], v12 offset:8512
    v_mfma_f32_16x16x32_bf16 v[252:255], a[96:99], a[148:151], v[252:255]
    ds_read_b64_tr_b16 a[102:103], v12 offset:8768
    v_mfma_f32_16x16x32_bf16 a[12:15], a[104:107], a[148:151], a[12:15]
    ds_read_b64_tr_b16 a[96:97], v12 offset:64
    v_mfma_f32_16x16x32_bf16 a[12:15], a[108:111], a[164:167], a[12:15]
    ds_read_b64_tr_b16 a[98:99], v12 offset:320
    v_mfma_f32_16x16x32_bf16 a[8:11], a[108:111], a[160:163], a[8:11]
    buffer_load_dwordx4 v5, s[8:11], s27 offen offset:0 nt lds
    v_mfma_f32_16x16x32_bf16 a[8:11], a[104:107], a[144:147], a[8:11]
    v_mfma_f32_16x16x32_bf16 a[4:7], a[104:107], a[140:143], a[4:7]
    v_mfma_f32_16x16x32_bf16 a[4:7], a[108:111], a[156:159], a[4:7]
    v_mfma_f32_16x16x32_bf16 a[0:3], a[108:111], a[152:155], a[0:3]
    ds_read_b64_tr_b16 a[108:109], v12 offset:25408
    v_mfma_f32_16x16x32_bf16 a[0:3], a[104:107], a[136:139], a[0:3]
    ds_read_b64_tr_b16 a[110:111], v12 offset:25664
    v_mfma_f32_16x16x32_bf16 a[16:19], a[112:115], a[136:139], a[16:19]
    ds_read_b64_tr_b16 a[104:105], v12 offset:16960
    v_mfma_f32_16x16x32_bf16 a[16:19], a[116:119], a[152:155], a[16:19]
    ds_read_b64_tr_b16 a[106:107], v12 offset:17216
    v_mfma_f32_16x16x32_bf16 a[20:23], a[116:119], a[156:159], a[20:23]
    buffer_load_dwordx4 v6, s[8:11], s27 offen offset:1056 nt lds
    v_mfma_f32_16x16x32_bf16 a[20:23], a[112:115], a[140:143], a[20:23]
    v_mfma_f32_16x16x32_bf16 a[24:27], a[112:115], a[144:147], a[24:27]
    v_mfma_f32_16x16x32_bf16 a[24:27], a[116:119], a[160:163], a[24:27]
    v_mfma_f32_16x16x32_bf16 a[28:31], a[116:119], a[164:167], a[28:31]
    ds_read_b64_tr_b16 a[116:117], v12 offset:8544
    v_mfma_f32_16x16x32_bf16 a[28:31], a[112:115], a[148:151], a[28:31]
    ds_read_b64_tr_b16 a[118:119], v12 offset:8800
    v_mfma_f32_16x16x32_bf16 a[44:47], a[148:151], a[120:123], a[44:47]
    ds_read_b64_tr_b16 a[112:113], v12 offset:96
    v_mfma_f32_16x16x32_bf16 a[44:47], a[164:167], a[124:127], a[44:47]
    ds_read_b64_tr_b16 a[114:115], v12 offset:352
    v_mfma_f32_16x16x32_bf16 a[40:43], a[160:163], a[124:127], a[40:43]
    global_load_dword a236, v23, s[56:57]
    v_mfma_f32_16x16x32_bf16 a[40:43], a[144:147], a[120:123], a[40:43]
    v_mfma_f32_16x16x32_bf16 a[36:39], a[140:143], a[120:123], a[36:39]
    v_mfma_f32_16x16x32_bf16 a[36:39], a[156:159], a[124:127], a[36:39]
    v_mfma_f32_16x16x32_bf16 a[32:35], a[152:155], a[124:127], a[32:35]
    ds_read_b64_tr_b16 a[124:125], v12 offset:25440
    v_mfma_f32_16x16x32_bf16 a[32:35], a[136:139], a[120:123], a[32:35]
    ds_read_b64_tr_b16 a[126:127], v12 offset:25696
    v_mfma_f32_16x16x32_bf16 a[48:51], a[136:139], a[128:131], a[48:51]
    ds_read_b64_tr_b16 a[120:121], v12 offset:16992
    v_mfma_f32_16x16x32_bf16 a[48:51], a[152:155], a[132:135], a[48:51]
    ds_read_b64_tr_b16 a[122:123], v12 offset:17248
    v_mfma_f32_16x16x32_bf16 a[52:55], a[156:159], a[132:135], a[52:55]
    v_add_u32 v23, 1048576, v23
    v_mfma_f32_16x16x32_bf16 a[52:55], a[140:143], a[128:131], a[52:55]
    v_mfma_f32_16x16x32_bf16 a[56:59], a[144:147], a[128:131], a[56:59]
    v_mfma_f32_16x16x32_bf16 a[56:59], a[160:163], a[132:135], a[56:59]
    v_mfma_f32_16x16x32_bf16 a[60:63], a[164:167], a[132:135], a[60:63]
    ds_read_b64_tr_b16 a[132:133], v12 offset:8576
    v_mfma_f32_16x16x32_bf16 a[60:63], a[148:151], a[128:131], a[60:63]
    ds_read_b64_tr_b16 a[134:135], v12 offset:8832
    ds_read_b64_tr_b16 a[128:129], v12 offset:128
    ds_read_b64_tr_b16 a[130:131], v12 offset:384
    s_waitcnt vmcnt(10) lgkmcnt(6)
    v_mfma_f32_16x16x32_bf16 v[32:35], a[64:67], a[168:171], v[32:35]
    v_mfma_f32_16x16x32_bf16 v[32:35], a[68:71], a[184:187], v[32:35]
    buffer_load_dwordx4 a[136:139], v10, s[16:19], s29 offen offset:0 sc1
    v_mfma_f32_16x16x32_bf16 v[36:39], a[68:71], a[188:191], v[36:39]
    v_mfma_f32_16x16x32_bf16 v[36:39], a[64:67], a[172:175], v[36:39]
    v_mfma_f32_16x16x32_bf16 v[40:43], a[64:67], a[176:179], v[40:43]
    buffer_load_dwordx4 a[140:143], v10, s[16:19], s29 offen offset:1024 sc1
    v_mfma_f32_16x16x32_bf16 v[40:43], a[68:71], a[192:195], v[40:43]
    v_mfma_f32_16x16x32_bf16 v[44:47], a[68:71], a[196:199], v[44:47]
    ds_read_b64_tr_b16 a[68:69], v12 offset:25472
    v_mfma_f32_16x16x32_bf16 v[44:47], a[64:67], a[180:183], v[44:47]
    ds_read_b64_tr_b16 a[70:71], v12 offset:25728
    v_mfma_f32_16x16x32_bf16 v[60:63], a[72:75], a[180:183], v[60:63]
    ds_read_b64_tr_b16 a[64:65], v12 offset:17024
    v_mfma_f32_16x16x32_bf16 v[60:63], a[76:79], a[196:199], v[60:63]
    ds_read_b64_tr_b16 a[66:67], v12 offset:17280
    v_mfma_f32_16x16x32_bf16 v[56:59], a[76:79], a[192:195], v[56:59]
    buffer_load_dwordx4 a[144:147], v10, s[16:19], s29 offen offset:2048 sc1
    v_mfma_f32_16x16x32_bf16 v[56:59], a[72:75], a[176:179], v[56:59]
    v_mfma_f32_16x16x32_bf16 v[52:55], a[72:75], a[172:175], v[52:55]
    buffer_load_dwordx4 a[148:151], v10, s[16:19], s29 offen offset:3072 sc1
    v_mfma_f32_16x16x32_bf16 v[52:55], a[76:79], a[188:191], v[52:55]
    v_mfma_f32_16x16x32_bf16 v[48:51], a[76:79], a[184:187], v[48:51]
    ds_read_b64_tr_b16 a[76:77], v12 offset:8608
    v_mfma_f32_16x16x32_bf16 v[48:51], a[72:75], a[168:171], v[48:51]
    ds_read_b64_tr_b16 a[78:79], v12 offset:8864
    v_mfma_f32_16x16x32_bf16 v[64:67], a[80:83], a[168:171], v[64:67]
    ds_read_b64_tr_b16 a[72:73], v12 offset:160
    v_mfma_f32_16x16x32_bf16 v[64:67], a[84:87], a[184:187], v[64:67]
    ds_read_b64_tr_b16 a[74:75], v12 offset:416
    v_mfma_f32_16x16x32_bf16 v[68:71], a[84:87], a[188:191], v[68:71]
    s_add_u32 s29, s29, 4096
    v_mfma_f32_16x16x32_bf16 v[68:71], a[80:83], a[172:175], v[68:71]
    buffer_load_dwordx4 a[152:155], v10, s[16:19], s29 offen offset:0 sc1
    v_mfma_f32_16x16x32_bf16 v[72:75], a[80:83], a[176:179], v[72:75]
    v_mfma_f32_16x16x32_bf16 v[72:75], a[84:87], a[192:195], v[72:75]
    v_mfma_f32_16x16x32_bf16 v[76:79], a[84:87], a[196:199], v[76:79]
    ds_read_b64_tr_b16 a[84:85], v12 offset:25504
    v_mfma_f32_16x16x32_bf16 v[76:79], a[80:83], a[180:183], v[76:79]
    ds_read_b64_tr_b16 a[86:87], v12 offset:25760
    v_mfma_f32_16x16x32_bf16 v[92:95], a[88:91], a[180:183], v[92:95]
    ds_read_b64_tr_b16 a[80:81], v12 offset:17056
    v_mfma_f32_16x16x32_bf16 v[92:95], a[92:95], a[196:199], v[92:95]
    ds_read_b64_tr_b16 a[82:83], v12 offset:17312
    v_mfma_f32_16x16x32_bf16 v[88:91], a[92:95], a[192:195], v[88:91]
    buffer_load_dwordx4 a[156:159], v10, s[16:19], s29 offen offset:1024 sc1
    v_mfma_f32_16x16x32_bf16 v[88:91], a[88:91], a[176:179], v[88:91]
    buffer_load_dwordx4 a[160:163], v10, s[16:19], s29 offen offset:2048 sc1
    v_mfma_f32_16x16x32_bf16 v[84:87], a[88:91], a[172:175], v[84:87]
    v_mfma_f32_16x16x32_bf16 v[84:87], a[92:95], a[188:191], v[84:87]
    v_mfma_f32_16x16x32_bf16 v[80:83], a[92:95], a[184:187], v[80:83]
    ds_read_b64_tr_b16 a[92:93], v12 offset:8640
    v_mfma_f32_16x16x32_bf16 v[80:83], a[88:91], a[168:171], v[80:83]
    ds_read_b64_tr_b16 a[94:95], v12 offset:8896
    v_mfma_f32_16x16x32_bf16 v[96:99], a[96:99], a[168:171], v[96:99]
    ds_read_b64_tr_b16 a[88:89], v12 offset:192
    v_mfma_f32_16x16x32_bf16 v[96:99], a[100:103], a[184:187], v[96:99]
    ds_read_b64_tr_b16 a[90:91], v12 offset:448
    v_mfma_f32_16x16x32_bf16 v[100:103], a[100:103], a[188:191], v[100:103]
    buffer_load_dwordx4 a[164:167], v10, s[16:19], s29 offen offset:3072 sc1
    v_mfma_f32_16x16x32_bf16 v[100:103], a[96:99], a[172:175], v[100:103]
    s_add_u32 s29, s29, 4096
    v_mfma_f32_16x16x32_bf16 v[104:107], a[96:99], a[176:179], v[104:107]
    v_mfma_f32_16x16x32_bf16 v[104:107], a[100:103], a[192:195], v[104:107]
    v_mfma_f32_16x16x32_bf16 v[108:111], a[100:103], a[196:199], v[108:111]
    ds_read_b64_tr_b16 a[100:101], v12 offset:25536
    v_mfma_f32_16x16x32_bf16 v[108:111], a[96:99], a[180:183], v[108:111]
    ds_read_b64_tr_b16 a[102:103], v12 offset:25792
    v_mfma_f32_16x16x32_bf16 v[124:127], a[104:107], a[180:183], v[124:127]
    ds_read_b64_tr_b16 a[96:97], v12 offset:17088
    v_mfma_f32_16x16x32_bf16 v[124:127], a[108:111], a[196:199], v[124:127]
    ds_read_b64_tr_b16 a[98:99], v12 offset:17344
    v_mfma_f32_16x16x32_bf16 v[120:123], a[108:111], a[192:195], v[120:123]
    buffer_load_dwordx4 v7, s[8:11], s27 offen offset:2112 nt lds
    v_mfma_f32_16x16x32_bf16 v[120:123], a[104:107], a[176:179], v[120:123]
    buffer_load_dwordx4 v8, s[8:11], s27 offen offset:3168 nt lds
    v_mfma_f32_16x16x32_bf16 v[116:119], a[104:107], a[172:175], v[116:119]
    v_subrev_u32 v11, s34, v11
    v_mfma_f32_16x16x32_bf16 v[116:119], a[108:111], a[188:191], v[116:119]
    v_subrev_u32_e64 v13, s34, v13
    v_mfma_f32_16x16x32_bf16 v[112:115], a[108:111], a[184:187], v[112:115]
    ds_read_b64_tr_b16 a[108:109], v12 offset:8672
    v_mfma_f32_16x16x32_bf16 v[112:115], a[104:107], a[168:171], v[112:115]
    ds_read_b64_tr_b16 a[110:111], v12 offset:8928
    v_mfma_f32_16x16x32_bf16 v[128:131], a[112:115], a[168:171], v[128:131]
    ds_read_b64_tr_b16 a[104:105], v12 offset:224
    v_mfma_f32_16x16x32_bf16 v[128:131], a[116:119], a[184:187], v[128:131]
    ds_read_b64_tr_b16 a[106:107], v12 offset:480
    v_mfma_f32_16x16x32_bf16 v[132:135], a[116:119], a[188:191], v[132:135]
    s_mov_b32 m0, s33
    v_mfma_f32_16x16x32_bf16 v[132:135], a[112:115], a[172:175], v[132:135]
    s_add_u32 s27, s27, 458752
    v_mfma_f32_16x16x32_bf16 v[136:139], a[112:115], a[176:179], v[136:139]
    v_subrev_u32 v14, s34, v14
    v_mfma_f32_16x16x32_bf16 v[136:139], a[116:119], a[192:195], v[136:139]
    buffer_load_dwordx4 v9, s[12:15], s28 offen offset:0 nt lds
    v_mfma_f32_16x16x32_bf16 v[140:143], a[116:119], a[196:199], v[140:143]
    ds_read_b64_tr_b16 a[116:117], v12 offset:25568
    v_mfma_f32_16x16x32_bf16 v[140:143], a[112:115], a[180:183], v[140:143]
    ds_read_b64_tr_b16 a[118:119], v12 offset:25824
    s_waitcnt lgkmcnt(6)
    v_mfma_f32_16x16x32_bf16 v[156:159], a[120:123], a[180:183], v[156:159]
    ds_read_b64_tr_b16 a[112:113], v12 offset:17120
    v_mfma_f32_16x16x32_bf16 v[156:159], a[124:127], a[196:199], v[156:159]
    ds_read_b64_tr_b16 a[114:115], v12 offset:17376
    v_mfma_f32_16x16x32_bf16 v[152:155], a[124:127], a[192:195], v[152:155]
    s_add_u32 s28, s28, 128
    v_mfma_f32_16x16x32_bf16 v[152:155], a[120:123], a[176:179], v[152:155]
    v_mfma_f32_16x16x32_bf16 v[148:151], a[120:123], a[172:175], v[148:151]
    v_mfma_f32_16x16x32_bf16 v[148:151], a[124:127], a[188:191], v[148:151]
    s_add_u32 s31, s31, s34
    v_mfma_f32_16x16x32_bf16 v[144:147], a[124:127], a[184:187], v[144:147]
    ds_read_b128 a[124:127], v16 offset:0
    v_mfma_f32_16x16x32_bf16 v[144:147], a[120:123], a[168:171], v[144:147]
    ds_read_b128 a[120:123], v15 offset:0
    v_mfma_f32_16x16x32_bf16 v[160:163], a[128:131], a[168:171], v[160:163]
    v_mfma_f32_16x16x32_bf16 v[160:163], a[132:135], a[184:187], v[160:163]
    s_add_u32 s33, s33, s34
    v_mfma_f32_16x16x32_bf16 v[164:167], a[132:135], a[188:191], v[164:167]
    v_mfma_f32_16x16x32_bf16 v[164:167], a[128:131], a[172:175], v[164:167]
    v_mfma_f32_16x16x32_bf16 v[168:171], a[128:131], a[176:179], v[168:171]
    v_mfma_f32_16x16x32_bf16 v[168:171], a[132:135], a[192:195], v[168:171]
    v_mfma_f32_16x16x32_bf16 v[172:175], a[132:135], a[196:199], v[172:175]
    ds_read_b128 a[132:135], v16 offset:2048
    v_mfma_f32_16x16x32_bf16 v[172:175], a[128:131], a[180:183], v[172:175]
    ds_read_b128 a[128:131], v15 offset:2048
    v_mfma_f32_16x16x32_bf16 v[176:179], a[64:67], a[168:171], v[176:179]
    v_mfma_f32_16x16x32_bf16 v[176:179], a[68:71], a[184:187], v[176:179]
    global_load_dword a236, v24, s[52:53]
    v_mfma_f32_16x16x32_bf16 v[180:183], a[68:71], a[188:191], v[180:183]
    v_subrev_u32 v12, s34, v12
    v_mfma_f32_16x16x32_bf16 v[180:183], a[64:67], a[172:175], v[180:183]
    v_subrev_u32_e64 v15, s34, v15
    v_mfma_f32_16x16x32_bf16 v[184:187], a[64:67], a[176:179], v[184:187]
    v_subrev_u32_e64 v16, s34, v16
    v_mfma_f32_16x16x32_bf16 v[184:187], a[68:71], a[192:195], v[184:187]
    v_mfma_f32_16x16x32_bf16 v[188:191], a[68:71], a[196:199], v[188:191]
    v_mfma_f32_16x16x32_bf16 v[188:191], a[64:67], a[180:183], v[188:191]
    v_mfma_f32_16x16x32_bf16 v[204:207], a[72:75], a[180:183], v[204:207]
    v_mfma_f32_16x16x32_bf16 v[204:207], a[76:79], a[196:199], v[204:207]
    v_mfma_f32_16x16x32_bf16 v[200:203], a[76:79], a[192:195], v[200:203]
    v_mfma_f32_16x16x32_bf16 v[200:203], a[72:75], a[176:179], v[200:203]
    s_waitcnt vmcnt(19)
    s_waitcnt lgkmcnt(0)
    s_barrier
    ds_read_b64_tr_b16 a[68:69], v11 offset:8448
    v_mfma_f32_16x16x32_bf16 v[196:199], a[72:75], a[172:175], v[196:199]
    ds_read_b64_tr_b16 a[70:71], v11 offset:8704
    v_mfma_f32_16x16x32_bf16 v[196:199], a[76:79], a[188:191], v[196:199]
    ds_read_b64_tr_b16 a[64:65], v11 offset:0
    v_mfma_f32_16x16x32_bf16 v[192:195], a[76:79], a[184:187], v[192:195]
    ds_read_b64_tr_b16 a[66:67], v11 offset:256
    v_mfma_f32_16x16x32_bf16 v[192:195], a[72:75], a[168:171], v[192:195]
    ds_read_b64_tr_b16 a[76:77], v11 offset:25344
    v_mfma_f32_16x16x32_bf16 v[208:211], a[80:83], a[168:171], v[208:211]
    ds_read_b64_tr_b16 a[78:79], v11 offset:25600
    v_mfma_f32_16x16x32_bf16 v[208:211], a[84:87], a[184:187], v[208:211]
    ds_read_b64_tr_b16 a[72:73], v11 offset:16896
    v_mfma_f32_16x16x32_bf16 v[212:215], a[84:87], a[188:191], v[212:215]
    ds_read_b64_tr_b16 a[74:75], v11 offset:17152
    v_mfma_f32_16x16x32_bf16 v[212:215], a[80:83], a[172:175], v[212:215]
    v_mfma_f32_16x16x32_bf16 v[216:219], a[80:83], a[176:179], v[216:219]
    v_mfma_f32_16x16x32_bf16 v[216:219], a[84:87], a[192:195], v[216:219]
    v_mfma_f32_16x16x32_bf16 v[220:223], a[84:87], a[196:199], v[220:223]
    ds_read_b64_tr_b16 a[84:85], v11 offset:8480
    v_mfma_f32_16x16x32_bf16 v[220:223], a[80:83], a[180:183], v[220:223]
    ds_read_b64_tr_b16 a[86:87], v11 offset:8736
    v_mfma_f32_16x16x32_bf16 v[236:239], a[88:91], a[180:183], v[236:239]
    ds_read_b64_tr_b16 a[80:81], v11 offset:32
    v_mfma_f32_16x16x32_bf16 v[236:239], a[92:95], a[196:199], v[236:239]
    ds_read_b64_tr_b16 a[82:83], v11 offset:288
    v_mfma_f32_16x16x32_bf16 v[232:235], a[92:95], a[192:195], v[232:235]
    v_mfma_f32_16x16x32_bf16 v[232:235], a[88:91], a[176:179], v[232:235]
    v_mfma_f32_16x16x32_bf16 v[228:231], a[88:91], a[172:175], v[228:231]
    v_mfma_f32_16x16x32_bf16 v[228:231], a[92:95], a[188:191], v[228:231]
    v_mfma_f32_16x16x32_bf16 v[224:227], a[92:95], a[184:187], v[224:227]
    ds_read_b64_tr_b16 a[92:93], v11 offset:25376
    v_mfma_f32_16x16x32_bf16 v[224:227], a[88:91], a[168:171], v[224:227]
    ds_read_b64_tr_b16 a[94:95], v11 offset:25632
    v_mfma_f32_16x16x32_bf16 v[240:243], a[96:99], a[168:171], v[240:243]
    ds_read_b64_tr_b16 a[88:89], v11 offset:16928
    v_mfma_f32_16x16x32_bf16 v[240:243], a[100:103], a[184:187], v[240:243]
    ds_read_b64_tr_b16 a[90:91], v11 offset:17184
    v_mfma_f32_16x16x32_bf16 v[244:247], a[100:103], a[188:191], v[244:247]
    v_mfma_f32_16x16x32_bf16 v[244:247], a[96:99], a[172:175], v[244:247]
    v_add_u32 v24, 262144, v24
    v_mfma_f32_16x16x32_bf16 v[248:251], a[96:99], a[176:179], v[248:251]
    v_mfma_f32_16x16x32_bf16 v[248:251], a[100:103], a[192:195], v[248:251]
    v_mfma_f32_16x16x32_bf16 v[252:255], a[100:103], a[196:199], v[252:255]
    ds_read_b64_tr_b16 a[100:101], v11 offset:8512
    v_mfma_f32_16x16x32_bf16 v[252:255], a[96:99], a[180:183], v[252:255]
    ds_read_b64_tr_b16 a[102:103], v11 offset:8768
    v_mfma_f32_16x16x32_bf16 a[12:15], a[104:107], a[180:183], a[12:15]
    ds_read_b64_tr_b16 a[96:97], v11 offset:64
    v_mfma_f32_16x16x32_bf16 a[12:15], a[108:111], a[196:199], a[12:15]
    ds_read_b64_tr_b16 a[98:99], v11 offset:320
    v_mfma_f32_16x16x32_bf16 a[8:11], a[108:111], a[192:195], a[8:11]
    v_mfma_f32_16x16x32_bf16 a[8:11], a[104:107], a[176:179], a[8:11]
    v_mfma_f32_16x16x32_bf16 a[4:7], a[104:107], a[172:175], a[4:7]
    v_mfma_f32_16x16x32_bf16 a[4:7], a[108:111], a[188:191], a[4:7]
    v_mfma_f32_16x16x32_bf16 a[0:3], a[108:111], a[184:187], a[0:3]
    ds_read_b64_tr_b16 a[108:109], v11 offset:25408
    v_mfma_f32_16x16x32_bf16 a[0:3], a[104:107], a[168:171], a[0:3]
    ds_read_b64_tr_b16 a[110:111], v11 offset:25664
    v_mfma_f32_16x16x32_bf16 a[16:19], a[112:115], a[168:171], a[16:19]
    ds_read_b64_tr_b16 a[104:105], v11 offset:16960
    v_mfma_f32_16x16x32_bf16 a[16:19], a[116:119], a[184:187], a[16:19]
    ds_read_b64_tr_b16 a[106:107], v11 offset:17216
    v_mfma_f32_16x16x32_bf16 a[20:23], a[116:119], a[188:191], a[20:23]
    v_mfma_f32_16x16x32_bf16 a[20:23], a[112:115], a[172:175], a[20:23]
    v_mfma_f32_16x16x32_bf16 a[24:27], a[112:115], a[176:179], a[24:27]
    v_mfma_f32_16x16x32_bf16 a[24:27], a[116:119], a[192:195], a[24:27]
    v_mfma_f32_16x16x32_bf16 a[28:31], a[116:119], a[196:199], a[28:31]
    ds_read_b64_tr_b16 a[116:117], v11 offset:8544
    v_mfma_f32_16x16x32_bf16 a[28:31], a[112:115], a[180:183], a[28:31]
    ds_read_b64_tr_b16 a[118:119], v11 offset:8800
    v_mfma_f32_16x16x32_bf16 a[44:47], a[180:183], a[120:123], a[44:47]
    ds_read_b64_tr_b16 a[112:113], v11 offset:96
    v_mfma_f32_16x16x32_bf16 a[44:47], a[196:199], a[124:127], a[44:47]
    ds_read_b64_tr_b16 a[114:115], v11 offset:352
    v_mfma_f32_16x16x32_bf16 a[40:43], a[192:195], a[124:127], a[40:43]
    v_mfma_f32_16x16x32_bf16 a[40:43], a[176:179], a[120:123], a[40:43]
    v_mfma_f32_16x16x32_bf16 a[36:39], a[172:175], a[120:123], a[36:39]
    s_sub_u32 s34, 0, s34
    v_mfma_f32_16x16x32_bf16 a[36:39], a[188:191], a[124:127], a[36:39]
    v_mfma_f32_16x16x32_bf16 a[32:35], a[184:187], a[124:127], a[32:35]
    ds_read_b64_tr_b16 a[124:125], v11 offset:25440
    v_mfma_f32_16x16x32_bf16 a[32:35], a[168:171], a[120:123], a[32:35]
    ds_read_b64_tr_b16 a[126:127], v11 offset:25696
    v_mfma_f32_16x16x32_bf16 a[48:51], a[168:171], a[128:131], a[48:51]
    ds_read_b64_tr_b16 a[120:121], v11 offset:16992
    v_mfma_f32_16x16x32_bf16 a[48:51], a[184:187], a[132:135], a[48:51]
    ds_read_b64_tr_b16 a[122:123], v11 offset:17248
    v_mfma_f32_16x16x32_bf16 a[52:55], a[188:191], a[132:135], a[52:55]
    v_mfma_f32_16x16x32_bf16 a[52:55], a[172:175], a[128:131], a[52:55]
    v_mfma_f32_16x16x32_bf16 a[56:59], a[176:179], a[128:131], a[56:59]
    v_mfma_f32_16x16x32_bf16 a[56:59], a[192:195], a[132:135], a[56:59]
    v_mfma_f32_16x16x32_bf16 a[60:63], a[196:199], a[132:135], a[60:63]
    ds_read_b64_tr_b16 a[132:133], v11 offset:8576
    v_mfma_f32_16x16x32_bf16 a[60:63], a[180:183], a[128:131], a[60:63]
    ds_read_b64_tr_b16 a[134:135], v11 offset:8832
    ds_read_b64_tr_b16 a[128:129], v11 offset:128
    ds_read_b64_tr_b16 a[130:131], v11 offset:384
    s_getpc_b64 s[58:59]
L_pc2A:
    s_add_u32 s58, s58, L_k3_code-L_pc2A
    s_addc_u32 s59, s59, 0
    v_and_b32 v19, 63, v0
    v_min_u32 v19, 11, v19
    s_lshr_b32 s3, s2, 3
    s_mul_i32 s3, s3, 12
    v_add_lshl_u32 v19, v19, s3, 7
    v_min_u32 v19, L_text_end-L_k3_code-4, v19
    global_load_dword a237, v19, s[58:59]
    s_getpc_b64 s[58:59]
L_pceA:
    s_add_u32 s58, s58, L_k2_epiA-L_pceA
    s_addc_u32 s59, s59, 0
    v_lshlrev_b32_e64 v19, 6, v0
    global_load_dword a238, v19, s[58:59]
    s_waitcnt vmcnt(4) lgkmcnt(6)
    v_mfma_f32_16x16x32_bf16 v[32:35], a[64:67], a[136:139], v[32:35]
    v_mfma_f32_16x16x32_bf16 v[32:35], a[68:71], a[152:155], v[32:35]
    buffer_load_dwordx4 a[168:171], v10, s[16:19], s29 offen offset:0 sc1
    v_mfma_f32_16x16x32_bf16 v[36:39], a[68:71], a[156:159], v[36:39]
    v_mfma_f32_16x16x32_bf16 v[36:39], a[64:67], a[140:143], v[36:39]
    v_mfma_f32_16x16x32_bf16 v[40:43], a[64:67], a[144:147], v[40:43]
    v_mfma_f32_16x16x32_bf16 v[40:43], a[68:71], a[160:163], v[40:43]
    v_mfma_f32_16x16x32_bf16 v[44:47], a[68:71], a[164:167], v[44:47]
    ds_read_b64_tr_b16 a[68:69], v11 offset:25472
    v_mfma_f32_16x16x32_bf16 v[44:47], a[64:67], a[148:151], v[44:47]
    ds_read_b64_tr_b16 a[70:71], v11 offset:25728
    v_mfma_f32_16x16x32_bf16 v[60:63], a[72:75], a[148:151], v[60:63]
    ds_read_b64_tr_b16 a[64:65], v11 offset:17024
    v_mfma_f32_16x16x32_bf16 v[60:63], a[76:79], a[164:167], v[60:63]
    ds_read_b64_tr_b16 a[66:67], v11 offset:17280
    v_mfma_f32_16x16x32_bf16 v[56:59], a[76:79], a[160:163], v[56:59]
    buffer_load_dwordx4 a[172:175], v10, s[16:19], s29 offen offset:1024 sc1
    v_mfma_f32_16x16x32_bf16 v[56:59], a[72:75], a[144:147], v[56:59]
    v_mfma_f32_16x16x32_bf16 v[52:55], a[72:75], a[140:143], v[52:55]
    v_mfma_f32_16x16x32_bf16 v[52:55], a[76:79], a[156:159], v[52:55]
    v_mfma_f32_16x16x32_bf16 v[48:51], a[76:79], a[152:155], v[48:51]
    ds_read_b64_tr_b16 a[76:77], v11 offset:8608
    v_mfma_f32_16x16x32_bf16 v[48:51], a[72:75], a[136:139], v[48:51]
    ds_read_b64_tr_b16 a[78:79], v11 offset:8864
    v_mfma_f32_16x16x32_bf16 v[64:67], a[80:83], a[136:139], v[64:67]
    ds_read_b64_tr_b16 a[72:73], v11 offset:160
    v_mfma_f32_16x16x32_bf16 v[64:67], a[84:87], a[152:155], v[64:67]
    ds_read_b64_tr_b16 a[74:75], v11 offset:416
    v_mfma_f32_16x16x32_bf16 v[68:71], a[84:87], a[156:159], v[68:71]
    buffer_load_dwordx4 a[176:179], v10, s[16:19], s29 offen offset:2048 sc1
    v_mfma_f32_16x16x32_bf16 v[68:71], a[80:83], a[140:143], v[68:71]
    v_mfma_f32_16x16x32_bf16 v[72:75], a[80:83], a[144:147], v[72:75]
    v_mfma_f32_16x16x32_bf16 v[72:75], a[84:87], a[160:163], v[72:75]
    buffer_load_dwordx4 a[180:183], v10, s[16:19], s29 offen offset:3072 sc1
    v_mfma_f32_16x16x32_bf16 v[76:79], a[84:87], a[164:167], v[76:79]
    ds_read_b64_tr_b16 a[84:85], v11 offset:25504
    v_mfma_f32_16x16x32_bf16 v[76:79], a[80:83], a[148:151], v[76:79]
    ds_read_b64_tr_b16 a[86:87], v11 offset:25760
    v_mfma_f32_16x16x32_bf16 v[92:95], a[88:91], a[148:151], v[92:95]
    ds_read_b64_tr_b16 a[80:81], v11 offset:17056
    v_mfma_f32_16x16x32_bf16 v[92:95], a[92:95], a[164:167], v[92:95]
    ds_read_b64_tr_b16 a[82:83], v11 offset:17312
    v_mfma_f32_16x16x32_bf16 v[88:91], a[92:95], a[160:163], v[88:91]
    v_mfma_f32_16x16x32_bf16 v[88:91], a[88:91], a[144:147], v[88:91]
    v_mfma_f32_16x16x32_bf16 v[84:87], a[88:91], a[140:143], v[84:87]
    s_add_u32 s29, s29, 4096
    v_mfma_f32_16x16x32_bf16 v[84:87], a[92:95], a[156:159], v[84:87]
    v_mfma_f32_16x16x32_bf16 v[80:83], a[92:95], a[152:155], v[80:83]
    ds_read_b64_tr_b16 a[92:93], v11 offset:8640
    v_mfma_f32_16x16x32_bf16 v[80:83], a[88:91], a[136:139], v[80:83]
    ds_read_b64_tr_b16 a[94:95], v11 offset:8896
    v_mfma_f32_16x16x32_bf16 v[96:99], a[96:99], a[136:139], v[96:99]
    ds_read_b64_tr_b16 a[88:89], v11 offset:192
    v_mfma_f32_16x16x32_bf16 v[96:99], a[100:103], a[152:155], v[96:99]
    ds_read_b64_tr_b16 a[90:91], v11 offset:448
    v_mfma_f32_16x16x32_bf16 v[100:103], a[100:103], a[156:159], v[100:103]
    v_mfma_f32_16x16x32_bf16 v[100:103], a[96:99], a[140:143], v[100:103]
    buffer_load_dwordx4 a[184:187], v10, s[16:19], s29 offen offset:0 sc1
    v_mfma_f32_16x16x32_bf16 v[104:107], a[96:99], a[144:147], v[104:107]
    v_mfma_f32_16x16x32_bf16 v[104:107], a[100:103], a[160:163], v[104:107]
    v_mfma_f32_16x16x32_bf16 v[108:111], a[100:103], a[164:167], v[108:111]
    ds_read_b64_tr_b16 a[100:101], v11 offset:25536
    v_mfma_f32_16x16x32_bf16 v[108:111], a[96:99], a[148:151], v[108:111]
    ds_read_b64_tr_b16 a[102:103], v11 offset:25792
    v_mfma_f32_16x16x32_bf16 v[124:127], a[104:107], a[148:151], v[124:127]
    ds_read_b64_tr_b16 a[96:97], v11 offset:17088
    v_mfma_f32_16x16x32_bf16 v[124:127], a[108:111], a[164:167], v[124:127]
    ds_read_b64_tr_b16 a[98:99], v11 offset:17344
    v_mfma_f32_16x16x32_bf16 v[120:123], a[108:111], a[160:163], v[120:123]
    buffer_load_dwordx4 a[188:191], v10, s[16:19], s29 offen offset:1024 sc1
    v_mfma_f32_16x16x32_bf16 v[120:123], a[104:107], a[144:147], v[120:123]
    v_mfma_f32_16x16x32_bf16 v[116:119], a[104:107], a[140:143], v[116:119]
    v_mfma_f32_16x16x32_bf16 v[116:119], a[108:111], a[156:159], v[116:119]
    v_mfma_f32_16x16x32_bf16 v[112:115], a[108:111], a[152:155], v[112:115]
    ds_read_b64_tr_b16 a[108:109], v11 offset:8672
    v_mfma_f32_16x16x32_bf16 v[112:115], a[104:107], a[136:139], v[112:115]
    ds_read_b64_tr_b16 a[110:111], v11 offset:8928
    v_mfma_f32_16x16x32_bf16 v[128:131], a[112:115], a[136:139], v[128:131]
    ds_read_b64_tr_b16 a[104:105], v11 offset:224
    v_mfma_f32_16x16x32_bf16 v[128:131], a[116:119], a[152:155], v[128:131]
    ds_read_b64_tr_b16 a[106:107], v11 offset:480
    v_mfma_f32_16x16x32_bf16 v[132:135], a[116:119], a[156:159], v[132:135]
    buffer_load_dwordx4 a[192:195], v10, s[16:19], s29 offen offset:2048 sc1
    v_mfma_f32_16x16x32_bf16 v[132:135], a[112:115], a[140:143], v[132:135]
    v_mfma_f32_16x16x32_bf16 v[136:139], a[112:115], a[144:147], v[136:139]
    v_mfma_f32_16x16x32_bf16 v[136:139], a[116:119], a[160:163], v[136:139]
    v_mfma_f32_16x16x32_bf16 v[140:143], a[116:119], a[164:167], v[140:143]
    ds_read_b64_tr_b16 a[116:117], v11 offset:25568
    v_mfma_f32_16x16x32_bf16 v[140:143], a[112:115], a[148:151], v[140:143]
    ds_read_b64_tr_b16 a[118:119], v11 offset:25824
    s_waitcnt lgkmcnt(6)
    v_mfma_f32_16x16x32_bf16 v[156:159], a[120:123], a[148:151], v[156:159]
    ds_read_b64_tr_b16 a[112:113], v11 offset:17120
    v_mfma_f32_16x16x32_bf16 v[156:159], a[124:127], a[164:167], v[156:159]
    ds_read_b64_tr_b16 a[114:115], v11 offset:17376
    v_mfma_f32_16x16x32_bf16 v[152:155], a[124:127], a[160:163], v[152:155]
    buffer_load_dwordx4 a[196:199], v10, s[16:19], s29 offen offset:3072 sc1
    v_mfma_f32_16x16x32_bf16 v[152:155], a[120:123], a[144:147], v[152:155]
    v_mfma_f32_16x16x32_bf16 v[148:151], a[120:123], a[140:143], v[148:151]
    v_mfma_f32_16x16x32_bf16 v[148:151], a[124:127], a[156:159], v[148:151]
    v_mfma_f32_16x16x32_bf16 v[144:147], a[124:127], a[152:155], v[144:147]
    ds_read_b128 a[124:127], v14 offset:0
    v_mfma_f32_16x16x32_bf16 v[144:147], a[120:123], a[136:139], v[144:147]
    ds_read_b128 a[120:123], v13 offset:0
    v_mfma_f32_16x16x32_bf16 v[160:163], a[128:131], a[136:139], v[160:163]
    s_add_u32 s29, s29, 4096
    v_mfma_f32_16x16x32_bf16 v[160:163], a[132:135], a[152:155], v[160:163]
    v_mfma_f32_16x16x32_bf16 v[164:167], a[132:135], a[156:159], v[164:167]
    v_mfma_f32_16x16x32_bf16 v[164:167], a[128:131], a[140:143], v[164:167]
    v_mfma_f32_16x16x32_bf16 v[168:171], a[128:131], a[144:147], v[168:171]
    v_mfma_f32_16x16x32_bf16 v[168:171], a[132:135], a[160:163], v[168:171]
    v_mfma_f32_16x16x32_bf16 v[172:175], a[132:135], a[164:167], v[172:175]
    ds_read_b128 a[132:135], v14 offset:2048
    v_mfma_f32_16x16x32_bf16 v[172:175], a[128:131], a[148:151], v[172:175]
    ds_read_b128 a[128:131], v13 offset:2048
    v_mfma_f32_16x16x32_bf16 v[176:179], a[64:67], a[136:139], v[176:179]
    v_mfma_f32_16x16x32_bf16 v[176:179], a[68:71], a[152:155], v[176:179]
    v_accvgpr_read_b32 v1, a240
    v_mfma_f32_16x16x32_bf16 v[180:183], a[68:71], a[156:159], v[180:183]
    v_mfma_f32_16x16x32_bf16 v[180:183], a[64:67], a[140:143], v[180:183]
    v_mfma_f32_16x16x32_bf16 v[184:187], a[64:67], a[144:147], v[184:187]
    v_mfma_f32_16x16x32_bf16 v[184:187], a[68:71], a[160:163], v[184:187]
    v_mfma_f32_16x16x32_bf16 v[188:191], a[68:71], a[164:167], v[188:191]
    v_mfma_f32_16x16x32_bf16 v[188:191], a[64:67], a[148:151], v[188:191]
    v_mfma_f32_16x16x32_bf16 v[204:207], a[72:75], a[148:151], v[204:207]
    v_mfma_f32_16x16x32_bf16 v[204:207], a[76:79], a[164:167], v[204:207]
    v_accvgpr_read_b32 v2, a241
    v_mfma_f32_16x16x32_bf16 v[200:203], a[76:79], a[160:163], v[200:203]
    v_mfma_f32_16x16x32_bf16 v[200:203], a[72:75], a[144:147], v[200:203]
    s_waitcnt vmcnt(9)
    s_waitcnt lgkmcnt(0)
    s_barrier
    ds_read_b64_tr_b16 a[68:69], v12 offset:8448
    v_mfma_f32_16x16x32_bf16 v[196:199], a[72:75], a[140:143], v[196:199]
    ds_read_b64_tr_b16 a[70:71], v12 offset:8704
    v_mfma_f32_16x16x32_bf16 v[196:199], a[76:79], a[156:159], v[196:199]
    ds_read_b64_tr_b16 a[64:65], v12 offset:0
    v_mfma_f32_16x16x32_bf16 v[192:195], a[76:79], a[152:155], v[192:195]
    ds_read_b64_tr_b16 a[66:67], v12 offset:256
    v_mfma_f32_16x16x32_bf16 v[192:195], a[72:75], a[136:139], v[192:195]
    ds_read_b64_tr_b16 a[76:77], v12 offset:25344
    v_mfma_f32_16x16x32_bf16 v[208:211], a[80:83], a[136:139], v[208:211]
    ds_read_b64_tr_b16 a[78:79], v12 offset:25600
    v_mfma_f32_16x16x32_bf16 v[208:211], a[84:87], a[152:155], v[208:211]
    ds_read_b64_tr_b16 a[72:73], v12 offset:16896
    v_mfma_f32_16x16x32_bf16 v[212:215], a[84:87], a[156:159], v[212:215]
    ds_read_b64_tr_b16 a[74:75], v12 offset:17152
    v_mfma_f32_16x16x32_bf16 v[212:215], a[80:83], a[140:143], v[212:215]
    v_accvgpr_read_b32 v3, a242
    v_mfma_f32_16x16x32_bf16 v[216:219], a[80:83], a[144:147], v[216:219]
    v_mfma_f32_16x16x32_bf16 v[216:219], a[84:87], a[160:163], v[216:219]
    v_mfma_f32_16x16x32_bf16 v[220:223], a[84:87], a[164:167], v[220:223]
    ds_read_b64_tr_b16 a[84:85], v12 offset:8480
    v_mfma_f32_16x16x32_bf16 v[220:223], a[80:83], a[148:151], v[220:223]
    ds_read_b64_tr_b16 a[86:87], v12 offset:8736
    v_mfma_f32_16x16x32_bf16 v[236:239], a[88:91], a[148:151], v[236:239]
    ds_read_b64_tr_b16 a[80:81], v12 offset:32
    v_mfma_f32_16x16x32_bf16 v[236:239], a[92:95], a[164:167], v[236:239]
    ds_read_b64_tr_b16 a[82:83], v12 offset:288
    v_mfma_f32_16x16x32_bf16 v[232:235], a[92:95], a[160:163], v[232:235]
    v_accvgpr_read_b32 v4, a243
    v_mfma_f32_16x16x32_bf16 v[232:235], a[88:91], a[144:147], v[232:235]
    v_mfma_f32_16x16x32_bf16 v[228:231], a[88:91], a[140:143], v[228:231]
    v_mfma_f32_16x16x32_bf16 v[228:231], a[92:95], a[156:159], v[228:231]
    v_mfma_f32_16x16x32_bf16 v[224:227], a[92:95], a[152:155], v[224:227]
    ds_read_b64_tr_b16 a[92:93], v12 offset:25376
    v_mfma_f32_16x16x32_bf16 v[224:227], a[88:91], a[136:139], v[224:227]
    ds_read_b64_tr_b16 a[94:95], v12 offset:25632
    v_mfma_f32_16x16x32_bf16 v[240:243], a[96:99], a[136:139], v[240:243]
    ds_read_b64_tr_b16 a[88:89], v12 offset:16928
    v_mfma_f32_16x16x32_bf16 v[240:243], a[100:103], a[152:155], v[240:243]
    ds_read_b64_tr_b16 a[90:91], v12 offset:17184
    v_mfma_f32_16x16x32_bf16 v[244:247], a[100:103], a[156:159], v[244:247]
    v_mfma_f32_16x16x32_bf16 v[244:247], a[96:99], a[140:143], v[244:247]
    v_accvgpr_read_b32 v5, a244
    v_mfma_f32_16x16x32_bf16 v[248:251], a[96:99], a[144:147], v[248:251]
    v_mfma_f32_16x16x32_bf16 v[248:251], a[100:103], a[160:163], v[248:251]
    v_mfma_f32_16x16x32_bf16 v[252:255], a[100:103], a[164:167], v[252:255]
    ds_read_b64_tr_b16 a[100:101], v12 offset:8512
    v_mfma_f32_16x16x32_bf16 v[252:255], a[96:99], a[148:151], v[252:255]
    ds_read_b64_tr_b16 a[102:103], v12 offset:8768
    v_mfma_f32_16x16x32_bf16 a[12:15], a[104:107], a[148:151], a[12:15]
    ds_read_b64_tr_b16 a[96:97], v12 offset:64
    v_mfma_f32_16x16x32_bf16 a[12:15], a[108:111], a[164:167], a[12:15]
    ds_read_b64_tr_b16 a[98:99], v12 offset:320
    v_mfma_f32_16x16x32_bf16 a[8:11], a[108:111], a[160:163], a[8:11]
    v_mfma_f32_16x16x32_bf16 a[8:11], a[104:107], a[144:147], a[8:11]
    v_accvgpr_read_b32 v6, a245
    v_mfma_f32_16x16x32_bf16 a[4:7], a[104:107], a[140:143], a[4:7]
    v_mfma_f32_16x16x32_bf16 a[4:7], a[108:111], a[156:159], a[4:7]
    v_mfma_f32_16x16x32_bf16 a[0:3], a[108:111], a[152:155], a[0:3]
    ds_read_b64_tr_b16 a[108:109], v12 offset:25408
    v_mfma_f32_16x16x32_bf16 a[0:3], a[104:107], a[136:139], a[0:3]
    ds_read_b64_tr_b16 a[110:111], v12 offset:25664
    v_mfma_f32_16x16x32_bf16 a[16:19], a[112:115], a[136:139], a[16:19]
    ds_read_b64_tr_b16 a[104:105], v12 offset:16960
    v_mfma_f32_16x16x32_bf16 a[16:19], a[116:119], a[152:155], a[16:19]
    ds_read_b64_tr_b16 a[106:107], v12 offset:17216
    v_mfma_f32_16x16x32_bf16 a[20:23], a[116:119], a[156:159], a[20:23]
    v_mfma_f32_16x16x32_bf16 a[20:23], a[112:115], a[140:143], a[20:23]
    v_mfma_f32_16x16x32_bf16 a[24:27], a[112:115], a[144:147], a[24:27]
    v_accvgpr_read_b32 v7, a246
    v_mfma_f32_16x16x32_bf16 a[24:27], a[116:119], a[160:163], a[24:27]
    v_mfma_f32_16x16x32_bf16 a[28:31], a[116:119], a[164:167], a[28:31]
    ds_read_b64_tr_b16 a[116:117], v12 offset:8544
    v_mfma_f32_16x16x32_bf16 a[28:31], a[112:115], a[148:151], a[28:31]
    ds_read_b64_tr_b16 a[118:119], v12 offset:8800
    v_mfma_f32_16x16x32_bf16 a[44:47], a[148:151], a[120:123], a[44:47]
    ds_read_b64_tr_b16 a[112:113], v12 offset:96
    v_mfma_f32_16x16x32_bf16 a[44:47], a[164:167], a[124:127], a[44:47]
    ds_read_b64_tr_b16 a[114:115], v12 offset:352
    v_mfma_f32_16x16x32_bf16 a[40:43], a[160:163], a[124:127], a[40:43]
    v_mfma_f32_16x16x32_bf16 a[40:43], a[144:147], a[120:123], a[40:43]
    v_mfma_f32_16x16x32_bf16 a[36:39], a[140:143], a[120:123], a[36:39]
    v_accvgpr_read_b32 v8, a247
    v_mfma_f32_16x16x32_bf16 a[36:39], a[156:159], a[124:127], a[36:39]
    v_mfma_f32_16x16x32_bf16 a[32:35], a[152:155], a[124:127], a[32:35]
    ds_read_b64_tr_b16 a[124:125], v12 offset:25440
    v_mfma_f32_16x16x32_bf16 a[32:35], a[136:139], a[120:123], a[32:35]
    ds_read_b64_tr_b16 a[126:127], v12 offset:25696
    v_mfma_f32_16x16x32_bf16 a[48:51], a[136:139], a[128:131], a[48:51]
    ds_read_b64_tr_b16 a[120:121], v12 offset:16992
    v_mfma_f32_16x16x32_bf16 a[48:51], a[152:155], a[132:135], a[48:51]
    ds_read_b64_tr_b16 a[122:123], v12 offset:17248
    v_mfma_f32_16x16x32_bf16 a[52:55], a[156:159], a[132:135], a[52:55]
    v_mfma_f32_16x16x32_bf16 a[52:55], a[140:143], a[128:131], a[52:55]
    v_mfma_f32_16x16x32_bf16 a[56:59], a[144:147], a[128:131], a[56:59]
    v_mfma_f32_16x16x32_bf16 a[56:59], a[160:163], a[132:135], a[56:59]
    v_mfma_f32_16x16x32_bf16 a[60:63], a[164:167], a[132:135], a[60:63]
    ds_read_b64_tr_b16 a[132:133], v12 offset:8576
    v_mfma_f32_16x16x32_bf16 a[60:63], a[148:151], a[128:131], a[60:63]
    ds_read_b64_tr_b16 a[134:135], v12 offset:8832
    ds_read_b64_tr_b16 a[128:129], v12 offset:128
    ds_read_b64_tr_b16 a[130:131], v12 offset:384
    s_waitcnt vmcnt(0) lgkmcnt(6)
    v_mfma_f32_16x16x32_bf16 v[32:35], a[64:67], a[168:171], v[32:35]
    v_mfma_f32_16x16x32_bf16 v[32:35], a[68:71], a[184:187], v[32:35]
    s_add_u32 s78, s77, s72
    s_xor_b32 s72, s54, 0
    v_mfma_f32_16x16x32_bf16 v[36:39], a[68:71], a[188:191], v[36:39]
    v_mfma_f32_16x16x32_bf16 v[36:39], a[64:67], a[172:175], v[36:39]
    v_mfma_f32_16x16x32_bf16 v[40:43], a[64:67], a[176:179], v[40:43]
    v_mfma_f32_16x16x32_bf16 v[40:43], a[68:71], a[192:195], v[40:43]
    s_add_u32 m0, s76, 0
    v_mfma_f32_16x16x32_bf16 v[44:47], a[68:71], a[196:199], v[44:47]
    ds_read_b64_tr_b16 a[68:69], v12 offset:25472
    v_mfma_f32_16x16x32_bf16 v[44:47], a[64:67], a[180:183], v[44:47]
    ds_read_b64_tr_b16 a[70:71], v12 offset:25728
    v_mfma_f32_16x16x32_bf16 v[60:63], a[72:75], a[180:183], v[60:63]
    ds_read_b64_tr_b16 a[64:65], v12 offset:17024
    v_mfma_f32_16x16x32_bf16 v[60:63], a[76:79], a[196:199], v[60:63]
    ds_read_b64_tr_b16 a[66:67], v12 offset:17280
    v_mfma_f32_16x16x32_bf16 v[56:59], a[76:79], a[192:195], v[56:59]
    buffer_load_dwordx4 v1, s[68:71], s78 offen offset:0 lds
    v_mfma_f32_16x16x32_bf16 v[56:59], a[72:75], a[176:179], v[56:59]
    v_mfma_f32_16x16x32_bf16 v[52:55], a[72:75], a[172:175], v[52:55]
    v_mfma_f32_16x16x32_bf16 v[52:55], a[76:79], a[188:191], v[52:55]
    buffer_load_dwordx4 v2, s[68:71], s78 offen offset:1024 lds
    v_mfma_f32_16x16x32_bf16 v[48:51], a[76:79], a[184:187], v[48:51]
    ds_read_b64_tr_b16 a[76:77], v12 offset:8608
    v_mfma_f32_16x16x32_bf16 v[48:51], a[72:75], a[168:171], v[48:51]
    ds_read_b64_tr_b16 a[78:79], v12 offset:8864
    v_mfma_f32_16x16x32_bf16 v[64:67], a[80:83], a[168:171], v[64:67]
    ds_read_b64_tr_b16 a[72:73], v12 offset:160
    v_mfma_f32_16x16x32_bf16 v[64:67], a[84:87], a[184:187], v[64:67]
    ds_read_b64_tr_b16 a[74:75], v12 offset:416
    v_mfma_f32_16x16x32_bf16 v[68:71], a[84:87], a[188:191], v[68:71]
    buffer_load_dwordx4 v3, s[68:71], s78 offen offset:2048 lds
    v_mfma_f32_16x16x32_bf16 v[68:71], a[80:83], a[172:175], v[68:71]
    v_mfma_f32_16x16x32_bf16 v[72:75], a[80:83], a[176:179], v[72:75]
    v_mfma_f32_16x16x32_bf16 v[72:75], a[84:87], a[192:195], v[72:75]
    buffer_load_dwordx4 v4, s[68:71], s78 offen offset:3072 lds
    v_mfma_f32_16x16x32_bf16 v[76:79], a[84:87], a[196:199], v[76:79]
    ds_read_b64_tr_b16 a[84:85], v12 offset:25504
    v_mfma_f32_16x16x32_bf16 v[76:79], a[80:83], a[180:183], v[76:79]
    ds_read_b64_tr_b16 a[86:87], v12 offset:25760
    v_mfma_f32_16x16x32_bf16 v[92:95], a[88:91], a[180:183], v[92:95]
    ds_read_b64_tr_b16 a[80:81], v12 offset:17056
    v_mfma_f32_16x16x32_bf16 v[92:95], a[92:95], a[196:199], v[92:95]
    ds_read_b64_tr_b16 a[82:83], v12 offset:17312
    v_mfma_f32_16x16x32_bf16 v[88:91], a[92:95], a[192:195], v[88:91]
    s_add_u32 m0, s76, 4096
    v_mfma_f32_16x16x32_bf16 v[88:91], a[88:91], a[176:179], v[88:91]
    v_mfma_f32_16x16x32_bf16 v[84:87], a[88:91], a[172:175], v[84:87]
    v_mfma_f32_16x16x32_bf16 v[84:87], a[92:95], a[188:191], v[84:87]
    buffer_load_dwordx4 v5, s[68:71], s78 offen offset:0 lds
    v_mfma_f32_16x16x32_bf16 v[80:83], a[92:95], a[184:187], v[80:83]
    ds_read_b64_tr_b16 a[92:93], v12 offset:8640
    v_mfma_f32_16x16x32_bf16 v[80:83], a[88:91], a[168:171], v[80:83]
    ds_read_b64_tr_b16 a[94:95], v12 offset:8896
    v_mfma_f32_16x16x32_bf16 v[96:99], a[96:99], a[168:171], v[96:99]
    ds_read_b64_tr_b16 a[88:89], v12 offset:192
    v_mfma_f32_16x16x32_bf16 v[96:99], a[100:103], a[184:187], v[96:99]
    ds_read_b64_tr_b16 a[90:91], v12 offset:448
    v_mfma_f32_16x16x32_bf16 v[100:103], a[100:103], a[188:191], v[100:103]
    buffer_load_dwordx4 v6, s[68:71], s78 offen offset:1024 lds
    v_mfma_f32_16x16x32_bf16 v[100:103], a[96:99], a[172:175], v[100:103]
    v_mfma_f32_16x16x32_bf16 v[104:107], a[96:99], a[176:179], v[104:107]
    v_mfma_f32_16x16x32_bf16 v[104:107], a[100:103], a[192:195], v[104:107]
    buffer_load_dwordx4 v7, s[68:71], s78 offen offset:2048 lds
    v_mfma_f32_16x16x32_bf16 v[108:111], a[100:103], a[196:199], v[108:111]
    ds_read_b64_tr_b16 a[100:101], v12 offset:25536
    v_mfma_f32_16x16x32_bf16 v[108:111], a[96:99], a[180:183], v[108:111]
    ds_read_b64_tr_b16 a[102:103], v12 offset:25792
    v_mfma_f32_16x16x32_bf16 v[124:127], a[104:107], a[180:183], v[124:127]
    ds_read_b64_tr_b16 a[96:97], v12 offset:17088
    v_mfma_f32_16x16x32_bf16 v[124:127], a[108:111], a[196:199], v[124:127]
    ds_read_b64_tr_b16 a[98:99], v12 offset:17344
    v_mfma_f32_16x16x32_bf16 v[120:123], a[108:111], a[192:195], v[120:123]
    buffer_load_dwordx4 v8, s[68:71], s78 offen offset:3072 lds
    v_mfma_f32_16x16x32_bf16 v[120:123], a[104:107], a[176:179], v[120:123]
    v_mfma_f32_16x16x32_bf16 v[116:119], a[104:107], a[172:175], v[116:119]
    v_mfma_f32_16x16x32_bf16 v[116:119], a[108:111], a[188:191], v[116:119]
    s_add_u32 s78, s77, s73
    s_xor_b32 s73, s54, 262144
    v_mfma_f32_16x16x32_bf16 v[112:115], a[108:111], a[184:187], v[112:115]
    ds_read_b64_tr_b16 a[108:109], v12 offset:8672
    v_mfma_f32_16x16x32_bf16 v[112:115], a[104:107], a[168:171], v[112:115]
    ds_read_b64_tr_b16 a[110:111], v12 offset:8928
    v_mfma_f32_16x16x32_bf16 v[128:131], a[112:115], a[168:171], v[128:131]
    ds_read_b64_tr_b16 a[104:105], v12 offset:224
    v_mfma_f32_16x16x32_bf16 v[128:131], a[116:119], a[184:187], v[128:131]
    ds_read_b64_tr_b16 a[106:107], v12 offset:480
    v_mfma_f32_16x16x32_bf16 v[132:135], a[116:119], a[188:191], v[132:135]
    s_add_u32 m0, s76, 16384
    v_mfma_f32_16x16x32_bf16 v[132:135], a[112:115], a[172:175], v[132:135]
    v_mfma_f32_16x16x32_bf16 v[136:139], a[112:115], a[176:179], v[136:139]
    v_mfma_f32_16x16x32_bf16 v[136:139], a[116:119], a[192:195], v[136:139]
    buffer_load_dwordx4 v1, s[68:71], s78 offen offset:0 lds
    v_mfma_f32_16x16x32_bf16 v[140:143], a[116:119], a[196:199], v[140:143]
    ds_read_b64_tr_b16 a[116:117], v12 offset:25568
    v_mfma_f32_16x16x32_bf16 v[140:143], a[112:115], a[180:183], v[140:143]
    ds_read_b64_tr_b16 a[118:119], v12 offset:25824
    s_waitcnt lgkmcnt(6)
    v_mfma_f32_16x16x32_bf16 v[156:159], a[120:123], a[180:183], v[156:159]
    ds_read_b64_tr_b16 a[112:113], v12 offset:17120
    v_mfma_f32_16x16x32_bf16 v[156:159], a[124:127], a[196:199], v[156:159]
    ds_read_b64_tr_b16 a[114:115], v12 offset:17376
    v_mfma_f32_16x16x32_bf16 v[152:155], a[124:127], a[192:195], v[152:155]
    buffer_load_dwordx4 v2, s[68:71], s78 offen offset:1024 lds
    v_mfma_f32_16x16x32_bf16 v[152:155], a[120:123], a[176:179], v[152:155]
    v_mfma_f32_16x16x32_bf16 v[148:151], a[120:123], a[172:175], v[148:151]
    v_mfma_f32_16x16x32_bf16 v[148:151], a[124:127], a[188:191], v[148:151]
    buffer_load_dwordx4 v3, s[68:71], s78 offen offset:2048 lds
    v_mfma_f32_16x16x32_bf16 v[144:147], a[124:127], a[184:187], v[144:147]
    ds_read_b128 a[124:127], v16 offset:0
    v_mfma_f32_16x16x32_bf16 v[144:147], a[120:123], a[168:171], v[144:147]
    ds_read_b128 a[120:123], v15 offset:0
    v_mfma_f32_16x16x32_bf16 v[160:163], a[128:131], a[168:171], v[160:163]
    v_mfma_f32_16x16x32_bf16 v[160:163], a[132:135], a[184:187], v[160:163]
    buffer_load_dwordx4 v4, s[68:71], s78 offen offset:3072 lds
    v_mfma_f32_16x16x32_bf16 v[164:167], a[132:135], a[188:191], v[164:167]
    v_mfma_f32_16x16x32_bf16 v[164:167], a[128:131], a[172:175], v[164:167]
    v_mfma_f32_16x16x32_bf16 v[168:171], a[128:131], a[176:179], v[168:171]
    v_mfma_f32_16x16x32_bf16 v[168:171], a[132:135], a[192:195], v[168:171]
    v_mfma_f32_16x16x32_bf16 v[172:175], a[132:135], a[196:199], v[172:175]
    ds_read_b128 a[132:135], v16 offset:2048
    v_mfma_f32_16x16x32_bf16 v[172:175], a[128:131], a[180:183], v[172:175]
    ds_read_b128 a[128:131], v15 offset:2048
    v_mfma_f32_16x16x32_bf16 v[176:179], a[64:67], a[168:171], v[176:179]
    v_mfma_f32_16x16x32_bf16 v[176:179], a[68:71], a[184:187], v[176:179]
    s_add_u32 m0, s76, 20480
    v_mfma_f32_16x16x32_bf16 v[180:183], a[68:71], a[188:191], v[180:183]
    v_mfma_f32_16x16x32_bf16 v[180:183], a[64:67], a[172:175], v[180:183]
    v_mfma_f32_16x16x32_bf16 v[184:187], a[64:67], a[176:179], v[184:187]
    v_mfma_f32_16x16x32_bf16 v[184:187], a[68:71], a[192:195], v[184:187]
    v_mfma_f32_16x16x32_bf16 v[188:191], a[68:71], a[196:199], v[188:191]
    v_mfma_f32_16x16x32_bf16 v[188:191], a[64:67], a[180:183], v[188:191]
    buffer_load_dwordx4 v5, s[68:71], s78 offen offset:0 lds
    v_mfma_f32_16x16x32_bf16 v[204:207], a[72:75], a[180:183], v[204:207]
    v_mfma_f32_16x16x32_bf16 v[204:207], a[76:79], a[196:199], v[204:207]
    v_mfma_f32_16x16x32_bf16 v[200:203], a[76:79], a[192:195], v[200:203]
    v_mfma_f32_16x16x32_bf16 v[200:203], a[72:75], a[176:179], v[200:203]
    v_mfma_f32_16x16x32_bf16 v[196:199], a[72:75], a[172:175], v[196:199]
    v_mfma_f32_16x16x32_bf16 v[196:199], a[76:79], a[188:191], v[196:199]
    buffer_load_dwordx4 v6, s[68:71], s78 offen offset:1024 lds
    v_mfma_f32_16x16x32_bf16 v[192:195], a[76:79], a[184:187], v[192:195]
    v_mfma_f32_16x16x32_bf16 v[192:195], a[72:75], a[168:171], v[192:195]
    v_mfma_f32_16x16x32_bf16 v[208:211], a[80:83], a[168:171], v[208:211]
    v_mfma_f32_16x16x32_bf16 v[208:211], a[84:87], a[184:187], v[208:211]
    v_mfma_f32_16x16x32_bf16 v[212:215], a[84:87], a[188:191], v[212:215]
    v_mfma_f32_16x16x32_bf16 v[212:215], a[80:83], a[172:175], v[212:215]
    buffer_load_dwordx4 v7, s[68:71], s78 offen offset:2048 lds
    v_mfma_f32_16x16x32_bf16 v[216:219], a[80:83], a[176:179], v[216:219]
    v_mfma_f32_16x16x32_bf16 v[216:219], a[84:87], a[192:195], v[216:219]
    v_mfma_f32_16x16x32_bf16 v[220:223], a[84:87], a[196:199], v[220:223]
    v_mfma_f32_16x16x32_bf16 v[220:223], a[80:83], a[180:183], v[220:223]
    v_mfma_f32_16x16x32_bf16 v[236:239], a[88:91], a[180:183], v[236:239]
    v_mfma_f32_16x16x32_bf16 v[236:239], a[92:95], a[196:199], v[236:239]
    buffer_load_dwordx4 v8, s[68:71], s78 offen offset:3072 lds
    v_mfma_f32_16x16x32_bf16 v[232:235], a[92:95], a[192:195], v[232:235]
    v_mfma_f32_16x16x32_bf16 v[232:235], a[88:91], a[176:179], v[232:235]
    v_mfma_f32_16x16x32_bf16 v[228:231], a[88:91], a[172:175], v[228:231]
    v_mfma_f32_16x16x32_bf16 v[228:231], a[92:95], a[188:191], v[228:231]
    v_mfma_f32_16x16x32_bf16 v[224:227], a[92:95], a[184:187], v[224:227]
    v_mfma_f32_16x16x32_bf16 v[224:227], a[88:91], a[168:171], v[224:227]
    s_add_u32 s78, s77, s74
    s_xor_b32 s74, s54, 524288
    v_mfma_f32_16x16x32_bf16 v[240:243], a[96:99], a[168:171], v[240:243]
    v_mfma_f32_16x16x32_bf16 v[240:243], a[100:103], a[184:187], v[240:243]
    v_mfma_f32_16x16x32_bf16 v[244:247], a[100:103], a[188:191], v[244:247]
    v_mfma_f32_16x16x32_bf16 v[244:247], a[96:99], a[172:175], v[244:247]
    v_mfma_f32_16x16x32_bf16 v[248:251], a[96:99], a[176:179], v[248:251]
    v_mfma_f32_16x16x32_bf16 v[248:251], a[100:103], a[192:195], v[248:251]
    v_mfma_f32_16x16x32_bf16 v[252:255], a[100:103], a[196:199], v[252:255]
    s_add_u32 m0, s76, 32768
    v_mfma_f32_16x16x32_bf16 v[252:255], a[96:99], a[180:183], v[252:255]
    s_waitcnt lgkmcnt(6)
    v_mfma_f32_16x16x32_bf16 a[12:15], a[104:107], a[180:183], a[12:15]
    v_mfma_f32_16x16x32_bf16 a[12:15], a[108:111], a[196:199], a[12:15]
    v_mfma_f32_16x16x32_bf16 a[8:11], a[108:111], a[192:195], a[8:11]
    v_mfma_f32_16x16x32_bf16 a[8:11], a[104:107], a[176:179], a[8:11]
    v_mfma_f32_16x16x32_bf16 a[4:7], a[104:107], a[172:175], a[4:7]
    buffer_load_dwordx4 v1, s[68:71], s78 offen offset:0 lds
    v_mfma_f32_16x16x32_bf16 a[4:7], a[108:111], a[188:191], a[4:7]
    v_mfma_f32_16x16x32_bf16 a[0:3], a[108:111], a[184:187], a[0:3]
    v_mfma_f32_16x16x32_bf16 a[0:3], a[104:107], a[168:171], a[0:3]
    s_waitcnt lgkmcnt(4)
    v_mfma_f32_16x16x32_bf16 a[16:19], a[112:115], a[168:171], a[16:19]
    v_mfma_f32_16x16x32_bf16 a[16:19], a[116:119], a[184:187], a[16:19]
    v_mfma_f32_16x16x32_bf16 a[20:23], a[116:119], a[188:191], a[20:23]
    buffer_load_dwordx4 v2, s[68:71], s78 offen offset:1024 lds
    v_mfma_f32_16x16x32_bf16 a[20:23], a[112:115], a[172:175], a[20:23]
    v_mfma_f32_16x16x32_bf16 a[24:27], a[112:115], a[176:179], a[24:27]
    v_mfma_f32_16x16x32_bf16 a[24:27], a[116:119], a[192:195], a[24:27]
    v_mfma_f32_16x16x32_bf16 a[28:31], a[116:119], a[196:199], a[28:31]
    v_mfma_f32_16x16x32_bf16 a[28:31], a[112:115], a[180:183], a[28:31]
    s_waitcnt lgkmcnt(2)
    v_mfma_f32_16x16x32_bf16 a[44:47], a[180:183], a[120:123], a[44:47]
    buffer_load_dwordx4 v3, s[68:71], s78 offen offset:2048 lds
    v_mfma_f32_16x16x32_bf16 a[44:47], a[196:199], a[124:127], a[44:47]
    v_mfma_f32_16x16x32_bf16 a[40:43], a[192:195], a[124:127], a[40:43]
    v_mfma_f32_16x16x32_bf16 a[40:43], a[176:179], a[120:123], a[40:43]
    v_mfma_f32_16x16x32_bf16 a[36:39], a[172:175], a[120:123], a[36:39]
    v_mfma_f32_16x16x32_bf16 a[36:39], a[188:191], a[124:127], a[36:39]
    v_mfma_f32_16x16x32_bf16 a[32:35], a[184:187], a[124:127], a[32:35]
    buffer_load_dwordx4 v4, s[68:71], s78 offen offset:3072 lds
    v_mfma_f32_16x16x32_bf16 a[32:35], a[168:171], a[120:123], a[32:35]
    s_waitcnt lgkmcnt(0)
    v_mfma_f32_16x16x32_bf16 a[48:51], a[168:171], a[128:131], a[48:51]
    v_mfma_f32_16x16x32_bf16 a[48:51], a[184:187], a[132:135], a[48:51]
    v_mfma_f32_16x16x32_bf16 a[52:55], a[188:191], a[132:135], a[52:55]
    v_mfma_f32_16x16x32_bf16 a[52:55], a[172:175], a[128:131], a[52:55]
    v_mfma_f32_16x16x32_bf16 a[56:59], a[176:179], a[128:131], a[56:59]
    v_mfma_f32_16x16x32_bf16 a[56:59], a[192:195], a[132:135], a[56:59]
    v_mfma_f32_16x16x32_bf16 a[60:63], a[196:199], a[132:135], a[60:63]
    v_mfma_f32_16x16x32_bf16 a[60:63], a[180:183], a[128:131], a[60:63]
L_k2_epiA:
    v_accvgpr_read_b32 v2, a200
    v_accvgpr_read_b32 v3, a201
    s_nop 7
    v_accvgpr_read_b32 v12, a32
    v_accvgpr_read_b32 v13, a48
    v_accvgpr_read_b32 v14, a33
    v_accvgpr_read_b32 v15, a49
    v_pk_fma_f32 v[14:15], v[12:13], v[2:3], v[14:15] op_sel_hi:[1,0,1]
    v_pk_fma_f32 v[14:15], v[12:13], v[2:3], v[14:15] op_sel:[1,1,0] op_sel_hi:[0,1,1] neg_lo:[0,1,0]
    v_accvgpr_read_b32 v12, a34
    v_accvgpr_read_b32 v13, a50
    v_pk_fma_f32 v[12:13], v[14:15], v[2:3], v[12:13] op_sel_hi:[1,0,1]
    v_pk_fma_f32 v[12:13], v[14:15], v[2:3], v[12:13] op_sel:[1,1,0] op_sel_hi:[0,1,1] neg_lo:[0,1,0]
    v_accvgpr_read_b32 v14, a35
    v_accvgpr_read_b32 v15, a51
    v_pk_fma_f32 v[14:15], v[12:13], v[2:3], v[14:15] op_sel_hi:[1,0,1]
    v_pk_fma_f32 v[14:15], v[12:13], v[2:3], v[14:15] op_sel:[1,1,0] op_sel_hi:[0,1,1] neg_lo:[0,1,0]
    v_accvgpr_read_b32 v12, a36
    v_accvgpr_read_b32 v13, a52
    v_pk_fma_f32 v[12:13], v[14:15], v[2:3], v[12:13] op_sel_hi:[1,0,1]
    v_pk_fma_f32 v[12:13], v[14:15], v[2:3], v[12:13] op_sel:[1,1,0] op_sel_hi:[0,1,1] neg_lo:[0,1,0]
    v_accvgpr_read_b32 v14, a37
    v_accvgpr_read_b32 v15, a53
    v_pk_fma_f32 v[14:15], v[12:13], v[2:3], v[14:15] op_sel_hi:[1,0,1]
    v_pk_fma_f32 v[14:15], v[12:13], v[2:3], v[14:15] op_sel:[1,1,0] op_sel_hi:[0,1,1] neg_lo:[0,1,0]
    v_accvgpr_read_b32 v12, a38
    v_accvgpr_read_b32 v13, a54
    v_pk_fma_f32 v[12:13], v[14:15], v[2:3], v[12:13] op_sel_hi:[1,0,1]
    v_pk_fma_f32 v[12:13], v[14:15], v[2:3], v[12:13] op_sel:[1,1,0] op_sel_hi:[0,1,1] neg_lo:[0,1,0]
    v_accvgpr_read_b32 v14, a39
    v_accvgpr_read_b32 v15, a55
    v_pk_fma_f32 v[14:15], v[12:13], v[2:3], v[14:15] op_sel_hi:[1,0,1]
    v_pk_fma_f32 v[14:15], v[12:13], v[2:3], v[14:15] op_sel:[1,1,0] op_sel_hi:[0,1,1] neg_lo:[0,1,0]
    v_accvgpr_read_b32 v12, a40
    v_accvgpr_read_b32 v13, a56
    v_pk_fma_f32 v[12:13], v[14:15], v[2:3], v[12:13] op_sel_hi:[1,0,1]
    v_pk_fma_f32 v[12:13], v[14:15], v[2:3], v[12:13] op_sel:[1,1,0] op_sel_hi:[0,1,1] neg_lo:[0,1,0]
    v_accvgpr_read_b32 v14, a41
    v_accvgpr_read_b32 v15, a57
    v_pk_fma_f32 v[14:15], v[12:13], v[2:3], v[14:15] op_sel_hi:[1,0,1]
    v_pk_fma_f32 v[14:15], v[12:13], v[2:3], v[14:15] op_sel:[1,1,0] op_sel_hi:[0,1,1] neg_lo:[0,1,0]
    v_accvgpr_read_b32 v12, a42
    v_accvgpr_read_b32 v13, a58
    v_pk_fma_f32 v[12:13], v[14:15], v[2:3], v[12:13] op_sel_hi:[1,0,1]
    v_pk_fma_f32 v[12:13], v[14:15], v[2:3], v[12:13] op_sel:[1,1,0] op_sel_hi:[0,1,1] neg_lo:[0,1,0]
    v_accvgpr_read_b32 v14, a43
    v_accvgpr_read_b32 v15, a59
    v_pk_fma_f32 v[14:15], v[12:13], v[2:3], v[14:15] op_sel_hi:[1,0,1]
    v_pk_fma_f32 v[14:15], v[12:13], v[2:3], v[14:15] op_sel:[1,1,0] op_sel_hi:[0,1,1] neg_lo:[0,1,0]
    v_accvgpr_read_b32 v12, a44
    v_accvgpr_read_b32 v13, a60
    v_pk_fma_f32 v[12:13], v[14:15], v[2:3], v[12:13] op_sel_hi:[1,0,1]
    v_pk_fma_f32 v[12:13], v[14:15], v[2:3], v[12:13] op_sel:[1,1,0] op_sel_hi:[0,1,1] neg_lo:[0,1,0]
    v_accvgpr_read_b32 v14, a45
    v_accvgpr_read_b32 v15, a61
    v_pk_fma_f32 v[14:15], v[12:13], v[2:3], v[14:15] op_sel_hi:[1,0,1]
    v_pk_fma_f32 v[14:15], v[12:13], v[2:3], v[14:15] op_sel:[1,1,0] op_sel_hi:[0,1,1] neg_lo:[0,1,0]
    v_accvgpr_read_b32 v12, a46
    v_accvgpr_read_b32 v13, a62
    v_pk_fma_f32 v[12:13], v[14:15], v[2:3], v[12:13] op_sel_hi:[1,0,1]
    v_pk_fma_f32 v[12:13], v[14:15], v[2:3], v[12:13] op_sel:[1,1,0] op_sel_hi:[0,1,1] neg_lo:[0,1,0]
    v_accvgpr_read_b32 v14, a47
    v_accvgpr_read_b32 v15, a63
    v_pk_fma_f32 v[14:15], v[12:13], v[2:3], v[14:15] op_sel_hi:[1,0,1]
    v_pk_fma_f32 v[14:15], v[12:13], v[2:3], v[14:15] op_sel:[1,1,0] op_sel_hi:[0,1,1] neg_lo:[0,1,0]
    v_lshrrev_b32 v12, 4, v0
    v_mul_u32_u24 v12, 640, v12
    v_and_b32_e64 v1, 15, v0
    v_lshl_add_u32 v1, v1, 3, v12
    ds_write_b64 v1, v[14:15] offset:45056
    s_waitcnt lgkmcnt(0)
    s_barrier
    s_cmp_eq_u32 s64, 0
    s_cbranch_scc1 L_noxe
    s_mov_b32 s16, s50
    s_mov_b32 s17, s51
    s_mov_b32 s18, 4194304
    s_mov_b32 s19, 0x00020000
    v_bfe_u32 v12, v0, 2, 4
    v_lshlrev_b32 v12, 11, v12
    v_and_b32 v13, 3, v0
    v_lshl_add_u32 v12, v13, 4, v12
    s_lshl_b32 s3, s61, 8
    s_lshl_b32 s4, s62, 7
    s_add_u32 s3, s3, s4
    s_lshl_b32 s4, s65, 17
    s_add_u32 s3, s3, s4
    s_lshl_b32 s4, s26, 13
    s_add_u32 m0, s4, 131072
    s_nop 0
    buffer_load_dwordx4 v12, s[16:19], s3 offen lds
    s_add_u32 s3, s3, 32768
    s_add_u32 m0, s4, 132096
    s_nop 0
    buffer_load_dwordx4 v12, s[16:19], s3 offen lds
    s_add_u32 s3, s3, 32768
    s_add_u32 m0, s4, 133120
    s_nop 0
    buffer_load_dwordx4 v12, s[16:19], s3 offen lds
    s_add_u32 s3, s3, 32768
    s_add_u32 m0, s4, 134144
    s_nop 0
    buffer_load_dwordx4 v12, s[16:19], s3 offen lds
    s_add_u32 s3, s3, 32768
L_noxe:
    v_and_b32 v12, 63, v0
    v_min_u32 v12, 15, v12
    v_lshlrev_b32 v12, 3, v12
    s_lshl_b32 s39, s24, 14
    s_lshl_b32 s3, s38, 4
    s_add_u32 s39, s39, s3
    s_add_u32 s39, s39, 35651584
    s_cmp_ge_u32 s26, 1
    s_cbranch_scc1 L_k2_nox1A
    ds_read_b64 a[64:65], v12 offset:45056
    ds_read_b64 a[66:67], v12 offset:45696
    ds_read_b64 a[68:69], v12 offset:46336
    ds_read_b64 a[70:71], v12 offset:46976
    ds_read_b64 a[72:73], v12 offset:47616
    ds_read_b64 a[74:75], v12 offset:48256
    ds_read_b64 a[76:77], v12 offset:48896
    ds_read_b64 a[78:79], v12 offset:49536
    ds_read_b64 a[80:81], v12 offset:50176
    ds_read_b64 a[82:83], v12 offset:50816
    ds_read_b64 a[84:85], v12 offset:51456
    ds_read_b64 a[86:87], v12 offset:52096
    ds_read_b64 a[88:89], v12 offset:52736
    ds_read_b64 a[90:91], v12 offset:53376
    ds_read_b64 a[92:93], v12 offset:54016
    ds_read_b64 a[94:95], v12 offset:54656
    v_accvgpr_read_b32 v14, a230
    v_accvgpr_read_b32 v15, a231
    v_mov_b32 v16, 0
    v_mov_b32 v17, 0
    ds_write_b64 v12, v[16:17] offset:55296
    s_waitcnt lgkmcnt(0)
    v_accvgpr_read_b32 v18, a64
    v_accvgpr_read_b32 v19, a65
    v_pk_fma_f32 v[18:19], v[16:17], v[14:15], v[18:19] op_sel_hi:[1,0,1]
    v_pk_fma_f32 v[18:19], v[16:17], v[14:15], v[18:19] op_sel:[1,1,0] op_sel_hi:[0,1,1] neg_lo:[0,1,0]
    ds_write_b64 v12, v[18:19] offset:55936
    v_accvgpr_read_b32 v20, a66
    v_accvgpr_read_b32 v21, a67
    v_pk_fma_f32 v[20:21], v[18:19], v[14:15], v[20:21] op_sel_hi:[1,0,1]
    v_pk_fma_f32 v[20:21], v[18:19], v[14:15], v[20:21] op_sel:[1,1,0] op_sel_hi:[0,1,1] neg_lo:[0,1,0]
    ds_write_b64 v12, v[20:21] offset:56576
    v_accvgpr_read_b32 v22, a68
    v_accvgpr_read_b32 v23, a69
    v_pk_fma_f32 v[22:23], v[20:21], v[14:15], v[22:23] op_sel_hi:[1,0,1]
    v_pk_fma_f32 v[22:23], v[20:21], v[14:15], v[22:23] op_sel:[1,1,0] op_sel_hi:[0,1,1] neg_lo:[0,1,0]
    ds_write_b64 v12, v[22:23] offset:57216
    v_accvgpr_read_b32 v16, a70
    v_accvgpr_read_b32 v17, a71
    v_pk_fma_f32 v[16:17], v[22:23], v[14:15], v[16:17] op_sel_hi:[1,0,1]
    v_pk_fma_f32 v[16:17], v[22:23], v[14:15], v[16:17] op_sel:[1,1,0] op_sel_hi:[0,1,1] neg_lo:[0,1,0]
    ds_write_b64 v12, v[16:17] offset:57856
    v_accvgpr_read_b32 v18, a72
    v_accvgpr_read_b32 v19, a73
    v_pk_fma_f32 v[18:19], v[16:17], v[14:15], v[18:19] op_sel_hi:[1,0,1]
    v_pk_fma_f32 v[18:19], v[16:17], v[14:15], v[18:19] op_sel:[1,1,0] op_sel_hi:[0,1,1] neg_lo:[0,1,0]
    ds_write_b64 v12, v[18:19] offset:58496
    v_accvgpr_read_b32 v20, a74
    v_accvgpr_read_b32 v21, a75
    v_pk_fma_f32 v[20:21], v[18:19], v[14:15], v[20:21] op_sel_hi:[1,0,1]
    v_pk_fma_f32 v[20:21], v[18:19], v[14:15], v[20:21] op_sel:[1,1,0] op_sel_hi:[0,1,1] neg_lo:[0,1,0]
    ds_write_b64 v12, v[20:21] offset:59136
    v_accvgpr_read_b32 v22, a76
    v_accvgpr_read_b32 v23, a77
    v_pk_fma_f32 v[22:23], v[20:21], v[14:15], v[22:23] op_sel_hi:[1,0,1]
    v_pk_fma_f32 v[22:23], v[20:21], v[14:15], v[22:23] op_sel:[1,1,0] op_sel_hi:[0,1,1] neg_lo:[0,1,0]
    ds_write_b64 v12, v[22:23] offset:59776
    v_accvgpr_read_b32 v16, a78
    v_accvgpr_read_b32 v17, a79
    v_pk_fma_f32 v[16:17], v[22:23], v[14:15], v[16:17] op_sel_hi:[1,0,1]
    v_pk_fma_f32 v[16:17], v[22:23], v[14:15], v[16:17] op_sel:[1,1,0] op_sel_hi:[0,1,1] neg_lo:[0,1,0]
    ds_write_b64 v12, v[16:17] offset:60416
    v_accvgpr_read_b32 v18, a80
    v_accvgpr_read_b32 v19, a81
    v_pk_fma_f32 v[18:19], v[16:17], v[14:15], v[18:19] op_sel_hi:[1,0,1]
    v_pk_fma_f32 v[18:19], v[16:17], v[14:15], v[18:19] op_sel:[1,1,0] op_sel_hi:[0,1,1] neg_lo:[0,1,0]
    ds_write_b64 v12, v[18:19] offset:61056
    v_accvgpr_read_b32 v20, a82
    v_accvgpr_read_b32 v21, a83
    v_pk_fma_f32 v[20:21], v[18:19], v[14:15], v[20:21] op_sel_hi:[1,0,1]
    v_pk_fma_f32 v[20:21], v[18:19], v[14:15], v[20:21] op_sel:[1,1,0] op_sel_hi:[0,1,1] neg_lo:[0,1,0]
    ds_write_b64 v12, v[20:21] offset:61696
    v_accvgpr_read_b32 v22, a84
    v_accvgpr_read_b32 v23, a85
    v_pk_fma_f32 v[22:23], v[20:21], v[14:15], v[22:23] op_sel_hi:[1,0,1]
    v_pk_fma_f32 v[22:23], v[20:21], v[14:15], v[22:23] op_sel:[1,1,0] op_sel_hi:[0,1,1] neg_lo:[0,1,0]
    ds_write_b64 v12, v[22:23] offset:62336
    v_accvgpr_read_b32 v16, a86
    v_accvgpr_read_b32 v17, a87
    v_pk_fma_f32 v[16:17], v[22:23], v[14:15], v[16:17] op_sel_hi:[1,0,1]
    v_pk_fma_f32 v[16:17], v[22:23], v[14:15], v[16:17] op_sel:[1,1,0] op_sel_hi:[0,1,1] neg_lo:[0,1,0]
    ds_write_b64 v12, v[16:17] offset:62976
    v_accvgpr_read_b32 v18, a88
    v_accvgpr_read_b32 v19, a89
    v_pk_fma_f32 v[18:19], v[16:17], v[14:15], v[18:19] op_sel_hi:[1,0,1]
    v_pk_fma_f32 v[18:19], v[16:17], v[14:15], v[18:19] op_sel:[1,1,0] op_sel_hi:[0,1,1] neg_lo:[0,1,0]
    ds_write_b64 v12, v[18:19] offset:63616
    v_accvgpr_read_b32 v20, a90
    v_accvgpr_read_b32 v21, a91
    v_pk_fma_f32 v[20:21], v[18:19], v[14:15], v[20:21] op_sel_hi:[1,0,1]
    v_pk_fma_f32 v[20:21], v[18:19], v[14:15], v[20:21] op_sel:[1,1,0] op_sel_hi:[0,1,1] neg_lo:[0,1,0]
    ds_write_b64 v12, v[20:21] offset:64256
    v_accvgpr_read_b32 v22, a92
    v_accvgpr_read_b32 v23, a93
    v_pk_fma_f32 v[22:23], v[20:21], v[14:15], v[22:23] op_sel_hi:[1,0,1]
    v_pk_fma_f32 v[22:23], v[20:21], v[14:15], v[22:23] op_sel:[1,1,0] op_sel_hi:[0,1,1] neg_lo:[0,1,0]
    ds_write_b64 v12, v[22:23] offset:64896
    v_accvgpr_read_b32 v16, a94
    v_accvgpr_read_b32 v17, a95
    v_pk_fma_f32 v[16:17], v[22:23], v[14:15], v[16:17] op_sel_hi:[1,0,1]
    v_pk_fma_f32 v[16:17], v[22:23], v[14:15], v[16:17] op_sel:[1,1,0] op_sel_hi:[0,1,1] neg_lo:[0,1,0]
    s_add_u32 s4, s48, s49
    v_mov_b32 v24, v16
    v_mov_b32 v25, s48
    v_mov_b32 v26, v17
    v_mov_b32 v27, s4
    v_lshlrev_b32_e64 v13, 1, v12
    s_add_u32 s3, s39, 114688
    buffer_store_dwordx4 v[24:27], v13, s[20:23], s3 offen sc1
L_k2_nox1A:
    s_mov_b32 s4, 0xc0135761
    s_mov_b32 s6, 0xbdd2d3e8
    s_mov_b32 s7, s6
    v_bfe_u32 v16, v0, 4, 1
    v_bfe_u32 v17, v0, 5, 1
    v_and_b32 v18, 15, v0
    v_lshlrev_b32_e64 v30, 10, v16
    v_lshl_add_u32 v30, v17, 8, v30
    v_lshl_add_u32 v30, v18, 4, v30
    v_mov_b32 v16, s4
    v_lshlrev_b32 v13, 1, v12
    v_mov_b32_e64 v31, v1
    s_mul_i32 s40, s36, 458752
    s_add_u32 s40, s40, 4194304
    s_lshl_b32 s41, s37, 7
    s_add_u32 s40, s40, s41
    s_add_u32 s41, s40, 4096
    s_lshl_b32 s42, s45, 6
    s_add_u32 s42, s42, s40
    s_add_u32 s43, s42, 4096
    v_pk_mul_f32 v[18:19], v[32:33], v[32:33]
    v_pk_mul_f32 v[20:21], v[34:35], v[34:35]
    v_pk_mul_f32 v[22:23], v[36:37], v[36:37]
    v_pk_mul_f32 v[28:29], v[38:39], v[38:39]
    v_pk_mul_f32 v[48:49], v[48:49], v[32:33]
    v_pk_mul_f32 v[50:51], v[50:51], v[34:35]
    v_pk_mul_f32 v[52:53], v[52:53], v[36:37]
    v_pk_mul_f32 v[54:55], v[54:55], v[38:39]
    v_pk_fma_f32 v[18:19], v[18:19], s[6:7], v[16:17] op_sel_hi:[1,1,0]
    v_pk_fma_f32 v[20:21], v[20:21], s[6:7], v[16:17] op_sel_hi:[1,1,0]
    v_pk_fma_f32 v[22:23], v[22:23], s[6:7], v[16:17] op_sel_hi:[1,1,0]
    v_pk_fma_f32 v[28:29], v[28:29], s[6:7], v[16:17] op_sel_hi:[1,1,0]
    v_pk_mul_f32 v[32:33], v[32:33], v[18:19]
    v_pk_mul_f32 v[34:35], v[34:35], v[20:21]
    v_pk_mul_f32 v[36:37], v[36:37], v[22:23]
    v_pk_mul_f32 v[38:39], v[38:39], v[28:29]
    v_exp_f32 v32, v32
    v_exp_f32 v33, v33
    v_exp_f32 v34, v34
    v_exp_f32 v35, v35
    v_exp_f32 v36, v36
    v_exp_f32 v37, v37
    v_exp_f32 v38, v38
    v_exp_f32 v39, v39
    v_pk_add_f32 v[32:33], v[32:33], 1.0 op_sel_hi:[1,0]
    v_pk_add_f32 v[34:35], v[34:35], 1.0 op_sel_hi:[1,0]
    v_pk_add_f32 v[36:37], v[36:37], 1.0 op_sel_hi:[1,0]
    v_pk_add_f32 v[38:39], v[38:39], 1.0 op_sel_hi:[1,0]
    v_rcp_f32 v32, v32
    v_rcp_f32 v33, v33
    v_rcp_f32 v34, v34
    v_rcp_f32 v35, v35
    v_rcp_f32 v36, v36
    v_rcp_f32 v37, v37
    v_rcp_f32 v38, v38
    v_rcp_f32 v39, v39
    v_pk_mul_f32 v[48:49], v[48:49], v[32:33]
    v_pk_mul_f32 v[50:51], v[50:51], v[34:35]
    v_pk_mul_f32 v[52:53], v[52:53], v[36:37]
    v_pk_mul_f32 v[54:55], v[54:55], v[38:39]
    v_cvt_pk_bf16_f32 v32, v48, v49
    v_cvt_pk_bf16_f32 v34, v52, v53
    v_cvt_pk_bf16_f32 v33, v50, v51
    v_cvt_pk_bf16_f32 v35, v54, v55
    v_permlane16_swap_b32 v32, v34
    s_nop 0
    v_permlane16_swap_b32 v33, v35
    buffer_store_dwordx4 v[32:35], v30, s[20:23], s40 offen offset:0 sc1
    v_pk_mul_f32 v[18:19], v[40:41], v[40:41]
    v_pk_mul_f32 v[20:21], v[42:43], v[42:43]
    v_pk_mul_f32 v[22:23], v[44:45], v[44:45]
    v_pk_mul_f32 v[28:29], v[46:47], v[46:47]
    v_pk_mul_f32 v[56:57], v[56:57], v[40:41]
    v_pk_mul_f32 v[58:59], v[58:59], v[42:43]
    v_pk_mul_f32 v[60:61], v[60:61], v[44:45]
    v_pk_mul_f32 v[62:63], v[62:63], v[46:47]
    v_pk_fma_f32 v[18:19], v[18:19], s[6:7], v[16:17] op_sel_hi:[1,1,0]
    v_pk_fma_f32 v[20:21], v[20:21], s[6:7], v[16:17] op_sel_hi:[1,1,0]
    v_pk_fma_f32 v[22:23], v[22:23], s[6:7], v[16:17] op_sel_hi:[1,1,0]
    v_pk_fma_f32 v[28:29], v[28:29], s[6:7], v[16:17] op_sel_hi:[1,1,0]
    v_pk_mul_f32 v[40:41], v[40:41], v[18:19]
    v_pk_mul_f32 v[42:43], v[42:43], v[20:21]
    v_pk_mul_f32 v[44:45], v[44:45], v[22:23]
    v_pk_mul_f32 v[46:47], v[46:47], v[28:29]
    v_exp_f32 v40, v40
    v_exp_f32 v41, v41
    v_exp_f32 v42, v42
    v_exp_f32 v43, v43
    v_exp_f32 v44, v44
    v_exp_f32 v45, v45
    v_exp_f32 v46, v46
    v_exp_f32_e64 v47, v47
    v_pk_add_f32 v[40:41], v[40:41], 1.0 op_sel_hi:[1,0]
    v_pk_add_f32 v[42:43], v[42:43], 1.0 op_sel_hi:[1,0]
    v_pk_add_f32 v[44:45], v[44:45], 1.0 op_sel_hi:[1,0]
    v_pk_add_f32 v[46:47], v[46:47], 1.0 op_sel_hi:[1,0]
    v_rcp_f32 v40, v40
    v_rcp_f32 v41, v41
    v_rcp_f32 v42, v42
    v_rcp_f32 v43, v43
    v_rcp_f32 v44, v44
    v_rcp_f32 v45, v45
    v_rcp_f32 v46, v46
    v_rcp_f32 v47, v47
    v_pk_mul_f32 v[56:57], v[56:57], v[40:41]
    v_pk_mul_f32 v[58:59], v[58:59], v[42:43]
    v_pk_mul_f32 v[60:61], v[60:61], v[44:45]
    v_pk_mul_f32 v[62:63], v[62:63], v[46:47]
    v_cvt_pk_bf16_f32 v40, v56, v57
    v_cvt_pk_bf16_f32 v42, v60, v61
    v_cvt_pk_bf16_f32 v41, v58, v59
    v_cvt_pk_bf16_f32 v43, v62, v63
    v_permlane16_swap_b32 v40, v42
    s_nop 0
    v_permlane16_swap_b32 v41, v43
    buffer_store_dwordx4 v[40:43], v30, s[20:23], s40 offen offset:2048 sc1
    v_pk_mul_f32 v[18:19], v[64:65], v[64:65]
    v_pk_mul_f32 v[20:21], v[66:67], v[66:67]
    v_pk_mul_f32 v[22:23], v[68:69], v[68:69]
    v_pk_mul_f32 v[28:29], v[70:71], v[70:71]
    v_pk_mul_f32 v[80:81], v[80:81], v[64:65]
    v_pk_mul_f32 v[82:83], v[82:83], v[66:67]
    v_pk_mul_f32 v[84:85], v[84:85], v[68:69]
    v_pk_mul_f32 v[86:87], v[86:87], v[70:71]
    v_pk_fma_f32 v[18:19], v[18:19], s[6:7], v[16:17] op_sel_hi:[1,1,0]
    v_pk_fma_f32 v[20:21], v[20:21], s[6:7], v[16:17] op_sel_hi:[1,1,0]
    v_pk_fma_f32 v[22:23], v[22:23], s[6:7], v[16:17] op_sel_hi:[1,1,0]
    v_pk_fma_f32 v[28:29], v[28:29], s[6:7], v[16:17] op_sel_hi:[1,1,0]
    v_pk_mul_f32 v[64:65], v[64:65], v[18:19]
    v_pk_mul_f32 v[66:67], v[66:67], v[20:21]
    v_pk_mul_f32 v[68:69], v[68:69], v[22:23]
    v_pk_mul_f32 v[70:71], v[70:71], v[28:29]
    v_exp_f32 v64, v64
    v_exp_f32 v65, v65
    v_exp_f32 v66, v66
    v_exp_f32 v67, v67
    v_exp_f32 v68, v68
    v_exp_f32 v69, v69
    v_exp_f32 v70, v70
    v_exp_f32_e64 v71, v71
    v_pk_add_f32 v[64:65], v[64:65], 1.0 op_sel_hi:[1,0]
    v_pk_add_f32 v[66:67], v[66:67], 1.0 op_sel_hi:[1,0]
    v_pk_add_f32 v[68:69], v[68:69], 1.0 op_sel_hi:[1,0]
    v_pk_add_f32 v[70:71], v[70:71], 1.0 op_sel_hi:[1,0]
    v_rcp_f32 v64, v64
    v_rcp_f32 v65, v65
    v_rcp_f32 v66, v66
    v_rcp_f32 v67, v67
    v_rcp_f32 v68, v68
    v_rcp_f32 v69, v69
    v_rcp_f32 v70, v70
    v_rcp_f32 v71, v71
    v_pk_mul_f32 v[80:81], v[80:81], v[64:65]
    v_pk_mul_f32 v[82:83], v[82:83], v[66:67]
    v_pk_mul_f32 v[84:85], v[84:85], v[68:69]
    v_pk_mul_f32 v[86:87], v[86:87], v[70:71]
    v_cvt_pk_bf16_f32 v64, v80, v81
    v_cvt_pk_bf16_f32 v66, v84, v85
    v_cvt_pk_bf16_f32 v65, v82, v83
    v_cvt_pk_bf16_f32 v67, v86, v87
    v_permlane16_swap_b32 v64, v66
    s_nop 0
    v_permlane16_swap_b32 v65, v67
    buffer_store_dwordx4 v[64:67], v30, s[20:23], s40 offen offset:512 sc1
    v_pk_mul_f32 v[18:19], v[72:73], v[72:73]
    v_pk_mul_f32 v[20:21], v[74:75], v[74:75]
    v_pk_mul_f32 v[22:23], v[76:77], v[76:77]
    v_pk_mul_f32 v[28:29], v[78:79], v[78:79]
    v_pk_mul_f32 v[88:89], v[88:89], v[72:73]
    v_pk_mul_f32 v[90:91], v[90:91], v[74:75]
    v_pk_mul_f32 v[92:93], v[92:93], v[76:77]
    v_pk_mul_f32 v[94:95], v[94:95], v[78:79]
    v_pk_fma_f32 v[18:19], v[18:19], s[6:7], v[16:17] op_sel_hi:[1,1,0]
    v_pk_fma_f32 v[20:21], v[20:21], s[6:7], v[16:17] op_sel_hi:[1,1,0]
    v_pk_fma_f32 v[22:23], v[22:23], s[6:7], v[16:17] op_sel_hi:[1,1,0]
    v_pk_fma_f32 v[28:29], v[28:29], s[6:7], v[16:17] op_sel_hi:[1,1,0]
    v_pk_mul_f32 v[72:73], v[72:73], v[18:19]
    v_pk_mul_f32 v[74:75], v[74:75], v[20:21]
    v_pk_mul_f32 v[76:77], v[76:77], v[22:23]
    v_pk_mul_f32 v[78:79], v[78:79], v[28:29]
    v_exp_f32 v72, v72
    v_exp_f32 v73, v73
    v_exp_f32 v74, v74
    v_exp_f32 v75, v75
    v_exp_f32 v76, v76
    v_exp_f32 v77, v77
    v_exp_f32 v78, v78
    v_exp_f32_e64 v79, v79
    v_pk_add_f32 v[72:73], v[72:73], 1.0 op_sel_hi:[1,0]
    v_pk_add_f32 v[74:75], v[74:75], 1.0 op_sel_hi:[1,0]
    v_pk_add_f32 v[76:77], v[76:77], 1.0 op_sel_hi:[1,0]
    v_pk_add_f32 v[78:79], v[78:79], 1.0 op_sel_hi:[1,0]
    v_rcp_f32 v72, v72
    v_rcp_f32 v73, v73
    v_rcp_f32 v74, v74
    v_rcp_f32 v75, v75
    v_rcp_f32 v76, v76
    v_rcp_f32 v77, v77
    v_rcp_f32 v78, v78
    v_rcp_f32 v79, v79
    v_pk_mul_f32 v[88:89], v[88:89], v[72:73]
    v_pk_mul_f32 v[90:91], v[90:91], v[74:75]
    v_pk_mul_f32 v[92:93], v[92:93], v[76:77]
    v_pk_mul_f32 v[94:95], v[94:95], v[78:79]
    v_cvt_pk_bf16_f32 v72, v88, v89
    v_cvt_pk_bf16_f32 v74, v92, v93
    v_cvt_pk_bf16_f32 v73, v90, v91
    v_cvt_pk_bf16_f32 v75, v94, v95
    v_permlane16_swap_b32 v72, v74
    s_nop 0
    v_permlane16_swap_b32 v73, v75
    buffer_store_dwordx4 v[72:75], v30, s[20:23], s40 offen offset:2560 sc1
    v_pk_mul_f32 v[18:19], v[96:97], v[96:97]
    v_pk_mul_f32 v[20:21], v[98:99], v[98:99]
    v_pk_mul_f32 v[22:23], v[100:101], v[100:101]
    v_pk_mul_f32 v[28:29], v[102:103], v[102:103]
    v_pk_mul_f32 v[112:113], v[112:113], v[96:97]
    v_pk_mul_f32 v[114:115], v[114:115], v[98:99]
    v_pk_mul_f32 v[116:117], v[116:117], v[100:101]
    v_pk_mul_f32 v[118:119], v[118:119], v[102:103]
    v_pk_fma_f32 v[18:19], v[18:19], s[6:7], v[16:17] op_sel_hi:[1,1,0]
    v_pk_fma_f32 v[20:21], v[20:21], s[6:7], v[16:17] op_sel_hi:[1,1,0]
    v_pk_fma_f32 v[22:23], v[22:23], s[6:7], v[16:17] op_sel_hi:[1,1,0]
    v_pk_fma_f32 v[28:29], v[28:29], s[6:7], v[16:17] op_sel_hi:[1,1,0]
    v_pk_mul_f32 v[96:97], v[96:97], v[18:19]
    v_pk_mul_f32 v[98:99], v[98:99], v[20:21]
    v_pk_mul_f32 v[100:101], v[100:101], v[22:23]
    v_pk_mul_f32 v[102:103], v[102:103], v[28:29]
    v_exp_f32 v96, v96
    v_exp_f32 v97, v97
    v_exp_f32 v98, v98
    v_exp_f32 v99, v99
    v_exp_f32 v100, v100
    v_exp_f32 v101, v101
    v_exp_f32 v102, v102
    v_exp_f32_e64 v103, v103
    v_pk_add_f32 v[96:97], v[96:97], 1.0 op_sel_hi:[1,0]
    v_pk_add_f32 v[98:99], v[98:99], 1.0 op_sel_hi:[1,0]
    v_pk_add_f32 v[100:101], v[100:101], 1.0 op_sel_hi:[1,0]
    v_pk_add_f32 v[102:103], v[102:103], 1.0 op_sel_hi:[1,0]
    v_rcp_f32 v96, v96
    v_rcp_f32 v97, v97
    v_rcp_f32 v98, v98
    v_rcp_f32 v99, v99
    v_rcp_f32 v100, v100
    v_rcp_f32 v101, v101
    v_rcp_f32 v102, v102
    v_rcp_f32 v103, v103
    v_pk_mul_f32 v[112:113], v[112:113], v[96:97]
    v_pk_mul_f32 v[114:115], v[114:115], v[98:99]
    v_pk_mul_f32 v[116:117], v[116:117], v[100:101]
    v_pk_mul_f32 v[118:119], v[118:119], v[102:103]
    v_cvt_pk_bf16_f32 v96, v112, v113
    v_cvt_pk_bf16_f32 v98, v116, v117
    v_cvt_pk_bf16_f32 v97, v114, v115
    v_cvt_pk_bf16_f32 v99, v118, v119
    v_permlane16_swap_b32 v96, v98
    s_nop 0
    v_permlane16_swap_b32 v97, v99
    buffer_store_dwordx4 v[96:99], v30, s[20:23], s41 offen offset:0 sc1
    v_pk_mul_f32 v[18:19], v[104:105], v[104:105]
    v_pk_mul_f32 v[20:21], v[106:107], v[106:107]
    v_pk_mul_f32 v[22:23], v[108:109], v[108:109]
    v_pk_mul_f32 v[28:29], v[110:111], v[110:111]
    v_pk_mul_f32 v[120:121], v[120:121], v[104:105]
    v_pk_mul_f32 v[122:123], v[122:123], v[106:107]
    v_pk_mul_f32 v[124:125], v[124:125], v[108:109]
    v_pk_mul_f32 v[126:127], v[126:127], v[110:111]
    v_pk_fma_f32 v[18:19], v[18:19], s[6:7], v[16:17] op_sel_hi:[1,1,0]
    v_pk_fma_f32 v[20:21], v[20:21], s[6:7], v[16:17] op_sel_hi:[1,1,0]
    v_pk_fma_f32 v[22:23], v[22:23], s[6:7], v[16:17] op_sel_hi:[1,1,0]
    v_pk_fma_f32 v[28:29], v[28:29], s[6:7], v[16:17] op_sel_hi:[1,1,0]
    v_pk_mul_f32 v[104:105], v[104:105], v[18:19]
    v_pk_mul_f32 v[106:107], v[106:107], v[20:21]
    v_pk_mul_f32 v[108:109], v[108:109], v[22:23]
    v_pk_mul_f32 v[110:111], v[110:111], v[28:29]
    v_exp_f32 v104, v104
    v_exp_f32 v105, v105
    v_exp_f32 v106, v106
    v_exp_f32 v107, v107
    v_exp_f32 v108, v108
    v_exp_f32 v109, v109
    v_exp_f32 v110, v110
    v_exp_f32_e64 v111, v111
    v_pk_add_f32 v[104:105], v[104:105], 1.0 op_sel_hi:[1,0]
    v_pk_add_f32 v[106:107], v[106:107], 1.0 op_sel_hi:[1,0]
    v_pk_add_f32 v[108:109], v[108:109], 1.0 op_sel_hi:[1,0]
    v_pk_add_f32 v[110:111], v[110:111], 1.0 op_sel_hi:[1,0]
    v_rcp_f32 v104, v104
    v_rcp_f32 v105, v105
    v_rcp_f32 v106, v106
    v_rcp_f32 v107, v107
    v_rcp_f32 v108, v108
    v_rcp_f32 v109, v109
    v_rcp_f32 v110, v110
    v_rcp_f32 v111, v111
    v_pk_mul_f32 v[120:121], v[120:121], v[104:105]
    v_pk_mul_f32 v[122:123], v[122:123], v[106:107]
    v_pk_mul_f32 v[124:125], v[124:125], v[108:109]
    v_pk_mul_f32 v[126:127], v[126:127], v[110:111]
    v_cvt_pk_bf16_f32 v104, v120, v121
    v_cvt_pk_bf16_f32 v106, v124, v125
    v_cvt_pk_bf16_f32 v105, v122, v123
    v_cvt_pk_bf16_f32 v107, v126, v127
    v_permlane16_swap_b32 v104, v106
    s_nop 0
    v_permlane16_swap_b32 v105, v107
    buffer_store_dwordx4 v[104:107], v30, s[20:23], s41 offen offset:2048 sc1
    v_pk_mul_f32 v[18:19], v[128:129], v[128:129]
    v_pk_mul_f32 v[20:21], v[130:131], v[130:131]
    v_pk_mul_f32 v[22:23], v[132:133], v[132:133]
    v_pk_mul_f32 v[28:29], v[134:135], v[134:135]
    v_pk_mul_f32 v[144:145], v[144:145], v[128:129]
    v_pk_mul_f32 v[146:147], v[146:147], v[130:131]
    v_pk_mul_f32 v[148:149], v[148:149], v[132:133]
    v_pk_mul_f32 v[150:151], v[150:151], v[134:135]
    v_pk_fma_f32 v[18:19], v[18:19], s[6:7], v[16:17] op_sel_hi:[1,1,0]
    v_pk_fma_f32 v[20:21], v[20:21], s[6:7], v[16:17] op_sel_hi:[1,1,0]
    v_pk_fma_f32 v[22:23], v[22:23], s[6:7], v[16:17] op_sel_hi:[1,1,0]
    v_pk_fma_f32 v[28:29], v[28:29], s[6:7], v[16:17] op_sel_hi:[1,1,0]
    v_pk_mul_f32 v[128:129], v[128:129], v[18:19]
    v_pk_mul_f32 v[130:131], v[130:131], v[20:21]
    v_pk_mul_f32 v[132:133], v[132:133], v[22:23]
    v_pk_mul_f32 v[134:135], v[134:135], v[28:29]
    v_exp_f32 v128, v128
    v_exp_f32 v129, v129
    v_exp_f32 v130, v130
    v_exp_f32 v131, v131
    v_exp_f32 v132, v132
    v_exp_f32 v133, v133
    v_exp_f32 v134, v134
    v_exp_f32_e64 v135, v135
    v_pk_add_f32 v[128:129], v[128:129], 1.0 op_sel_hi:[1,0]
    v_pk_add_f32 v[130:131], v[130:131], 1.0 op_sel_hi:[1,0]
    v_pk_add_f32 v[132:133], v[132:133], 1.0 op_sel_hi:[1,0]
    v_pk_add_f32 v[134:135], v[134:135], 1.0 op_sel_hi:[1,0]
    v_rcp_f32 v128, v128
    v_rcp_f32 v129, v129
    v_rcp_f32 v130, v130
    v_rcp_f32 v131, v131
    v_rcp_f32 v132, v132
    v_rcp_f32 v133, v133
    v_rcp_f32 v134, v134
    v_rcp_f32 v135, v135
    v_pk_mul_f32 v[144:145], v[144:145], v[128:129]
    v_pk_mul_f32 v[146:147], v[146:147], v[130:131]
    v_pk_mul_f32 v[148:149], v[148:149], v[132:133]
    v_pk_mul_f32 v[150:151], v[150:151], v[134:135]
    v_cvt_pk_bf16_f32 v128, v144, v145
    v_cvt_pk_bf16_f32 v130, v148, v149
    v_cvt_pk_bf16_f32 v129, v146, v147
    v_cvt_pk_bf16_f32 v131, v150, v151
    v_permlane16_swap_b32 v128, v130
    s_nop 0
    v_permlane16_swap_b32 v129, v131
    buffer_store_dwordx4 v[128:131], v30, s[20:23], s41 offen offset:512 sc1
    v_pk_mul_f32 v[18:19], v[136:137], v[136:137]
    v_pk_mul_f32 v[20:21], v[138:139], v[138:139]
    v_pk_mul_f32 v[22:23], v[140:141], v[140:141]
    v_pk_mul_f32 v[28:29], v[142:143], v[142:143]
    v_pk_mul_f32 v[152:153], v[152:153], v[136:137]
    v_pk_mul_f32 v[154:155], v[154:155], v[138:139]
    v_pk_mul_f32 v[156:157], v[156:157], v[140:141]
    v_pk_mul_f32 v[158:159], v[158:159], v[142:143]
    v_pk_fma_f32 v[18:19], v[18:19], s[6:7], v[16:17] op_sel_hi:[1,1,0]
    v_pk_fma_f32 v[20:21], v[20:21], s[6:7], v[16:17] op_sel_hi:[1,1,0]
    v_pk_fma_f32 v[22:23], v[22:23], s[6:7], v[16:17] op_sel_hi:[1,1,0]
    v_pk_fma_f32 v[28:29], v[28:29], s[6:7], v[16:17] op_sel_hi:[1,1,0]
    v_pk_mul_f32 v[136:137], v[136:137], v[18:19]
    v_pk_mul_f32 v[138:139], v[138:139], v[20:21]
    v_pk_mul_f32 v[140:141], v[140:141], v[22:23]
    v_pk_mul_f32 v[142:143], v[142:143], v[28:29]
    v_exp_f32 v136, v136
    v_exp_f32 v137, v137
    v_exp_f32 v138, v138
    v_exp_f32 v139, v139
    v_exp_f32 v140, v140
    v_exp_f32 v141, v141
    v_exp_f32 v142, v142
    v_exp_f32_e64 v143, v143
    v_pk_add_f32 v[136:137], v[136:137], 1.0 op_sel_hi:[1,0]
    v_pk_add_f32 v[138:139], v[138:139], 1.0 op_sel_hi:[1,0]
    v_pk_add_f32 v[140:141], v[140:141], 1.0 op_sel_hi:[1,0]
    v_pk_add_f32 v[142:143], v[142:143], 1.0 op_sel_hi:[1,0]
    v_rcp_f32 v136, v136
    v_rcp_f32 v137, v137
    v_rcp_f32 v138, v138
    v_rcp_f32 v139, v139
    v_rcp_f32 v140, v140
    v_rcp_f32 v141, v141
    v_rcp_f32 v142, v142
    v_rcp_f32 v143, v143
    v_pk_mul_f32 v[152:153], v[152:153], v[136:137]
    v_pk_mul_f32 v[154:155], v[154:155], v[138:139]
    v_pk_mul_f32 v[156:157], v[156:157], v[140:141]
    v_pk_mul_f32 v[158:159], v[158:159], v[142:143]
    v_cvt_pk_bf16_f32 v136, v152, v153
    v_cvt_pk_bf16_f32 v138, v156, v157
    v_cvt_pk_bf16_f32 v137, v154, v155
    v_cvt_pk_bf16_f32 v139, v158, v159
    v_permlane16_swap_b32 v136, v138
    s_nop 0
    v_permlane16_swap_b32 v137, v139
    buffer_store_dwordx4 v[136:139], v30, s[20:23], s41 offen offset:2560 sc1
    v_pk_mul_f32 v[18:19], v[160:161], v[160:161]
    v_pk_mul_f32 v[20:21], v[162:163], v[162:163]
    v_pk_mul_f32 v[22:23], v[164:165], v[164:165]
    v_pk_mul_f32 v[28:29], v[166:167], v[166:167]
    v_pk_mul_f32 v[176:177], v[176:177], v[160:161]
    v_pk_mul_f32 v[178:179], v[178:179], v[162:163]
    v_pk_mul_f32 v[180:181], v[180:181], v[164:165]
    v_pk_mul_f32 v[182:183], v[182:183], v[166:167]
    v_pk_fma_f32 v[18:19], v[18:19], s[6:7], v[16:17] op_sel_hi:[1,1,0]
    v_pk_fma_f32 v[20:21], v[20:21], s[6:7], v[16:17] op_sel_hi:[1,1,0]
    v_pk_fma_f32 v[22:23], v[22:23], s[6:7], v[16:17] op_sel_hi:[1,1,0]
    v_pk_fma_f32 v[28:29], v[28:29], s[6:7], v[16:17] op_sel_hi:[1,1,0]
    v_pk_mul_f32 v[160:161], v[160:161], v[18:19]
    v_pk_mul_f32 v[162:163], v[162:163], v[20:21]
    v_pk_mul_f32 v[164:165], v[164:165], v[22:23]
    v_pk_mul_f32 v[166:167], v[166:167], v[28:29]
    v_exp_f32 v160, v160
    v_exp_f32 v161, v161
    v_exp_f32 v162, v162
    v_exp_f32 v163, v163
    v_exp_f32 v164, v164
    v_exp_f32 v165, v165
    v_exp_f32 v166, v166
    v_exp_f32_e64 v167, v167
    v_pk_add_f32 v[160:161], v[160:161], 1.0 op_sel_hi:[1,0]
    v_pk_add_f32 v[162:163], v[162:163], 1.0 op_sel_hi:[1,0]
    v_pk_add_f32 v[164:165], v[164:165], 1.0 op_sel_hi:[1,0]
    v_pk_add_f32 v[166:167], v[166:167], 1.0 op_sel_hi:[1,0]
    v_rcp_f32 v160, v160
    v_rcp_f32 v161, v161
    v_rcp_f32 v162, v162
    v_rcp_f32 v163, v163
    v_rcp_f32 v164, v164
    v_rcp_f32 v165, v165
    v_rcp_f32 v166, v166
    v_rcp_f32 v167, v167
    v_pk_mul_f32 v[176:177], v[176:177], v[160:161]
    v_pk_mul_f32 v[178:179], v[178:179], v[162:163]
    v_pk_mul_f32 v[180:181], v[180:181], v[164:165]
    v_pk_mul_f32 v[182:183], v[182:183], v[166:167]
    v_cvt_pk_bf16_f32 v160, v176, v177
    v_cvt_pk_bf16_f32 v162, v180, v181
    v_cvt_pk_bf16_f32 v161, v178, v179
    v_cvt_pk_bf16_f32 v163, v182, v183
    v_permlane16_swap_b32 v160, v162
    s_nop 0
    v_permlane16_swap_b32 v161, v163
    buffer_store_dwordx4 v[160:163], v30, s[20:23], s42 offen offset:0 sc1
    v_pk_mul_f32 v[18:19], v[168:169], v[168:169]
    v_pk_mul_f32 v[20:21], v[170:171], v[170:171]
    v_pk_mul_f32 v[22:23], v[172:173], v[172:173]
    v_pk_mul_f32 v[28:29], v[174:175], v[174:175]
    v_pk_mul_f32 v[184:185], v[184:185], v[168:169]
    v_pk_mul_f32 v[186:187], v[186:187], v[170:171]
    v_pk_mul_f32 v[188:189], v[188:189], v[172:173]
    v_pk_mul_f32 v[190:191], v[190:191], v[174:175]
    v_pk_fma_f32 v[18:19], v[18:19], s[6:7], v[16:17] op_sel_hi:[1,1,0]
    v_pk_fma_f32 v[20:21], v[20:21], s[6:7], v[16:17] op_sel_hi:[1,1,0]
    v_pk_fma_f32 v[22:23], v[22:23], s[6:7], v[16:17] op_sel_hi:[1,1,0]
    v_pk_fma_f32 v[28:29], v[28:29], s[6:7], v[16:17] op_sel_hi:[1,1,0]
    v_pk_mul_f32 v[168:169], v[168:169], v[18:19]
    v_pk_mul_f32 v[170:171], v[170:171], v[20:21]
    v_pk_mul_f32 v[172:173], v[172:173], v[22:23]
    v_pk_mul_f32 v[174:175], v[174:175], v[28:29]
    v_exp_f32 v168, v168
    v_exp_f32 v169, v169
    v_exp_f32 v170, v170
    v_exp_f32 v171, v171
    v_exp_f32 v172, v172
    v_exp_f32 v173, v173
    v_exp_f32 v174, v174
    v_exp_f32_e64 v175, v175
    v_pk_add_f32 v[168:169], v[168:169], 1.0 op_sel_hi:[1,0]
    v_pk_add_f32 v[170:171], v[170:171], 1.0 op_sel_hi:[1,0]
    v_pk_add_f32 v[172:173], v[172:173], 1.0 op_sel_hi:[1,0]
    v_pk_add_f32 v[174:175], v[174:175], 1.0 op_sel_hi:[1,0]
    v_rcp_f32 v168, v168
    v_rcp_f32 v169, v169
    v_rcp_f32 v170, v170
    v_rcp_f32 v171, v171
    v_rcp_f32 v172, v172
    v_rcp_f32 v173, v173
    v_rcp_f32 v174, v174
    v_rcp_f32 v175, v175
    v_pk_mul_f32 v[184:185], v[184:185], v[168:169]
    v_pk_mul_f32 v[186:187], v[186:187], v[170:171]
    v_pk_mul_f32 v[188:189], v[188:189], v[172:173]
    v_pk_mul_f32 v[190:191], v[190:191], v[174:175]
    v_cvt_pk_bf16_f32 v168, v184, v185
    v_cvt_pk_bf16_f32 v170, v188, v189
    v_cvt_pk_bf16_f32 v169, v186, v187
    v_cvt_pk_bf16_f32 v171, v190, v191
    v_permlane16_swap_b32 v168, v170
    s_nop 0
    v_permlane16_swap_b32 v169, v171
    buffer_store_dwordx4 v[168:171], v30, s[20:23], s42 offen offset:2048 sc1
    v_pk_mul_f32 v[18:19], v[192:193], v[192:193]
    v_pk_mul_f32 v[20:21], v[194:195], v[194:195]
    v_pk_mul_f32 v[22:23], v[196:197], v[196:197]
    v_pk_mul_f32 v[28:29], v[198:199], v[198:199]
    v_pk_mul_f32 v[208:209], v[208:209], v[192:193]
    v_pk_mul_f32 v[210:211], v[210:211], v[194:195]
    v_pk_mul_f32 v[212:213], v[212:213], v[196:197]
    v_pk_mul_f32 v[214:215], v[214:215], v[198:199]
    v_pk_fma_f32 v[18:19], v[18:19], s[6:7], v[16:17] op_sel_hi:[1,1,0]
    v_pk_fma_f32 v[20:21], v[20:21], s[6:7], v[16:17] op_sel_hi:[1,1,0]
    v_pk_fma_f32 v[22:23], v[22:23], s[6:7], v[16:17] op_sel_hi:[1,1,0]
    v_pk_fma_f32 v[28:29], v[28:29], s[6:7], v[16:17] op_sel_hi:[1,1,0]
    v_pk_mul_f32 v[192:193], v[192:193], v[18:19]
    v_pk_mul_f32 v[194:195], v[194:195], v[20:21]
    v_pk_mul_f32 v[196:197], v[196:197], v[22:23]
    v_pk_mul_f32 v[198:199], v[198:199], v[28:29]
    v_exp_f32 v192, v192
    v_exp_f32 v193, v193
    v_exp_f32 v194, v194
    v_exp_f32 v195, v195
    v_exp_f32 v196, v196
    v_exp_f32 v197, v197
    v_exp_f32 v198, v198
    v_exp_f32_e64 v199, v199
    v_pk_add_f32 v[192:193], v[192:193], 1.0 op_sel_hi:[1,0]
    v_pk_add_f32 v[194:195], v[194:195], 1.0 op_sel_hi:[1,0]
    v_pk_add_f32 v[196:197], v[196:197], 1.0 op_sel_hi:[1,0]
    v_pk_add_f32 v[198:199], v[198:199], 1.0 op_sel_hi:[1,0]
    v_rcp_f32 v192, v192
    v_rcp_f32 v193, v193
    v_rcp_f32 v194, v194
    v_rcp_f32 v195, v195
    v_rcp_f32 v196, v196
    v_rcp_f32 v197, v197
    v_rcp_f32 v198, v198
    v_rcp_f32 v199, v199
    v_pk_mul_f32 v[208:209], v[208:209], v[192:193]
    v_pk_mul_f32 v[210:211], v[210:211], v[194:195]
    v_pk_mul_f32 v[212:213], v[212:213], v[196:197]
    v_pk_mul_f32 v[214:215], v[214:215], v[198:199]
    v_cvt_pk_bf16_f32 v192, v208, v209
    v_cvt_pk_bf16_f32 v194, v212, v213
    v_cvt_pk_bf16_f32 v193, v210, v211
    v_cvt_pk_bf16_f32 v195, v214, v215
    v_permlane16_swap_b32 v192, v194
    s_nop 0
    v_permlane16_swap_b32 v193, v195
    buffer_store_dwordx4 v[192:195], v30, s[20:23], s42 offen offset:512 sc1
    s_lshl_b32 s3, s2, 7
    s_lshl_b32 s4, s26, 3
    s_add_u32 s3, s3, s4
    s_add_u32 s3, s3, 35913792
    s_waitcnt vmcnt(3)
    s_mov_b64 exec, 1
    buffer_store_dwordx2 a[248:249], off, s[20:23], s3 sc1
    s_mov_b64 exec, -1
    v_pk_mul_f32 v[18:19], v[200:201], v[200:201]
    v_pk_mul_f32 v[20:21], v[202:203], v[202:203]
    v_pk_mul_f32 v[22:23], v[204:205], v[204:205]
    v_pk_mul_f32 v[28:29], v[206:207], v[206:207]
    v_pk_mul_f32 v[216:217], v[216:217], v[200:201]
    v_pk_mul_f32 v[218:219], v[218:219], v[202:203]
    v_pk_mul_f32 v[220:221], v[220:221], v[204:205]
    v_pk_mul_f32 v[222:223], v[222:223], v[206:207]
    v_pk_fma_f32 v[18:19], v[18:19], s[6:7], v[16:17] op_sel_hi:[1,1,0]
    v_pk_fma_f32 v[20:21], v[20:21], s[6:7], v[16:17] op_sel_hi:[1,1,0]
    v_pk_fma_f32 v[22:23], v[22:23], s[6:7], v[16:17] op_sel_hi:[1,1,0]
    v_pk_fma_f32 v[28:29], v[28:29], s[6:7], v[16:17] op_sel_hi:[1,1,0]
    v_pk_mul_f32 v[200:201], v[200:201], v[18:19]
    v_pk_mul_f32 v[202:203], v[202:203], v[20:21]
    v_pk_mul_f32 v[204:205], v[204:205], v[22:23]
    v_pk_mul_f32 v[206:207], v[206:207], v[28:29]
    v_exp_f32 v200, v200
    v_exp_f32 v201, v201
    v_exp_f32 v202, v202
    v_exp_f32 v203, v203
    v_exp_f32 v204, v204
    v_exp_f32 v205, v205
    v_exp_f32 v206, v206
    v_exp_f32_e64 v207, v207
    v_pk_add_f32 v[200:201], v[200:201], 1.0 op_sel_hi:[1,0]
    v_pk_add_f32 v[202:203], v[202:203], 1.0 op_sel_hi:[1,0]
    v_pk_add_f32 v[204:205], v[204:205], 1.0 op_sel_hi:[1,0]
    v_pk_add_f32 v[206:207], v[206:207], 1.0 op_sel_hi:[1,0]
    v_rcp_f32 v200, v200
    v_rcp_f32 v201, v201
    v_rcp_f32 v202, v202
    v_rcp_f32 v203, v203
    v_rcp_f32 v204, v204
    v_rcp_f32 v205, v205
    v_rcp_f32 v206, v206
    v_rcp_f32 v207, v207
    v_pk_mul_f32 v[216:217], v[216:217], v[200:201]
    v_pk_mul_f32 v[218:219], v[218:219], v[202:203]
    v_pk_mul_f32 v[220:221], v[220:221], v[204:205]
    v_pk_mul_f32 v[222:223], v[222:223], v[206:207]
    v_cvt_pk_bf16_f32 v200, v216, v217
    v_cvt_pk_bf16_f32 v202, v220, v221
    v_cvt_pk_bf16_f32 v201, v218, v219
    v_cvt_pk_bf16_f32 v203, v222, v223
    v_permlane16_swap_b32 v200, v202
    s_nop 0
    v_permlane16_swap_b32 v201, v203
    buffer_store_dwordx4 v[200:203], v30, s[20:23], s42 offen offset:2560 sc1
    s_lshr_b32 s3, s26, 0
    s_cmp_lg_u32 s3, 1
    s_cbranch_scc1 L_k2_noelA
    s_add_u32 s3, s39, 0
    s_cmp_ge_u32 s24, 7
    s_cselect_b32 s3, s3, 0x7f000000
    buffer_load_dwordx4 v[32:35], v13, s[20:23], s3 offen sc1
    s_add_u32 s3, s39, 16384
    s_cmp_ge_u32 s24, 6
    s_cselect_b32 s3, s3, 0x7f000000
    buffer_load_dwordx4 v[36:39], v13, s[20:23], s3 offen sc1
    s_add_u32 s3, s39, 32768
    s_cmp_ge_u32 s24, 5
    s_cselect_b32 s3, s3, 0x7f000000
    buffer_load_dwordx4 v[40:43], v13, s[20:23], s3 offen sc1
    s_add_u32 s3, s39, 49152
    s_cmp_ge_u32 s24, 4
    s_cselect_b32 s3, s3, 0x7f000000
    buffer_load_dwordx4 v[44:47], v13, s[20:23], s3 offen sc1
    s_add_u32 s3, s39, 65536
    s_cmp_ge_u32 s24, 3
    s_cselect_b32 s3, s3, 0x7f000000
    buffer_load_dwordx4 v[48:51], v13, s[20:23], s3 offen sc1
    s_add_u32 s3, s39, 81920
    s_cmp_ge_u32 s24, 2
    s_cselect_b32 s3, s3, 0x7f000000
    buffer_load_dwordx4 v[52:55], v13, s[20:23], s3 offen sc1
    s_add_u32 s3, s39, 98304
    s_cmp_ge_u32 s24, 1
    s_cselect_b32 s3, s3, 0x7f000000
    buffer_load_dwordx4 v[56:59], v13, s[20:23], s3 offen sc1
L_k2_noelA:
    v_pk_mul_f32 v[18:19], v[224:225], v[224:225]
    v_pk_mul_f32 v[20:21], v[226:227], v[226:227]
    v_pk_mul_f32 v[22:23], v[228:229], v[228:229]
    v_pk_mul_f32 v[28:29], v[230:231], v[230:231]
    v_pk_mul_f32 v[240:241], v[240:241], v[224:225]
    v_pk_mul_f32 v[242:243], v[242:243], v[226:227]
    v_pk_mul_f32 v[244:245], v[244:245], v[228:229]
    v_pk_mul_f32 v[246:247], v[246:247], v[230:231]
    v_pk_fma_f32 v[18:19], v[18:19], s[6:7], v[16:17] op_sel_hi:[1,1,0]
    v_pk_fma_f32 v[20:21], v[20:21], s[6:7], v[16:17] op_sel_hi:[1,1,0]
    v_pk_fma_f32 v[22:23], v[22:23], s[6:7], v[16:17] op_sel_hi:[1,1,0]
    v_pk_fma_f32 v[28:29], v[28:29], s[6:7], v[16:17] op_sel_hi:[1,1,0]
    v_pk_mul_f32 v[224:225], v[224:225], v[18:19]
    v_pk_mul_f32 v[226:227], v[226:227], v[20:21]
    v_pk_mul_f32 v[228:229], v[228:229], v[22:23]
    v_pk_mul_f32 v[230:231], v[230:231], v[28:29]
    v_exp_f32 v224, v224
    v_exp_f32 v225, v225
    v_exp_f32 v226, v226
    v_exp_f32 v227, v227
    v_exp_f32 v228, v228
    v_exp_f32 v229, v229
    v_exp_f32 v230, v230
    v_exp_f32 v231, v231
    v_pk_add_f32 v[224:225], v[224:225], 1.0 op_sel_hi:[1,0]
    v_pk_add_f32 v[226:227], v[226:227], 1.0 op_sel_hi:[1,0]
    v_pk_add_f32 v[228:229], v[228:229], 1.0 op_sel_hi:[1,0]
    v_pk_add_f32 v[230:231], v[230:231], 1.0 op_sel_hi:[1,0]
    v_rcp_f32 v224, v224
    v_rcp_f32 v225, v225
    v_rcp_f32 v226, v226
    v_rcp_f32 v227, v227
    v_rcp_f32 v228, v228
    v_rcp_f32 v229, v229
    v_rcp_f32 v230, v230
    v_rcp_f32 v231, v231
    v_pk_mul_f32 v[240:241], v[240:241], v[224:225]
    v_pk_mul_f32 v[242:243], v[242:243], v[226:227]
    v_pk_mul_f32 v[244:245], v[244:245], v[228:229]
    v_pk_mul_f32 v[246:247], v[246:247], v[230:231]
    v_cvt_pk_bf16_f32 v224, v240, v241
    v_cvt_pk_bf16_f32 v226, v244, v245
    v_cvt_pk_bf16_f32 v225, v242, v243
    v_cvt_pk_bf16_f32 v227, v246, v247
    v_permlane16_swap_b32 v224, v226
    s_nop 0
    v_permlane16_swap_b32 v225, v227
    buffer_store_dwordx4 v[224:227], v30, s[20:23], s43 offen offset:0 sc1
    v_pk_mul_f32 v[18:19], v[232:233], v[232:233]
    v_pk_mul_f32 v[20:21], v[234:235], v[234:235]
    v_pk_mul_f32 v[22:23], v[236:237], v[236:237]
    v_pk_mul_f32 v[28:29], v[238:239], v[238:239]
    v_pk_mul_f32 v[248:249], v[248:249], v[232:233]
    v_pk_mul_f32 v[250:251], v[250:251], v[234:235]
    v_pk_mul_f32 v[252:253], v[252:253], v[236:237]
    v_pk_mul_f32 v[254:255], v[254:255], v[238:239]
    v_pk_fma_f32 v[18:19], v[18:19], s[6:7], v[16:17] op_sel_hi:[1,1,0]
    v_pk_fma_f32 v[20:21], v[20:21], s[6:7], v[16:17] op_sel_hi:[1,1,0]
    v_pk_fma_f32 v[22:23], v[22:23], s[6:7], v[16:17] op_sel_hi:[1,1,0]
    v_pk_fma_f32 v[28:29], v[28:29], s[6:7], v[16:17] op_sel_hi:[1,1,0]
    v_pk_mul_f32 v[232:233], v[232:233], v[18:19]
    v_pk_mul_f32 v[234:235], v[234:235], v[20:21]
    v_pk_mul_f32 v[236:237], v[236:237], v[22:23]
    v_pk_mul_f32 v[238:239], v[238:239], v[28:29]
    v_exp_f32 v232, v232
    v_exp_f32 v233, v233
    v_exp_f32 v234, v234
    v_exp_f32 v235, v235
    v_exp_f32 v236, v236
    v_exp_f32 v237, v237
    v_exp_f32 v238, v238
    v_exp_f32_e64 v239, v239
    v_pk_add_f32 v[232:233], v[232:233], 1.0 op_sel_hi:[1,0]
    v_pk_add_f32 v[234:235], v[234:235], 1.0 op_sel_hi:[1,0]
    v_pk_add_f32 v[236:237], v[236:237], 1.0 op_sel_hi:[1,0]
    v_pk_add_f32 v[238:239], v[238:239], 1.0 op_sel_hi:[1,0]
    v_rcp_f32 v232, v232
    v_rcp_f32 v233, v233
    v_rcp_f32 v234, v234
    v_rcp_f32 v235, v235
    v_rcp_f32 v236, v236
    v_rcp_f32 v237, v237
    v_rcp_f32 v238, v238
    v_rcp_f32 v239, v239
    v_pk_mul_f32 v[248:249], v[248:249], v[232:233]
    v_pk_mul_f32 v[250:251], v[250:251], v[234:235]
    v_pk_mul_f32 v[252:253], v[252:253], v[236:237]
    v_pk_mul_f32 v[254:255], v[254:255], v[238:239]
    v_cvt_pk_bf16_f32 v232, v248, v249
    v_cvt_pk_bf16_f32 v234, v252, v253
    v_cvt_pk_bf16_f32 v233, v250, v251
    v_cvt_pk_bf16_f32 v235, v254, v255
    v_permlane16_swap_b32 v232, v234
    s_nop 0
    v_permlane16_swap_b32 v233, v235
    buffer_store_dwordx4 v[232:235], v30, s[20:23], s43 offen offset:2048 sc1
    v_accvgpr_read_b32 v96, a0
    v_accvgpr_read_b32 v112, a16
    v_accvgpr_read_b32 v97, a1
    v_accvgpr_read_b32 v113, a17
    v_accvgpr_read_b32 v98, a2
    v_accvgpr_read_b32 v114, a18
    v_accvgpr_read_b32 v99, a3
    v_accvgpr_read_b32 v115, a19
    v_accvgpr_read_b32 v100, a4
    v_accvgpr_read_b32 v116, a20
    v_accvgpr_read_b32 v101, a5
    v_accvgpr_read_b32 v117, a21
    v_accvgpr_read_b32 v102, a6
    v_accvgpr_read_b32 v118, a22
    v_accvgpr_read_b32 v103, a7
    v_accvgpr_read_b32 v119, a23
    v_pk_mul_f32 v[18:19], v[96:97], v[96:97]
    v_pk_mul_f32 v[20:21], v[98:99], v[98:99]
    v_pk_mul_f32 v[22:23], v[100:101], v[100:101]
    v_pk_mul_f32 v[28:29], v[102:103], v[102:103]
    v_pk_mul_f32 v[112:113], v[112:113], v[96:97]
    v_pk_mul_f32 v[114:115], v[114:115], v[98:99]
    v_pk_mul_f32 v[116:117], v[116:117], v[100:101]
    v_pk_mul_f32 v[118:119], v[118:119], v[102:103]
    v_pk_fma_f32 v[18:19], v[18:19], s[6:7], v[16:17] op_sel_hi:[1,1,0]
    v_pk_fma_f32 v[20:21], v[20:21], s[6:7], v[16:17] op_sel_hi:[1,1,0]
    v_pk_fma_f32 v[22:23], v[22:23], s[6:7], v[16:17] op_sel_hi:[1,1,0]
    v_pk_fma_f32 v[28:29], v[28:29], s[6:7], v[16:17] op_sel_hi:[1,1,0]
    v_pk_mul_f32 v[96:97], v[96:97], v[18:19]
    v_pk_mul_f32 v[98:99], v[98:99], v[20:21]
    v_pk_mul_f32 v[100:101], v[100:101], v[22:23]
    v_pk_mul_f32 v[102:103], v[102:103], v[28:29]
    v_exp_f32 v96, v96
    v_exp_f32 v97, v97
    v_exp_f32 v98, v98
    v_exp_f32 v99, v99
    v_exp_f32 v100, v100
    v_exp_f32 v101, v101
    v_exp_f32 v102, v102
    v_exp_f32_e64 v103, v103
    v_pk_add_f32 v[96:97], v[96:97], 1.0 op_sel_hi:[1,0]
    v_pk_add_f32 v[98:99], v[98:99], 1.0 op_sel_hi:[1,0]
    v_pk_add_f32 v[100:101], v[100:101], 1.0 op_sel_hi:[1,0]
    v_pk_add_f32 v[102:103], v[102:103], 1.0 op_sel_hi:[1,0]
    v_rcp_f32 v96, v96
    v_rcp_f32 v97, v97
    v_rcp_f32 v98, v98
    v_rcp_f32 v99, v99
    v_rcp_f32 v100, v100
    v_rcp_f32 v101, v101
    v_rcp_f32 v102, v102
    v_rcp_f32 v103, v103
    v_pk_mul_f32 v[112:113], v[112:113], v[96:97]
    v_pk_mul_f32 v[114:115], v[114:115], v[98:99]
    v_pk_mul_f32 v[116:117], v[116:117], v[100:101]
    v_pk_mul_f32 v[118:119], v[118:119], v[102:103]
    v_cvt_pk_bf16_f32 v96, v112, v113
    v_cvt_pk_bf16_f32 v98, v116, v117
    v_cvt_pk_bf16_f32 v97, v114, v115
    v_cvt_pk_bf16_f32 v99, v118, v119
    v_permlane16_swap_b32 v96, v98
    s_nop 0
    v_permlane16_swap_b32 v97, v99
    buffer_store_dwordx4 v[96:99], v30, s[20:23], s43 offen offset:512 sc1
    v_accvgpr_read_b32 v104, a8
    v_accvgpr_read_b32 v120, a24
    v_accvgpr_read_b32 v105, a9
    v_accvgpr_read_b32 v121, a25
    v_accvgpr_read_b32 v106, a10
    v_accvgpr_read_b32 v122, a26
    v_accvgpr_read_b32 v107, a11
    v_accvgpr_read_b32 v123, a27
    v_accvgpr_read_b32 v108, a12
    v_accvgpr_read_b32 v124, a28
    v_accvgpr_read_b32 v109, a13
    v_accvgpr_read_b32 v125, a29
    v_accvgpr_read_b32 v110, a14
    v_accvgpr_read_b32 v126, a30
    v_accvgpr_read_b32 v111, a15
    v_accvgpr_read_b32 v127, a31
    v_pk_mul_f32 v[18:19], v[104:105], v[104:105]
    v_pk_mul_f32 v[20:21], v[106:107], v[106:107]
    v_pk_mul_f32 v[22:23], v[108:109], v[108:109]
    v_pk_mul_f32 v[28:29], v[110:111], v[110:111]
    v_pk_mul_f32 v[120:121], v[120:121], v[104:105]
    v_pk_mul_f32 v[122:123], v[122:123], v[106:107]
    v_pk_mul_f32 v[124:125], v[124:125], v[108:109]
    v_pk_mul_f32 v[126:127], v[126:127], v[110:111]
    v_pk_fma_f32 v[18:19], v[18:19], s[6:7], v[16:17] op_sel_hi:[1,1,0]
    v_pk_fma_f32 v[20:21], v[20:21], s[6:7], v[16:17] op_sel_hi:[1,1,0]
    v_pk_fma_f32 v[22:23], v[22:23], s[6:7], v[16:17] op_sel_hi:[1,1,0]
    v_pk_fma_f32 v[28:29], v[28:29], s[6:7], v[16:17] op_sel_hi:[1,1,0]
    v_pk_mul_f32 v[104:105], v[104:105], v[18:19]
    v_pk_mul_f32 v[106:107], v[106:107], v[20:21]
    v_pk_mul_f32 v[108:109], v[108:109], v[22:23]
    v_pk_mul_f32 v[110:111], v[110:111], v[28:29]
    v_exp_f32 v104, v104
    v_exp_f32 v105, v105
    v_exp_f32 v106, v106
    v_exp_f32 v107, v107
    v_exp_f32 v108, v108
    v_exp_f32 v109, v109
    v_exp_f32 v110, v110
    v_exp_f32_e64 v111, v111
    v_pk_add_f32 v[104:105], v[104:105], 1.0 op_sel_hi:[1,0]
    v_pk_add_f32 v[106:107], v[106:107], 1.0 op_sel_hi:[1,0]
    v_pk_add_f32 v[108:109], v[108:109], 1.0 op_sel_hi:[1,0]
    v_pk_add_f32 v[110:111], v[110:111], 1.0 op_sel_hi:[1,0]
    v_rcp_f32 v104, v104
    v_rcp_f32 v105, v105
    v_rcp_f32 v106, v106
    v_rcp_f32 v107, v107
    v_rcp_f32 v108, v108
    v_rcp_f32 v109, v109
    v_rcp_f32 v110, v110
    v_rcp_f32 v111, v111
    v_pk_mul_f32 v[120:121], v[120:121], v[104:105]
    v_pk_mul_f32 v[122:123], v[122:123], v[106:107]
    v_pk_mul_f32 v[124:125], v[124:125], v[108:109]
    v_pk_mul_f32 v[126:127], v[126:127], v[110:111]
    v_cvt_pk_bf16_f32 v104, v120, v121
    v_cvt_pk_bf16_f32 v106, v124, v125
    v_cvt_pk_bf16_f32 v105, v122, v123
    v_cvt_pk_bf16_f32 v107, v126, v127
    v_permlane16_swap_b32 v104, v106
    s_nop 0
    v_permlane16_swap_b32 v105, v107
    buffer_store_dwordx4 v[104:107], v30, s[20:23], s43 offen offset:2560 sc1
    s_lshr_b32 s3, s26, 0
    s_cmp_lg_u32 s3, 1
    s_cbranch_scc1 L_k2_nox2A
    s_mov_b32 s55, 0x40000
    s_waitcnt vmcnt(4)
L_k2_pollA:
    v_mov_b32 v18, 0
    s_add_u32 s6, s48, s49
    s_cmp_ge_u32 s24, 7
    s_cselect_b32 s4, s48, 0
    s_cselect_b32 s5, s6, 0
    v_xor_b32 v19, s4, v33
    v_xor_b32 v20, s5, v35
    v_or3_b32 v18, v18, v19, v20
    s_cmp_ge_u32 s24, 6
    s_cselect_b32 s4, s48, 0
    s_cselect_b32 s5, s6, 0
    v_xor_b32 v19, s4, v37
    v_xor_b32_e64 v20, s5, v39
    v_or3_b32 v18, v18, v19, v20
    s_cmp_ge_u32 s24, 5
    s_cselect_b32 s4, s48, 0
    s_cselect_b32 s5, s6, 0
    v_xor_b32 v19, s4, v41
    v_xor_b32_e64 v20, s5, v43
    v_or3_b32 v18, v18, v19, v20
    s_cmp_ge_u32 s24, 4
    s_cselect_b32 s4, s48, 0
    s_cselect_b32 s5, s6, 0
    v_xor_b32 v19, s4, v45
    v_xor_b32_e64 v20, s5, v47
    v_or3_b32 v18, v18, v19, v20
    s_cmp_ge_u32 s24, 3
    s_cselect_b32 s4, s48, 0
    s_cselect_b32 s5, s6, 0
    v_xor_b32 v19, s4, v49
    v_xor_b32_e64 v20, s5, v51
    v_or3_b32 v18, v18, v19, v20
    s_cmp_ge_u32 s24, 2
    s_cselect_b32 s4, s48, 0
    s_cselect_b32 s5, s6, 0
    v_xor_b32 v19, s4, v53
    v_xor_b32_e64 v20, s5, v55
    v_or3_b32 v18, v18, v19, v20
    s_cmp_ge_u32 s24, 1
    s_cselect_b32 s4, s48, 0
    s_cselect_b32 s5, s6, 0
    v_xor_b32 v19, s4, v57
    v_xor_b32_e64 v20, s5, v59
    v_or3_b32 v18, v18, v19, v20
    v_cmp_ne_u32 vcc, 0, v18
    s_cbranch_vccz L_k2_gotA
    s_sleep 1
    s_add_u32 s3, s39, 0
    s_cmp_ge_u32 s24, 7
    s_cselect_b32 s3, s3, 0x7f000000
    buffer_load_dwordx4 v[32:35], v13, s[20:23], s3 offen sc1
    s_add_u32 s3, s39, 16384
    s_cmp_ge_u32 s24, 6
    s_cselect_b32 s3, s3, 0x7f000000
    buffer_load_dwordx4 v[36:39], v13, s[20:23], s3 offen sc1
    s_add_u32 s3, s39, 32768
    s_cmp_ge_u32 s24, 5
    s_cselect_b32 s3, s3, 0x7f000000
    buffer_load_dwordx4 v[40:43], v13, s[20:23], s3 offen sc1
    s_add_u32 s3, s39, 49152
    s_cmp_ge_u32 s24, 4
    s_cselect_b32 s3, s3, 0x7f000000
    buffer_load_dwordx4 v[44:47], v13, s[20:23], s3 offen sc1
    s_add_u32 s3, s39, 65536
    s_cmp_ge_u32 s24, 3
    s_cselect_b32 s3, s3, 0x7f000000
    buffer_load_dwordx4 v[48:51], v13, s[20:23], s3 offen sc1
    s_add_u32 s3, s39, 81920
    s_cmp_ge_u32 s24, 2
    s_cselect_b32 s3, s3, 0x7f000000
    buffer_load_dwordx4 v[52:55], v13, s[20:23], s3 offen sc1
    s_add_u32 s3, s39, 98304
    s_cmp_ge_u32 s24, 1
    s_cselect_b32 s3, s3, 0x7f000000
    buffer_load_dwordx4 v[56:59], v13, s[20:23], s3 offen sc1
    s_waitcnt vmcnt(0)
    s_sub_u32 s55, s55, 1
    s_cmp_lg_u32 s55, 0
    s_cbranch_scc1 L_k2_pollA
L_k2_gotA:
    v_accvgpr_read_b32 v18, a232
    v_accvgpr_read_b32 v19, a233
    v_mov_b32 v33, v34
    v_mov_b32 v37, v38
    v_mov_b32 v41, v42
    v_mov_b32 v45, v46
    v_mov_b32 v49, v50
    v_mov_b32 v53, v54
    v_mov_b32 v57, v58
    v_pk_fma_f32 v[36:37], v[32:33], v[18:19], v[36:37] op_sel_hi:[1,0,1]
    v_pk_fma_f32 v[36:37], v[32:33], v[18:19], v[36:37] op_sel:[1,1,0] op_sel_hi:[0,1,1] neg_lo:[0,1,0]
    v_pk_fma_f32 v[40:41], v[36:37], v[18:19], v[40:41] op_sel_hi:[1,0,1]
    v_pk_fma_f32 v[40:41], v[36:37], v[18:19], v[40:41] op_sel:[1,1,0] op_sel_hi:[0,1,1] neg_lo:[0,1,0]
    v_pk_fma_f32 v[44:45], v[40:41], v[18:19], v[44:45] op_sel_hi:[1,0,1]
    v_pk_fma_f32 v[44:45], v[40:41], v[18:19], v[44:45] op_sel:[1,1,0] op_sel_hi:[0,1,1] neg_lo:[0,1,0]
    v_pk_fma_f32 v[48:49], v[44:45], v[18:19], v[48:49] op_sel_hi:[1,0,1]
    v_pk_fma_f32 v[48:49], v[44:45], v[18:19], v[48:49] op_sel:[1,1,0] op_sel_hi:[0,1,1] neg_lo:[0,1,0]
    v_pk_fma_f32 v[52:53], v[48:49], v[18:19], v[52:53] op_sel_hi:[1,0,1]
    v_pk_fma_f32 v[52:53], v[48:49], v[18:19], v[52:53] op_sel:[1,1,0] op_sel_hi:[0,1,1] neg_lo:[0,1,0]
    v_pk_fma_f32 v[56:57], v[52:53], v[18:19], v[56:57] op_sel_hi:[1,0,1]
    v_pk_fma_f32 v[56:57], v[52:53], v[18:19], v[56:57] op_sel:[1,1,0] op_sel_hi:[0,1,1] neg_lo:[0,1,0]
    ds_write_b64 v12, v[56:57] offset:36864
    s_waitcnt lgkmcnt(0)
L_k2_nox2A:
    s_lshl_b32 s3, s2, 2
    s_add_u32 s3, s3, s26
    s_cmp_lg_u32 s3, 3
    s_cbranch_scc1 L_noep
    v_and_b32 v18, 63, v0
    v_lshlrev_b32_e64 v18, 7, v18
    s_mov_b32 s55, 0x40000
L_ep:
    s_mov_b32 s3, 35913728
    buffer_load_dwordx2 v[32:33], v18, s[20:23], s3 offen sc1
    s_mov_b32 s3, 35921920
    buffer_load_dwordx2 v[34:35], v18, s[20:23], s3 offen sc1
    s_mov_b32 s3, 35930112
    buffer_load_dwordx2 v[36:37], v18, s[20:23], s3 offen sc1
    s_mov_b32 s3, 35938304
    buffer_load_dwordx2 v[38:39], v18, s[20:23], s3 offen sc1
    s_waitcnt vmcnt(0)
    s_mov_b64 s[4:5], 0
    v_cmp_ne_u64 vcc, s[48:49], v[32:33]
    s_nop 1
    s_or_b64 s[4:5], s[4:5], vcc
    v_cmp_ne_u64 vcc, s[48:49], v[34:35]
    s_nop 1
    s_or_b64 s[4:5], s[4:5], vcc
    v_cmp_ne_u64 vcc, s[48:49], v[36:37]
    s_nop 1
    s_or_b64 s[4:5], s[4:5], vcc
    v_cmp_ne_u64 vcc, s[48:49], v[38:39]
    s_nop 1
    s_or_b64 s[4:5], s[4:5], vcc
    s_cbranch_scc0 L_epok
    s_sub_u32 s55, s55, 1
    s_cmp_lg_u32 s55, 0
    s_cbranch_scc1 L_ep
L_epok:
    s_mov_b32 s3, 36175872
    buffer_store_dwordx2 a[248:249], off, s[20:23], s3 sc1
L_noep:
    s_cmp_eq_u32 s64, 0
    s_cbranch_scc1 L_finAs
    s_load_dwordx2 s[44:45], s[0:1], 64
    s_load_dwordx2 s[46:47], s[0:1], 104
    s_load_dwordx2 s[58:59], s[0:1], 0
    v_accvgpr_read_b32 v1, a240
    v_accvgpr_read_b32 v2, a241
    v_accvgpr_read_b32 v3, a242
    v_accvgpr_read_b32 v4, a243
    v_accvgpr_read_b32 v5, a244
    v_accvgpr_read_b32 v6, a245
    v_accvgpr_read_b32 v7, a246
    v_accvgpr_read_b32 v8, a247
    v_and_b32 v18, 63, v0
    v_lshlrev_b32_e64 v9, 4, v18
    s_xor_b32 s80, s79, 0
    s_lshl_b32 s80, s80, 13
    s_xor_b32 s81, s79, 1
    s_lshl_b32 s81, s81, 13
    s_xor_b32 s82, s79, 2
    s_lshl_b32 s82, s82, 13
    s_xor_b32 s83, s79, 3
    s_lshl_b32 s83, s83, 13
    s_lshl_b32 s3, s60, 3
    s_add_u32 s3, s3, s61
    s_lshl_b32 s86, s2, 7
    s_add_u32 s86, s86, 35913728
    s_lshl_b32 s87, s3, 16
    s_lshl_b32 s3, s26, 14
    s_add_u32 s87, s87, s3
    s_add_u32 s87, s87, 27262976
    s_lshr_b32 s90, s60, 1
    s_lshl_b32 s90, s90, 12
    s_add_u32 s93, s90, 35979264
    s_add_u32 s28, s90, 35946496
    s_and_b32 s3, s2, 1
    s_lshl_b32 s3, s3, 7
    s_add_u32 s90, s90, s3
    s_add_u32 s90, s90, 35913792
    s_and_b32 s3, s65, 3
    s_lshl_b32 s3, s3, 3
    s_add_u32 s90, s90, s3
    s_add_u32 s93, s93, s3
    s_lshl_b32 s33, s2, 7
    s_lshl_b32 s3, s26, 3
    s_add_u32 s33, s33, s3
    s_add_u32 s33, s33, 35979264
    s_lshl_b32 s89, s26, 13
    s_add_u32 s89, s89, 131072
    s_mul_i32 s92, s65, 458752
    s_add_u32 s92, s92, 4194304
    s_mul_i32 s84, s62, 196608
    s_add_u32 s84, s84, s92
    s_add_u32 s84, s84, 65536
    s_mov_b32 s3, 828807272
    s_cmp_eq_u32 s62, 0
    s_cselect_b32 s29, 805638736, s3
    s_mov_b32 s32, s29
    v_bfe_u32 v19, v18, 2, 2
    v_lshrrev_b32 v20, 4, v18
    v_lshl_add_u32 v21, v20, 3, v19
    v_lshlrev_b32 v21, 8, v21
    v_and_b32 v22, 3, v18
    v_lshl_add_u32 v21, v22, 3, v21
    s_lshl_b32 s3, s62, 16
    v_add_u32 v21, s3, v21
    v_bfe_u32 v19, v18, 2, 3
    s_lshl_b32 s3, s62, 2
    v_xor_b32 v19, s3, v19
    v_xor_b32_e64 v20, 0, v19
    v_lshl_add_u32 v10, v20, 5, v21
    v_xor_b32_e64 v20, 1, v19
    v_lshl_add_u32 v11, v20, 5, v21
    v_xor_b32_e64 v20, 2, v19
    v_lshl_add_u32 v12, v20, 5, v21
    v_xor_b32_e64 v20, 3, v19
    v_lshl_add_u32 v13, v20, 5, v21
    v_xor_b32_e64 v20, 4, v19
    v_lshl_add_u32 v14, v20, 5, v21
    v_xor_b32_e64 v20, 5, v19
    v_lshl_add_u32 v15, v20, 5, v21
    v_xor_b32_e64 v20, 6, v19
    v_lshl_add_u32 v16, v20, 5, v21
    v_xor_b32_e64 v20, 7, v19
    v_lshl_add_u32 v17, v20, 5, v21
    s_lshl_b32 s88, s65, 5
    s_lshl_b32 s3, s61, 2
    s_add_u32 s88, s88, s3
    s_lshl_b32 s3, s62, 1
    s_add_u32 s88, s88, s3
    s_lshl_b32 s88, s88, 12
    s_add_u32 s88, s88, 0
    s_lshl_b32 s3, s61, 8
    s_lshl_b32 s4, s62, 7
    s_add_u32 s3, s3, s4
    s_add_u32 s3, s3, 0
    s_lshl_b32 s39, s65, 17
    s_add_u32 s39, s39, s3
    v_and_b32 v19, 15, v18
    v_lshrrev_b32 v26, 4, v18
    v_lshlrev_b32 v26, 16, v26
    v_lshl_add_u32 v23, v19, 2, v26
    v_add_u32_e64 v20, s89, v9
    v_xor_b32 v21, 0x4000, v20
    v_bfe_u32 v19, v18, 1, 1
    v_lshlrev_b32 v19, 8, v19
    v_lshrrev_b32 v26, 2, v18
    v_lshl_add_u32 v19, v26, 4, v19
    v_lshlrev_b32 v24, 11, v26
    v_and_b32 v26, 1, v18
    v_lshl_add_u32 v19, v26, 3, v19
    v_add_u32 v22, s89, v19
    v_and_b32 v26, 3, v18
    v_lshl_add_u32 v24, v26, 4, v24
    v_lshrrev_b32 v19, 4, v18
    v_lshlrev_b32 v19, 10, v19
    v_lshl_add_u32 v19, v26, 3, v19
    v_bfe_u32 v26, v18, 2, 2
    v_lshl_add_u32 v19, v26, 6, v19
    v_add_u32 v25, s89, v19
    s_mov_b32 s80, 0
    s_mov_b32 s81, 16384
    s_mov_b32 s82, 32768
    s_mov_b32 s83, 49152
    s_lshl_b32 s27, s79, 14
    s_add_u32 s66, s87, 9437184
    s_xor_b32 s67, s86, 128
    s_add_u32 s67, s67, 98304
    s_waitcnt lgkmcnt(0)
    s_mov_b32 s12, s58
    s_mov_b32 s13, s59
    s_mov_b32 s14, 4194304
    s_mov_b32 s15, 0x00020000
    v_and_b32 v92, 15, v0
    v_lshlrev_b32 v92, 8, v92
    buffer_load_dwordx2 v[26:27], v92, s[20:23], s90 offen sc1
    s_waitcnt vmcnt(0) lgkmcnt(0)
    s_barrier
    s_cmp_lg_u32 s26, 0
    s_cbranch_scc1 L_sighAf
    s_lshl_b32 s3, s2, 7
    s_add_u32 s3, s3, 35946496
    s_mov_b64 exec, 1
    buffer_store_dwordx2 a[248:249], off, s[20:23], s3 sc1
    s_mov_b64 exec, -1
L_sighAf:
    v_cmp_ne_u64 vcc, s[48:49], v[26:27]
    s_nop 1
    s_mov_b64 s[30:31], vcc
    s_cbranch_vccnz L_noflAf
    s_add_u32 s85, s84, s80
    s_xor_b32 s80, s27, 0
    buffer_load_dwordx4 a[64:67], v9, s[20:23], s85 offen offset:0 sc1
    buffer_load_dwordx4 a[68:71], v9, s[20:23], s85 offen offset:1024 sc1
    buffer_load_dwordx4 a[72:75], v9, s[20:23], s85 offen offset:2048 sc1
    buffer_load_dwordx4 a[76:79], v9, s[20:23], s85 offen offset:3072 sc1
    s_add_u32 s85, s85, 4096
    buffer_load_dwordx4 a[80:83], v9, s[20:23], s85 offen offset:0 sc1
    buffer_load_dwordx4 a[84:87], v9, s[20:23], s85 offen offset:1024 sc1
    buffer_load_dwordx4 a[88:91], v9, s[20:23], s85 offen offset:2048 sc1
    buffer_load_dwordx4 a[92:95], v9, s[20:23], s85 offen offset:3072 sc1
    s_add_u32 s85, s84, s81
    s_xor_b32 s81, s27, 16384
    buffer_load_dwordx4 a[96:99], v9, s[20:23], s85 offen offset:0 sc1
    buffer_load_dwordx4 a[100:103], v9, s[20:23], s85 offen offset:1024 sc1
    buffer_load_dwordx4 a[104:107], v9, s[20:23], s85 offen offset:2048 sc1
    buffer_load_dwordx4 a[108:111], v9, s[20:23], s85 offen offset:3072 sc1
    s_add_u32 m0, s89, 4096
    s_nop 0
    buffer_load_dwordx4 v9, s[20:23], s88 offen offset:0 sc1 lds
    buffer_load_dwordx4 v9, s[20:23], s88 offen offset:1024 sc1 lds
    buffer_load_dwordx4 v9, s[20:23], s88 offen offset:2048 sc1 lds
    buffer_load_dwordx4 v9, s[20:23], s88 offen offset:3072 sc1 lds
L_noflAf:
    v_and_b32 v90, 15, v0
    v_lshlrev_b32_e64 v90, 3, v90
    ds_read_b64 v[32:33], v31 offset:55296
    ds_read_b64 v[44:45], v90 offset:36864
    v_accvgpr_read_b32 v56, a204
    v_accvgpr_read_b32 v68, a202
    v_accvgpr_read_b32 v80, a200
    v_accvgpr_read_b32 v57, a205
    v_accvgpr_read_b32 v69, a203
    v_accvgpr_read_b32 v81, a201
    s_mul_i32 s3, s26, 4608
    s_add_u32 s3, s3, 110592
    v_and_b32_e64 v28, 15, v0
    v_mul_u32_u24 v28, 144, v28
    v_bfe_u32 v91, v0, 4, 2
    v_lshl_add_u32 v28, v91, 5, v28
    v_add_u32_e64 v28, s3, v28
    v_bfe_u32 v29, v0, 5, 1
    v_bfe_u32 v91, v0, 2, 2
    v_lshl_add_u32 v29, v29, 3, v91
    v_mul_u32_u24 v29, 144, v29
    v_and_b32_e64 v91, 3, v0
    v_lshl_add_u32 v29, v91, 5, v29
    v_bfe_u32 v91, v0, 4, 1
    v_lshl_add_u32 v29, v91, 3, v29
    v_add_u32 v29, s3, v29
    s_lshl_b32 s40, s36, 18
    s_add_u32 s40, s40, 18874368
    s_lshr_b32 s41, s38, 4
    s_waitcnt lgkmcnt(0)
    v_pk_fma_f32 v[32:33], v[44:45], v[56:57], v[32:33] op_sel_hi:[1,0,1]
    v_pk_fma_f32 v[32:33], v[44:45], v[56:57], v[32:33] op_sel:[1,1,0] op_sel_hi:[0,1,1] neg_lo:[0,1,0]
    v_accvgpr_read_b32 v44, a32
    v_accvgpr_read_b32 v45, a48
    v_pk_fma_f32 v[44:45], v[32:33], v[80:81], v[44:45] op_sel_hi:[1,0,1]
    v_pk_fma_f32 v[44:45], v[32:33], v[80:81], v[44:45] op_sel:[1,1,0] op_sel_hi:[0,1,1] neg_lo:[0,1,0]
    v_pk_mul_f32 v[48:49], v[44:45], v[68:69] op_sel_hi:[1,0]
    v_pk_fma_f32 v[48:49], v[44:45], v[68:69], v[48:49] op_sel:[1,1,0] op_sel_hi:[0,1,1] neg_lo:[0,1,0]
    v_accvgpr_read_b32 v46, a33
    v_accvgpr_read_b32 v47, a49
    v_pk_fma_f32 v[46:47], v[44:45], v[80:81], v[46:47] op_sel_hi:[1,0,1]
    v_pk_fma_f32 v[46:47], v[44:45], v[80:81], v[46:47] op_sel:[1,1,0] op_sel_hi:[0,1,1] neg_lo:[0,1,0]
    v_pk_mul_f32 v[50:51], v[46:47], v[68:69] op_sel_hi:[1,0]
    v_pk_fma_f32 v[50:51], v[46:47], v[68:69], v[50:51] op_sel:[1,1,0] op_sel_hi:[0,1,1] neg_lo:[0,1,0]
    v_cvt_pk_bf16_f32 v96, v48, v50
    v_cvt_pk_bf16_f32 v104, v49, v51
    v_accvgpr_read_b32 v44, a34
    v_accvgpr_read_b32 v45, a50
    v_pk_fma_f32 v[44:45], v[46:47], v[80:81], v[44:45] op_sel_hi:[1,0,1]
    v_pk_fma_f32 v[44:45], v[46:47], v[80:81], v[44:45] op_sel:[1,1,0] op_sel_hi:[0,1,1] neg_lo:[0,1,0]
    v_pk_mul_f32 v[48:49], v[44:45], v[68:69] op_sel_hi:[1,0]
    v_pk_fma_f32 v[48:49], v[44:45], v[68:69], v[48:49] op_sel:[1,1,0] op_sel_hi:[0,1,1] neg_lo:[0,1,0]
    v_accvgpr_read_b32 v46, a35
    v_accvgpr_read_b32 v47, a51
    v_pk_fma_f32 v[46:47], v[44:45], v[80:81], v[46:47] op_sel_hi:[1,0,1]
    v_pk_fma_f32 v[46:47], v[44:45], v[80:81], v[46:47] op_sel:[1,1,0] op_sel_hi:[0,1,1] neg_lo:[0,1,0]
    v_pk_mul_f32 v[50:51], v[46:47], v[68:69] op_sel_hi:[1,0]
    v_pk_fma_f32 v[50:51], v[46:47], v[68:69], v[50:51] op_sel:[1,1,0] op_sel_hi:[0,1,1] neg_lo:[0,1,0]
    v_cvt_pk_bf16_f32 v97, v48, v50
    v_cvt_pk_bf16_f32 v105, v49, v51
    v_accvgpr_read_b32 v44, a36
    v_accvgpr_read_b32 v45, a52
    v_pk_fma_f32 v[44:45], v[46:47], v[80:81], v[44:45] op_sel_hi:[1,0,1]
    v_pk_fma_f32 v[44:45], v[46:47], v[80:81], v[44:45] op_sel:[1,1,0] op_sel_hi:[0,1,1] neg_lo:[0,1,0]
    v_pk_mul_f32 v[48:49], v[44:45], v[68:69] op_sel_hi:[1,0]
    v_pk_fma_f32 v[48:49], v[44:45], v[68:69], v[48:49] op_sel:[1,1,0] op_sel_hi:[0,1,1] neg_lo:[0,1,0]
    v_accvgpr_read_b32 v46, a37
    v_accvgpr_read_b32 v47, a53
    v_pk_fma_f32 v[46:47], v[44:45], v[80:81], v[46:47] op_sel_hi:[1,0,1]
    v_pk_fma_f32 v[46:47], v[44:45], v[80:81], v[46:47] op_sel:[1,1,0] op_sel_hi:[0,1,1] neg_lo:[0,1,0]
    v_pk_mul_f32 v[50:51], v[46:47], v[68:69] op_sel_hi:[1,0]
    v_pk_fma_f32 v[50:51], v[46:47], v[68:69], v[50:51] op_sel:[1,1,0] op_sel_hi:[0,1,1] neg_lo:[0,1,0]
    v_cvt_pk_bf16_f32 v98, v48, v50
    v_cvt_pk_bf16_f32 v106, v49, v51
    v_accvgpr_read_b32 v44, a38
    v_accvgpr_read_b32 v45, a54
    v_pk_fma_f32 v[44:45], v[46:47], v[80:81], v[44:45] op_sel_hi:[1,0,1]
    v_pk_fma_f32 v[44:45], v[46:47], v[80:81], v[44:45] op_sel:[1,1,0] op_sel_hi:[0,1,1] neg_lo:[0,1,0]
    v_pk_mul_f32 v[48:49], v[44:45], v[68:69] op_sel_hi:[1,0]
    v_pk_fma_f32 v[48:49], v[44:45], v[68:69], v[48:49] op_sel:[1,1,0] op_sel_hi:[0,1,1] neg_lo:[0,1,0]
    v_accvgpr_read_b32 v46, a39
    v_accvgpr_read_b32 v47, a55
    v_pk_fma_f32 v[46:47], v[44:45], v[80:81], v[46:47] op_sel_hi:[1,0,1]
    v_pk_fma_f32 v[46:47], v[44:45], v[80:81], v[46:47] op_sel:[1,1,0] op_sel_hi:[0,1,1] neg_lo:[0,1,0]
    v_pk_mul_f32 v[50:51], v[46:47], v[68:69] op_sel_hi:[1,0]
    v_pk_fma_f32 v[50:51], v[46:47], v[68:69], v[50:51] op_sel:[1,1,0] op_sel_hi:[0,1,1] neg_lo:[0,1,0]
    v_cvt_pk_bf16_f32 v99, v48, v50
    v_cvt_pk_bf16_f32 v107, v49, v51
    v_accvgpr_read_b32 v44, a40
    v_accvgpr_read_b32 v45, a56
    v_pk_fma_f32 v[44:45], v[46:47], v[80:81], v[44:45] op_sel_hi:[1,0,1]
    v_pk_fma_f32 v[44:45], v[46:47], v[80:81], v[44:45] op_sel:[1,1,0] op_sel_hi:[0,1,1] neg_lo:[0,1,0]
    v_pk_mul_f32 v[48:49], v[44:45], v[68:69] op_sel_hi:[1,0]
    v_pk_fma_f32 v[48:49], v[44:45], v[68:69], v[48:49] op_sel:[1,1,0] op_sel_hi:[0,1,1] neg_lo:[0,1,0]
    v_accvgpr_read_b32 v46, a41
    v_accvgpr_read_b32 v47, a57
    v_pk_fma_f32 v[46:47], v[44:45], v[80:81], v[46:47] op_sel_hi:[1,0,1]
    v_pk_fma_f32 v[46:47], v[44:45], v[80:81], v[46:47] op_sel:[1,1,0] op_sel_hi:[0,1,1] neg_lo:[0,1,0]
    v_pk_mul_f32 v[50:51], v[46:47], v[68:69] op_sel_hi:[1,0]
    v_pk_fma_f32 v[50:51], v[46:47], v[68:69], v[50:51] op_sel:[1,1,0] op_sel_hi:[0,1,1] neg_lo:[0,1,0]
    v_cvt_pk_bf16_f32 v100, v48, v50
    v_cvt_pk_bf16_f32 v108, v49, v51
    v_accvgpr_read_b32 v44, a42
    v_accvgpr_read_b32 v45, a58
    v_pk_fma_f32 v[44:45], v[46:47], v[80:81], v[44:45] op_sel_hi:[1,0,1]
    v_pk_fma_f32 v[44:45], v[46:47], v[80:81], v[44:45] op_sel:[1,1,0] op_sel_hi:[0,1,1] neg_lo:[0,1,0]
    v_pk_mul_f32 v[48:49], v[44:45], v[68:69] op_sel_hi:[1,0]
    v_pk_fma_f32 v[48:49], v[44:45], v[68:69], v[48:49] op_sel:[1,1,0] op_sel_hi:[0,1,1] neg_lo:[0,1,0]
    v_accvgpr_read_b32 v46, a43
    v_accvgpr_read_b32 v47, a59
    v_pk_fma_f32 v[46:47], v[44:45], v[80:81], v[46:47] op_sel_hi:[1,0,1]
    v_pk_fma_f32 v[46:47], v[44:45], v[80:81], v[46:47] op_sel:[1,1,0] op_sel_hi:[0,1,1] neg_lo:[0,1,0]
    v_pk_mul_f32 v[50:51], v[46:47], v[68:69] op_sel_hi:[1,0]
    v_pk_fma_f32 v[50:51], v[46:47], v[68:69], v[50:51] op_sel:[1,1,0] op_sel_hi:[0,1,1] neg_lo:[0,1,0]
    v_cvt_pk_bf16_f32 v101, v48, v50
    v_cvt_pk_bf16_f32 v109, v49, v51
    v_accvgpr_read_b32 v44, a44
    v_accvgpr_read_b32 v45, a60
    v_pk_fma_f32 v[44:45], v[46:47], v[80:81], v[44:45] op_sel_hi:[1,0,1]
    v_pk_fma_f32 v[44:45], v[46:47], v[80:81], v[44:45] op_sel:[1,1,0] op_sel_hi:[0,1,1] neg_lo:[0,1,0]
    v_pk_mul_f32 v[48:49], v[44:45], v[68:69] op_sel_hi:[1,0]
    v_pk_fma_f32 v[48:49], v[44:45], v[68:69], v[48:49] op_sel:[1,1,0] op_sel_hi:[0,1,1] neg_lo:[0,1,0]
    v_accvgpr_read_b32 v46, a45
    v_accvgpr_read_b32 v47, a61
    v_pk_fma_f32 v[46:47], v[44:45], v[80:81], v[46:47] op_sel_hi:[1,0,1]
    v_pk_fma_f32 v[46:47], v[44:45], v[80:81], v[46:47] op_sel:[1,1,0] op_sel_hi:[0,1,1] neg_lo:[0,1,0]
    v_pk_mul_f32 v[50:51], v[46:47], v[68:69] op_sel_hi:[1,0]
    v_pk_fma_f32 v[50:51], v[46:47], v[68:69], v[50:51] op_sel:[1,1,0] op_sel_hi:[0,1,1] neg_lo:[0,1,0]
    v_cvt_pk_bf16_f32 v102, v48, v50
    v_cvt_pk_bf16_f32 v110, v49, v51
    v_accvgpr_read_b32 v44, a46
    v_accvgpr_read_b32 v45, a62
    v_pk_fma_f32 v[44:45], v[46:47], v[80:81], v[44:45] op_sel_hi:[1,0,1]
    v_pk_fma_f32 v[44:45], v[46:47], v[80:81], v[44:45] op_sel:[1,1,0] op_sel_hi:[0,1,1] neg_lo:[0,1,0]
    v_pk_mul_f32 v[48:49], v[44:45], v[68:69] op_sel_hi:[1,0]
    v_pk_fma_f32 v[48:49], v[44:45], v[68:69], v[48:49] op_sel:[1,1,0] op_sel_hi:[0,1,1] neg_lo:[0,1,0]
    v_accvgpr_read_b32 v46, a47
    v_accvgpr_read_b32 v47, a63
    v_pk_fma_f32 v[46:47], v[44:45], v[80:81], v[46:47] op_sel_hi:[1,0,1]
    v_pk_fma_f32 v[46:47], v[44:45], v[80:81], v[46:47] op_sel:[1,1,0] op_sel_hi:[0,1,1] neg_lo:[0,1,0]
    v_pk_mul_f32 v[50:51], v[46:47], v[68:69] op_sel_hi:[1,0]
    v_pk_fma_f32 v[50:51], v[46:47], v[68:69], v[50:51] op_sel:[1,1,0] op_sel_hi:[0,1,1] neg_lo:[0,1,0]
    v_cvt_pk_bf16_f32 v103, v48, v50
    v_cvt_pk_bf16_f32 v111, v49, v51
    ds_write_b128 v28, v[96:99] offset:0
    ds_write_b128 v28, v[100:103] offset:16
    ds_write_b128 v28, v[104:107] offset:2304
    ds_write_b128 v28, v[108:111] offset:2320
    ds_read_b64_tr_b16 v[112:113], v29 offset:0
    ds_read_b64_tr_b16 v[114:115], v29 offset:576
    ds_read_b64_tr_b16 v[116:117], v29 offset:16
    ds_read_b64_tr_b16 v[118:119], v29 offset:592
    ds_read_b64_tr_b16 v[120:121], v29 offset:2304
    ds_read_b64_tr_b16 v[122:123], v29 offset:2880
    ds_read_b64_tr_b16 v[124:125], v29 offset:2320
    ds_read_b64_tr_b16 v[126:127], v29 offset:2896
    s_add_u32 s42, s41, 0
    s_lshr_b32 s43, s42, 1
    s_lshl_b32 s43, s43, 12
    s_and_b32 s42, s42, 1
    s_lshl_b32 s42, s42, 9
    s_add_u32 s43, s43, s42
    s_add_u32 s43, s43, s40
    s_add_u32 s42, s43, 131072
    s_waitcnt lgkmcnt(0)
    buffer_store_dwordx4 v[112:115], v30, s[20:23], s43 offen offset:0 sc1
    buffer_store_dwordx4 v[116:119], v30, s[20:23], s43 offen offset:2048 sc1
    buffer_store_dwordx4 v[120:123], v30, s[20:23], s42 offen offset:0 sc1
    buffer_store_dwordx4 v[124:127], v30, s[20:23], s42 offen offset:2048 sc1
    ds_read_b64_tr_b16 a[0:1], v10 offset:0
    ds_read_b64_tr_b16 a[2:3], v10 offset:1024
    ds_read_b64_tr_b16 a[4:5], v10 offset:8192
    ds_read_b64_tr_b16 a[6:7], v10 offset:9216
    ds_read_b64_tr_b16 a[8:9], v11 offset:0
    ds_read_b64_tr_b16 a[10:11], v11 offset:1024
    ds_read_b64_tr_b16 a[12:13], v11 offset:8192
    ds_read_b64_tr_b16 a[14:15], v11 offset:9216
    ds_read_b64_tr_b16 a[16:17], v12 offset:0
    ds_read_b64_tr_b16 a[18:19], v12 offset:1024
    ds_read_b64_tr_b16 a[20:21], v12 offset:8192
    ds_read_b64_tr_b16 a[22:23], v12 offset:9216
    ds_read_b64_tr_b16 a[24:25], v13 offset:0
    ds_read_b64_tr_b16 a[26:27], v13 offset:1024
    ds_read_b64_tr_b16 a[28:29], v13 offset:8192
    ds_read_b64_tr_b16 a[30:31], v13 offset:9216
    s_cmp_eq_u64 s[30:31], 0
    s_cbranch_scc1 L_haveflAf
    buffer_load_dwordx2 v[26:27], v92, s[20:23], s90 offen sc1
    s_mov_b32 s55, 0x40000
    s_waitcnt vmcnt(0)
L_wchAf:
    v_cmp_ne_u64 vcc, s[48:49], v[26:27]
    s_cbranch_vccz L_gchAf
    s_sleep 1
    buffer_load_dwordx2 v[26:27], v92, s[20:23], s90 offen sc1
    s_waitcnt vmcnt(0)
    s_sub_u32 s55, s55, 1
    s_cmp_lg_u32 s55, 0
    s_cbranch_scc1 L_wchAf
L_gchAf:
    s_add_u32 s85, s84, s80
    s_xor_b32 s80, s27, 0
    buffer_load_dwordx4 a[64:67], v9, s[20:23], s85 offen offset:0 sc1
    buffer_load_dwordx4 a[68:71], v9, s[20:23], s85 offen offset:1024 sc1
    buffer_load_dwordx4 a[72:75], v9, s[20:23], s85 offen offset:2048 sc1
    buffer_load_dwordx4 a[76:79], v9, s[20:23], s85 offen offset:3072 sc1
    s_add_u32 s85, s85, 4096
    buffer_load_dwordx4 a[80:83], v9, s[20:23], s85 offen offset:0 sc1
    buffer_load_dwordx4 a[84:87], v9, s[20:23], s85 offen offset:1024 sc1
    buffer_load_dwordx4 a[88:91], v9, s[20:23], s85 offen offset:2048 sc1
    buffer_load_dwordx4 a[92:95], v9, s[20:23], s85 offen offset:3072 sc1
    s_add_u32 s85, s84, s81
    s_xor_b32 s81, s27, 16384
    buffer_load_dwordx4 a[96:99], v9, s[20:23], s85 offen offset:0 sc1
    buffer_load_dwordx4 a[100:103], v9, s[20:23], s85 offen offset:1024 sc1
    buffer_load_dwordx4 a[104:107], v9, s[20:23], s85 offen offset:2048 sc1
    buffer_load_dwordx4 a[108:111], v9, s[20:23], s85 offen offset:3072 sc1
    s_add_u32 m0, s89, 4096
    s_nop 0
    buffer_load_dwordx4 v9, s[20:23], s88 offen offset:0 sc1 lds
    buffer_load_dwordx4 v9, s[20:23], s88 offen offset:1024 sc1 lds
    buffer_load_dwordx4 v9, s[20:23], s88 offen offset:2048 sc1 lds
    buffer_load_dwordx4 v9, s[20:23], s88 offen offset:3072 sc1 lds
    s_waitcnt vmcnt(4)
L_haveflAf:
    s_waitcnt vmcnt(8)
    v_and_b32 v92, 31, v0
    v_lshlrev_b32_e64 v92, 7, v92
    s_branch L_k3_ffn
L_finAs:
    s_load_dwordx2 s[44:45], s[0:1], 64
    s_load_dwordx2 s[46:47], s[0:1], 104
    s_load_dwordx2 s[58:59], s[0:1], 0
    v_accvgpr_read_b32 v1, a240
    v_accvgpr_read_b32 v2, a241
    v_accvgpr_read_b32 v3, a242
    v_accvgpr_read_b32 v4, a243
    v_accvgpr_read_b32 v5, a244
    v_accvgpr_read_b32 v6, a245
    v_accvgpr_read_b32 v7, a246
    v_accvgpr_read_b32 v8, a247
    v_and_b32 v18, 63, v0
    v_lshlrev_b32_e64 v9, 4, v18
    s_xor_b32 s80, s79, 0
    s_lshl_b32 s80, s80, 13
    s_xor_b32 s81, s79, 1
    s_lshl_b32 s81, s81, 13
    s_xor_b32 s82, s79, 2
    s_lshl_b32 s82, s82, 13
    s_xor_b32 s83, s79, 3
    s_lshl_b32 s83, s83, 13
    s_lshl_b32 s3, s60, 3
    s_add_u32 s3, s3, s61
    s_lshl_b32 s86, s2, 7
    s_add_u32 s86, s86, 35913728
    s_lshl_b32 s87, s3, 16
    s_lshl_b32 s3, s26, 14
    s_add_u32 s87, s87, s3
    s_add_u32 s87, s87, 27262976
    s_lshr_b32 s90, s60, 1
    s_lshl_b32 s90, s90, 12
    s_add_u32 s93, s90, 35979264
    s_add_u32 s28, s90, 35946496
    s_and_b32 s3, s2, 1
    s_lshl_b32 s3, s3, 7
    s_add_u32 s90, s90, s3
    s_add_u32 s90, s90, 35913792
    s_and_b32 s3, s65, 3
    s_lshl_b32 s3, s3, 3
    s_add_u32 s90, s90, s3
    s_add_u32 s93, s93, s3
    s_lshl_b32 s33, s2, 7
    s_lshl_b32 s3, s26, 3
    s_add_u32 s33, s33, s3
    s_add_u32 s33, s33, 35979264
    s_lshl_b32 s89, s26, 13
    s_add_u32 s89, s89, 131072
    s_mul_i32 s92, s65, 458752
    s_add_u32 s92, s92, 4194304
    s_mul_i32 s84, s62, 196608
    s_add_u32 s84, s84, s92
    v_bfe_u32 v19, v18, 2, 2
    v_lshrrev_b32 v20, 4, v18
    v_lshl_add_u32 v21, v20, 3, v19
    v_lshlrev_b32 v21, 8, v21
    v_and_b32 v22, 3, v18
    v_lshl_add_u32 v21, v22, 3, v21
    s_lshl_b32 s3, s62, 16
    v_add_u32 v21, s3, v21
    v_bfe_u32 v19, v18, 2, 3
    s_lshl_b32 s3, s62, 2
    v_xor_b32 v19, s3, v19
    v_xor_b32_e64 v20, 0, v19
    v_lshl_add_u32 v10, v20, 5, v21
    v_xor_b32_e64 v20, 1, v19
    v_lshl_add_u32 v11, v20, 5, v21
    v_xor_b32_e64 v20, 2, v19
    v_lshl_add_u32 v12, v20, 5, v21
    v_xor_b32_e64 v20, 3, v19
    v_lshl_add_u32 v13, v20, 5, v21
    v_xor_b32_e64 v20, 4, v19
    v_lshl_add_u32 v14, v20, 5, v21
    v_xor_b32_e64 v20, 5, v19
    v_lshl_add_u32 v15, v20, 5, v21
    v_xor_b32_e64 v20, 6, v19
    v_lshl_add_u32 v16, v20, 5, v21
    v_xor_b32_e64 v20, 7, v19
    v_lshl_add_u32 v17, v20, 5, v21
    s_lshl_b32 s88, s65, 5
    s_lshl_b32 s3, s61, 2
    s_add_u32 s88, s88, s3
    s_lshl_b32 s3, s62, 1
    s_add_u32 s88, s88, s3
    s_lshl_b32 s88, s88, 12
    s_add_u32 s88, s88, 4096
    s_lshl_b32 s3, s61, 8
    s_lshl_b32 s4, s62, 7
    s_add_u32 s3, s3, s4
    s_add_u32 s3, s3, 64
    s_lshl_b32 s39, s65, 17
    s_add_u32 s39, s39, s3
    v_and_b32 v19, 15, v18
    v_lshrrev_b32 v26, 4, v18
    v_lshlrev_b32_e64 v26, 16, v26
    v_lshl_add_u32 v23, v19, 2, v26
    v_add_u32_e64 v20, s89, v9
    v_xor_b32 v21, 0x4000, v20
    v_bfe_u32 v19, v18, 1, 1
    v_lshlrev_b32 v19, 8, v19
    v_lshrrev_b32 v26, 2, v18
    v_lshl_add_u32 v19, v26, 4, v19
    v_lshlrev_b32 v24, 11, v26
    v_and_b32 v26, 1, v18
    v_lshl_add_u32 v19, v26, 3, v19
    v_add_u32 v22, s89, v19
    v_and_b32 v26, 3, v18
    v_lshl_add_u32 v24, v26, 4, v24
    v_lshrrev_b32 v19, 4, v18
    v_lshlrev_b32 v19, 10, v19
    v_lshl_add_u32 v19, v26, 3, v19
    v_bfe_u32 v26, v18, 2, 2
    v_lshl_add_u32 v19, v26, 6, v19
    v_add_u32 v25, s89, v19
    s_mov_b32 s80, 0
    s_mov_b32 s81, 16384
    s_mov_b32 s82, 32768
    s_mov_b32 s83, 49152
    s_lshl_b32 s27, s79, 13
    s_add_u32 s66, s87, 9437184
    s_xor_b32 s67, s86, 0
    s_add_u32 s67, s67, 98304
    s_waitcnt lgkmcnt(0)
    s_mov_b32 s12, s58
    s_mov_b32 s13, s59
    s_mov_b32 s14, 4194304
    s_mov_b32 s15, 0x00020000
    v_and_b32 v92, 7, v0
    v_lshlrev_b32_e64 v92, 8, v92
    buffer_load_dwordx2 v[26:27], v92, s[20:23], s90 offen sc1
    s_waitcnt vmcnt(0) lgkmcnt(0)
    s_barrier
    s_cmp_lg_u32 s26, 0
    s_cbranch_scc1 L_sighAs
    s_lshl_b32 s3, s2, 7
    s_add_u32 s3, s3, 35946496
    s_mov_b64 exec, 1
    buffer_store_dwordx2 a[248:249], off, s[20:23], s3 sc1
    s_mov_b64 exec, -1
L_sighAs:
    v_cmp_ne_u64 vcc, s[48:49], v[26:27]
    s_nop 1
    s_mov_b64 s[30:31], vcc
    s_cbranch_vccnz L_noflAs
    s_add_u32 s85, s84, s80
    s_xor_b32 s80, s27, 0
    buffer_load_dwordx4 a[64:67], v9, s[20:23], s85 offen offset:0 sc1
    buffer_load_dwordx4 a[68:71], v9, s[20:23], s85 offen offset:1024 sc1
    buffer_load_dwordx4 a[72:75], v9, s[20:23], s85 offen offset:2048 sc1
    buffer_load_dwordx4 a[76:79], v9, s[20:23], s85 offen offset:3072 sc1
    s_add_u32 s85, s85, 4096
    buffer_load_dwordx4 a[80:83], v9, s[20:23], s85 offen offset:0 sc1
    buffer_load_dwordx4 a[84:87], v9, s[20:23], s85 offen offset:1024 sc1
    buffer_load_dwordx4 a[88:91], v9, s[20:23], s85 offen offset:2048 sc1
    buffer_load_dwordx4 a[92:95], v9, s[20:23], s85 offen offset:3072 sc1
    s_add_u32 s85, s84, s81
    s_xor_b32 s81, s27, 8192
    buffer_load_dwordx4 a[96:99], v9, s[20:23], s85 offen offset:0 sc1
    buffer_load_dwordx4 a[100:103], v9, s[20:23], s85 offen offset:1024 sc1
    buffer_load_dwordx4 a[104:107], v9, s[20:23], s85 offen offset:2048 sc1
    buffer_load_dwordx4 a[108:111], v9, s[20:23], s85 offen offset:3072 sc1
L_noflAs:
    v_and_b32 v90, 15, v0
    v_lshlrev_b32 v90, 3, v90
    ds_read_b64 v[32:33], v31 offset:55296
    ds_read_b64 v[44:45], v90 offset:36864
    v_accvgpr_read_b32 v56, a204
    v_accvgpr_read_b32 v68, a202
    v_accvgpr_read_b32 v80, a200
    v_accvgpr_read_b32 v57, a205
    v_accvgpr_read_b32 v69, a203
    v_accvgpr_read_b32 v81, a201
    s_mul_i32 s3, s26, 4608
    s_add_u32 s3, s3, 110592
    v_and_b32_e64 v28, 15, v0
    v_mul_u32_u24 v28, 144, v28
    v_bfe_u32 v91, v0, 4, 2
    v_lshl_add_u32 v28, v91, 5, v28
    v_add_u32_e64 v28, s3, v28
    v_bfe_u32 v29, v0, 5, 1
    v_bfe_u32 v91, v0, 2, 2
    v_lshl_add_u32 v29, v29, 3, v91
    v_mul_u32_u24 v29, 144, v29
    v_and_b32_e64 v91, 3, v0
    v_lshl_add_u32 v29, v91, 5, v29
    v_bfe_u32 v91, v0, 4, 1
    v_lshl_add_u32 v29, v91, 3, v29
    v_add_u32 v29, s3, v29
    s_lshl_b32 s40, s36, 18
    s_add_u32 s40, s40, 18874368
    s_lshr_b32 s41, s38, 4
    s_waitcnt lgkmcnt(0)
    v_pk_fma_f32 v[32:33], v[44:45], v[56:57], v[32:33] op_sel_hi:[1,0,1]
    v_pk_fma_f32 v[32:33], v[44:45], v[56:57], v[32:33] op_sel:[1,1,0] op_sel_hi:[0,1,1] neg_lo:[0,1,0]
    v_accvgpr_read_b32 v44, a32
    v_accvgpr_read_b32 v45, a48
    v_pk_fma_f32 v[44:45], v[32:33], v[80:81], v[44:45] op_sel_hi:[1,0,1]
    v_pk_fma_f32 v[44:45], v[32:33], v[80:81], v[44:45] op_sel:[1,1,0] op_sel_hi:[0,1,1] neg_lo:[0,1,0]
    v_pk_mul_f32 v[48:49], v[44:45], v[68:69] op_sel_hi:[1,0]
    v_pk_fma_f32 v[48:49], v[44:45], v[68:69], v[48:49] op_sel:[1,1,0] op_sel_hi:[0,1,1] neg_lo:[0,1,0]
    v_accvgpr_read_b32 v46, a33
    v_accvgpr_read_b32 v47, a49
    v_pk_fma_f32 v[46:47], v[44:45], v[80:81], v[46:47] op_sel_hi:[1,0,1]
    v_pk_fma_f32 v[46:47], v[44:45], v[80:81], v[46:47] op_sel:[1,1,0] op_sel_hi:[0,1,1] neg_lo:[0,1,0]
    v_pk_mul_f32 v[50:51], v[46:47], v[68:69] op_sel_hi:[1,0]
    v_pk_fma_f32 v[50:51], v[46:47], v[68:69], v[50:51] op_sel:[1,1,0] op_sel_hi:[0,1,1] neg_lo:[0,1,0]
    v_cvt_pk_bf16_f32 v96, v48, v50
    v_cvt_pk_bf16_f32 v104, v49, v51
    v_accvgpr_read_b32 v44, a34
    v_accvgpr_read_b32 v45, a50
    v_pk_fma_f32 v[44:45], v[46:47], v[80:81], v[44:45] op_sel_hi:[1,0,1]
    v_pk_fma_f32 v[44:45], v[46:47], v[80:81], v[44:45] op_sel:[1,1,0] op_sel_hi:[0,1,1] neg_lo:[0,1,0]
    v_pk_mul_f32 v[48:49], v[44:45], v[68:69] op_sel_hi:[1,0]
    v_pk_fma_f32 v[48:49], v[44:45], v[68:69], v[48:49] op_sel:[1,1,0] op_sel_hi:[0,1,1] neg_lo:[0,1,0]
    v_accvgpr_read_b32 v46, a35
    v_accvgpr_read_b32 v47, a51
    v_pk_fma_f32 v[46:47], v[44:45], v[80:81], v[46:47] op_sel_hi:[1,0,1]
    v_pk_fma_f32 v[46:47], v[44:45], v[80:81], v[46:47] op_sel:[1,1,0] op_sel_hi:[0,1,1] neg_lo:[0,1,0]
    v_pk_mul_f32 v[50:51], v[46:47], v[68:69] op_sel_hi:[1,0]
    v_pk_fma_f32 v[50:51], v[46:47], v[68:69], v[50:51] op_sel:[1,1,0] op_sel_hi:[0,1,1] neg_lo:[0,1,0]
    v_cvt_pk_bf16_f32 v97, v48, v50
    v_cvt_pk_bf16_f32 v105, v49, v51
    v_accvgpr_read_b32 v44, a36
    v_accvgpr_read_b32 v45, a52
    v_pk_fma_f32 v[44:45], v[46:47], v[80:81], v[44:45] op_sel_hi:[1,0,1]
    v_pk_fma_f32 v[44:45], v[46:47], v[80:81], v[44:45] op_sel:[1,1,0] op_sel_hi:[0,1,1] neg_lo:[0,1,0]
    v_pk_mul_f32 v[48:49], v[44:45], v[68:69] op_sel_hi:[1,0]
    v_pk_fma_f32 v[48:49], v[44:45], v[68:69], v[48:49] op_sel:[1,1,0] op_sel_hi:[0,1,1] neg_lo:[0,1,0]
    v_accvgpr_read_b32 v46, a37
    v_accvgpr_read_b32 v47, a53
    v_pk_fma_f32 v[46:47], v[44:45], v[80:81], v[46:47] op_sel_hi:[1,0,1]
    v_pk_fma_f32 v[46:47], v[44:45], v[80:81], v[46:47] op_sel:[1,1,0] op_sel_hi:[0,1,1] neg_lo:[0,1,0]
    v_pk_mul_f32 v[50:51], v[46:47], v[68:69] op_sel_hi:[1,0]
    v_pk_fma_f32 v[50:51], v[46:47], v[68:69], v[50:51] op_sel:[1,1,0] op_sel_hi:[0,1,1] neg_lo:[0,1,0]
    v_cvt_pk_bf16_f32 v98, v48, v50
    v_cvt_pk_bf16_f32 v106, v49, v51
    v_accvgpr_read_b32 v44, a38
    v_accvgpr_read_b32 v45, a54
    v_pk_fma_f32 v[44:45], v[46:47], v[80:81], v[44:45] op_sel_hi:[1,0,1]
    v_pk_fma_f32 v[44:45], v[46:47], v[80:81], v[44:45] op_sel:[1,1,0] op_sel_hi:[0,1,1] neg_lo:[0,1,0]
    v_pk_mul_f32 v[48:49], v[44:45], v[68:69] op_sel_hi:[1,0]
    v_pk_fma_f32 v[48:49], v[44:45], v[68:69], v[48:49] op_sel:[1,1,0] op_sel_hi:[0,1,1] neg_lo:[0,1,0]
    v_accvgpr_read_b32 v46, a39
    v_accvgpr_read_b32 v47, a55
    v_pk_fma_f32 v[46:47], v[44:45], v[80:81], v[46:47] op_sel_hi:[1,0,1]
    v_pk_fma_f32 v[46:47], v[44:45], v[80:81], v[46:47] op_sel:[1,1,0] op_sel_hi:[0,1,1] neg_lo:[0,1,0]
    v_pk_mul_f32 v[50:51], v[46:47], v[68:69] op_sel_hi:[1,0]
    v_pk_fma_f32 v[50:51], v[46:47], v[68:69], v[50:51] op_sel:[1,1,0] op_sel_hi:[0,1,1] neg_lo:[0,1,0]
    v_cvt_pk_bf16_f32 v99, v48, v50
    v_cvt_pk_bf16_f32 v107, v49, v51
    v_accvgpr_read_b32 v44, a40
    v_accvgpr_read_b32 v45, a56
    v_pk_fma_f32 v[44:45], v[46:47], v[80:81], v[44:45] op_sel_hi:[1,0,1]
    v_pk_fma_f32 v[44:45], v[46:47], v[80:81], v[44:45] op_sel:[1,1,0] op_sel_hi:[0,1,1] neg_lo:[0,1,0]
    v_pk_mul_f32 v[48:49], v[44:45], v[68:69] op_sel_hi:[1,0]
    v_pk_fma_f32 v[48:49], v[44:45], v[68:69], v[48:49] op_sel:[1,1,0] op_sel_hi:[0,1,1] neg_lo:[0,1,0]
    v_accvgpr_read_b32 v46, a41
    v_accvgpr_read_b32 v47, a57
    v_pk_fma_f32 v[46:47], v[44:45], v[80:81], v[46:47] op_sel_hi:[1,0,1]
    v_pk_fma_f32 v[46:47], v[44:45], v[80:81], v[46:47] op_sel:[1,1,0] op_sel_hi:[0,1,1] neg_lo:[0,1,0]
    v_pk_mul_f32 v[50:51], v[46:47], v[68:69] op_sel_hi:[1,0]
    v_pk_fma_f32 v[50:51], v[46:47], v[68:69], v[50:51] op_sel:[1,1,0] op_sel_hi:[0,1,1] neg_lo:[0,1,0]
    v_cvt_pk_bf16_f32 v100, v48, v50
    v_cvt_pk_bf16_f32 v108, v49, v51
    v_accvgpr_read_b32 v44, a42
    v_accvgpr_read_b32 v45, a58
    v_pk_fma_f32 v[44:45], v[46:47], v[80:81], v[44:45] op_sel_hi:[1,0,1]
    v_pk_fma_f32 v[44:45], v[46:47], v[80:81], v[44:45] op_sel:[1,1,0] op_sel_hi:[0,1,1] neg_lo:[0,1,0]
    v_pk_mul_f32 v[48:49], v[44:45], v[68:69] op_sel_hi:[1,0]
    v_pk_fma_f32 v[48:49], v[44:45], v[68:69], v[48:49] op_sel:[1,1,0] op_sel_hi:[0,1,1] neg_lo:[0,1,0]
    v_accvgpr_read_b32 v46, a43
    v_accvgpr_read_b32 v47, a59
    v_pk_fma_f32 v[46:47], v[44:45], v[80:81], v[46:47] op_sel_hi:[1,0,1]
    v_pk_fma_f32 v[46:47], v[44:45], v[80:81], v[46:47] op_sel:[1,1,0] op_sel_hi:[0,1,1] neg_lo:[0,1,0]
    v_pk_mul_f32 v[50:51], v[46:47], v[68:69] op_sel_hi:[1,0]
    v_pk_fma_f32 v[50:51], v[46:47], v[68:69], v[50:51] op_sel:[1,1,0] op_sel_hi:[0,1,1] neg_lo:[0,1,0]
    v_cvt_pk_bf16_f32 v101, v48, v50
    v_cvt_pk_bf16_f32 v109, v49, v51
    v_accvgpr_read_b32 v44, a44
    v_accvgpr_read_b32 v45, a60
    v_pk_fma_f32 v[44:45], v[46:47], v[80:81], v[44:45] op_sel_hi:[1,0,1]
    v_pk_fma_f32 v[44:45], v[46:47], v[80:81], v[44:45] op_sel:[1,1,0] op_sel_hi:[0,1,1] neg_lo:[0,1,0]
    v_pk_mul_f32 v[48:49], v[44:45], v[68:69] op_sel_hi:[1,0]
    v_pk_fma_f32 v[48:49], v[44:45], v[68:69], v[48:49] op_sel:[1,1,0] op_sel_hi:[0,1,1] neg_lo:[0,1,0]
    v_accvgpr_read_b32 v46, a45
    v_accvgpr_read_b32 v47, a61
    v_pk_fma_f32 v[46:47], v[44:45], v[80:81], v[46:47] op_sel_hi:[1,0,1]
    v_pk_fma_f32 v[46:47], v[44:45], v[80:81], v[46:47] op_sel:[1,1,0] op_sel_hi:[0,1,1] neg_lo:[0,1,0]
    v_pk_mul_f32 v[50:51], v[46:47], v[68:69] op_sel_hi:[1,0]
    v_pk_fma_f32 v[50:51], v[46:47], v[68:69], v[50:51] op_sel:[1,1,0] op_sel_hi:[0,1,1] neg_lo:[0,1,0]
    v_cvt_pk_bf16_f32 v102, v48, v50
    v_cvt_pk_bf16_f32 v110, v49, v51
    v_accvgpr_read_b32 v44, a46
    v_accvgpr_read_b32 v45, a62
    v_pk_fma_f32 v[44:45], v[46:47], v[80:81], v[44:45] op_sel_hi:[1,0,1]
    v_pk_fma_f32 v[44:45], v[46:47], v[80:81], v[44:45] op_sel:[1,1,0] op_sel_hi:[0,1,1] neg_lo:[0,1,0]
    v_pk_mul_f32 v[48:49], v[44:45], v[68:69] op_sel_hi:[1,0]
    v_pk_fma_f32 v[48:49], v[44:45], v[68:69], v[48:49] op_sel:[1,1,0] op_sel_hi:[0,1,1] neg_lo:[0,1,0]
    v_accvgpr_read_b32 v46, a47
    v_accvgpr_read_b32 v47, a63
    v_pk_fma_f32 v[46:47], v[44:45], v[80:81], v[46:47] op_sel_hi:[1,0,1]
    v_pk_fma_f32 v[46:47], v[44:45], v[80:81], v[46:47] op_sel:[1,1,0] op_sel_hi:[0,1,1] neg_lo:[0,1,0]
    v_pk_mul_f32 v[50:51], v[46:47], v[68:69] op_sel_hi:[1,0]
    v_pk_fma_f32 v[50:51], v[46:47], v[68:69], v[50:51] op_sel:[1,1,0] op_sel_hi:[0,1,1] neg_lo:[0,1,0]
    v_cvt_pk_bf16_f32 v103, v48, v50
    v_cvt_pk_bf16_f32 v111, v49, v51
    ds_write_b128 v28, v[96:99] offset:0
    ds_write_b128 v28, v[100:103] offset:16
    ds_write_b128 v28, v[104:107] offset:2304
    ds_write_b128 v28, v[108:111] offset:2320
    ds_read_b64_tr_b16 v[112:113], v29 offset:0
    ds_read_b64_tr_b16 v[114:115], v29 offset:576
    ds_read_b64_tr_b16 v[116:117], v29 offset:16
    ds_read_b64_tr_b16 v[118:119], v29 offset:592
    ds_read_b64_tr_b16 v[120:121], v29 offset:2304
    ds_read_b64_tr_b16 v[122:123], v29 offset:2880
    ds_read_b64_tr_b16 v[124:125], v29 offset:2320
    ds_read_b64_tr_b16 v[126:127], v29 offset:2896
    s_add_u32 s42, s41, 0
    s_lshr_b32 s43, s42, 1
    s_lshl_b32 s43, s43, 12
    s_and_b32 s42, s42, 1
    s_lshl_b32 s42, s42, 9
    s_add_u32 s43, s43, s42
    s_add_u32 s43, s43, s40
    s_add_u32 s42, s43, 131072
    s_waitcnt lgkmcnt(0)
    buffer_store_dwordx4 v[112:115], v30, s[20:23], s43 offen offset:0 sc1
    buffer_store_dwordx4 v[116:119], v30, s[20:23], s43 offen offset:2048 sc1
    buffer_store_dwordx4 v[120:123], v30, s[20:23], s42 offen offset:0 sc1
    buffer_store_dwordx4 v[124:127], v30, s[20:23], s42 offen offset:2048 sc1
    s_xor_b32 s16, s79, 0
    s_lshl_b32 s16, s16, 7
    s_xor_b32 s17, s79, 1
    s_lshl_b32 s17, s17, 7
    s_xor_b32 s18, s79, 2
    s_lshl_b32 s18, s18, 7
    s_xor_b32 s19, s79, 3
    s_lshl_b32 s19, s19, 7
    s_lshl_b32 s3, s61, 18
    s_lshl_b32 s4, s63, 17
    s_add_u32 s3, s3, s4
    v_lshrrev_b32 v44, 4, v18
    v_and_b32 v45, 7, v18
    v_xor_b32 v45, v45, v44
    v_lshrrev_b32 v46, 3, v18
    v_lshlrev_b32 v46, 11, v46
    v_add_u32_e64 v46, s3, v46
    v_lshl_add_u32 v44, v45, 4, v46
    v_xor_b32_e64 v45, 4, v45
    v_lshl_add_u32 v45, v45, 4, v46
    v_add_u32_e64 v32, 0, v44
    v_add_u32 v33, 15360, v45
    v_add_u32 v34, 30720, v44
    v_add_u32 v35, 46080, v45
    v_add_u32 v36, 65536, v44
    v_add_u32 v37, 80896, v45
    v_add_u32 v38, 96256, v44
    v_add_u32 v39, 111616, v45
    s_mov_b32 s91, 0
    s_mov_b32 s8, s52
    s_mov_b32 s9, s53
    s_mov_b32 s10, 2097152
    s_mov_b32 s11, 0x00020000
    s_lshl_b32 s92, s65, 1
    s_add_u32 s92, s92, s62
    s_lshl_b32 s92, s92, 17
    s_add_u32 s92, s92, 18874368
    v_and_b32 v44, 15, v18
    v_lshrrev_b32 v45, 1, v44
    v_lshrrev_b32 v46, 4, v18
    v_xor_b32 v45, v45, v46
    v_lshlrev_b32_e64 v45, 4, v45
    v_lshl_add_u32 v44, v44, 7, v45
    s_mul_i32 s3, s62, 73728
    v_add_u32 v40, s3, v44
    v_xor_b32 v41, 64, v40
    v_xor_b32 v42, 8192, v40
    v_xor_b32 v43, 8192, v41
    ds_read_b64_tr_b16 a[0:1], v10 offset:0
    ds_read_b64_tr_b16 a[2:3], v10 offset:1024
    ds_read_b64_tr_b16 a[4:5], v10 offset:8192
    ds_read_b64_tr_b16 a[6:7], v10 offset:9216
    ds_read_b64_tr_b16 a[8:9], v11 offset:0
    ds_read_b64_tr_b16 a[10:11], v11 offset:1024
    ds_read_b64_tr_b16 a[12:13], v11 offset:8192
    ds_read_b64_tr_b16 a[14:15], v11 offset:9216
    ds_read_b64_tr_b16 a[16:17], v12 offset:0
    ds_read_b64_tr_b16 a[18:19], v12 offset:1024
    ds_read_b64_tr_b16 a[20:21], v12 offset:8192
    ds_read_b64_tr_b16 a[22:23], v12 offset:9216
    ds_read_b64_tr_b16 a[24:25], v13 offset:0
    ds_read_b64_tr_b16 a[26:27], v13 offset:1024
    ds_read_b64_tr_b16 a[28:29], v13 offset:8192
    ds_read_b64_tr_b16 a[30:31], v13 offset:9216
    s_cmp_eq_u64 s[30:31], 0
    s_cbranch_scc1 L_haveflAs
    buffer_load_dwordx2 v[26:27], v92, s[20:23], s90 offen sc1
    s_mov_b32 s55, 0x40000
    s_waitcnt vmcnt(0)
L_wchAs:
    v_cmp_ne_u64 vcc, s[48:49], v[26:27]
    s_cbranch_vccz L_gchAs
    s_sleep 1
    buffer_load_dwordx2 v[26:27], v92, s[20:23], s90 offen sc1
    s_waitcnt vmcnt(0)
    s_sub_u32 s55, s55, 1
    s_cmp_lg_u32 s55, 0
    s_cbranch_scc1 L_wchAs
L_gchAs:
    s_add_u32 s85, s84, s80
    s_xor_b32 s80, s27, 0
    buffer_load_dwordx4 a[64:67], v9, s[20:23], s85 offen offset:0 sc1
    buffer_load_dwordx4 a[68:71], v9, s[20:23], s85 offen offset:1024 sc1
    buffer_load_dwordx4 a[72:75], v9, s[20:23], s85 offen offset:2048 sc1
    buffer_load_dwordx4 a[76:79], v9, s[20:23], s85 offen offset:3072 sc1
    s_add_u32 s85, s85, 4096
    buffer_load_dwordx4 a[80:83], v9, s[20:23], s85 offen offset:0 sc1
    buffer_load_dwordx4 a[84:87], v9, s[20:23], s85 offen offset:1024 sc1
    buffer_load_dwordx4 a[88:91], v9, s[20:23], s85 offen offset:2048 sc1
    buffer_load_dwordx4 a[92:95], v9, s[20:23], s85 offen offset:3072 sc1
    s_add_u32 s85, s84, s81
    s_xor_b32 s81, s27, 8192
    buffer_load_dwordx4 a[96:99], v9, s[20:23], s85 offen offset:0 sc1
    buffer_load_dwordx4 a[100:103], v9, s[20:23], s85 offen offset:1024 sc1
    buffer_load_dwordx4 a[104:107], v9, s[20:23], s85 offen offset:2048 sc1
    buffer_load_dwordx4 a[108:111], v9, s[20:23], s85 offen offset:3072 sc1
    s_waitcnt vmcnt(0)
L_haveflAs:
    s_waitcnt vmcnt(4)
    s_branch L_k3_ssm
L_k2_B:
    v_bfe_u32 v19, v18, 3, 1
    v_bfe_u32 v20, v18, 4, 1
    v_lshlrev_b32_e64 v19, 3, v19
    v_lshl_or_b32 v19, v20, 2, v19
    v_bfe_u32 v20, v18, 5, 1
    v_lshl_or_b32 v19, v20, 4, v19
    v_and_b32 v20, 7, v18
    v_mul_u32_u24 v19, s7, v19
    v_lshl_add_u32 v19, v20, 4, v19
    v_add_u32_e64 v1, s6, v19
    v_add_u32 v2, 6112, v1
    v_add_u32 v3, 12224, v1
    v_add_u32 v4, 18336, v1
    s_mul_i32 s3, s5, 40
    s_add_u32 s3, s3, s38
    s_lshl_b32 s3, s3, 11
    s_lshl_b32 s4, s5, 2
    v_lshrrev_b32 v19, 4, v18
    v_and_b32 v20, 7, v18
    v_xor_b32 v20, v20, v19
    v_xor_b32 v20, s4, v20
    v_lshrrev_b32 v21, 3, v18
    v_lshlrev_b32 v21, 11, v21
    v_add_u32_e64 v21, s3, v21
    v_lshl_add_u32 v5, v20, 4, v21
    v_xor_b32_e64 v20, 64, v5
    v_add_u32 v6, 15360, v20
    v_add_u32 v7, 30720, v5
    v_add_u32 v8, 46080, v20
    v_add_u32 v9, 65536, v5
    s_mul_i32 s30, s26, 4224
    s_add_u32 s31, s30, 37888
    s_mul_i32 s32, s26, 5120
    s_add_u32 s32, s32, 16896
    s_add_u32 s33, s32, 37888
    s_mov_b32 s16, s50
    s_mov_b32 s17, s51
    s_mov_b32 s18, 4194304
    s_mov_b32 s19, 0x00020000
    s_mov_b32 s50, s60
    s_mov_b32 s51, s61
    v_accvgpr_write_b32 a0, 0
    v_accvgpr_write_b32 a1, 0
    v_accvgpr_write_b32 a2, 0
    v_accvgpr_write_b32 a3, 0
    v_accvgpr_write_b32 a4, 0
    v_accvgpr_write_b32 a5, 0
    v_accvgpr_write_b32 a6, 0
    v_accvgpr_write_b32 a7, 0
    v_accvgpr_write_b32 a8, 0
    v_accvgpr_write_b32 a9, 0
    v_accvgpr_write_b32 a10, 0
    v_accvgpr_write_b32 a11, 0
    v_accvgpr_write_b32 a12, 0
    v_accvgpr_write_b32 a13, 0
    v_accvgpr_write_b32 a14, 0
    v_accvgpr_write_b32 a15, 0
    v_accvgpr_write_b32 a16, 0
    v_accvgpr_write_b32 a17, 0
    v_accvgpr_write_b32 a18, 0
    v_accvgpr_write_b32 a19, 0
    v_accvgpr_write_b32 a20, 0
    v_accvgpr_write_b32 a21, 0
    v_accvgpr_write_b32 a22, 0
    v_accvgpr_write_b32 a23, 0
    v_accvgpr_write_b32 a24, 0
    v_accvgpr_write_b32 a25, 0
    v_accvgpr_write_b32 a26, 0
    v_accvgpr_write_b32 a27, 0
    v_accvgpr_write_b32 a28, 0
    v_accvgpr_write_b32 a29, 0
    v_accvgpr_write_b32 a30, 0
    v_accvgpr_write_b32 a31, 0
    v_accvgpr_write_b32 a32, 0
    v_accvgpr_write_b32 a33, 0
    v_accvgpr_write_b32 a34, 0
    v_accvgpr_write_b32 a35, 0
    v_accvgpr_write_b32 a36, 0
    v_accvgpr_write_b32 a37, 0
    v_accvgpr_write_b32 a38, 0
    v_accvgpr_write_b32 a39, 0
    v_accvgpr_write_b32 a40, 0
    v_accvgpr_write_b32 a41, 0
    v_accvgpr_write_b32 a42, 0
    v_accvgpr_write_b32 a43, 0
    v_accvgpr_write_b32 a44, 0
    v_accvgpr_write_b32 a45, 0
    v_accvgpr_write_b32 a46, 0
    v_accvgpr_write_b32 a47, 0
    v_accvgpr_write_b32 a48, 0
    v_accvgpr_write_b32 a49, 0
    v_accvgpr_write_b32 a50, 0
    v_accvgpr_write_b32 a51, 0
    v_accvgpr_write_b32 a52, 0
    v_accvgpr_write_b32 a53, 0
    v_accvgpr_write_b32 a54, 0
    v_accvgpr_write_b32 a55, 0
    v_accvgpr_write_b32 a56, 0
    v_accvgpr_write_b32 a57, 0
    v_accvgpr_write_b32 a58, 0
    v_accvgpr_write_b32 a59, 0
    v_accvgpr_write_b32 a60, 0
    v_accvgpr_write_b32 a61, 0
    v_accvgpr_write_b32 a62, 0
    v_accvgpr_write_b32 a63, 0
    v_bfe_u32 v19, v18, 2, 2
    v_mul_u32_u24 v19, 1056, v19
    v_bfe_u32 v20, v18, 4, 1
    v_lshl_add_u32 v19, v20, 7, v19
    v_bfe_u32 v20, v18, 5, 1
    v_lshl_add_u32 v19, v20, 9, v19
    v_and_b32_e64 v20, 3, v18
    v_lshl_add_u32 v11, v20, 3, v19
    v_add_u32 v12, 37888, v11
    v_and_b32 v19, 15, v18
    v_lshrrev_b32 v20, 1, v19
    v_lshrrev_b32 v21, 4, v18
    v_xor_b32 v20, v20, v21
    v_lshlrev_b32_e64 v20, 4, v20
    v_lshl_add_u32 v19, v19, 7, v20
    v_xor_b32_e64 v20, 64, v19
    v_add_u32 v13, 16896, v19
    v_add_u32 v14, 16896, v20
    v_add_u32 v15, 37888, v13
    v_add_u32 v16, 37888, v14
    s_lshl_b32 s3, s2, 2
    s_add_u32 s3, s3, s26
    s_lshl_b32 s4, s3, 3
    v_and_b32 v19, 7, v18
    v_add_lshl_u32 v23, v19, s4, 7
    s_lshl_b32 s3, s2, 1
    s_add_u32 s3, s3, s5
    s_lshl_b32 s3, s3, 2
    v_and_b32 v19, 3, v18
    v_add_lshl_u32 v24, v19, s3, 7
    v_mov_b32 v104, 0
    v_mov_b32 v105, 0
    v_mov_b32 v106, 0
    v_mov_b32 v107, 0
    v_mov_b32 v108, 0
    v_mov_b32 v109, 0
    v_mov_b32 v110, 0
    v_mov_b32 v111, 0
    v_mov_b32 v112, 0
    v_mov_b32 v113, 0
    v_mov_b32 v114, 0
    v_mov_b32 v115, 0
    v_mov_b32 v116, 0
    v_mov_b32 v117, 0
    v_mov_b32 v118, 0
    v_mov_b32 v119, 0
    v_mov_b32 v120, 0
    v_mov_b32 v121, 0
    v_mov_b32 v122, 0
    v_mov_b32 v123, 0
    v_mov_b32 v124, 0
    v_mov_b32 v125, 0
    v_mov_b32 v126, 0
    v_mov_b32 v127, 0
    v_mov_b32 v128, 0
    v_mov_b32 v129, 0
    v_mov_b32 v130, 0
    v_mov_b32 v131, 0
    v_mov_b32 v132, 0
    v_mov_b32 v133, 0
    v_mov_b32 v134, 0
    v_mov_b32 v135, 0
    v_mov_b32 v136, 0
    v_mov_b32 v137, 0
    v_mov_b32 v138, 0
    v_mov_b32 v139, 0
    v_mov_b32 v140, 0
    v_mov_b32 v141, 0
    v_mov_b32 v142, 0
    v_mov_b32 v143, 0
    v_mov_b32 v144, 0
    v_mov_b32 v145, 0
    v_mov_b32 v146, 0
    v_mov_b32 v147, 0
    v_mov_b32 v148, 0
    v_mov_b32 v149, 0
    v_mov_b32 v150, 0
    v_mov_b32 v151, 0
    v_mov_b32 v152, 0
    v_mov_b32 v153, 0
    v_mov_b32 v154, 0
    v_mov_b32 v155, 0
    v_mov_b32 v156, 0
    v_mov_b32 v157, 0
    v_mov_b32 v158, 0
    v_mov_b32 v159, 0
    v_mov_b32 v160, 0
    v_mov_b32 v161, 0
    v_mov_b32 v162, 0
    v_mov_b32 v163, 0
    v_mov_b32 v164, 0
    v_mov_b32 v165, 0
    v_mov_b32 v166, 0
    v_mov_b32 v167, 0
    v_mov_b32 v168, 0
    v_mov_b32 v169, 0
    v_mov_b32 v170, 0
    v_mov_b32 v171, 0
    v_mov_b32 v172, 0
    v_mov_b32 v173, 0
    v_mov_b32 v174, 0
    v_mov_b32 v175, 0
    v_mov_b32 v176, 0
    v_mov_b32 v177, 0
    v_mov_b32 v178, 0
    v_mov_b32 v179, 0
    v_mov_b32 v180, 0
    v_mov_b32 v181, 0
    v_mov_b32 v182, 0
    v_mov_b32 v183, 0
    v_mov_b32 v184, 0
    v_mov_b32 v185, 0
    v_mov_b32 v186, 0
    v_mov_b32 v187, 0
    v_mov_b32 v188, 0
    v_mov_b32 v189, 0
    v_mov_b32 v190, 0
    v_mov_b32 v191, 0
    v_mov_b32 v192, 0
    v_mov_b32 v193, 0
    v_mov_b32 v194, 0
    v_mov_b32 v195, 0
    v_mov_b32 v196, 0
    v_mov_b32 v197, 0
    v_mov_b32 v198, 0
    v_mov_b32 v199, 0
    v_mov_b32 v200, 0
    v_mov_b32 v201, 0
    v_mov_b32 v202, 0
    v_mov_b32 v203, 0
    v_mov_b32 v204, 0
    v_mov_b32 v205, 0
    v_mov_b32 v206, 0
    v_mov_b32 v207, 0
    v_mov_b32 v208, 0
    v_mov_b32 v209, 0
    v_mov_b32 v210, 0
    v_mov_b32 v211, 0
    v_mov_b32 v212, 0
    v_mov_b32 v213, 0
    v_mov_b32 v214, 0
    v_mov_b32 v215, 0
    v_mov_b32 v216, 0
    v_mov_b32 v217, 0
    v_mov_b32 v218, 0
    v_mov_b32 v219, 0
    v_mov_b32 v220, 0
    v_mov_b32 v221, 0
    v_mov_b32 v222, 0
    v_mov_b32 v223, 0
    v_mov_b32 v224, 0
    v_mov_b32 v225, 0
    v_mov_b32 v226, 0
    v_mov_b32 v227, 0
    v_mov_b32 v228, 0
    v_mov_b32 v229, 0
    v_mov_b32 v230, 0
    v_mov_b32 v231, 0
    v_mov_b32 v232, 0
    v_mov_b32 v233, 0
    v_mov_b32 v234, 0
    v_mov_b32 v235, 0
    v_mov_b32 v236, 0
    v_mov_b32 v237, 0
    v_mov_b32 v238, 0
    v_mov_b32 v239, 0
    v_mov_b32 v240, 0
    v_mov_b32 v241, 0
    v_mov_b32 v242, 0
    v_mov_b32 v243, 0
    v_mov_b32 v244, 0
    v_mov_b32 v245, 0
    v_mov_b32 v246, 0
    v_mov_b32 v247, 0
    v_mov_b32 v248, 0
    v_mov_b32 v249, 0
    v_mov_b32 v250, 0
    v_mov_b32 v251, 0
    v_mov_b32 v252, 0
    v_mov_b32 v253, 0
    v_mov_b32 v254, 0
    v_mov_b32_e64 v255, 0
    s_and_b32 s64, s2, 1
    s_xor_b32 s64, s64, 1
    s_lshr_b32 s4, s2, 5
    s_bfe_u32 s6, s2, 0x20003
    s_bfe_u32 s3, s2, 0x10002
    s_lshl_b32 s3, s3, 3
    s_add_u32 s60, s3, s4
    s_bfe_u32 s3, s2, 0x10001
    s_lshl_b32 s3, s3, 2
    s_add_u32 s61, s3, s6
    s_add_u32 s79, s4, s6
    s_and_b32 s79, s79, 3
    s_lshr_b32 s62, s26, 1
    s_and_b32 s63, s26, 1
    s_lshl_b32 s65, s60, 1
    s_add_u32 s65, s65, s63
    s_lshl_b32 s76, s62, 16
    s_lshl_b32 s3, s63, 13
    s_add_u32 s76, s76, s3
    s_mov_b32 s71, 0x00020000
    s_mov_b32 s72, 0
    s_mov_b32 s73, 262144
    s_mov_b32 s74, 524288
    s_mov_b32 s75, 786432
    s_lshl_b32 s54, s79, 18
    s_lshl_b32 s3, s63, 16
    s_lshl_b32 s4, s61, 8
    s_add_u32 s3, s3, s4
    v_lshrrev_b32_e64 v19, 4, v18
    v_bfe_u32 v20, v18, 1, 3
    v_xor_b32 v20, v20, v19
    v_and_b32 v21, 1, v18
    v_lshlrev_b32_e64 v21, 4, v21
    v_lshl_add_u32 v21, v19, 11, v21
    v_add_u32_e64 v21, s3, v21
    v_lshl_add_u32 v19, v20, 5, v21
    v_xor_b32_e64 v20, 4, v20
    v_lshl_add_u32 v20, v20, 5, v21
    v_add_u32_e64 v21, 0, v19
    v_accvgpr_write_b32 a240, v21
    v_add_u32 v21, 7168, v19
    v_accvgpr_write_b32 a241, v21
    v_add_u32 v21, 14336, v20
    v_accvgpr_write_b32 a242, v21
    v_add_u32 v21, 21504, v20
    v_accvgpr_write_b32 a243, v21
    v_add_u32 v21, 32768, v19
    v_accvgpr_write_b32 a244, v21
    v_add_u32 v21, 39936, v19
    v_accvgpr_write_b32 a245, v21
    v_add_u32 v21, 47104, v20
    v_accvgpr_write_b32 a246, v21
    v_add_u32 v21, 54272, v20
    v_accvgpr_write_b32 a247, v21
    s_mul_i32 s77, s62, 3145728
    s_lshl_b32 s3, s64, 20
    s_add_u32 s77, s77, s3
    s_mov_b32 s68, s56
    s_mov_b32 s69, s57
    s_mov_b32 s70, 7340032
    s_waitcnt vmcnt(6)
    v_readfirstlane_b32 s48, v62
    v_readfirstlane_b32 s49, v63
    s_add_u32 s48, s48, 1
    s_addc_u32 s49, s49, 0
    s_max_u32 s48, s48, 1
    v_accvgpr_write_b32 a248, s48
    v_accvgpr_write_b32 a249, s49
    v_lshlrev_b32_e64 v64, 16, v40
    v_and_b32 v65, 0xffff0000, v40
    v_lshlrev_b32_e64 v66, 16, v41
    v_and_b32 v67, 0xffff0000, v41
    v_lshlrev_b32_e64 v68, 16, v42
    v_and_b32 v69, 0xffff0000, v42
    v_lshlrev_b32_e64 v70, 16, v43
    v_and_b32 v71, 0xffff0000, v43
    v_lshlrev_b32_e64 v72, 16, v44
    v_and_b32 v73, 0xffff0000, v44
    v_lshlrev_b32_e64 v74, 16, v45
    v_and_b32 v75, 0xffff0000, v45
    v_lshlrev_b32_e64 v76, 16, v46
    v_and_b32 v77, 0xffff0000, v46
    v_lshlrev_b32_e64 v78, 16, v47
    v_and_b32 v79, 0xffff0000, v47
    v_lshlrev_b32_e64 v80, 16, v48
    v_and_b32 v81, 0xffff0000, v48
    v_lshlrev_b32_e64 v82, 16, v49
    v_and_b32 v83, 0xffff0000, v49
    v_lshlrev_b32_e64 v84, 16, v50
    v_and_b32 v85, 0xffff0000, v50
    v_lshlrev_b32_e64 v86, 16, v51
    v_and_b32 v87, 0xffff0000, v51
    v_lshlrev_b32_e64 v88, 16, v52
    v_and_b32 v89, 0xffff0000, v52
    v_lshlrev_b32_e64 v90, 16, v53
    v_and_b32 v91, 0xffff0000, v53
    v_lshlrev_b32_e64 v92, 16, v54
    v_and_b32 v93, 0xffff0000, v54
    v_lshlrev_b32_e64 v94, 16, v55
    v_and_b32 v95, 0xffff0000, v55
    v_pk_add_f32 v[32:33], v[64:65], v[66:67]
    v_pk_add_f32 v[34:35], v[68:69], v[70:71]
    v_pk_add_f32 v[32:33], v[32:33], v[72:73]
    v_pk_add_f32 v[34:35], v[34:35], v[74:75]
    v_pk_add_f32 v[32:33], v[32:33], v[76:77]
    v_pk_add_f32 v[34:35], v[34:35], v[78:79]
    v_pk_add_f32 v[32:33], v[32:33], v[80:81]
    v_pk_add_f32 v[34:35], v[34:35], v[82:83]
    v_pk_add_f32 v[32:33], v[32:33], v[84:85]
    v_pk_add_f32 v[34:35], v[34:35], v[86:87]
    v_pk_add_f32 v[32:33], v[32:33], v[88:89]
    v_pk_add_f32 v[34:35], v[34:35], v[90:91]
    v_pk_add_f32 v[32:33], v[32:33], v[92:93]
    v_pk_add_f32 v[34:35], v[34:35], v[94:95]
    v_pk_add_f32 v[32:33], v[32:33], v[34:35]
    v_add_f32 v32, v32, v33
    s_nop 1
    v_add_f32_dpp v32, v32, v32 quad_perm:[1,0,3,2] row_mask:0xf bank_mask:0xf
    s_nop 1
    v_add_f32_dpp v32, v32, v32 quad_perm:[2,3,0,1] row_mask:0xf bank_mask:0xf
    s_nop 1
    v_add_f32_dpp v32, v32, v32 row_half_mirror row_mask:0xf bank_mask:0xf
    s_nop 1
    v_add_f32_dpp v32, v32, v32 row_mirror row_mask:0xf bank_mask:0xf
    v_mov_b32 v33, v32
    s_nop 1
    v_permlane16_swap_b32 v32, v33
    s_nop 1
    v_add_f32 v32, v32, v33
    v_mul_f32 v38, 0xba800000, v32
    v_pk_add_f32 v[96:97], v[64:65], v[38:39] op_sel_hi:[1,0]
    v_pk_mul_f32 v[32:33], v[96:97], v[96:97]
    v_pk_add_f32 v[98:99], v[66:67], v[38:39] op_sel_hi:[1,0]
    v_pk_mul_f32 v[34:35], v[98:99], v[98:99]
    v_pk_add_f32 v[100:101], v[68:69], v[38:39] op_sel_hi:[1,0]
    v_pk_fma_f32 v[32:33], v[100:101], v[100:101], v[32:33]
    v_pk_add_f32 v[102:103], v[70:71], v[38:39] op_sel_hi:[1,0]
    v_pk_fma_f32 v[34:35], v[102:103], v[102:103], v[34:35]
    v_pk_add_f32 v[96:97], v[72:73], v[38:39] op_sel_hi:[1,0]
    v_pk_fma_f32 v[32:33], v[96:97], v[96:97], v[32:33]
    v_pk_add_f32 v[98:99], v[74:75], v[38:39] op_sel_hi:[1,0]
    v_pk_fma_f32 v[34:35], v[98:99], v[98:99], v[34:35]
    v_pk_add_f32 v[100:101], v[76:77], v[38:39] op_sel_hi:[1,0]
    v_pk_fma_f32 v[32:33], v[100:101], v[100:101], v[32:33]
    v_pk_add_f32 v[102:103], v[78:79], v[38:39] op_sel_hi:[1,0]
    v_pk_fma_f32 v[34:35], v[102:103], v[102:103], v[34:35]
    v_pk_add_f32 v[96:97], v[80:81], v[38:39] op_sel_hi:[1,0]
    v_pk_fma_f32 v[32:33], v[96:97], v[96:97], v[32:33]
    v_pk_add_f32 v[98:99], v[82:83], v[38:39] op_sel_hi:[1,0]
    v_pk_fma_f32 v[34:35], v[98:99], v[98:99], v[34:35]
    v_pk_add_f32 v[100:101], v[84:85], v[38:39] op_sel_hi:[1,0]
    v_pk_fma_f32 v[32:33], v[100:101], v[100:101], v[32:33]
    v_pk_add_f32 v[102:103], v[86:87], v[38:39] op_sel_hi:[1,0]
    v_pk_fma_f32 v[34:35], v[102:103], v[102:103], v[34:35]
    v_pk_add_f32 v[96:97], v[88:89], v[38:39] op_sel_hi:[1,0]
    v_pk_fma_f32 v[32:33], v[96:97], v[96:97], v[32:33]
    v_pk_add_f32 v[98:99], v[90:91], v[38:39] op_sel_hi:[1,0]
    v_pk_fma_f32 v[34:35], v[98:99], v[98:99], v[34:35]
    v_pk_add_f32 v[100:101], v[92:93], v[38:39] op_sel_hi:[1,0]
    v_pk_fma_f32 v[32:33], v[100:101], v[100:101], v[32:33]
    v_pk_add_f32 v[102:103], v[94:95], v[38:39] op_sel_hi:[1,0]
    v_pk_fma_f32 v[34:35], v[102:103], v[102:103], v[34:35]
    v_pk_add_f32 v[32:33], v[32:33], v[34:35]
    v_add_f32 v32, v32, v33
    s_nop 1
    v_add_f32_dpp v32, v32, v32 quad_perm:[1,0,3,2] row_mask:0xf bank_mask:0xf
    s_nop 1
    v_add_f32_dpp v32, v32, v32 quad_perm:[2,3,0,1] row_mask:0xf bank_mask:0xf
    s_nop 1
    v_add_f32_dpp v32, v32, v32 row_half_mirror row_mask:0xf bank_mask:0xf
    s_nop 1
    v_add_f32_dpp v32, v32, v32 row_mirror row_mask:0xf bank_mask:0xf
    v_mov_b32 v33, v32
    s_nop 1
    v_permlane16_swap_b32 v32, v33
    s_nop 1
    v_add_f32 v32, v32, v33
    v_mul_f32 v39, 0x3a800000, v32
    v_cvt_pk_bf16_f32 v36, v38, v39
    v_lshlrev_b32_e64 v38, 16, v36
    v_and_b32 v36, 0xffff0000, v36
    v_add_f32 v36, 0x3727c5ac, v36
    v_cvt_pk_bf16_f32 v36, v36, v36
    v_lshlrev_b32 v36, 16, v36
    v_sqrt_f32_e64 v36, v36
    s_nop 0
    v_cvt_pk_bf16_f32 v36, v36, v36
    v_lshlrev_b32 v36, 16, v36
    v_rcp_f32 v36, v36
    v_pk_add_f32 v[64:65], v[64:65], v[38:39] op_sel_hi:[1,0]
    v_pk_add_f32 v[66:67], v[66:67], v[38:39] op_sel_hi:[1,0]
    v_pk_add_f32 v[68:69], v[68:69], v[38:39] op_sel_hi:[1,0]
    v_pk_add_f32 v[70:71], v[70:71], v[38:39] op_sel_hi:[1,0]
    v_cvt_pk_bf16_f32 v40, v64, v65
    v_cvt_pk_bf16_f32 v41, v66, v67
    v_cvt_pk_bf16_f32 v42, v68, v69
    v_cvt_pk_bf16_f32 v43, v70, v71
    v_lshlrev_b32_e64 v64, 16, v40
    v_and_b32 v65, 0xffff0000, v40
    v_lshlrev_b32_e64 v66, 16, v41
    v_and_b32 v67, 0xffff0000, v41
    v_lshlrev_b32_e64 v68, 16, v42
    v_and_b32 v69, 0xffff0000, v42
    v_lshlrev_b32_e64 v70, 16, v43
    v_and_b32 v71, 0xffff0000, v43
    v_pk_mul_f32 v[64:65], v[64:65], v[36:37] op_sel_hi:[1,0]
    v_pk_mul_f32 v[66:67], v[66:67], v[36:37] op_sel_hi:[1,0]
    v_pk_mul_f32 v[68:69], v[68:69], v[36:37] op_sel_hi:[1,0]
    v_pk_mul_f32 v[70:71], v[70:71], v[36:37] op_sel_hi:[1,0]
    v_cvt_pk_bf16_f32 v40, v64, v65
    v_cvt_pk_bf16_f32 v41, v66, v67
    v_cvt_pk_bf16_f32 v42, v68, v69
    v_cvt_pk_bf16_f32 v43, v70, v71
    ds_write_b128 v26, v[40:43] offset:0
    v_pk_add_f32 v[72:73], v[72:73], v[38:39] op_sel_hi:[1,0]
    v_pk_add_f32 v[74:75], v[74:75], v[38:39] op_sel_hi:[1,0]
    v_pk_add_f32 v[76:77], v[76:77], v[38:39] op_sel_hi:[1,0]
    v_pk_add_f32 v[78:79], v[78:79], v[38:39] op_sel_hi:[1,0]
    v_cvt_pk_bf16_f32 v44, v72, v73
    v_cvt_pk_bf16_f32 v45, v74, v75
    v_cvt_pk_bf16_f32 v46, v76, v77
    v_cvt_pk_bf16_f32 v47, v78, v79
    v_lshlrev_b32_e64 v72, 16, v44
    v_and_b32 v73, 0xffff0000, v44
    v_lshlrev_b32_e64 v74, 16, v45
    v_and_b32 v75, 0xffff0000, v45
    v_lshlrev_b32_e64 v76, 16, v46
    v_and_b32 v77, 0xffff0000, v46
    v_lshlrev_b32_e64 v78, 16, v47
    v_and_b32 v79, 0xffff0000, v47
    v_pk_mul_f32 v[72:73], v[72:73], v[36:37] op_sel_hi:[1,0]
    v_pk_mul_f32 v[74:75], v[74:75], v[36:37] op_sel_hi:[1,0]
    v_pk_mul_f32 v[76:77], v[76:77], v[36:37] op_sel_hi:[1,0]
    v_pk_mul_f32 v[78:79], v[78:79], v[36:37] op_sel_hi:[1,0]
    v_cvt_pk_bf16_f32 v44, v72, v73
    v_cvt_pk_bf16_f32 v45, v74, v75
    v_cvt_pk_bf16_f32 v46, v76, v77
    v_cvt_pk_bf16_f32 v47, v78, v79
    ds_write_b128 v26, v[44:47] offset:4096
    v_pk_add_f32 v[80:81], v[80:81], v[38:39] op_sel_hi:[1,0]
    v_pk_add_f32 v[82:83], v[82:83], v[38:39] op_sel_hi:[1,0]
    v_pk_add_f32 v[84:85], v[84:85], v[38:39] op_sel_hi:[1,0]
    v_pk_add_f32 v[86:87], v[86:87], v[38:39] op_sel_hi:[1,0]
    v_cvt_pk_bf16_f32 v48, v80, v81
    v_cvt_pk_bf16_f32 v49, v82, v83
    v_cvt_pk_bf16_f32 v50, v84, v85
    v_cvt_pk_bf16_f32 v51, v86, v87
    v_lshlrev_b32_e64 v80, 16, v48
    v_and_b32 v81, 0xffff0000, v48
    v_lshlrev_b32_e64 v82, 16, v49
    v_and_b32 v83, 0xffff0000, v49
    v_lshlrev_b32_e64 v84, 16, v50
    v_and_b32 v85, 0xffff0000, v50
    v_lshlrev_b32_e64 v86, 16, v51
    v_and_b32 v87, 0xffff0000, v51
    v_pk_mul_f32 v[80:81], v[80:81], v[36:37] op_sel_hi:[1,0]
    v_pk_mul_f32 v[82:83], v[82:83], v[36:37] op_sel_hi:[1,0]
    v_pk_mul_f32 v[84:85], v[84:85], v[36:37] op_sel_hi:[1,0]
    v_pk_mul_f32 v[86:87], v[86:87], v[36:37] op_sel_hi:[1,0]
    v_cvt_pk_bf16_f32 v48, v80, v81
    v_cvt_pk_bf16_f32 v49, v82, v83
    v_cvt_pk_bf16_f32 v50, v84, v85
    v_cvt_pk_bf16_f32 v51, v86, v87
    ds_write_b128 v26, v[48:51] offset:8192
    v_pk_add_f32 v[88:89], v[88:89], v[38:39] op_sel_hi:[1,0]
    v_pk_add_f32 v[90:91], v[90:91], v[38:39] op_sel_hi:[1,0]
    v_pk_add_f32 v[92:93], v[92:93], v[38:39] op_sel_hi:[1,0]
    v_pk_add_f32 v[94:95], v[94:95], v[38:39] op_sel_hi:[1,0]
    v_cvt_pk_bf16_f32 v52, v88, v89
    v_cvt_pk_bf16_f32 v53, v90, v91
    v_cvt_pk_bf16_f32 v54, v92, v93
    v_cvt_pk_bf16_f32 v55, v94, v95
    v_lshlrev_b32_e64 v88, 16, v52
    v_and_b32 v89, 0xffff0000, v52
    v_lshlrev_b32_e64 v90, 16, v53
    v_and_b32 v91, 0xffff0000, v53
    v_lshlrev_b32_e64 v92, 16, v54
    v_and_b32 v93, 0xffff0000, v54
    v_lshlrev_b32_e64 v94, 16, v55
    v_and_b32 v95, 0xffff0000, v55
    v_pk_mul_f32 v[88:89], v[88:89], v[36:37] op_sel_hi:[1,0]
    v_pk_mul_f32 v[90:91], v[90:91], v[36:37] op_sel_hi:[1,0]
    v_pk_mul_f32 v[92:93], v[92:93], v[36:37] op_sel_hi:[1,0]
    v_pk_mul_f32 v[94:95], v[94:95], v[36:37] op_sel_hi:[1,0]
    v_cvt_pk_bf16_f32 v52, v88, v89
    v_cvt_pk_bf16_f32 v53, v90, v91
    v_cvt_pk_bf16_f32 v54, v92, v93
    v_cvt_pk_bf16_f32 v55, v94, v95
    ds_write_b128 v26, v[52:55] offset:12288
    s_waitcnt lgkmcnt(0)
    s_barrier
    ds_read_b128 v[40:43], v27 offset:0
    ds_read_b128 v[44:47], v27 offset:4096
    ds_read_b128 v[48:51], v27 offset:8192
    ds_read_b128 v[52:55], v27 offset:12288
    s_mov_b32 s3, 0
    s_waitcnt lgkmcnt(3)
    buffer_store_dwordx4 v[40:43], v25, s[20:23], s3 offen sc1
    s_mov_b32 s3, 32768
    s_waitcnt lgkmcnt(2)
    buffer_store_dwordx4 v[44:47], v25, s[20:23], s3 offen sc1
    s_mov_b32 s3, 65536
    s_waitcnt lgkmcnt(1)
    buffer_store_dwordx4 v[48:51], v25, s[20:23], s3 offen sc1
    s_mov_b32 s3, 98304
    s_waitcnt lgkmcnt(0)
    buffer_store_dwordx4 v[52:55], v25, s[20:23], s3 offen sc1
    s_waitcnt vmcnt(4)
    s_mov_b32 s3, 0x3fb8aa3b
    s_mov_b32 s4, 0x3e22f983
    s_mov_b32 s6, 0x31dc9c88
    s_cmp_ge_u32 s26, 4
    s_cbranch_scc1 L_noparB
    v_lshlrev_b32 v56, 16, v56
    v_lshlrev_b32 v57, 16, v57
    v_lshlrev_b32 v58, 16, v58
    v_mul_f32 v68, s3, v58
    v_exp_f32_e64 v68, v68
    s_nop 0
    v_cvt_pk_bf16_f32 v68, v68, v68
    v_lshlrev_b32 v68, 16, v68
    v_mul_f32 v69, v68, v56
    v_mul_f32 v70, v68, v57
    v_mul_f32 v73, s3, v69
    v_exp_f32 v73, v73
    v_mul_f32 v71, s4, v70
    v_fma_f32 v72, v70, s4, -v71
    v_fma_f32 v72, v70, s6, v72
    v_rndne_f32 v64, v71
    v_sub_f32 v71, v71, v64
    v_add_f32 v71, v71, v72
    v_cos_f32 v64, v71
    v_sin_f32 v65, v71
    s_nop 0
    v_mul_f32 v64, v64, v73
    v_mul_f32 v65, v65, v73
    v_add_f32 v68, -1.0, v64
    v_mul_f32 v69, v56, v56
    v_fmac_f32 v69, v57, v57
    v_rcp_f32 v69, v69
    v_mul_f32 v66, v68, v56
    v_fmac_f32 v66, v65, v57
    v_mul_f32_e64 v67, v65, v56
    v_fma_f32 v67, -v68, v57, v67
    v_mul_f32 v66, v66, v69
    v_mul_f32 v67, v67, v69
    v_lshlrev_b32_e64 v74, 1, v28
    v_add_u32 v74, 151552, v74
    v_add_u32 v75, 152832, v28
    v_cmp_gt_u32 vcc, 80, v0
    s_nop 1
    s_mov_b64 exec, vcc
    ds_write_b128 v74, v[64:67]
    s_mov_b64 exec, -1
    v_pk_mul_f32 v[76:77], v[64:65], v[64:65] op_sel_hi:[1,0]
    v_pk_fma_f32 v[76:77], v[64:65], v[64:65], v[76:77] op_sel:[1,1,0] op_sel_hi:[0,1,1] neg_lo:[0,1,0]
    v_pk_mul_f32 v[78:79], v[76:77], v[76:77] op_sel_hi:[1,0]
    v_pk_fma_f32 v[78:79], v[76:77], v[76:77], v[78:79] op_sel:[1,1,0] op_sel_hi:[0,1,1] neg_lo:[0,1,0]
    v_pk_mul_f32 v[76:77], v[78:79], v[78:79] op_sel_hi:[1,0]
    v_pk_fma_f32 v[76:77], v[78:79], v[78:79], v[76:77] op_sel:[1,1,0] op_sel_hi:[0,1,1] neg_lo:[0,1,0]
    v_pk_mul_f32 v[78:79], v[76:77], v[76:77] op_sel_hi:[1,0]
    v_pk_fma_f32 v[78:79], v[76:77], v[76:77], v[78:79] op_sel:[1,1,0] op_sel_hi:[0,1,1] neg_lo:[0,1,0]
    v_mov_b32 v80, 1.0
    v_mov_b32 v81, 0
    s_mov_b64 exec, vcc
    ds_write_b64 v75, v[80:81]
    ds_write_b64 v75, v[78:79] offset:640
    s_mov_b64 exec, -1
    v_pk_mul_f32 v[84:85], v[78:79], v[78:79] op_sel_hi:[1,0]
    v_pk_fma_f32 v[84:85], v[78:79], v[78:79], v[84:85] op_sel:[1,1,0] op_sel_hi:[0,1,1] neg_lo:[0,1,0]
    s_mov_b64 exec, vcc
    ds_write_b64 v75, v[84:85] offset:1280
    s_mov_b64 exec, -1
    v_pk_mul_f32 v[86:87], v[84:85], v[78:79] op_sel_hi:[1,0]
    v_pk_fma_f32 v[86:87], v[84:85], v[78:79], v[86:87] op_sel:[1,1,0] op_sel_hi:[0,1,1] neg_lo:[0,1,0]
    s_mov_b64 exec, vcc
    ds_write_b64 v75, v[86:87] offset:1920
    s_mov_b64 exec, -1
    v_pk_mul_f32 v[80:81], v[86:87], v[78:79] op_sel_hi:[1,0]
    v_pk_fma_f32 v[80:81], v[86:87], v[78:79], v[80:81] op_sel:[1,1,0] op_sel_hi:[0,1,1] neg_lo:[0,1,0]
    s_mov_b64 exec, vcc
    ds_write_b64 v75, v[80:81] offset:2560
    s_mov_b64 exec, -1
    v_pk_mul_f32 v[82:83], v[80:81], v[78:79] op_sel_hi:[1,0]
    v_pk_fma_f32 v[82:83], v[80:81], v[78:79], v[82:83] op_sel:[1,1,0] op_sel_hi:[0,1,1] neg_lo:[0,1,0]
    s_mov_b64 exec, vcc
    ds_write_b64 v75, v[82:83] offset:3200
    s_mov_b64 exec, -1
    v_pk_mul_f32 v[84:85], v[82:83], v[78:79] op_sel_hi:[1,0]
    v_pk_fma_f32 v[84:85], v[82:83], v[78:79], v[84:85] op_sel:[1,1,0] op_sel_hi:[0,1,1] neg_lo:[0,1,0]
    s_mov_b64 exec, vcc
    ds_write_b64 v75, v[84:85] offset:3840
    s_mov_b64 exec, -1
    v_pk_mul_f32 v[86:87], v[84:85], v[78:79] op_sel_hi:[1,0]
    v_pk_fma_f32 v[86:87], v[84:85], v[78:79], v[86:87] op_sel:[1,1,0] op_sel_hi:[0,1,1] neg_lo:[0,1,0]
    s_mov_b64 exec, vcc
    ds_write_b64 v75, v[86:87] offset:4480
    s_mov_b64 exec, -1
    v_pk_mul_f32 v[80:81], v[86:87], v[78:79] op_sel_hi:[1,0]
    v_pk_fma_f32 v[80:81], v[86:87], v[78:79], v[80:81] op_sel:[1,1,0] op_sel_hi:[0,1,1] neg_lo:[0,1,0]
    s_mov_b64 exec, vcc
    ds_write_b64 v75, v[80:81] offset:5120
    s_mov_b64 exec, -1
    v_pk_mul_f32 v[82:83], v[80:81], v[78:79] op_sel_hi:[1,0]
    v_pk_fma_f32 v[82:83], v[80:81], v[78:79], v[82:83] op_sel:[1,1,0] op_sel_hi:[0,1,1] neg_lo:[0,1,0]
    s_mov_b64 exec, vcc
    ds_write_b64 v75, v[82:83] offset:5760
    s_mov_b64 exec, -1
    v_pk_mul_f32 v[84:85], v[82:83], v[78:79] op_sel_hi:[1,0]
    v_pk_fma_f32 v[84:85], v[82:83], v[78:79], v[84:85] op_sel:[1,1,0] op_sel_hi:[0,1,1] neg_lo:[0,1,0]
    s_mov_b64 exec, vcc
    ds_write_b64 v75, v[84:85] offset:6400
    s_mov_b64 exec, -1
    v_pk_mul_f32 v[86:87], v[84:85], v[78:79] op_sel_hi:[1,0]
    v_pk_fma_f32 v[86:87], v[84:85], v[78:79], v[86:87] op_sel:[1,1,0] op_sel_hi:[0,1,1] neg_lo:[0,1,0]
    s_mov_b64 exec, vcc
    ds_write_b64 v75, v[86:87] offset:7040
    s_mov_b64 exec, -1
    v_pk_mul_f32 v[80:81], v[86:87], v[78:79] op_sel_hi:[1,0]
    v_pk_fma_f32 v[80:81], v[86:87], v[78:79], v[80:81] op_sel:[1,1,0] op_sel_hi:[0,1,1] neg_lo:[0,1,0]
    s_mov_b64 exec, vcc
    ds_write_b64 v75, v[80:81] offset:7680
    s_mov_b64 exec, -1
    v_pk_mul_f32 v[82:83], v[80:81], v[78:79] op_sel_hi:[1,0]
    v_pk_fma_f32 v[82:83], v[80:81], v[78:79], v[82:83] op_sel:[1,1,0] op_sel_hi:[0,1,1] neg_lo:[0,1,0]
    s_mov_b64 exec, vcc
    ds_write_b64 v75, v[82:83] offset:8320
    s_mov_b64 exec, -1
    v_pk_mul_f32 v[84:85], v[82:83], v[78:79] op_sel_hi:[1,0]
    v_pk_fma_f32 v[84:85], v[82:83], v[78:79], v[84:85] op_sel:[1,1,0] op_sel_hi:[0,1,1] neg_lo:[0,1,0]
    s_mov_b64 exec, vcc
    ds_write_b64 v75, v[84:85] offset:8960
    s_mov_b64 exec, -1
    v_pk_mul_f32 v[86:87], v[84:85], v[78:79] op_sel_hi:[1,0]
    v_pk_fma_f32 v[86:87], v[84:85], v[78:79], v[86:87] op_sel:[1,1,0] op_sel_hi:[0,1,1] neg_lo:[0,1,0]
    s_mov_b64 exec, vcc
    ds_write_b64 v75, v[86:87] offset:9600
    s_mov_b64 exec, -1
    v_pk_mul_f32 v[80:81], v[86:87], v[78:79] op_sel_hi:[1,0]
    v_pk_fma_f32 v[80:81], v[86:87], v[78:79], v[80:81] op_sel:[1,1,0] op_sel_hi:[0,1,1] neg_lo:[0,1,0]
    v_accvgpr_write_b32 a230, v78
    v_accvgpr_write_b32 a231, v79
    v_accvgpr_write_b32 a232, v80
    v_accvgpr_write_b32 a233, v81
L_noparB:
    s_waitcnt vmcnt(0) lgkmcnt(0)
    s_barrier
    s_cmp_lg_u32 s26, 0
    s_cbranch_scc1 L_sigxB
    s_lshl_b32 s3, s2, 7
    s_add_u32 s3, s3, 35913728
    s_mov_b64 exec, 1
    buffer_store_dwordx2 a[248:249], off, s[20:23], s3 sc1
    s_mov_b64 exec, -1
L_sigxB:
    s_mov_b32 m0, s30
    s_nop 0
    buffer_load_dwordx4 v1, s[8:11], s27 offen offset:0 nt lds
    buffer_load_dwordx4 v2, s[8:11], s27 offen offset:1056 nt lds
    buffer_load_dwordx4 v3, s[8:11], s27 offen offset:2112 nt lds
    buffer_load_dwordx4 v4, s[8:11], s27 offen offset:3168 nt lds
    s_mov_b32 m0, s32
    s_add_u32 s27, s27, 458752
    buffer_load_dwordx4 v5, s[12:15], s28 offen offset:0 nt lds
    buffer_load_dwordx4 v6, s[12:15], s28 offen offset:1024 nt lds
    buffer_load_dwordx4 v7, s[12:15], s28 offen offset:2048 nt lds
    buffer_load_dwordx4 v8, s[12:15], s28 offen offset:3072 nt lds
    s_add_u32 m0, s32, 4096
    s_nop 0
    buffer_load_dwordx4 v9, s[12:15], s28 offen offset:0 nt lds
    s_add_u32 s28, s28, 128
    s_add_u32 s30, s30, s34
    s_add_u32 s32, s32, s34
    s_mov_b32 m0, s31
    s_nop 0
    buffer_load_dwordx4 v1, s[8:11], s27 offen offset:0 nt lds
    buffer_load_dwordx4 v2, s[8:11], s27 offen offset:1056 nt lds
    buffer_load_dwordx4 v3, s[8:11], s27 offen offset:2112 nt lds
    buffer_load_dwordx4 v4, s[8:11], s27 offen offset:3168 nt lds
    s_mov_b32 m0, s33
    s_add_u32 s27, s27, 458752
    buffer_load_dwordx4 v5, s[12:15], s28 offen offset:0 nt lds
    buffer_load_dwordx4 v6, s[12:15], s28 offen offset:1024 nt lds
    buffer_load_dwordx4 v7, s[12:15], s28 offen offset:2048 nt lds
    buffer_load_dwordx4 v8, s[12:15], s28 offen offset:3072 nt lds
    s_add_u32 m0, s33, 4096
    s_nop 0
    buffer_load_dwordx4 v9, s[12:15], s28 offen offset:0 nt lds
    s_add_u32 s28, s28, 128
    s_add_u32 s31, s31, s34
    s_add_u32 s33, s33, s34
    v_mov_b32 v32, 0
    v_mov_b32 v33, 0
    v_mov_b32 v34, 0
    v_mov_b32 v35, 0
    v_mov_b32 v36, 0
    v_mov_b32 v37, 0
    v_mov_b32 v38, 0
    v_mov_b32 v39, 0
    v_mov_b32 v40, 0
    v_mov_b32 v41, 0
    v_mov_b32 v42, 0
    v_mov_b32 v43, 0
    v_mov_b32 v44, 0
    v_mov_b32 v45, 0
    v_mov_b32 v46, 0
    v_mov_b32 v47, 0
    v_mov_b32 v48, 0
    v_mov_b32 v49, 0
    v_mov_b32 v50, 0
    v_mov_b32 v51, 0
    v_mov_b32 v52, 0
    v_mov_b32 v53, 0
    v_mov_b32 v54, 0
    v_mov_b32 v55, 0
    v_mov_b32 v56, 0
    v_mov_b32 v57, 0
    v_mov_b32 v58, 0
    v_mov_b32 v59, 0
    v_mov_b32 v60, 0
    v_mov_b32 v61, 0
    v_mov_b32 v62, 0
    v_mov_b32 v63, 0
    v_mov_b32 v64, 0
    v_mov_b32 v65, 0
    v_mov_b32 v66, 0
    v_mov_b32 v67, 0
    v_mov_b32 v68, 0
    v_mov_b32 v69, 0
    v_mov_b32 v70, 0
    v_mov_b32 v71, 0
    v_mov_b32 v72, 0
    v_mov_b32 v73, 0
    v_mov_b32 v74, 0
    v_mov_b32 v75, 0
    v_mov_b32 v76, 0
    v_mov_b32 v77, 0
    v_mov_b32 v78, 0
    v_mov_b32 v79, 0
    v_mov_b32 v80, 0
    v_mov_b32 v81, 0
    v_mov_b32 v82, 0
    v_mov_b32 v83, 0
    v_mov_b32 v84, 0
    v_mov_b32 v85, 0
    v_mov_b32 v86, 0
    v_mov_b32 v87, 0
    v_mov_b32 v88, 0
    v_mov_b32 v89, 0
    v_mov_b32 v90, 0
    v_mov_b32 v91, 0
    v_mov_b32 v92, 0
    v_mov_b32 v93, 0
    v_mov_b32 v94, 0
    v_mov_b32 v95, 0
    v_mov_b32 v96, 0
    v_mov_b32 v97, 0
    v_mov_b32 v98, 0
    v_mov_b32 v99, 0
    v_mov_b32 v100, 0
    v_mov_b32 v101, 0
    v_mov_b32 v102, 0
    v_mov_b32 v103, 0
    v_and_b32 v26, 31, v0
    v_lshlrev_b32_e64 v26, 7, v26
    s_lshl_b32 s58, s24, 12
    s_add_u32 s58, s58, 35913728
    buffer_load_dwordx2 v[30:31], v26, s[20:23], s58 offen sc1
    s_waitcnt vmcnt(10) lgkmcnt(0)
    s_barrier
    v_and_b32 v19, 15, v18
    v_lshlrev_b32 v20, 4, v19
    v_add_u32 v20, 151552, v20
    v_lshrrev_b32_e64 v21, 4, v0
    v_mul_u32_u24 v21, 640, v21
    v_lshl_add_u32 v21, v19, 3, v21
    v_add_u32 v21, 152832, v21
    ds_read_b128 a[200:203], v20 offset:0
    ds_read_b64 a[204:205], v21 offset:0
    ds_read_b128 a[206:209], v20 offset:256
    ds_read_b64 a[210:211], v21 offset:128
    ds_read_b128 a[212:215], v20 offset:512
    ds_read_b64 a[216:217], v21 offset:256
    ds_read_b128 a[218:221], v20 offset:768
    ds_read_b64 a[222:223], v21 offset:384
    ds_read_b128 a[224:227], v20 offset:1024
    ds_read_b64 a[228:229], v21 offset:512
    ds_read_b64_tr_b16 a[64:65], v11 offset:0
    ds_read_b64_tr_b16 a[66:67], v11 offset:256
    ds_read_b64_tr_b16 a[68:69], v11 offset:4224
    ds_read_b64_tr_b16 a[70:71], v11 offset:4480
    ds_read_b64_tr_b16 a[72:73], v11 offset:8448
    ds_read_b64_tr_b16 a[74:75], v11 offset:8704
    ds_read_b64_tr_b16 a[76:77], v11 offset:12672
    ds_read_b64_tr_b16 a[78:79], v11 offset:12928
    ds_read_b64_tr_b16 a[80:81], v11 offset:32
    ds_read_b64_tr_b16 a[82:83], v11 offset:288
    ds_read_b64_tr_b16 a[84:85], v11 offset:4256
    ds_read_b64_tr_b16 a[86:87], v11 offset:4512
    ds_read_b64_tr_b16 a[88:89], v11 offset:8480
    ds_read_b64_tr_b16 a[90:91], v11 offset:8736
    ds_read_b64_tr_b16 a[92:93], v11 offset:12704
    ds_read_b64_tr_b16 a[94:95], v11 offset:12960
    ds_read_b64_tr_b16 a[96:97], v11 offset:64
    ds_read_b64_tr_b16 a[98:99], v11 offset:320
    ds_read_b64_tr_b16 a[100:101], v11 offset:4288
    ds_read_b64_tr_b16 a[102:103], v11 offset:4544
    ds_read_b64_tr_b16 a[104:105], v11 offset:8512
    ds_read_b64_tr_b16 a[106:107], v11 offset:8768
    ds_read_b64_tr_b16 a[108:109], v11 offset:12736
    ds_read_b64_tr_b16 a[110:111], v11 offset:12992
    ds_read_b64_tr_b16 a[112:113], v11 offset:96
    ds_read_b64_tr_b16 a[114:115], v11 offset:352
    ds_read_b64_tr_b16 a[116:117], v11 offset:4320
    ds_read_b64_tr_b16 a[118:119], v11 offset:4576
    ds_read_b64_tr_b16 a[120:121], v11 offset:8544
    ds_read_b64_tr_b16 a[122:123], v11 offset:8800
    ds_read_b64_tr_b16 a[124:125], v11 offset:12768
    ds_read_b64_tr_b16 a[126:127], v11 offset:13024
    ds_read_b128 a[128:131], v13 offset:0
    ds_read_b128 a[132:135], v14 offset:0
    s_mov_b32 s55, 0x40000
    s_waitcnt vmcnt(0)
L_wxB:
    v_cmp_ne_u64 vcc, s[48:49], v[30:31]
    s_cbranch_vccz L_gxB
    s_sleep 1
    buffer_load_dwordx2 v[30:31], v26, s[20:23], s58 offen sc1
    s_waitcnt vmcnt(0)
    s_sub_u32 s55, s55, 1
    s_cmp_lg_u32 s55, 0
    s_cbranch_scc1 L_wxB
L_gxB:
    buffer_load_dwordx4 a[136:139], v10, s[16:19], s29 offen offset:0 sc1
    buffer_load_dwordx4 a[140:143], v10, s[16:19], s29 offen offset:1024 sc1
    buffer_load_dwordx4 a[144:147], v10, s[16:19], s29 offen offset:2048 sc1
    buffer_load_dwordx4 a[148:151], v10, s[16:19], s29 offen offset:3072 sc1
    s_add_u32 s29, s29, 4096
    buffer_load_dwordx4 a[152:155], v10, s[16:19], s29 offen offset:0 sc1
    buffer_load_dwordx4 a[156:159], v10, s[16:19], s29 offen offset:1024 sc1
    buffer_load_dwordx4 a[160:163], v10, s[16:19], s29 offen offset:2048 sc1
    buffer_load_dwordx4 a[164:167], v10, s[16:19], s29 offen offset:3072 sc1
    s_add_u32 s29, s29, 4096
    s_mov_b32 m0, s30
    s_nop 0
    buffer_load_dwordx4 v1, s[8:11], s27 offen offset:0 nt lds
    buffer_load_dwordx4 v2, s[8:11], s27 offen offset:1056 nt lds
    buffer_load_dwordx4 v3, s[8:11], s27 offen offset:2112 nt lds
    buffer_load_dwordx4 v4, s[8:11], s27 offen offset:3168 nt lds
    s_mov_b32 m0, s32
    s_add_u32 s27, s27, 458752
    buffer_load_dwordx4 v5, s[12:15], s28 offen offset:0 nt lds
    buffer_load_dwordx4 v6, s[12:15], s28 offen offset:1024 nt lds
    global_load_dword a236, v24, s[52:53]
    v_add_u32 v24, 262144, v24
    s_mov_b32 s34, 0xfffed800
    s_mov_b32 s35, 0
    s_waitcnt vmcnt(7) lgkmcnt(0)
    .p2align 6
L_k2_loopB:
    s_waitcnt vmcnt(10) lgkmcnt(6)
    v_mfma_f32_16x16x32_bf16 v[32:35], a[64:67], a[136:139], v[32:35]
    v_mfma_f32_16x16x32_bf16 v[32:35], a[68:71], a[152:155], v[32:35]
    buffer_load_dwordx4 a[168:171], v10, s[16:19], s29 offen offset:0 sc1
    v_mfma_f32_16x16x32_bf16 v[36:39], a[68:71], a[156:159], v[36:39]
    v_mfma_f32_16x16x32_bf16 v[36:39], a[64:67], a[140:143], v[36:39]
    v_mfma_f32_16x16x32_bf16 v[40:43], a[64:67], a[144:147], v[40:43]
    v_mfma_f32_16x16x32_bf16 v[40:43], a[68:71], a[160:163], v[40:43]
    buffer_load_dwordx4 a[172:175], v10, s[16:19], s29 offen offset:1024 sc1
    v_mfma_f32_16x16x32_bf16 v[44:47], a[68:71], a[164:167], v[44:47]
    ds_read_b128 a[68:71], v14 offset:2048
    v_mfma_f32_16x16x32_bf16 v[44:47], a[64:67], a[148:151], v[44:47]
    ds_read_b128 a[64:67], v13 offset:2048
    v_mfma_f32_16x16x32_bf16 v[60:63], a[72:75], a[148:151], v[60:63]
    v_mfma_f32_16x16x32_bf16 v[60:63], a[76:79], a[164:167], v[60:63]
    buffer_load_dwordx4 a[176:179], v10, s[16:19], s29 offen offset:2048 sc1
    v_mfma_f32_16x16x32_bf16 v[56:59], a[76:79], a[160:163], v[56:59]
    v_mfma_f32_16x16x32_bf16 v[56:59], a[72:75], a[144:147], v[56:59]
    v_mfma_f32_16x16x32_bf16 v[52:55], a[72:75], a[140:143], v[52:55]
    v_mfma_f32_16x16x32_bf16 v[52:55], a[76:79], a[156:159], v[52:55]
    buffer_load_dwordx4 a[180:183], v10, s[16:19], s29 offen offset:3072 sc1
    v_mfma_f32_16x16x32_bf16 v[48:51], a[76:79], a[152:155], v[48:51]
    ds_read_b128 a[76:79], v14 offset:4096
    v_mfma_f32_16x16x32_bf16 v[48:51], a[72:75], a[136:139], v[48:51]
    ds_read_b128 a[72:75], v13 offset:4096
    v_mfma_f32_16x16x32_bf16 v[64:67], a[80:83], a[136:139], v[64:67]
    v_mfma_f32_16x16x32_bf16 v[64:67], a[84:87], a[152:155], v[64:67]
    s_add_u32 s29, s29, 4096
    v_mfma_f32_16x16x32_bf16 v[68:71], a[84:87], a[156:159], v[68:71]
    v_mfma_f32_16x16x32_bf16 v[68:71], a[80:83], a[140:143], v[68:71]
    v_mfma_f32_16x16x32_bf16 v[72:75], a[80:83], a[144:147], v[72:75]
    v_mfma_f32_16x16x32_bf16 v[72:75], a[84:87], a[160:163], v[72:75]
    buffer_load_dwordx4 a[184:187], v10, s[16:19], s29 offen offset:0 sc1
    v_mfma_f32_16x16x32_bf16 v[76:79], a[84:87], a[164:167], v[76:79]
    ds_read_b128 a[84:87], v14 offset:6144
    v_mfma_f32_16x16x32_bf16 v[76:79], a[80:83], a[148:151], v[76:79]
    ds_read_b128 a[80:83], v13 offset:6144
    v_mfma_f32_16x16x32_bf16 v[92:95], a[88:91], a[148:151], v[92:95]
    v_mfma_f32_16x16x32_bf16 v[92:95], a[92:95], a[164:167], v[92:95]
    buffer_load_dwordx4 a[188:191], v10, s[16:19], s29 offen offset:1024 sc1
    v_mfma_f32_16x16x32_bf16 v[88:91], a[92:95], a[160:163], v[88:91]
    v_mfma_f32_16x16x32_bf16 v[88:91], a[88:91], a[144:147], v[88:91]
    v_mfma_f32_16x16x32_bf16 v[84:87], a[88:91], a[140:143], v[84:87]
    v_mfma_f32_16x16x32_bf16 v[84:87], a[92:95], a[156:159], v[84:87]
    buffer_load_dwordx4 a[192:195], v10, s[16:19], s29 offen offset:2048 sc1
    v_mfma_f32_16x16x32_bf16 v[80:83], a[92:95], a[152:155], v[80:83]
    ds_read_b128 a[92:95], v14 offset:8192
    v_mfma_f32_16x16x32_bf16 v[80:83], a[88:91], a[136:139], v[80:83]
    ds_read_b128 a[88:91], v13 offset:8192
    v_mfma_f32_16x16x32_bf16 v[96:99], a[96:99], a[136:139], v[96:99]
    v_mfma_f32_16x16x32_bf16 v[96:99], a[100:103], a[152:155], v[96:99]
    buffer_load_dwordx4 a[196:199], v10, s[16:19], s29 offen offset:3072 sc1
    v_mfma_f32_16x16x32_bf16 v[100:103], a[100:103], a[156:159], v[100:103]
    v_mfma_f32_16x16x32_bf16 v[100:103], a[96:99], a[140:143], v[100:103]
    v_mfma_f32_16x16x32_bf16 v[104:107], a[96:99], a[144:147], v[104:107]
    v_mfma_f32_16x16x32_bf16 v[104:107], a[100:103], a[160:163], v[104:107]
    s_add_u32 s29, s29, 4096
    v_mfma_f32_16x16x32_bf16 v[108:111], a[100:103], a[164:167], v[108:111]
    ds_read_b128 a[100:103], v14 offset:10240
    v_mfma_f32_16x16x32_bf16 v[108:111], a[96:99], a[148:151], v[108:111]
    ds_read_b128 a[96:99], v13 offset:10240
    v_mfma_f32_16x16x32_bf16 v[124:127], a[104:107], a[148:151], v[124:127]
    v_mfma_f32_16x16x32_bf16 v[124:127], a[108:111], a[164:167], v[124:127]
    buffer_load_dwordx4 v7, s[12:15], s28 offen offset:2048 nt lds
    v_mfma_f32_16x16x32_bf16 v[120:123], a[108:111], a[160:163], v[120:123]
    v_mfma_f32_16x16x32_bf16 v[120:123], a[104:107], a[144:147], v[120:123]
    v_mfma_f32_16x16x32_bf16 v[116:119], a[104:107], a[140:143], v[116:119]
    v_mfma_f32_16x16x32_bf16 v[116:119], a[108:111], a[156:159], v[116:119]
    buffer_load_dwordx4 v8, s[12:15], s28 offen offset:3072 nt lds
    v_mfma_f32_16x16x32_bf16 v[112:115], a[108:111], a[152:155], v[112:115]
    ds_read_b128 a[108:111], v14 offset:12288
    v_mfma_f32_16x16x32_bf16 v[112:115], a[104:107], a[136:139], v[112:115]
    ds_read_b128 a[104:107], v13 offset:12288
    v_mfma_f32_16x16x32_bf16 v[128:131], a[112:115], a[136:139], v[128:131]
    v_mfma_f32_16x16x32_bf16 v[128:131], a[116:119], a[152:155], v[128:131]
    s_add_u32 m0, s32, 4096
    v_mfma_f32_16x16x32_bf16 v[132:135], a[116:119], a[156:159], v[132:135]
    v_mfma_f32_16x16x32_bf16 v[132:135], a[112:115], a[140:143], v[132:135]
    v_mfma_f32_16x16x32_bf16 v[136:139], a[112:115], a[144:147], v[136:139]
    v_mfma_f32_16x16x32_bf16 v[136:139], a[116:119], a[160:163], v[136:139]
    buffer_load_dwordx4 v9, s[12:15], s28 offen offset:0 nt lds
    v_mfma_f32_16x16x32_bf16 v[140:143], a[116:119], a[164:167], v[140:143]
    ds_read_b128 a[116:119], v14 offset:14336
    v_mfma_f32_16x16x32_bf16 v[140:143], a[112:115], a[148:151], v[140:143]
    ds_read_b128 a[112:115], v13 offset:14336
    s_waitcnt lgkmcnt(6)
    v_mfma_f32_16x16x32_bf16 v[156:159], a[120:123], a[148:151], v[156:159]
    v_mfma_f32_16x16x32_bf16 v[156:159], a[124:127], a[164:167], v[156:159]
    s_add_u32 s28, s28, 128
    v_mfma_f32_16x16x32_bf16 v[152:155], a[124:127], a[160:163], v[152:155]
    v_mfma_f32_16x16x32_bf16 v[152:155], a[120:123], a[144:147], v[152:155]
    v_mfma_f32_16x16x32_bf16 v[148:151], a[120:123], a[140:143], v[148:151]
    v_mfma_f32_16x16x32_bf16 v[148:151], a[124:127], a[156:159], v[148:151]
    s_add_u32 s30, s30, s34
    v_mfma_f32_16x16x32_bf16 v[144:147], a[124:127], a[152:155], v[144:147]
    ds_read_b128 a[124:127], v14 offset:16384
    v_mfma_f32_16x16x32_bf16 v[144:147], a[120:123], a[136:139], v[144:147]
    ds_read_b128 a[120:123], v13 offset:16384
    v_mfma_f32_16x16x32_bf16 v[160:163], a[136:139], a[128:131], v[160:163]
    v_mfma_f32_16x16x32_bf16 v[160:163], a[152:155], a[132:135], v[160:163]
    s_add_u32 s32, s32, s34
    v_mfma_f32_16x16x32_bf16 v[164:167], a[156:159], a[132:135], v[164:167]
    v_mfma_f32_16x16x32_bf16 v[164:167], a[140:143], a[128:131], v[164:167]
    v_mfma_f32_16x16x32_bf16 v[168:171], a[144:147], a[128:131], v[168:171]
    v_mfma_f32_16x16x32_bf16 v[168:171], a[160:163], a[132:135], v[168:171]
    v_mfma_f32_16x16x32_bf16 v[172:175], a[164:167], a[132:135], v[172:175]
    ds_read_b128 a[132:135], v14 offset:18432
    v_mfma_f32_16x16x32_bf16 v[172:175], a[148:151], a[128:131], v[172:175]
    ds_read_b128 a[128:131], v13 offset:18432
    v_mfma_f32_16x16x32_bf16 v[176:179], a[136:139], a[64:67], v[176:179]
    v_mfma_f32_16x16x32_bf16 v[176:179], a[152:155], a[68:71], v[176:179]
    s_mov_b32 m0, s31
    v_mfma_f32_16x16x32_bf16 v[180:183], a[156:159], a[68:71], v[180:183]
    v_mfma_f32_16x16x32_bf16 v[180:183], a[140:143], a[64:67], v[180:183]
    v_mfma_f32_16x16x32_bf16 v[184:187], a[144:147], a[64:67], v[184:187]
    v_mfma_f32_16x16x32_bf16 v[184:187], a[160:163], a[68:71], v[184:187]
    v_mfma_f32_16x16x32_bf16 v[188:191], a[164:167], a[68:71], v[188:191]
    v_mfma_f32_16x16x32_bf16 v[188:191], a[148:151], a[64:67], v[188:191]
    buffer_load_dwordx4 v1, s[8:11], s27 offen offset:0 nt lds
    v_mfma_f32_16x16x32_bf16 v[204:207], a[148:151], a[72:75], v[204:207]
    v_mfma_f32_16x16x32_bf16 v[204:207], a[164:167], a[76:79], v[204:207]
    v_mfma_f32_16x16x32_bf16 v[200:203], a[160:163], a[76:79], v[200:203]
    v_mfma_f32_16x16x32_bf16 v[200:203], a[144:147], a[72:75], v[200:203]
    s_waitcnt vmcnt(19)
    s_waitcnt lgkmcnt(0)
    s_barrier
    ds_read_b64_tr_b16 a[68:69], v12 offset:4224
    v_mfma_f32_16x16x32_bf16 v[196:199], a[140:143], a[72:75], v[196:199]
    ds_read_b64_tr_b16 a[70:71], v12 offset:4480
    v_mfma_f32_16x16x32_bf16 v[196:199], a[156:159], a[76:79], v[196:199]
    ds_read_b64_tr_b16 a[64:65], v12 offset:0
    v_mfma_f32_16x16x32_bf16 v[192:195], a[152:155], a[76:79], v[192:195]
    ds_read_b64_tr_b16 a[66:67], v12 offset:256
    v_mfma_f32_16x16x32_bf16 v[192:195], a[136:139], a[72:75], v[192:195]
    ds_read_b64_tr_b16 a[76:77], v12 offset:12672
    v_mfma_f32_16x16x32_bf16 v[208:211], a[136:139], a[80:83], v[208:211]
    ds_read_b64_tr_b16 a[78:79], v12 offset:12928
    v_mfma_f32_16x16x32_bf16 v[208:211], a[152:155], a[84:87], v[208:211]
    ds_read_b64_tr_b16 a[72:73], v12 offset:8448
    v_mfma_f32_16x16x32_bf16 v[212:215], a[156:159], a[84:87], v[212:215]
    ds_read_b64_tr_b16 a[74:75], v12 offset:8704
    v_mfma_f32_16x16x32_bf16 v[212:215], a[140:143], a[80:83], v[212:215]
    buffer_load_dwordx4 v2, s[8:11], s27 offen offset:1056 nt lds
    v_mfma_f32_16x16x32_bf16 v[216:219], a[144:147], a[80:83], v[216:219]
    buffer_load_dwordx4 v3, s[8:11], s27 offen offset:2112 nt lds
    v_mfma_f32_16x16x32_bf16 v[216:219], a[160:163], a[84:87], v[216:219]
    v_mfma_f32_16x16x32_bf16 v[220:223], a[164:167], a[84:87], v[220:223]
    ds_read_b64_tr_b16 a[84:85], v12 offset:4256
    v_mfma_f32_16x16x32_bf16 v[220:223], a[148:151], a[80:83], v[220:223]
    ds_read_b64_tr_b16 a[86:87], v12 offset:4512
    v_mfma_f32_16x16x32_bf16 v[236:239], a[148:151], a[88:91], v[236:239]
    ds_read_b64_tr_b16 a[80:81], v12 offset:32
    v_mfma_f32_16x16x32_bf16 v[236:239], a[164:167], a[92:95], v[236:239]
    ds_read_b64_tr_b16 a[82:83], v12 offset:288
    v_mfma_f32_16x16x32_bf16 v[232:235], a[160:163], a[92:95], v[232:235]
    buffer_load_dwordx4 v4, s[8:11], s27 offen offset:3168 nt lds
    v_mfma_f32_16x16x32_bf16 v[232:235], a[144:147], a[88:91], v[232:235]
    v_mfma_f32_16x16x32_bf16 v[228:231], a[140:143], a[88:91], v[228:231]
    v_mfma_f32_16x16x32_bf16 v[228:231], a[156:159], a[92:95], v[228:231]
    v_mfma_f32_16x16x32_bf16 v[224:227], a[152:155], a[92:95], v[224:227]
    ds_read_b64_tr_b16 a[92:93], v12 offset:12704
    v_mfma_f32_16x16x32_bf16 v[224:227], a[136:139], a[88:91], v[224:227]
    ds_read_b64_tr_b16 a[94:95], v12 offset:12960
    v_mfma_f32_16x16x32_bf16 v[240:243], a[136:139], a[96:99], v[240:243]
    ds_read_b64_tr_b16 a[88:89], v12 offset:8480
    v_mfma_f32_16x16x32_bf16 v[240:243], a[152:155], a[100:103], v[240:243]
    ds_read_b64_tr_b16 a[90:91], v12 offset:8736
    v_mfma_f32_16x16x32_bf16 v[244:247], a[156:159], a[100:103], v[244:247]
    s_mov_b32 m0, s33
    v_mfma_f32_16x16x32_bf16 v[244:247], a[140:143], a[96:99], v[244:247]
    v_mfma_f32_16x16x32_bf16 v[248:251], a[144:147], a[96:99], v[248:251]
    v_mfma_f32_16x16x32_bf16 v[248:251], a[160:163], a[100:103], v[248:251]
    v_mfma_f32_16x16x32_bf16 v[252:255], a[164:167], a[100:103], v[252:255]
    ds_read_b64_tr_b16 a[100:101], v12 offset:4288
    v_mfma_f32_16x16x32_bf16 v[252:255], a[148:151], a[96:99], v[252:255]
    ds_read_b64_tr_b16 a[102:103], v12 offset:4544
    v_mfma_f32_16x16x32_bf16 a[12:15], a[148:151], a[104:107], a[12:15]
    ds_read_b64_tr_b16 a[96:97], v12 offset:64
    v_mfma_f32_16x16x32_bf16 a[12:15], a[164:167], a[108:111], a[12:15]
    ds_read_b64_tr_b16 a[98:99], v12 offset:320
    v_mfma_f32_16x16x32_bf16 a[8:11], a[160:163], a[108:111], a[8:11]
    s_add_u32 s27, s27, 458752
    v_mfma_f32_16x16x32_bf16 a[8:11], a[144:147], a[104:107], a[8:11]
    v_mfma_f32_16x16x32_bf16 a[4:7], a[140:143], a[104:107], a[4:7]
    buffer_load_dwordx4 v5, s[12:15], s28 offen offset:0 nt lds
    v_mfma_f32_16x16x32_bf16 a[4:7], a[156:159], a[108:111], a[4:7]
    v_mfma_f32_16x16x32_bf16 a[0:3], a[152:155], a[108:111], a[0:3]
    ds_read_b64_tr_b16 a[108:109], v12 offset:12736
    v_mfma_f32_16x16x32_bf16 a[0:3], a[136:139], a[104:107], a[0:3]
    ds_read_b64_tr_b16 a[110:111], v12 offset:12992
    v_mfma_f32_16x16x32_bf16 a[16:19], a[136:139], a[112:115], a[16:19]
    ds_read_b64_tr_b16 a[104:105], v12 offset:8512
    v_mfma_f32_16x16x32_bf16 a[16:19], a[152:155], a[116:119], a[16:19]
    ds_read_b64_tr_b16 a[106:107], v12 offset:8768
    v_mfma_f32_16x16x32_bf16 a[20:23], a[156:159], a[116:119], a[20:23]
    buffer_load_dwordx4 v6, s[12:15], s28 offen offset:1024 nt lds
    v_mfma_f32_16x16x32_bf16 a[20:23], a[140:143], a[112:115], a[20:23]
    v_mfma_f32_16x16x32_bf16 a[24:27], a[144:147], a[112:115], a[24:27]
    v_mfma_f32_16x16x32_bf16 a[24:27], a[160:163], a[116:119], a[24:27]
    v_mfma_f32_16x16x32_bf16 a[28:31], a[164:167], a[116:119], a[28:31]
    ds_read_b64_tr_b16 a[116:117], v12 offset:4320
    v_mfma_f32_16x16x32_bf16 a[28:31], a[148:151], a[112:115], a[28:31]
    ds_read_b64_tr_b16 a[118:119], v12 offset:4576
    v_mfma_f32_16x16x32_bf16 a[44:47], a[148:151], a[120:123], a[44:47]
    ds_read_b64_tr_b16 a[112:113], v12 offset:96
    v_mfma_f32_16x16x32_bf16 a[44:47], a[164:167], a[124:127], a[44:47]
    ds_read_b64_tr_b16 a[114:115], v12 offset:352
    v_mfma_f32_16x16x32_bf16 a[40:43], a[160:163], a[124:127], a[40:43]
    global_load_dword a236, v23, s[56:57]
    v_mfma_f32_16x16x32_bf16 a[40:43], a[144:147], a[120:123], a[40:43]
    v_mfma_f32_16x16x32_bf16 a[36:39], a[140:143], a[120:123], a[36:39]
    v_mfma_f32_16x16x32_bf16 a[36:39], a[156:159], a[124:127], a[36:39]
    v_mfma_f32_16x16x32_bf16 a[32:35], a[152:155], a[124:127], a[32:35]
    ds_read_b64_tr_b16 a[124:125], v12 offset:12768
    v_mfma_f32_16x16x32_bf16 a[32:35], a[136:139], a[120:123], a[32:35]
    ds_read_b64_tr_b16 a[126:127], v12 offset:13024
    v_mfma_f32_16x16x32_bf16 a[48:51], a[136:139], a[128:131], a[48:51]
    ds_read_b64_tr_b16 a[120:121], v12 offset:8544
    v_mfma_f32_16x16x32_bf16 a[48:51], a[152:155], a[132:135], a[48:51]
    ds_read_b64_tr_b16 a[122:123], v12 offset:8800
    v_mfma_f32_16x16x32_bf16 a[52:55], a[156:159], a[132:135], a[52:55]
    v_add_u32 v23, 1048576, v23
    v_mfma_f32_16x16x32_bf16 a[52:55], a[140:143], a[128:131], a[52:55]
    v_mfma_f32_16x16x32_bf16 a[56:59], a[144:147], a[128:131], a[56:59]
    v_mfma_f32_16x16x32_bf16 a[56:59], a[160:163], a[132:135], a[56:59]
    v_mfma_f32_16x16x32_bf16 a[60:63], a[164:167], a[132:135], a[60:63]
    ds_read_b128 a[132:135], v16 offset:0
    v_mfma_f32_16x16x32_bf16 a[60:63], a[148:151], a[128:131], a[60:63]
    ds_read_b128 a[128:131], v15 offset:0
    s_waitcnt vmcnt(10) lgkmcnt(6)
    v_mfma_f32_16x16x32_bf16 v[32:35], a[64:67], a[168:171], v[32:35]
    v_mfma_f32_16x16x32_bf16 v[32:35], a[68:71], a[184:187], v[32:35]
    buffer_load_dwordx4 a[136:139], v10, s[16:19], s29 offen offset:0 sc1
    v_mfma_f32_16x16x32_bf16 v[36:39], a[68:71], a[188:191], v[36:39]
    v_mfma_f32_16x16x32_bf16 v[36:39], a[64:67], a[172:175], v[36:39]
    v_mfma_f32_16x16x32_bf16 v[40:43], a[64:67], a[176:179], v[40:43]
    v_mfma_f32_16x16x32_bf16 v[40:43], a[68:71], a[192:195], v[40:43]
    buffer_load_dwordx4 a[140:143], v10, s[16:19], s29 offen offset:1024 sc1
    v_mfma_f32_16x16x32_bf16 v[44:47], a[68:71], a[196:199], v[44:47]
    ds_read_b128 a[68:71], v16 offset:2048
    v_mfma_f32_16x16x32_bf16 v[44:47], a[64:67], a[180:183], v[44:47]
    ds_read_b128 a[64:67], v15 offset:2048
    v_mfma_f32_16x16x32_bf16 v[60:63], a[72:75], a[180:183], v[60:63]
    v_mfma_f32_16x16x32_bf16 v[60:63], a[76:79], a[196:199], v[60:63]
    buffer_load_dwordx4 a[144:147], v10, s[16:19], s29 offen offset:2048 sc1
    v_mfma_f32_16x16x32_bf16 v[56:59], a[76:79], a[192:195], v[56:59]
    v_mfma_f32_16x16x32_bf16 v[56:59], a[72:75], a[176:179], v[56:59]
    v_mfma_f32_16x16x32_bf16 v[52:55], a[72:75], a[172:175], v[52:55]
    v_mfma_f32_16x16x32_bf16 v[52:55], a[76:79], a[188:191], v[52:55]
    buffer_load_dwordx4 a[148:151], v10, s[16:19], s29 offen offset:3072 sc1
    v_mfma_f32_16x16x32_bf16 v[48:51], a[76:79], a[184:187], v[48:51]
    ds_read_b128 a[76:79], v16 offset:4096
    v_mfma_f32_16x16x32_bf16 v[48:51], a[72:75], a[168:171], v[48:51]
    ds_read_b128 a[72:75], v15 offset:4096
    v_mfma_f32_16x16x32_bf16 v[64:67], a[80:83], a[168:171], v[64:67]
    v_mfma_f32_16x16x32_bf16 v[64:67], a[84:87], a[184:187], v[64:67]
    s_add_u32 s29, s29, 4096
    v_mfma_f32_16x16x32_bf16 v[68:71], a[84:87], a[188:191], v[68:71]
    v_mfma_f32_16x16x32_bf16 v[68:71], a[80:83], a[172:175], v[68:71]
    v_mfma_f32_16x16x32_bf16 v[72:75], a[80:83], a[176:179], v[72:75]
    v_mfma_f32_16x16x32_bf16 v[72:75], a[84:87], a[192:195], v[72:75]
    buffer_load_dwordx4 a[152:155], v10, s[16:19], s29 offen offset:0 sc1
    v_mfma_f32_16x16x32_bf16 v[76:79], a[84:87], a[196:199], v[76:79]
    ds_read_b128 a[84:87], v16 offset:6144
    v_mfma_f32_16x16x32_bf16 v[76:79], a[80:83], a[180:183], v[76:79]
    ds_read_b128 a[80:83], v15 offset:6144
    v_mfma_f32_16x16x32_bf16 v[92:95], a[88:91], a[180:183], v[92:95]
    v_mfma_f32_16x16x32_bf16 v[92:95], a[92:95], a[196:199], v[92:95]
    buffer_load_dwordx4 a[156:159], v10, s[16:19], s29 offen offset:1024 sc1
    v_mfma_f32_16x16x32_bf16 v[88:91], a[92:95], a[192:195], v[88:91]
    v_mfma_f32_16x16x32_bf16 v[88:91], a[88:91], a[176:179], v[88:91]
    v_mfma_f32_16x16x32_bf16 v[84:87], a[88:91], a[172:175], v[84:87]
    v_mfma_f32_16x16x32_bf16 v[84:87], a[92:95], a[188:191], v[84:87]
    buffer_load_dwordx4 a[160:163], v10, s[16:19], s29 offen offset:2048 sc1
    v_mfma_f32_16x16x32_bf16 v[80:83], a[92:95], a[184:187], v[80:83]
    ds_read_b128 a[92:95], v16 offset:8192
    v_mfma_f32_16x16x32_bf16 v[80:83], a[88:91], a[168:171], v[80:83]
    ds_read_b128 a[88:91], v15 offset:8192
    v_mfma_f32_16x16x32_bf16 v[96:99], a[96:99], a[168:171], v[96:99]
    v_mfma_f32_16x16x32_bf16 v[96:99], a[100:103], a[184:187], v[96:99]
    buffer_load_dwordx4 a[164:167], v10, s[16:19], s29 offen offset:3072 sc1
    v_mfma_f32_16x16x32_bf16 v[100:103], a[100:103], a[188:191], v[100:103]
    v_mfma_f32_16x16x32_bf16 v[100:103], a[96:99], a[172:175], v[100:103]
    v_mfma_f32_16x16x32_bf16 v[104:107], a[96:99], a[176:179], v[104:107]
    v_mfma_f32_16x16x32_bf16 v[104:107], a[100:103], a[192:195], v[104:107]
    s_add_u32 s29, s29, 4096
    v_mfma_f32_16x16x32_bf16 v[108:111], a[100:103], a[196:199], v[108:111]
    ds_read_b128 a[100:103], v16 offset:10240
    v_mfma_f32_16x16x32_bf16 v[108:111], a[96:99], a[180:183], v[108:111]
    ds_read_b128 a[96:99], v15 offset:10240
    v_mfma_f32_16x16x32_bf16 v[124:127], a[104:107], a[180:183], v[124:127]
    v_subrev_u32_e64 v11, s34, v11
    v_mfma_f32_16x16x32_bf16 v[124:127], a[108:111], a[196:199], v[124:127]
    buffer_load_dwordx4 v7, s[12:15], s28 offen offset:2048 nt lds
    v_mfma_f32_16x16x32_bf16 v[120:123], a[108:111], a[192:195], v[120:123]
    v_subrev_u32_e64 v13, s34, v13
    v_mfma_f32_16x16x32_bf16 v[120:123], a[104:107], a[176:179], v[120:123]
    v_subrev_u32_e64 v14, s34, v14
    v_mfma_f32_16x16x32_bf16 v[116:119], a[104:107], a[172:175], v[116:119]
    v_mfma_f32_16x16x32_bf16 v[116:119], a[108:111], a[188:191], v[116:119]
    buffer_load_dwordx4 v8, s[12:15], s28 offen offset:3072 nt lds
    v_mfma_f32_16x16x32_bf16 v[112:115], a[108:111], a[184:187], v[112:115]
    ds_read_b128 a[108:111], v16 offset:12288
    v_mfma_f32_16x16x32_bf16 v[112:115], a[104:107], a[168:171], v[112:115]
    ds_read_b128 a[104:107], v15 offset:12288
    v_mfma_f32_16x16x32_bf16 v[128:131], a[112:115], a[168:171], v[128:131]
    v_mfma_f32_16x16x32_bf16 v[128:131], a[116:119], a[184:187], v[128:131]
    s_add_u32 m0, s33, 4096
    v_mfma_f32_16x16x32_bf16 v[132:135], a[116:119], a[188:191], v[132:135]
    v_mfma_f32_16x16x32_bf16 v[132:135], a[112:115], a[172:175], v[132:135]
    v_mfma_f32_16x16x32_bf16 v[136:139], a[112:115], a[176:179], v[136:139]
    v_mfma_f32_16x16x32_bf16 v[136:139], a[116:119], a[192:195], v[136:139]
    buffer_load_dwordx4 v9, s[12:15], s28 offen offset:0 nt lds
    v_mfma_f32_16x16x32_bf16 v[140:143], a[116:119], a[196:199], v[140:143]
    ds_read_b128 a[116:119], v16 offset:14336
    v_mfma_f32_16x16x32_bf16 v[140:143], a[112:115], a[180:183], v[140:143]
    ds_read_b128 a[112:115], v15 offset:14336
    s_waitcnt lgkmcnt(6)
    v_mfma_f32_16x16x32_bf16 v[156:159], a[120:123], a[180:183], v[156:159]
    v_mfma_f32_16x16x32_bf16 v[156:159], a[124:127], a[196:199], v[156:159]
    s_add_u32 s28, s28, 128
    v_mfma_f32_16x16x32_bf16 v[152:155], a[124:127], a[192:195], v[152:155]
    v_mfma_f32_16x16x32_bf16 v[152:155], a[120:123], a[176:179], v[152:155]
    v_mfma_f32_16x16x32_bf16 v[148:151], a[120:123], a[172:175], v[148:151]
    v_mfma_f32_16x16x32_bf16 v[148:151], a[124:127], a[188:191], v[148:151]
    s_add_u32 s31, s31, s34
    v_mfma_f32_16x16x32_bf16 v[144:147], a[124:127], a[184:187], v[144:147]
    ds_read_b128 a[124:127], v16 offset:16384
    v_mfma_f32_16x16x32_bf16 v[144:147], a[120:123], a[168:171], v[144:147]
    ds_read_b128 a[120:123], v15 offset:16384
    v_mfma_f32_16x16x32_bf16 v[160:163], a[168:171], a[128:131], v[160:163]
    v_mfma_f32_16x16x32_bf16 v[160:163], a[184:187], a[132:135], v[160:163]
    s_add_u32 s33, s33, s34
    v_mfma_f32_16x16x32_bf16 v[164:167], a[188:191], a[132:135], v[164:167]
    v_mfma_f32_16x16x32_bf16 v[164:167], a[172:175], a[128:131], v[164:167]
    v_mfma_f32_16x16x32_bf16 v[168:171], a[176:179], a[128:131], v[168:171]
    v_mfma_f32_16x16x32_bf16 v[168:171], a[192:195], a[132:135], v[168:171]
    v_mfma_f32_16x16x32_bf16 v[172:175], a[196:199], a[132:135], v[172:175]
    ds_read_b128 a[132:135], v16 offset:18432
    v_mfma_f32_16x16x32_bf16 v[172:175], a[180:183], a[128:131], v[172:175]
    ds_read_b128 a[128:131], v15 offset:18432
    v_mfma_f32_16x16x32_bf16 v[176:179], a[168:171], a[64:67], v[176:179]
    v_mfma_f32_16x16x32_bf16 v[176:179], a[184:187], a[68:71], v[176:179]
    s_mov_b32 m0, s30
    v_mfma_f32_16x16x32_bf16 v[180:183], a[188:191], a[68:71], v[180:183]
    v_subrev_u32_e64 v12, s34, v12
    v_mfma_f32_16x16x32_bf16 v[180:183], a[172:175], a[64:67], v[180:183]
    v_subrev_u32_e64 v15, s34, v15
    v_mfma_f32_16x16x32_bf16 v[184:187], a[176:179], a[64:67], v[184:187]
    v_subrev_u32_e64 v16, s34, v16
    v_mfma_f32_16x16x32_bf16 v[184:187], a[192:195], a[68:71], v[184:187]
    v_mfma_f32_16x16x32_bf16 v[188:191], a[196:199], a[68:71], v[188:191]
    v_mfma_f32_16x16x32_bf16 v[188:191], a[180:183], a[64:67], v[188:191]
    buffer_load_dwordx4 v1, s[8:11], s27 offen offset:0 nt lds
    v_mfma_f32_16x16x32_bf16 v[204:207], a[180:183], a[72:75], v[204:207]
    v_mfma_f32_16x16x32_bf16 v[204:207], a[196:199], a[76:79], v[204:207]
    v_mfma_f32_16x16x32_bf16 v[200:203], a[192:195], a[76:79], v[200:203]
    v_mfma_f32_16x16x32_bf16 v[200:203], a[176:179], a[72:75], v[200:203]
    s_waitcnt vmcnt(19)
    s_waitcnt lgkmcnt(0)
    s_barrier
    ds_read_b64_tr_b16 a[68:69], v11 offset:4224
    v_mfma_f32_16x16x32_bf16 v[196:199], a[172:175], a[72:75], v[196:199]
    ds_read_b64_tr_b16 a[70:71], v11 offset:4480
    v_mfma_f32_16x16x32_bf16 v[196:199], a[188:191], a[76:79], v[196:199]
    ds_read_b64_tr_b16 a[64:65], v11 offset:0
    v_mfma_f32_16x16x32_bf16 v[192:195], a[184:187], a[76:79], v[192:195]
    ds_read_b64_tr_b16 a[66:67], v11 offset:256
    v_mfma_f32_16x16x32_bf16 v[192:195], a[168:171], a[72:75], v[192:195]
    ds_read_b64_tr_b16 a[76:77], v11 offset:12672
    v_mfma_f32_16x16x32_bf16 v[208:211], a[168:171], a[80:83], v[208:211]
    ds_read_b64_tr_b16 a[78:79], v11 offset:12928
    v_mfma_f32_16x16x32_bf16 v[208:211], a[184:187], a[84:87], v[208:211]
    ds_read_b64_tr_b16 a[72:73], v11 offset:8448
    v_mfma_f32_16x16x32_bf16 v[212:215], a[188:191], a[84:87], v[212:215]
    ds_read_b64_tr_b16 a[74:75], v11 offset:8704
    v_mfma_f32_16x16x32_bf16 v[212:215], a[172:175], a[80:83], v[212:215]
    buffer_load_dwordx4 v2, s[8:11], s27 offen offset:1056 nt lds
    v_mfma_f32_16x16x32_bf16 v[216:219], a[176:179], a[80:83], v[216:219]
    buffer_load_dwordx4 v3, s[8:11], s27 offen offset:2112 nt lds
    v_mfma_f32_16x16x32_bf16 v[216:219], a[192:195], a[84:87], v[216:219]
    v_mfma_f32_16x16x32_bf16 v[220:223], a[196:199], a[84:87], v[220:223]
    ds_read_b64_tr_b16 a[84:85], v11 offset:4256
    v_mfma_f32_16x16x32_bf16 v[220:223], a[180:183], a[80:83], v[220:223]
    ds_read_b64_tr_b16 a[86:87], v11 offset:4512
    v_mfma_f32_16x16x32_bf16 v[236:239], a[180:183], a[88:91], v[236:239]
    ds_read_b64_tr_b16 a[80:81], v11 offset:32
    v_mfma_f32_16x16x32_bf16 v[236:239], a[196:199], a[92:95], v[236:239]
    ds_read_b64_tr_b16 a[82:83], v11 offset:288
    v_mfma_f32_16x16x32_bf16 v[232:235], a[192:195], a[92:95], v[232:235]
    buffer_load_dwordx4 v4, s[8:11], s27 offen offset:3168 nt lds
    v_mfma_f32_16x16x32_bf16 v[232:235], a[176:179], a[88:91], v[232:235]
    v_mfma_f32_16x16x32_bf16 v[228:231], a[172:175], a[88:91], v[228:231]
    v_mfma_f32_16x16x32_bf16 v[228:231], a[188:191], a[92:95], v[228:231]
    v_mfma_f32_16x16x32_bf16 v[224:227], a[184:187], a[92:95], v[224:227]
    ds_read_b64_tr_b16 a[92:93], v11 offset:12704
    v_mfma_f32_16x16x32_bf16 v[224:227], a[168:171], a[88:91], v[224:227]
    ds_read_b64_tr_b16 a[94:95], v11 offset:12960
    v_mfma_f32_16x16x32_bf16 v[240:243], a[168:171], a[96:99], v[240:243]
    ds_read_b64_tr_b16 a[88:89], v11 offset:8480
    v_mfma_f32_16x16x32_bf16 v[240:243], a[184:187], a[100:103], v[240:243]
    ds_read_b64_tr_b16 a[90:91], v11 offset:8736
    v_mfma_f32_16x16x32_bf16 v[244:247], a[188:191], a[100:103], v[244:247]
    s_mov_b32 m0, s32
    v_mfma_f32_16x16x32_bf16 v[244:247], a[172:175], a[96:99], v[244:247]
    v_mfma_f32_16x16x32_bf16 v[248:251], a[176:179], a[96:99], v[248:251]
    v_mfma_f32_16x16x32_bf16 v[248:251], a[192:195], a[100:103], v[248:251]
    v_mfma_f32_16x16x32_bf16 v[252:255], a[196:199], a[100:103], v[252:255]
    ds_read_b64_tr_b16 a[100:101], v11 offset:4288
    v_mfma_f32_16x16x32_bf16 v[252:255], a[180:183], a[96:99], v[252:255]
    ds_read_b64_tr_b16 a[102:103], v11 offset:4544
    v_mfma_f32_16x16x32_bf16 a[12:15], a[180:183], a[104:107], a[12:15]
    ds_read_b64_tr_b16 a[96:97], v11 offset:64
    v_mfma_f32_16x16x32_bf16 a[12:15], a[196:199], a[108:111], a[12:15]
    ds_read_b64_tr_b16 a[98:99], v11 offset:320
    v_mfma_f32_16x16x32_bf16 a[8:11], a[192:195], a[108:111], a[8:11]
    s_add_u32 s27, s27, 458752
    v_mfma_f32_16x16x32_bf16 a[8:11], a[176:179], a[104:107], a[8:11]
    v_mfma_f32_16x16x32_bf16 a[4:7], a[172:175], a[104:107], a[4:7]
    buffer_load_dwordx4 v5, s[12:15], s28 offen offset:0 nt lds
    v_mfma_f32_16x16x32_bf16 a[4:7], a[188:191], a[108:111], a[4:7]
    v_mfma_f32_16x16x32_bf16 a[0:3], a[184:187], a[108:111], a[0:3]
    ds_read_b64_tr_b16 a[108:109], v11 offset:12736
    v_mfma_f32_16x16x32_bf16 a[0:3], a[168:171], a[104:107], a[0:3]
    ds_read_b64_tr_b16 a[110:111], v11 offset:12992
    v_mfma_f32_16x16x32_bf16 a[16:19], a[168:171], a[112:115], a[16:19]
    ds_read_b64_tr_b16 a[104:105], v11 offset:8512
    v_mfma_f32_16x16x32_bf16 a[16:19], a[184:187], a[116:119], a[16:19]
    ds_read_b64_tr_b16 a[106:107], v11 offset:8768
    v_mfma_f32_16x16x32_bf16 a[20:23], a[188:191], a[116:119], a[20:23]
    buffer_load_dwordx4 v6, s[12:15], s28 offen offset:1024 nt lds
    v_mfma_f32_16x16x32_bf16 a[20:23], a[172:175], a[112:115], a[20:23]
    v_mfma_f32_16x16x32_bf16 a[24:27], a[176:179], a[112:115], a[24:27]
    v_mfma_f32_16x16x32_bf16 a[24:27], a[192:195], a[116:119], a[24:27]
    v_mfma_f32_16x16x32_bf16 a[28:31], a[196:199], a[116:119], a[28:31]
    ds_read_b64_tr_b16 a[116:117], v11 offset:4320
    v_mfma_f32_16x16x32_bf16 a[28:31], a[180:183], a[112:115], a[28:31]
    ds_read_b64_tr_b16 a[118:119], v11 offset:4576
    v_mfma_f32_16x16x32_bf16 a[44:47], a[180:183], a[120:123], a[44:47]
    ds_read_b64_tr_b16 a[112:113], v11 offset:96
    v_mfma_f32_16x16x32_bf16 a[44:47], a[196:199], a[124:127], a[44:47]
    ds_read_b64_tr_b16 a[114:115], v11 offset:352
    v_mfma_f32_16x16x32_bf16 a[40:43], a[192:195], a[124:127], a[40:43]
    global_load_dword a236, v24, s[52:53]
    v_mfma_f32_16x16x32_bf16 a[40:43], a[176:179], a[120:123], a[40:43]
    v_mfma_f32_16x16x32_bf16 a[36:39], a[172:175], a[120:123], a[36:39]
    s_sub_u32 s34, 0, s34
    v_mfma_f32_16x16x32_bf16 a[36:39], a[188:191], a[124:127], a[36:39]
    v_mfma_f32_16x16x32_bf16 a[32:35], a[184:187], a[124:127], a[32:35]
    ds_read_b64_tr_b16 a[124:125], v11 offset:12768
    v_mfma_f32_16x16x32_bf16 a[32:35], a[168:171], a[120:123], a[32:35]
    ds_read_b64_tr_b16 a[126:127], v11 offset:13024
    v_mfma_f32_16x16x32_bf16 a[48:51], a[168:171], a[128:131], a[48:51]
    ds_read_b64_tr_b16 a[120:121], v11 offset:8544
    v_mfma_f32_16x16x32_bf16 a[48:51], a[184:187], a[132:135], a[48:51]
    ds_read_b64_tr_b16 a[122:123], v11 offset:8800
    v_mfma_f32_16x16x32_bf16 a[52:55], a[188:191], a[132:135], a[52:55]
    v_add_u32 v24, 262144, v24
    v_mfma_f32_16x16x32_bf16 a[52:55], a[172:175], a[128:131], a[52:55]
    v_mfma_f32_16x16x32_bf16 a[56:59], a[176:179], a[128:131], a[56:59]
    v_mfma_f32_16x16x32_bf16 a[56:59], a[192:195], a[132:135], a[56:59]
    v_mfma_f32_16x16x32_bf16 a[60:63], a[196:199], a[132:135], a[60:63]
    ds_read_b128 a[132:135], v14 offset:0
    v_mfma_f32_16x16x32_bf16 a[60:63], a[180:183], a[128:131], a[60:63]
    ds_read_b128 a[128:131], v13 offset:0
    s_add_u32 s35, s35, 1
    s_cmp_lt_u32 s35, 6
    s_cbranch_scc1 L_k2_loopB
    s_waitcnt vmcnt(10) lgkmcnt(6)
    v_mfma_f32_16x16x32_bf16 v[32:35], a[64:67], a[136:139], v[32:35]
    v_mfma_f32_16x16x32_bf16 v[32:35], a[68:71], a[152:155], v[32:35]
    buffer_load_dwordx4 a[168:171], v10, s[16:19], s29 offen offset:0 sc1
    v_mfma_f32_16x16x32_bf16 v[36:39], a[68:71], a[156:159], v[36:39]
    v_mfma_f32_16x16x32_bf16 v[36:39], a[64:67], a[140:143], v[36:39]
    v_mfma_f32_16x16x32_bf16 v[40:43], a[64:67], a[144:147], v[40:43]
    v_mfma_f32_16x16x32_bf16 v[40:43], a[68:71], a[160:163], v[40:43]
    buffer_load_dwordx4 a[172:175], v10, s[16:19], s29 offen offset:1024 sc1
    v_mfma_f32_16x16x32_bf16 v[44:47], a[68:71], a[164:167], v[44:47]
    ds_read_b128 a[68:71], v14 offset:2048
    v_mfma_f32_16x16x32_bf16 v[44:47], a[64:67], a[148:151], v[44:47]
    ds_read_b128 a[64:67], v13 offset:2048
    v_mfma_f32_16x16x32_bf16 v[60:63], a[72:75], a[148:151], v[60:63]
    v_mfma_f32_16x16x32_bf16 v[60:63], a[76:79], a[164:167], v[60:63]
    buffer_load_dwordx4 a[176:179], v10, s[16:19], s29 offen offset:2048 sc1
    v_mfma_f32_16x16x32_bf16 v[56:59], a[76:79], a[160:163], v[56:59]
    v_mfma_f32_16x16x32_bf16 v[56:59], a[72:75], a[144:147], v[56:59]
    v_mfma_f32_16x16x32_bf16 v[52:55], a[72:75], a[140:143], v[52:55]
    v_mfma_f32_16x16x32_bf16 v[52:55], a[76:79], a[156:159], v[52:55]
    buffer_load_dwordx4 a[180:183], v10, s[16:19], s29 offen offset:3072 sc1
    v_mfma_f32_16x16x32_bf16 v[48:51], a[76:79], a[152:155], v[48:51]
    ds_read_b128 a[76:79], v14 offset:4096
    v_mfma_f32_16x16x32_bf16 v[48:51], a[72:75], a[136:139], v[48:51]
    ds_read_b128 a[72:75], v13 offset:4096
    v_mfma_f32_16x16x32_bf16 v[64:67], a[80:83], a[136:139], v[64:67]
    v_mfma_f32_16x16x32_bf16 v[64:67], a[84:87], a[152:155], v[64:67]
    s_add_u32 s29, s29, 4096
    v_mfma_f32_16x16x32_bf16 v[68:71], a[84:87], a[156:159], v[68:71]
    v_mfma_f32_16x16x32_bf16 v[68:71], a[80:83], a[140:143], v[68:71]
    v_mfma_f32_16x16x32_bf16 v[72:75], a[80:83], a[144:147], v[72:75]
    v_mfma_f32_16x16x32_bf16 v[72:75], a[84:87], a[160:163], v[72:75]
    buffer_load_dwordx4 a[184:187], v10, s[16:19], s29 offen offset:0 sc1
    v_mfma_f32_16x16x32_bf16 v[76:79], a[84:87], a[164:167], v[76:79]
    ds_read_b128 a[84:87], v14 offset:6144
    v_mfma_f32_16x16x32_bf16 v[76:79], a[80:83], a[148:151], v[76:79]
    ds_read_b128 a[80:83], v13 offset:6144
    v_mfma_f32_16x16x32_bf16 v[92:95], a[88:91], a[148:151], v[92:95]
    v_mfma_f32_16x16x32_bf16 v[92:95], a[92:95], a[164:167], v[92:95]
    buffer_load_dwordx4 a[188:191], v10, s[16:19], s29 offen offset:1024 sc1
    v_mfma_f32_16x16x32_bf16 v[88:91], a[92:95], a[160:163], v[88:91]
    v_mfma_f32_16x16x32_bf16 v[88:91], a[88:91], a[144:147], v[88:91]
    v_mfma_f32_16x16x32_bf16 v[84:87], a[88:91], a[140:143], v[84:87]
    v_mfma_f32_16x16x32_bf16 v[84:87], a[92:95], a[156:159], v[84:87]
    buffer_load_dwordx4 a[192:195], v10, s[16:19], s29 offen offset:2048 sc1
    v_mfma_f32_16x16x32_bf16 v[80:83], a[92:95], a[152:155], v[80:83]
    ds_read_b128 a[92:95], v14 offset:8192
    v_mfma_f32_16x16x32_bf16 v[80:83], a[88:91], a[136:139], v[80:83]
    ds_read_b128 a[88:91], v13 offset:8192
    v_mfma_f32_16x16x32_bf16 v[96:99], a[96:99], a[136:139], v[96:99]
    v_mfma_f32_16x16x32_bf16 v[96:99], a[100:103], a[152:155], v[96:99]
    buffer_load_dwordx4 a[196:199], v10, s[16:19], s29 offen offset:3072 sc1
    v_mfma_f32_16x16x32_bf16 v[100:103], a[100:103], a[156:159], v[100:103]
    v_mfma_f32_16x16x32_bf16 v[100:103], a[96:99], a[140:143], v[100:103]
    v_mfma_f32_16x16x32_bf16 v[104:107], a[96:99], a[144:147], v[104:107]
    v_mfma_f32_16x16x32_bf16 v[104:107], a[100:103], a[160:163], v[104:107]
    s_add_u32 s29, s29, 4096
    v_mfma_f32_16x16x32_bf16 v[108:111], a[100:103], a[164:167], v[108:111]
    ds_read_b128 a[100:103], v14 offset:10240
    v_mfma_f32_16x16x32_bf16 v[108:111], a[96:99], a[148:151], v[108:111]
    ds_read_b128 a[96:99], v13 offset:10240
    v_mfma_f32_16x16x32_bf16 v[124:127], a[104:107], a[148:151], v[124:127]
    v_mfma_f32_16x16x32_bf16 v[124:127], a[108:111], a[164:167], v[124:127]
    buffer_load_dwordx4 v7, s[12:15], s28 offen offset:2048 nt lds
    v_mfma_f32_16x16x32_bf16 v[120:123], a[108:111], a[160:163], v[120:123]
    v_mfma_f32_16x16x32_bf16 v[120:123], a[104:107], a[144:147], v[120:123]
    v_mfma_f32_16x16x32_bf16 v[116:119], a[104:107], a[140:143], v[116:119]
    v_mfma_f32_16x16x32_bf16 v[116:119], a[108:111], a[156:159], v[116:119]
    buffer_load_dwordx4 v8, s[12:15], s28 offen offset:3072 nt lds
    v_mfma_f32_16x16x32_bf16 v[112:115], a[108:111], a[152:155], v[112:115]
    ds_read_b128 a[108:111], v14 offset:12288
    v_mfma_f32_16x16x32_bf16 v[112:115], a[104:107], a[136:139], v[112:115]
    ds_read_b128 a[104:107], v13 offset:12288
    v_mfma_f32_16x16x32_bf16 v[128:131], a[112:115], a[136:139], v[128:131]
    v_mfma_f32_16x16x32_bf16 v[128:131], a[116:119], a[152:155], v[128:131]
    s_add_u32 m0, s32, 4096
    v_mfma_f32_16x16x32_bf16 v[132:135], a[116:119], a[156:159], v[132:135]
    v_mfma_f32_16x16x32_bf16 v[132:135], a[112:115], a[140:143], v[132:135]
    v_mfma_f32_16x16x32_bf16 v[136:139], a[112:115], a[144:147], v[136:139]
    v_mfma_f32_16x16x32_bf16 v[136:139], a[116:119], a[160:163], v[136:139]
    buffer_load_dwordx4 v9, s[12:15], s28 offen offset:0 nt lds
    v_mfma_f32_16x16x32_bf16 v[140:143], a[116:119], a[164:167], v[140:143]
    ds_read_b128 a[116:119], v14 offset:14336
    v_mfma_f32_16x16x32_bf16 v[140:143], a[112:115], a[148:151], v[140:143]
    ds_read_b128 a[112:115], v13 offset:14336
    s_waitcnt lgkmcnt(6)
    v_mfma_f32_16x16x32_bf16 v[156:159], a[120:123], a[148:151], v[156:159]
    v_mfma_f32_16x16x32_bf16 v[156:159], a[124:127], a[164:167], v[156:159]
    s_add_u32 s28, s28, 128
    v_mfma_f32_16x16x32_bf16 v[152:155], a[124:127], a[160:163], v[152:155]
    v_mfma_f32_16x16x32_bf16 v[152:155], a[120:123], a[144:147], v[152:155]
    v_mfma_f32_16x16x32_bf16 v[148:151], a[120:123], a[140:143], v[148:151]
    v_mfma_f32_16x16x32_bf16 v[148:151], a[124:127], a[156:159], v[148:151]
    s_add_u32 s30, s30, s34
    v_mfma_f32_16x16x32_bf16 v[144:147], a[124:127], a[152:155], v[144:147]
    ds_read_b128 a[124:127], v14 offset:16384
    v_mfma_f32_16x16x32_bf16 v[144:147], a[120:123], a[136:139], v[144:147]
    ds_read_b128 a[120:123], v13 offset:16384
    v_mfma_f32_16x16x32_bf16 v[160:163], a[136:139], a[128:131], v[160:163]
    v_mfma_f32_16x16x32_bf16 v[160:163], a[152:155], a[132:135], v[160:163]
    s_add_u32 s32, s32, s34
    v_mfma_f32_16x16x32_bf16 v[164:167], a[156:159], a[132:135], v[164:167]
    v_mfma_f32_16x16x32_bf16 v[164:167], a[140:143], a[128:131], v[164:167]
    v_mfma_f32_16x16x32_bf16 v[168:171], a[144:147], a[128:131], v[168:171]
    v_mfma_f32_16x16x32_bf16 v[168:171], a[160:163], a[132:135], v[168:171]
    v_mfma_f32_16x16x32_bf16 v[172:175], a[164:167], a[132:135], v[172:175]
    ds_read_b128 a[132:135], v14 offset:18432
    v_mfma_f32_16x16x32_bf16 v[172:175], a[148:151], a[128:131], v[172:175]
    ds_read_b128 a[128:131], v13 offset:18432
    v_mfma_f32_16x16x32_bf16 v[176:179], a[136:139], a[64:67], v[176:179]
    v_mfma_f32_16x16x32_bf16 v[176:179], a[152:155], a[68:71], v[176:179]
    s_mov_b32 m0, s31
    v_mfma_f32_16x16x32_bf16 v[180:183], a[156:159], a[68:71], v[180:183]
    v_mfma_f32_16x16x32_bf16 v[180:183], a[140:143], a[64:67], v[180:183]
    v_mfma_f32_16x16x32_bf16 v[184:187], a[144:147], a[64:67], v[184:187]
    v_mfma_f32_16x16x32_bf16 v[184:187], a[160:163], a[68:71], v[184:187]
    v_mfma_f32_16x16x32_bf16 v[188:191], a[164:167], a[68:71], v[188:191]
    v_mfma_f32_16x16x32_bf16 v[188:191], a[148:151], a[64:67], v[188:191]
    buffer_load_dwordx4 v1, s[8:11], s27 offen offset:0 nt lds
    v_mfma_f32_16x16x32_bf16 v[204:207], a[148:151], a[72:75], v[204:207]
    v_mfma_f32_16x16x32_bf16 v[204:207], a[164:167], a[76:79], v[204:207]
    v_mfma_f32_16x16x32_bf16 v[200:203], a[160:163], a[76:79], v[200:203]
    v_mfma_f32_16x16x32_bf16 v[200:203], a[144:147], a[72:75], v[200:203]
    s_waitcnt vmcnt(19)
    s_waitcnt lgkmcnt(0)
    s_barrier
    ds_read_b64_tr_b16 a[68:69], v12 offset:4224
    v_mfma_f32_16x16x32_bf16 v[196:199], a[140:143], a[72:75], v[196:199]
    ds_read_b64_tr_b16 a[70:71], v12 offset:4480
    v_mfma_f32_16x16x32_bf16 v[196:199], a[156:159], a[76:79], v[196:199]
    ds_read_b64_tr_b16 a[64:65], v12 offset:0
    v_mfma_f32_16x16x32_bf16 v[192:195], a[152:155], a[76:79], v[192:195]
    ds_read_b64_tr_b16 a[66:67], v12 offset:256
    v_mfma_f32_16x16x32_bf16 v[192:195], a[136:139], a[72:75], v[192:195]
    ds_read_b64_tr_b16 a[76:77], v12 offset:12672
    v_mfma_f32_16x16x32_bf16 v[208:211], a[136:139], a[80:83], v[208:211]
    ds_read_b64_tr_b16 a[78:79], v12 offset:12928
    v_mfma_f32_16x16x32_bf16 v[208:211], a[152:155], a[84:87], v[208:211]
    ds_read_b64_tr_b16 a[72:73], v12 offset:8448
    v_mfma_f32_16x16x32_bf16 v[212:215], a[156:159], a[84:87], v[212:215]
    ds_read_b64_tr_b16 a[74:75], v12 offset:8704
    v_mfma_f32_16x16x32_bf16 v[212:215], a[140:143], a[80:83], v[212:215]
    buffer_load_dwordx4 v2, s[8:11], s27 offen offset:1056 nt lds
    v_mfma_f32_16x16x32_bf16 v[216:219], a[144:147], a[80:83], v[216:219]
    buffer_load_dwordx4 v3, s[8:11], s27 offen offset:2112 nt lds
    v_mfma_f32_16x16x32_bf16 v[216:219], a[160:163], a[84:87], v[216:219]
    v_mfma_f32_16x16x32_bf16 v[220:223], a[164:167], a[84:87], v[220:223]
    ds_read_b64_tr_b16 a[84:85], v12 offset:4256
    v_mfma_f32_16x16x32_bf16 v[220:223], a[148:151], a[80:83], v[220:223]
    ds_read_b64_tr_b16 a[86:87], v12 offset:4512
    v_mfma_f32_16x16x32_bf16 v[236:239], a[148:151], a[88:91], v[236:239]
    ds_read_b64_tr_b16 a[80:81], v12 offset:32
    v_mfma_f32_16x16x32_bf16 v[236:239], a[164:167], a[92:95], v[236:239]
    ds_read_b64_tr_b16 a[82:83], v12 offset:288
    v_mfma_f32_16x16x32_bf16 v[232:235], a[160:163], a[92:95], v[232:235]
    buffer_load_dwordx4 v4, s[8:11], s27 offen offset:3168 nt lds
    v_mfma_f32_16x16x32_bf16 v[232:235], a[144:147], a[88:91], v[232:235]
    v_mfma_f32_16x16x32_bf16 v[228:231], a[140:143], a[88:91], v[228:231]
    v_mfma_f32_16x16x32_bf16 v[228:231], a[156:159], a[92:95], v[228:231]
    v_mfma_f32_16x16x32_bf16 v[224:227], a[152:155], a[92:95], v[224:227]
    ds_read_b64_tr_b16 a[92:93], v12 offset:12704
    v_mfma_f32_16x16x32_bf16 v[224:227], a[136:139], a[88:91], v[224:227]
    ds_read_b64_tr_b16 a[94:95], v12 offset:12960
    v_mfma_f32_16x16x32_bf16 v[240:243], a[136:139], a[96:99], v[240:243]
    ds_read_b64_tr_b16 a[88:89], v12 offset:8480
    v_mfma_f32_16x16x32_bf16 v[240:243], a[152:155], a[100:103], v[240:243]
    ds_read_b64_tr_b16 a[90:91], v12 offset:8736
    v_mfma_f32_16x16x32_bf16 v[244:247], a[156:159], a[100:103], v[244:247]
    s_mov_b32 m0, s33
    v_mfma_f32_16x16x32_bf16 v[244:247], a[140:143], a[96:99], v[244:247]
    v_mfma_f32_16x16x32_bf16 v[248:251], a[144:147], a[96:99], v[248:251]
    v_mfma_f32_16x16x32_bf16 v[248:251], a[160:163], a[100:103], v[248:251]
    v_mfma_f32_16x16x32_bf16 v[252:255], a[164:167], a[100:103], v[252:255]
    ds_read_b64_tr_b16 a[100:101], v12 offset:4288
    v_mfma_f32_16x16x32_bf16 v[252:255], a[148:151], a[96:99], v[252:255]
    ds_read_b64_tr_b16 a[102:103], v12 offset:4544
    v_mfma_f32_16x16x32_bf16 a[12:15], a[148:151], a[104:107], a[12:15]
    ds_read_b64_tr_b16 a[96:97], v12 offset:64
    v_mfma_f32_16x16x32_bf16 a[12:15], a[164:167], a[108:111], a[12:15]
    ds_read_b64_tr_b16 a[98:99], v12 offset:320
    v_mfma_f32_16x16x32_bf16 a[8:11], a[160:163], a[108:111], a[8:11]
    s_add_u32 s27, s27, 458752
    v_mfma_f32_16x16x32_bf16 a[8:11], a[144:147], a[104:107], a[8:11]
    v_mfma_f32_16x16x32_bf16 a[4:7], a[140:143], a[104:107], a[4:7]
    buffer_load_dwordx4 v5, s[12:15], s28 offen offset:0 nt lds
    v_mfma_f32_16x16x32_bf16 a[4:7], a[156:159], a[108:111], a[4:7]
    v_mfma_f32_16x16x32_bf16 a[0:3], a[152:155], a[108:111], a[0:3]
    ds_read_b64_tr_b16 a[108:109], v12 offset:12736
    v_mfma_f32_16x16x32_bf16 a[0:3], a[136:139], a[104:107], a[0:3]
    ds_read_b64_tr_b16 a[110:111], v12 offset:12992
    v_mfma_f32_16x16x32_bf16 a[16:19], a[136:139], a[112:115], a[16:19]
    ds_read_b64_tr_b16 a[104:105], v12 offset:8512
    v_mfma_f32_16x16x32_bf16 a[16:19], a[152:155], a[116:119], a[16:19]
    ds_read_b64_tr_b16 a[106:107], v12 offset:8768
    v_mfma_f32_16x16x32_bf16 a[20:23], a[156:159], a[116:119], a[20:23]
    buffer_load_dwordx4 v6, s[12:15], s28 offen offset:1024 nt lds
    v_mfma_f32_16x16x32_bf16 a[20:23], a[140:143], a[112:115], a[20:23]
    v_mfma_f32_16x16x32_bf16 a[24:27], a[144:147], a[112:115], a[24:27]
    v_mfma_f32_16x16x32_bf16 a[24:27], a[160:163], a[116:119], a[24:27]
    v_mfma_f32_16x16x32_bf16 a[28:31], a[164:167], a[116:119], a[28:31]
    ds_read_b64_tr_b16 a[116:117], v12 offset:4320
    v_mfma_f32_16x16x32_bf16 a[28:31], a[148:151], a[112:115], a[28:31]
    ds_read_b64_tr_b16 a[118:119], v12 offset:4576
    v_mfma_f32_16x16x32_bf16 a[44:47], a[148:151], a[120:123], a[44:47]
    ds_read_b64_tr_b16 a[112:113], v12 offset:96
    v_mfma_f32_16x16x32_bf16 a[44:47], a[164:167], a[124:127], a[44:47]
    ds_read_b64_tr_b16 a[114:115], v12 offset:352
    v_mfma_f32_16x16x32_bf16 a[40:43], a[160:163], a[124:127], a[40:43]
    global_load_dword a236, v23, s[56:57]
    v_mfma_f32_16x16x32_bf16 a[40:43], a[144:147], a[120:123], a[40:43]
    v_mfma_f32_16x16x32_bf16 a[36:39], a[140:143], a[120:123], a[36:39]
    v_mfma_f32_16x16x32_bf16 a[36:39], a[156:159], a[124:127], a[36:39]
    v_mfma_f32_16x16x32_bf16 a[32:35], a[152:155], a[124:127], a[32:35]
    ds_read_b64_tr_b16 a[124:125], v12 offset:12768
    v_mfma_f32_16x16x32_bf16 a[32:35], a[136:139], a[120:123], a[32:35]
    ds_read_b64_tr_b16 a[126:127], v12 offset:13024
    v_mfma_f32_16x16x32_bf16 a[48:51], a[136:139], a[128:131], a[48:51]
    ds_read_b64_tr_b16 a[120:121], v12 offset:8544
    v_mfma_f32_16x16x32_bf16 a[48:51], a[152:155], a[132:135], a[48:51]
    ds_read_b64_tr_b16 a[122:123], v12 offset:8800
    v_mfma_f32_16x16x32_bf16 a[52:55], a[156:159], a[132:135], a[52:55]
    v_add_u32 v23, 1048576, v23
    v_mfma_f32_16x16x32_bf16 a[52:55], a[140:143], a[128:131], a[52:55]
    v_mfma_f32_16x16x32_bf16 a[56:59], a[144:147], a[128:131], a[56:59]
    v_mfma_f32_16x16x32_bf16 a[56:59], a[160:163], a[132:135], a[56:59]
    v_mfma_f32_16x16x32_bf16 a[60:63], a[164:167], a[132:135], a[60:63]
    ds_read_b128 a[132:135], v16 offset:0
    v_mfma_f32_16x16x32_bf16 a[60:63], a[148:151], a[128:131], a[60:63]
    ds_read_b128 a[128:131], v15 offset:0
    s_waitcnt vmcnt(10) lgkmcnt(6)
    v_mfma_f32_16x16x32_bf16 v[32:35], a[64:67], a[168:171], v[32:35]
    v_mfma_f32_16x16x32_bf16 v[32:35], a[68:71], a[184:187], v[32:35]
    buffer_load_dwordx4 a[136:139], v10, s[16:19], s29 offen offset:0 sc1
    v_mfma_f32_16x16x32_bf16 v[36:39], a[68:71], a[188:191], v[36:39]
    v_mfma_f32_16x16x32_bf16 v[36:39], a[64:67], a[172:175], v[36:39]
    v_mfma_f32_16x16x32_bf16 v[40:43], a[64:67], a[176:179], v[40:43]
    v_mfma_f32_16x16x32_bf16 v[40:43], a[68:71], a[192:195], v[40:43]
    buffer_load_dwordx4 a[140:143], v10, s[16:19], s29 offen offset:1024 sc1
    v_mfma_f32_16x16x32_bf16 v[44:47], a[68:71], a[196:199], v[44:47]
    ds_read_b128 a[68:71], v16 offset:2048
    v_mfma_f32_16x16x32_bf16 v[44:47], a[64:67], a[180:183], v[44:47]
    ds_read_b128 a[64:67], v15 offset:2048
    v_mfma_f32_16x16x32_bf16 v[60:63], a[72:75], a[180:183], v[60:63]
    v_mfma_f32_16x16x32_bf16 v[60:63], a[76:79], a[196:199], v[60:63]
    buffer_load_dwordx4 a[144:147], v10, s[16:19], s29 offen offset:2048 sc1
    v_mfma_f32_16x16x32_bf16 v[56:59], a[76:79], a[192:195], v[56:59]
    v_mfma_f32_16x16x32_bf16 v[56:59], a[72:75], a[176:179], v[56:59]
    v_mfma_f32_16x16x32_bf16 v[52:55], a[72:75], a[172:175], v[52:55]
    v_mfma_f32_16x16x32_bf16 v[52:55], a[76:79], a[188:191], v[52:55]
    buffer_load_dwordx4 a[148:151], v10, s[16:19], s29 offen offset:3072 sc1
    v_mfma_f32_16x16x32_bf16 v[48:51], a[76:79], a[184:187], v[48:51]
    ds_read_b128 a[76:79], v16 offset:4096
    v_mfma_f32_16x16x32_bf16 v[48:51], a[72:75], a[168:171], v[48:51]
    ds_read_b128 a[72:75], v15 offset:4096
    v_mfma_f32_16x16x32_bf16 v[64:67], a[80:83], a[168:171], v[64:67]
    v_mfma_f32_16x16x32_bf16 v[64:67], a[84:87], a[184:187], v[64:67]
    s_add_u32 s29, s29, 4096
    v_mfma_f32_16x16x32_bf16 v[68:71], a[84:87], a[188:191], v[68:71]
    v_mfma_f32_16x16x32_bf16 v[68:71], a[80:83], a[172:175], v[68:71]
    v_mfma_f32_16x16x32_bf16 v[72:75], a[80:83], a[176:179], v[72:75]
    v_mfma_f32_16x16x32_bf16 v[72:75], a[84:87], a[192:195], v[72:75]
    buffer_load_dwordx4 a[152:155], v10, s[16:19], s29 offen offset:0 sc1
    v_mfma_f32_16x16x32_bf16 v[76:79], a[84:87], a[196:199], v[76:79]
    ds_read_b128 a[84:87], v16 offset:6144
    v_mfma_f32_16x16x32_bf16 v[76:79], a[80:83], a[180:183], v[76:79]
    ds_read_b128 a[80:83], v15 offset:6144
    v_mfma_f32_16x16x32_bf16 v[92:95], a[88:91], a[180:183], v[92:95]
    v_mfma_f32_16x16x32_bf16 v[92:95], a[92:95], a[196:199], v[92:95]
    buffer_load_dwordx4 a[156:159], v10, s[16:19], s29 offen offset:1024 sc1
    v_mfma_f32_16x16x32_bf16 v[88:91], a[92:95], a[192:195], v[88:91]
    v_mfma_f32_16x16x32_bf16 v[88:91], a[88:91], a[176:179], v[88:91]
    v_mfma_f32_16x16x32_bf16 v[84:87], a[88:91], a[172:175], v[84:87]
    v_mfma_f32_16x16x32_bf16 v[84:87], a[92:95], a[188:191], v[84:87]
    buffer_load_dwordx4 a[160:163], v10, s[16:19], s29 offen offset:2048 sc1
    v_mfma_f32_16x16x32_bf16 v[80:83], a[92:95], a[184:187], v[80:83]
    ds_read_b128 a[92:95], v16 offset:8192
    v_mfma_f32_16x16x32_bf16 v[80:83], a[88:91], a[168:171], v[80:83]
    ds_read_b128 a[88:91], v15 offset:8192
    v_mfma_f32_16x16x32_bf16 v[96:99], a[96:99], a[168:171], v[96:99]
    v_mfma_f32_16x16x32_bf16 v[96:99], a[100:103], a[184:187], v[96:99]
    buffer_load_dwordx4 a[164:167], v10, s[16:19], s29 offen offset:3072 sc1
    v_mfma_f32_16x16x32_bf16 v[100:103], a[100:103], a[188:191], v[100:103]
    v_mfma_f32_16x16x32_bf16 v[100:103], a[96:99], a[172:175], v[100:103]
    v_mfma_f32_16x16x32_bf16 v[104:107], a[96:99], a[176:179], v[104:107]
    v_mfma_f32_16x16x32_bf16 v[104:107], a[100:103], a[192:195], v[104:107]
    s_add_u32 s29, s29, 4096
    v_mfma_f32_16x16x32_bf16 v[108:111], a[100:103], a[196:199], v[108:111]
    ds_read_b128 a[100:103], v16 offset:10240
    v_mfma_f32_16x16x32_bf16 v[108:111], a[96:99], a[180:183], v[108:111]
    ds_read_b128 a[96:99], v15 offset:10240
    v_mfma_f32_16x16x32_bf16 v[124:127], a[104:107], a[180:183], v[124:127]
    v_subrev_u32_e64 v11, s34, v11
    v_mfma_f32_16x16x32_bf16 v[124:127], a[108:111], a[196:199], v[124:127]
    buffer_load_dwordx4 v7, s[12:15], s28 offen offset:2048 nt lds
    v_mfma_f32_16x16x32_bf16 v[120:123], a[108:111], a[192:195], v[120:123]
    v_subrev_u32_e64 v13, s34, v13
    v_mfma_f32_16x16x32_bf16 v[120:123], a[104:107], a[176:179], v[120:123]
    v_subrev_u32_e64 v14, s34, v14
    v_mfma_f32_16x16x32_bf16 v[116:119], a[104:107], a[172:175], v[116:119]
    v_mfma_f32_16x16x32_bf16 v[116:119], a[108:111], a[188:191], v[116:119]
    buffer_load_dwordx4 v8, s[12:15], s28 offen offset:3072 nt lds
    v_mfma_f32_16x16x32_bf16 v[112:115], a[108:111], a[184:187], v[112:115]
    ds_read_b128 a[108:111], v16 offset:12288
    v_mfma_f32_16x16x32_bf16 v[112:115], a[104:107], a[168:171], v[112:115]
    ds_read_b128 a[104:107], v15 offset:12288
    v_mfma_f32_16x16x32_bf16 v[128:131], a[112:115], a[168:171], v[128:131]
    v_mfma_f32_16x16x32_bf16 v[128:131], a[116:119], a[184:187], v[128:131]
    s_add_u32 m0, s33, 4096
    v_mfma_f32_16x16x32_bf16 v[132:135], a[116:119], a[188:191], v[132:135]
    v_mfma_f32_16x16x32_bf16 v[132:135], a[112:115], a[172:175], v[132:135]
    v_mfma_f32_16x16x32_bf16 v[136:139], a[112:115], a[176:179], v[136:139]
    v_mfma_f32_16x16x32_bf16 v[136:139], a[116:119], a[192:195], v[136:139]
    buffer_load_dwordx4 v9, s[12:15], s28 offen offset:0 nt lds
    v_mfma_f32_16x16x32_bf16 v[140:143], a[116:119], a[196:199], v[140:143]
    ds_read_b128 a[116:119], v16 offset:14336
    v_mfma_f32_16x16x32_bf16 v[140:143], a[112:115], a[180:183], v[140:143]
    ds_read_b128 a[112:115], v15 offset:14336
    s_waitcnt lgkmcnt(6)
    v_mfma_f32_16x16x32_bf16 v[156:159], a[120:123], a[180:183], v[156:159]
    v_mfma_f32_16x16x32_bf16 v[156:159], a[124:127], a[196:199], v[156:159]
    s_add_u32 s28, s28, 128
    v_mfma_f32_16x16x32_bf16 v[152:155], a[124:127], a[192:195], v[152:155]
    v_mfma_f32_16x16x32_bf16 v[152:155], a[120:123], a[176:179], v[152:155]
    v_mfma_f32_16x16x32_bf16 v[148:151], a[120:123], a[172:175], v[148:151]
    v_mfma_f32_16x16x32_bf16 v[148:151], a[124:127], a[188:191], v[148:151]
    s_add_u32 s31, s31, s34
    v_mfma_f32_16x16x32_bf16 v[144:147], a[124:127], a[184:187], v[144:147]
    ds_read_b128 a[124:127], v16 offset:16384
    v_mfma_f32_16x16x32_bf16 v[144:147], a[120:123], a[168:171], v[144:147]
    ds_read_b128 a[120:123], v15 offset:16384
    v_mfma_f32_16x16x32_bf16 v[160:163], a[168:171], a[128:131], v[160:163]
    v_mfma_f32_16x16x32_bf16 v[160:163], a[184:187], a[132:135], v[160:163]
    s_add_u32 s33, s33, s34
    v_mfma_f32_16x16x32_bf16 v[164:167], a[188:191], a[132:135], v[164:167]
    v_mfma_f32_16x16x32_bf16 v[164:167], a[172:175], a[128:131], v[164:167]
    v_mfma_f32_16x16x32_bf16 v[168:171], a[176:179], a[128:131], v[168:171]
    v_mfma_f32_16x16x32_bf16 v[168:171], a[192:195], a[132:135], v[168:171]
    v_mfma_f32_16x16x32_bf16 v[172:175], a[196:199], a[132:135], v[172:175]
    ds_read_b128 a[132:135], v16 offset:18432
    v_mfma_f32_16x16x32_bf16 v[172:175], a[180:183], a[128:131], v[172:175]
    ds_read_b128 a[128:131], v15 offset:18432
    v_mfma_f32_16x16x32_bf16 v[176:179], a[168:171], a[64:67], v[176:179]
    v_mfma_f32_16x16x32_bf16 v[176:179], a[184:187], a[68:71], v[176:179]
    global_load_dword a236, v24, s[52:53]
    v_mfma_f32_16x16x32_bf16 v[180:183], a[188:191], a[68:71], v[180:183]
    v_subrev_u32 v12, s34, v12
    v_mfma_f32_16x16x32_bf16 v[180:183], a[172:175], a[64:67], v[180:183]
    v_subrev_u32_e64 v15, s34, v15
    v_mfma_f32_16x16x32_bf16 v[184:187], a[176:179], a[64:67], v[184:187]
    v_subrev_u32_e64 v16, s34, v16
    v_mfma_f32_16x16x32_bf16 v[184:187], a[192:195], a[68:71], v[184:187]
    v_mfma_f32_16x16x32_bf16 v[188:191], a[196:199], a[68:71], v[188:191]
    v_mfma_f32_16x16x32_bf16 v[188:191], a[180:183], a[64:67], v[188:191]
    v_mfma_f32_16x16x32_bf16 v[204:207], a[180:183], a[72:75], v[204:207]
    v_mfma_f32_16x16x32_bf16 v[204:207], a[196:199], a[76:79], v[204:207]
    v_mfma_f32_16x16x32_bf16 v[200:203], a[192:195], a[76:79], v[200:203]
    v_mfma_f32_16x16x32_bf16 v[200:203], a[176:179], a[72:75], v[200:203]
    s_waitcnt vmcnt(19)
    s_waitcnt lgkmcnt(0)
    s_barrier
    ds_read_b64_tr_b16 a[68:69], v11 offset:4224
    v_mfma_f32_16x16x32_bf16 v[196:199], a[172:175], a[72:75], v[196:199]
    ds_read_b64_tr_b16 a[70:71], v11 offset:4480
    v_mfma_f32_16x16x32_bf16 v[196:199], a[188:191], a[76:79], v[196:199]
    ds_read_b64_tr_b16 a[64:65], v11 offset:0
    v_mfma_f32_16x16x32_bf16 v[192:195], a[184:187], a[76:79], v[192:195]
    ds_read_b64_tr_b16 a[66:67], v11 offset:256
    v_mfma_f32_16x16x32_bf16 v[192:195], a[168:171], a[72:75], v[192:195]
    ds_read_b64_tr_b16 a[76:77], v11 offset:12672
    v_mfma_f32_16x16x32_bf16 v[208:211], a[168:171], a[80:83], v[208:211]
    ds_read_b64_tr_b16 a[78:79], v11 offset:12928
    v_mfma_f32_16x16x32_bf16 v[208:211], a[184:187], a[84:87], v[208:211]
    ds_read_b64_tr_b16 a[72:73], v11 offset:8448
    v_mfma_f32_16x16x32_bf16 v[212:215], a[188:191], a[84:87], v[212:215]
    ds_read_b64_tr_b16 a[74:75], v11 offset:8704
    v_mfma_f32_16x16x32_bf16 v[212:215], a[172:175], a[80:83], v[212:215]
    v_mfma_f32_16x16x32_bf16 v[216:219], a[176:179], a[80:83], v[216:219]
    v_mfma_f32_16x16x32_bf16 v[216:219], a[192:195], a[84:87], v[216:219]
    v_mfma_f32_16x16x32_bf16 v[220:223], a[196:199], a[84:87], v[220:223]
    ds_read_b64_tr_b16 a[84:85], v11 offset:4256
    v_mfma_f32_16x16x32_bf16 v[220:223], a[180:183], a[80:83], v[220:223]
    ds_read_b64_tr_b16 a[86:87], v11 offset:4512
    v_mfma_f32_16x16x32_bf16 v[236:239], a[180:183], a[88:91], v[236:239]
    ds_read_b64_tr_b16 a[80:81], v11 offset:32
    v_mfma_f32_16x16x32_bf16 v[236:239], a[196:199], a[92:95], v[236:239]
    ds_read_b64_tr_b16 a[82:83], v11 offset:288
    v_mfma_f32_16x16x32_bf16 v[232:235], a[192:195], a[92:95], v[232:235]
    v_mfma_f32_16x16x32_bf16 v[232:235], a[176:179], a[88:91], v[232:235]
    v_mfma_f32_16x16x32_bf16 v[228:231], a[172:175], a[88:91], v[228:231]
    v_mfma_f32_16x16x32_bf16 v[228:231], a[188:191], a[92:95], v[228:231]
    v_mfma_f32_16x16x32_bf16 v[224:227], a[184:187], a[92:95], v[224:227]
    ds_read_b64_tr_b16 a[92:93], v11 offset:12704
    v_mfma_f32_16x16x32_bf16 v[224:227], a[168:171], a[88:91], v[224:227]
    ds_read_b64_tr_b16 a[94:95], v11 offset:12960
    v_mfma_f32_16x16x32_bf16 v[240:243], a[168:171], a[96:99], v[240:243]
    ds_read_b64_tr_b16 a[88:89], v11 offset:8480
    v_mfma_f32_16x16x32_bf16 v[240:243], a[184:187], a[100:103], v[240:243]
    ds_read_b64_tr_b16 a[90:91], v11 offset:8736
    v_mfma_f32_16x16x32_bf16 v[244:247], a[188:191], a[100:103], v[244:247]
    v_mfma_f32_16x16x32_bf16 v[244:247], a[172:175], a[96:99], v[244:247]
    v_add_u32 v24, 262144, v24
    v_mfma_f32_16x16x32_bf16 v[248:251], a[176:179], a[96:99], v[248:251]
    v_mfma_f32_16x16x32_bf16 v[248:251], a[192:195], a[100:103], v[248:251]
    v_mfma_f32_16x16x32_bf16 v[252:255], a[196:199], a[100:103], v[252:255]
    ds_read_b64_tr_b16 a[100:101], v11 offset:4288
    v_mfma_f32_16x16x32_bf16 v[252:255], a[180:183], a[96:99], v[252:255]
    ds_read_b64_tr_b16 a[102:103], v11 offset:4544
    v_mfma_f32_16x16x32_bf16 a[12:15], a[180:183], a[104:107], a[12:15]
    ds_read_b64_tr_b16 a[96:97], v11 offset:64
    v_mfma_f32_16x16x32_bf16 a[12:15], a[196:199], a[108:111], a[12:15]
    ds_read_b64_tr_b16 a[98:99], v11 offset:320
    v_mfma_f32_16x16x32_bf16 a[8:11], a[192:195], a[108:111], a[8:11]
    v_mfma_f32_16x16x32_bf16 a[8:11], a[176:179], a[104:107], a[8:11]
    v_mfma_f32_16x16x32_bf16 a[4:7], a[172:175], a[104:107], a[4:7]
    v_mfma_f32_16x16x32_bf16 a[4:7], a[188:191], a[108:111], a[4:7]
    v_mfma_f32_16x16x32_bf16 a[0:3], a[184:187], a[108:111], a[0:3]
    ds_read_b64_tr_b16 a[108:109], v11 offset:12736
    v_mfma_f32_16x16x32_bf16 a[0:3], a[168:171], a[104:107], a[0:3]
    ds_read_b64_tr_b16 a[110:111], v11 offset:12992
    v_mfma_f32_16x16x32_bf16 a[16:19], a[168:171], a[112:115], a[16:19]
    ds_read_b64_tr_b16 a[104:105], v11 offset:8512
    v_mfma_f32_16x16x32_bf16 a[16:19], a[184:187], a[116:119], a[16:19]
    ds_read_b64_tr_b16 a[106:107], v11 offset:8768
    v_mfma_f32_16x16x32_bf16 a[20:23], a[188:191], a[116:119], a[20:23]
    v_mfma_f32_16x16x32_bf16 a[20:23], a[172:175], a[112:115], a[20:23]
    v_mfma_f32_16x16x32_bf16 a[24:27], a[176:179], a[112:115], a[24:27]
    v_mfma_f32_16x16x32_bf16 a[24:27], a[192:195], a[116:119], a[24:27]
    v_mfma_f32_16x16x32_bf16 a[28:31], a[196:199], a[116:119], a[28:31]
    ds_read_b64_tr_b16 a[116:117], v11 offset:4320
    v_mfma_f32_16x16x32_bf16 a[28:31], a[180:183], a[112:115], a[28:31]
    ds_read_b64_tr_b16 a[118:119], v11 offset:4576
    v_mfma_f32_16x16x32_bf16 a[44:47], a[180:183], a[120:123], a[44:47]
    ds_read_b64_tr_b16 a[112:113], v11 offset:96
    v_mfma_f32_16x16x32_bf16 a[44:47], a[196:199], a[124:127], a[44:47]
    ds_read_b64_tr_b16 a[114:115], v11 offset:352
    v_mfma_f32_16x16x32_bf16 a[40:43], a[192:195], a[124:127], a[40:43]
    v_mfma_f32_16x16x32_bf16 a[40:43], a[176:179], a[120:123], a[40:43]
    v_mfma_f32_16x16x32_bf16 a[36:39], a[172:175], a[120:123], a[36:39]
    s_sub_u32 s34, 0, s34
    v_mfma_f32_16x16x32_bf16 a[36:39], a[188:191], a[124:127], a[36:39]
    v_mfma_f32_16x16x32_bf16 a[32:35], a[184:187], a[124:127], a[32:35]
    ds_read_b64_tr_b16 a[124:125], v11 offset:12768
    v_mfma_f32_16x16x32_bf16 a[32:35], a[168:171], a[120:123], a[32:35]
    ds_read_b64_tr_b16 a[126:127], v11 offset:13024
    v_mfma_f32_16x16x32_bf16 a[48:51], a[168:171], a[128:131], a[48:51]
    ds_read_b64_tr_b16 a[120:121], v11 offset:8544
    v_mfma_f32_16x16x32_bf16 a[48:51], a[184:187], a[132:135], a[48:51]
    ds_read_b64_tr_b16 a[122:123], v11 offset:8800
    v_mfma_f32_16x16x32_bf16 a[52:55], a[188:191], a[132:135], a[52:55]
    v_mfma_f32_16x16x32_bf16 a[52:55], a[172:175], a[128:131], a[52:55]
    v_mfma_f32_16x16x32_bf16 a[56:59], a[176:179], a[128:131], a[56:59]
    v_mfma_f32_16x16x32_bf16 a[56:59], a[192:195], a[132:135], a[56:59]
    v_mfma_f32_16x16x32_bf16 a[60:63], a[196:199], a[132:135], a[60:63]
    ds_read_b128 a[132:135], v14 offset:0
    v_mfma_f32_16x16x32_bf16 a[60:63], a[180:183], a[128:131], a[60:63]
    ds_read_b128 a[128:131], v13 offset:0
    s_getpc_b64 s[58:59]
L_pc2B:
    s_add_u32 s58, s58, L_k3_code-L_pc2B
    s_addc_u32 s59, s59, 0
    v_and_b32 v19, 63, v0
    v_min_u32 v19, 11, v19
    s_lshr_b32 s3, s2, 3
    s_mul_i32 s3, s3, 12
    v_add_lshl_u32 v19, v19, s3, 7
    v_min_u32 v19, L_text_end-L_k3_code-4, v19
    global_load_dword a237, v19, s[58:59]
    s_getpc_b64 s[58:59]
L_pceB:
    s_add_u32 s58, s58, L_k2_epiB-L_pceB
    s_addc_u32 s59, s59, 0
    v_lshlrev_b32_e64 v19, 6, v0
    global_load_dword a238, v19, s[58:59]
    s_waitcnt vmcnt(4) lgkmcnt(6)
    v_mfma_f32_16x16x32_bf16 v[32:35], a[64:67], a[136:139], v[32:35]
    v_mfma_f32_16x16x32_bf16 v[32:35], a[68:71], a[152:155], v[32:35]
    buffer_load_dwordx4 a[168:171], v10, s[16:19], s29 offen offset:0 sc1
    v_mfma_f32_16x16x32_bf16 v[36:39], a[68:71], a[156:159], v[36:39]
    v_mfma_f32_16x16x32_bf16 v[36:39], a[64:67], a[140:143], v[36:39]
    v_mfma_f32_16x16x32_bf16 v[40:43], a[64:67], a[144:147], v[40:43]
    v_mfma_f32_16x16x32_bf16 v[40:43], a[68:71], a[160:163], v[40:43]
    v_mfma_f32_16x16x32_bf16 v[44:47], a[68:71], a[164:167], v[44:47]
    ds_read_b128 a[68:71], v14 offset:2048
    v_mfma_f32_16x16x32_bf16 v[44:47], a[64:67], a[148:151], v[44:47]
    ds_read_b128 a[64:67], v13 offset:2048
    v_mfma_f32_16x16x32_bf16 v[60:63], a[72:75], a[148:151], v[60:63]
    buffer_load_dwordx4 a[172:175], v10, s[16:19], s29 offen offset:1024 sc1
    v_mfma_f32_16x16x32_bf16 v[60:63], a[76:79], a[164:167], v[60:63]
    v_mfma_f32_16x16x32_bf16 v[56:59], a[76:79], a[160:163], v[56:59]
    v_mfma_f32_16x16x32_bf16 v[56:59], a[72:75], a[144:147], v[56:59]
    v_mfma_f32_16x16x32_bf16 v[52:55], a[72:75], a[140:143], v[52:55]
    v_mfma_f32_16x16x32_bf16 v[52:55], a[76:79], a[156:159], v[52:55]
    v_mfma_f32_16x16x32_bf16 v[48:51], a[76:79], a[152:155], v[48:51]
    ds_read_b128 a[76:79], v14 offset:4096
    v_mfma_f32_16x16x32_bf16 v[48:51], a[72:75], a[136:139], v[48:51]
    ds_read_b128 a[72:75], v13 offset:4096
    v_mfma_f32_16x16x32_bf16 v[64:67], a[80:83], a[136:139], v[64:67]
    buffer_load_dwordx4 a[176:179], v10, s[16:19], s29 offen offset:2048 sc1
    v_mfma_f32_16x16x32_bf16 v[64:67], a[84:87], a[152:155], v[64:67]
    v_mfma_f32_16x16x32_bf16 v[68:71], a[84:87], a[156:159], v[68:71]
    v_mfma_f32_16x16x32_bf16 v[68:71], a[80:83], a[140:143], v[68:71]
    v_mfma_f32_16x16x32_bf16 v[72:75], a[80:83], a[144:147], v[72:75]
    v_mfma_f32_16x16x32_bf16 v[72:75], a[84:87], a[160:163], v[72:75]
    buffer_load_dwordx4 a[180:183], v10, s[16:19], s29 offen offset:3072 sc1
    v_mfma_f32_16x16x32_bf16 v[76:79], a[84:87], a[164:167], v[76:79]
    ds_read_b128 a[84:87], v14 offset:6144
    v_mfma_f32_16x16x32_bf16 v[76:79], a[80:83], a[148:151], v[76:79]
    ds_read_b128 a[80:83], v13 offset:6144
    v_mfma_f32_16x16x32_bf16 v[92:95], a[88:91], a[148:151], v[92:95]
    v_mfma_f32_16x16x32_bf16 v[92:95], a[92:95], a[164:167], v[92:95]
    v_mfma_f32_16x16x32_bf16 v[88:91], a[92:95], a[160:163], v[88:91]
    v_mfma_f32_16x16x32_bf16 v[88:91], a[88:91], a[144:147], v[88:91]
    v_mfma_f32_16x16x32_bf16 v[84:87], a[88:91], a[140:143], v[84:87]
    s_add_u32 s29, s29, 4096
    v_mfma_f32_16x16x32_bf16 v[84:87], a[92:95], a[156:159], v[84:87]
    v_mfma_f32_16x16x32_bf16 v[80:83], a[92:95], a[152:155], v[80:83]
    ds_read_b128 a[92:95], v14 offset:8192
    v_mfma_f32_16x16x32_bf16 v[80:83], a[88:91], a[136:139], v[80:83]
    ds_read_b128 a[88:91], v13 offset:8192
    v_mfma_f32_16x16x32_bf16 v[96:99], a[96:99], a[136:139], v[96:99]
    v_mfma_f32_16x16x32_bf16 v[96:99], a[100:103], a[152:155], v[96:99]
    v_mfma_f32_16x16x32_bf16 v[100:103], a[100:103], a[156:159], v[100:103]
    v_mfma_f32_16x16x32_bf16 v[100:103], a[96:99], a[140:143], v[100:103]
    buffer_load_dwordx4 a[184:187], v10, s[16:19], s29 offen offset:0 sc1
    v_mfma_f32_16x16x32_bf16 v[104:107], a[96:99], a[144:147], v[104:107]
    v_mfma_f32_16x16x32_bf16 v[104:107], a[100:103], a[160:163], v[104:107]
    v_mfma_f32_16x16x32_bf16 v[108:111], a[100:103], a[164:167], v[108:111]
    ds_read_b128 a[100:103], v14 offset:10240
    v_mfma_f32_16x16x32_bf16 v[108:111], a[96:99], a[148:151], v[108:111]
    ds_read_b128 a[96:99], v13 offset:10240
    v_mfma_f32_16x16x32_bf16 v[124:127], a[104:107], a[148:151], v[124:127]
    v_mfma_f32_16x16x32_bf16 v[124:127], a[108:111], a[164:167], v[124:127]
    buffer_load_dwordx4 a[188:191], v10, s[16:19], s29 offen offset:1024 sc1
    v_mfma_f32_16x16x32_bf16 v[120:123], a[108:111], a[160:163], v[120:123]
    v_mfma_f32_16x16x32_bf16 v[120:123], a[104:107], a[144:147], v[120:123]
    v_mfma_f32_16x16x32_bf16 v[116:119], a[104:107], a[140:143], v[116:119]
    v_mfma_f32_16x16x32_bf16 v[116:119], a[108:111], a[156:159], v[116:119]
    v_mfma_f32_16x16x32_bf16 v[112:115], a[108:111], a[152:155], v[112:115]
    ds_read_b128 a[108:111], v14 offset:12288
    v_mfma_f32_16x16x32_bf16 v[112:115], a[104:107], a[136:139], v[112:115]
    ds_read_b128 a[104:107], v13 offset:12288
    v_mfma_f32_16x16x32_bf16 v[128:131], a[112:115], a[136:139], v[128:131]
    buffer_load_dwordx4 a[192:195], v10, s[16:19], s29 offen offset:2048 sc1
    v_mfma_f32_16x16x32_bf16 v[128:131], a[116:119], a[152:155], v[128:131]
    v_mfma_f32_16x16x32_bf16 v[132:135], a[116:119], a[156:159], v[132:135]
    v_mfma_f32_16x16x32_bf16 v[132:135], a[112:115], a[140:143], v[132:135]
    v_mfma_f32_16x16x32_bf16 v[136:139], a[112:115], a[144:147], v[136:139]
    v_mfma_f32_16x16x32_bf16 v[136:139], a[116:119], a[160:163], v[136:139]
    v_mfma_f32_16x16x32_bf16 v[140:143], a[116:119], a[164:167], v[140:143]
    ds_read_b128 a[116:119], v14 offset:14336
    v_mfma_f32_16x16x32_bf16 v[140:143], a[112:115], a[148:151], v[140:143]
    ds_read_b128 a[112:115], v13 offset:14336
    s_waitcnt lgkmcnt(6)
    v_mfma_f32_16x16x32_bf16 v[156:159], a[120:123], a[148:151], v[156:159]
    buffer_load_dwordx4 a[196:199], v10, s[16:19], s29 offen offset:3072 sc1
    v_mfma_f32_16x16x32_bf16 v[156:159], a[124:127], a[164:167], v[156:159]
    v_mfma_f32_16x16x32_bf16 v[152:155], a[124:127], a[160:163], v[152:155]
    v_mfma_f32_16x16x32_bf16 v[152:155], a[120:123], a[144:147], v[152:155]
    v_mfma_f32_16x16x32_bf16 v[148:151], a[120:123], a[140:143], v[148:151]
    v_mfma_f32_16x16x32_bf16 v[148:151], a[124:127], a[156:159], v[148:151]
    v_mfma_f32_16x16x32_bf16 v[144:147], a[124:127], a[152:155], v[144:147]
    ds_read_b128 a[124:127], v14 offset:16384
    v_mfma_f32_16x16x32_bf16 v[144:147], a[120:123], a[136:139], v[144:147]
    ds_read_b128 a[120:123], v13 offset:16384
    v_mfma_f32_16x16x32_bf16 v[160:163], a[136:139], a[128:131], v[160:163]
    s_add_u32 s29, s29, 4096
    v_mfma_f32_16x16x32_bf16 v[160:163], a[152:155], a[132:135], v[160:163]
    v_mfma_f32_16x16x32_bf16 v[164:167], a[156:159], a[132:135], v[164:167]
    v_mfma_f32_16x16x32_bf16 v[164:167], a[140:143], a[128:131], v[164:167]
    v_mfma_f32_16x16x32_bf16 v[168:171], a[144:147], a[128:131], v[168:171]
    v_mfma_f32_16x16x32_bf16 v[168:171], a[160:163], a[132:135], v[168:171]
    v_mfma_f32_16x16x32_bf16 v[172:175], a[164:167], a[132:135], v[172:175]
    ds_read_b128 a[132:135], v14 offset:18432
    v_mfma_f32_16x16x32_bf16 v[172:175], a[148:151], a[128:131], v[172:175]
    ds_read_b128 a[128:131], v13 offset:18432
    v_mfma_f32_16x16x32_bf16 v[176:179], a[136:139], a[64:67], v[176:179]
    v_mfma_f32_16x16x32_bf16 v[176:179], a[152:155], a[68:71], v[176:179]
    v_accvgpr_read_b32 v1, a240
    v_mfma_f32_16x16x32_bf16 v[180:183], a[156:159], a[68:71], v[180:183]
    v_mfma_f32_16x16x32_bf16 v[180:183], a[140:143], a[64:67], v[180:183]
    v_mfma_f32_16x16x32_bf16 v[184:187], a[144:147], a[64:67], v[184:187]
    v_mfma_f32_16x16x32_bf16 v[184:187], a[160:163], a[68:71], v[184:187]
    v_mfma_f32_16x16x32_bf16 v[188:191], a[164:167], a[68:71], v[188:191]
    v_mfma_f32_16x16x32_bf16 v[188:191], a[148:151], a[64:67], v[188:191]
    v_mfma_f32_16x16x32_bf16 v[204:207], a[148:151], a[72:75], v[204:207]
    v_mfma_f32_16x16x32_bf16 v[204:207], a[164:167], a[76:79], v[204:207]
    v_accvgpr_read_b32 v2, a241
    v_mfma_f32_16x16x32_bf16 v[200:203], a[160:163], a[76:79], v[200:203]
    v_mfma_f32_16x16x32_bf16 v[200:203], a[144:147], a[72:75], v[200:203]
    s_waitcnt vmcnt(9)
    s_waitcnt lgkmcnt(0)
    s_barrier
    ds_read_b64_tr_b16 a[68:69], v12 offset:4224
    v_mfma_f32_16x16x32_bf16 v[196:199], a[140:143], a[72:75], v[196:199]
    ds_read_b64_tr_b16 a[70:71], v12 offset:4480
    v_mfma_f32_16x16x32_bf16 v[196:199], a[156:159], a[76:79], v[196:199]
    ds_read_b64_tr_b16 a[64:65], v12 offset:0
    v_mfma_f32_16x16x32_bf16 v[192:195], a[152:155], a[76:79], v[192:195]
    ds_read_b64_tr_b16 a[66:67], v12 offset:256
    v_mfma_f32_16x16x32_bf16 v[192:195], a[136:139], a[72:75], v[192:195]
    ds_read_b64_tr_b16 a[76:77], v12 offset:12672
    v_mfma_f32_16x16x32_bf16 v[208:211], a[136:139], a[80:83], v[208:211]
    ds_read_b64_tr_b16 a[78:79], v12 offset:12928
    v_mfma_f32_16x16x32_bf16 v[208:211], a[152:155], a[84:87], v[208:211]
    ds_read_b64_tr_b16 a[72:73], v12 offset:8448
    v_mfma_f32_16x16x32_bf16 v[212:215], a[156:159], a[84:87], v[212:215]
    ds_read_b64_tr_b16 a[74:75], v12 offset:8704
    v_mfma_f32_16x16x32_bf16 v[212:215], a[140:143], a[80:83], v[212:215]
    v_accvgpr_read_b32 v3, a242
    v_mfma_f32_16x16x32_bf16 v[216:219], a[144:147], a[80:83], v[216:219]
    v_mfma_f32_16x16x32_bf16 v[216:219], a[160:163], a[84:87], v[216:219]
    v_mfma_f32_16x16x32_bf16 v[220:223], a[164:167], a[84:87], v[220:223]
    ds_read_b64_tr_b16 a[84:85], v12 offset:4256
    v_mfma_f32_16x16x32_bf16 v[220:223], a[148:151], a[80:83], v[220:223]
    ds_read_b64_tr_b16 a[86:87], v12 offset:4512
    v_mfma_f32_16x16x32_bf16 v[236:239], a[148:151], a[88:91], v[236:239]
    ds_read_b64_tr_b16 a[80:81], v12 offset:32
    v_mfma_f32_16x16x32_bf16 v[236:239], a[164:167], a[92:95], v[236:239]
    ds_read_b64_tr_b16 a[82:83], v12 offset:288
    v_mfma_f32_16x16x32_bf16 v[232:235], a[160:163], a[92:95], v[232:235]
    v_accvgpr_read_b32 v4, a243
    v_mfma_f32_16x16x32_bf16 v[232:235], a[144:147], a[88:91], v[232:235]
    v_mfma_f32_16x16x32_bf16 v[228:231], a[140:143], a[88:91], v[228:231]
    v_mfma_f32_16x16x32_bf16 v[228:231], a[156:159], a[92:95], v[228:231]
    v_mfma_f32_16x16x32_bf16 v[224:227], a[152:155], a[92:95], v[224:227]
    ds_read_b64_tr_b16 a[92:93], v12 offset:12704
    v_mfma_f32_16x16x32_bf16 v[224:227], a[136:139], a[88:91], v[224:227]
    ds_read_b64_tr_b16 a[94:95], v12 offset:12960
    v_mfma_f32_16x16x32_bf16 v[240:243], a[136:139], a[96:99], v[240:243]
    ds_read_b64_tr_b16 a[88:89], v12 offset:8480
    v_mfma_f32_16x16x32_bf16 v[240:243], a[152:155], a[100:103], v[240:243]
    ds_read_b64_tr_b16 a[90:91], v12 offset:8736
    v_mfma_f32_16x16x32_bf16 v[244:247], a[156:159], a[100:103], v[244:247]
    v_mfma_f32_16x16x32_bf16 v[244:247], a[140:143], a[96:99], v[244:247]
    v_accvgpr_read_b32 v5, a244
    v_mfma_f32_16x16x32_bf16 v[248:251], a[144:147], a[96:99], v[248:251]
    v_mfma_f32_16x16x32_bf16 v[248:251], a[160:163], a[100:103], v[248:251]
    v_mfma_f32_16x16x32_bf16 v[252:255], a[164:167], a[100:103], v[252:255]
    ds_read_b64_tr_b16 a[100:101], v12 offset:4288
    v_mfma_f32_16x16x32_bf16 v[252:255], a[148:151], a[96:99], v[252:255]
    ds_read_b64_tr_b16 a[102:103], v12 offset:4544
    v_mfma_f32_16x16x32_bf16 a[12:15], a[148:151], a[104:107], a[12:15]
    ds_read_b64_tr_b16 a[96:97], v12 offset:64
    v_mfma_f32_16x16x32_bf16 a[12:15], a[164:167], a[108:111], a[12:15]
    ds_read_b64_tr_b16 a[98:99], v12 offset:320
    v_mfma_f32_16x16x32_bf16 a[8:11], a[160:163], a[108:111], a[8:11]
    v_mfma_f32_16x16x32_bf16 a[8:11], a[144:147], a[104:107], a[8:11]
    v_accvgpr_read_b32 v6, a245
    v_mfma_f32_16x16x32_bf16 a[4:7], a[140:143], a[104:107], a[4:7]
    v_mfma_f32_16x16x32_bf16 a[4:7], a[156:159], a[108:111], a[4:7]
    v_mfma_f32_16x16x32_bf16 a[0:3], a[152:155], a[108:111], a[0:3]
    ds_read_b64_tr_b16 a[108:109], v12 offset:12736
    v_mfma_f32_16x16x32_bf16 a[0:3], a[136:139], a[104:107], a[0:3]
    ds_read_b64_tr_b16 a[110:111], v12 offset:12992
    v_mfma_f32_16x16x32_bf16 a[16:19], a[136:139], a[112:115], a[16:19]
    ds_read_b64_tr_b16 a[104:105], v12 offset:8512
    v_mfma_f32_16x16x32_bf16 a[16:19], a[152:155], a[116:119], a[16:19]
    ds_read_b64_tr_b16 a[106:107], v12 offset:8768
    v_mfma_f32_16x16x32_bf16 a[20:23], a[156:159], a[116:119], a[20:23]
    v_mfma_f32_16x16x32_bf16 a[20:23], a[140:143], a[112:115], a[20:23]
    v_mfma_f32_16x16x32_bf16 a[24:27], a[144:147], a[112:115], a[24:27]
    v_accvgpr_read_b32 v7, a246
    v_mfma_f32_16x16x32_bf16 a[24:27], a[160:163], a[116:119], a[24:27]
    v_mfma_f32_16x16x32_bf16 a[28:31], a[164:167], a[116:119], a[28:31]
    ds_read_b64_tr_b16 a[116:117], v12 offset:4320
    v_mfma_f32_16x16x32_bf16 a[28:31], a[148:151], a[112:115], a[28:31]
    ds_read_b64_tr_b16 a[118:119], v12 offset:4576
    v_mfma_f32_16x16x32_bf16 a[44:47], a[148:151], a[120:123], a[44:47]
    ds_read_b64_tr_b16 a[112:113], v12 offset:96
    v_mfma_f32_16x16x32_bf16 a[44:47], a[164:167], a[124:127], a[44:47]
    ds_read_b64_tr_b16 a[114:115], v12 offset:352
    v_mfma_f32_16x16x32_bf16 a[40:43], a[160:163], a[124:127], a[40:43]
    v_mfma_f32_16x16x32_bf16 a[40:43], a[144:147], a[120:123], a[40:43]
    v_mfma_f32_16x16x32_bf16 a[36:39], a[140:143], a[120:123], a[36:39]
    v_accvgpr_read_b32 v8, a247
    v_mfma_f32_16x16x32_bf16 a[36:39], a[156:159], a[124:127], a[36:39]
    v_mfma_f32_16x16x32_bf16 a[32:35], a[152:155], a[124:127], a[32:35]
    ds_read_b64_tr_b16 a[124:125], v12 offset:12768
    v_mfma_f32_16x16x32_bf16 a[32:35], a[136:139], a[120:123], a[32:35]
    ds_read_b64_tr_b16 a[126:127], v12 offset:13024
    v_mfma_f32_16x16x32_bf16 a[48:51], a[136:139], a[128:131], a[48:51]
    ds_read_b64_tr_b16 a[120:121], v12 offset:8544
    v_mfma_f32_16x16x32_bf16 a[48:51], a[152:155], a[132:135], a[48:51]
    ds_read_b64_tr_b16 a[122:123], v12 offset:8800
    v_mfma_f32_16x16x32_bf16 a[52:55], a[156:159], a[132:135], a[52:55]
    v_mfma_f32_16x16x32_bf16 a[52:55], a[140:143], a[128:131], a[52:55]
    v_mfma_f32_16x16x32_bf16 a[56:59], a[144:147], a[128:131], a[56:59]
    v_mfma_f32_16x16x32_bf16 a[56:59], a[160:163], a[132:135], a[56:59]
    v_mfma_f32_16x16x32_bf16 a[60:63], a[164:167], a[132:135], a[60:63]
    ds_read_b128 a[132:135], v16 offset:0
    v_mfma_f32_16x16x32_bf16 a[60:63], a[148:151], a[128:131], a[60:63]
    ds_read_b128 a[128:131], v15 offset:0
    s_waitcnt vmcnt(0) lgkmcnt(6)
    v_mfma_f32_16x16x32_bf16 v[32:35], a[64:67], a[168:171], v[32:35]
    v_mfma_f32_16x16x32_bf16 v[32:35], a[68:71], a[184:187], v[32:35]
    s_add_u32 s78, s77, s72
    s_xor_b32 s72, s54, 0
    v_mfma_f32_16x16x32_bf16 v[36:39], a[68:71], a[188:191], v[36:39]
    v_mfma_f32_16x16x32_bf16 v[36:39], a[64:67], a[172:175], v[36:39]
    v_mfma_f32_16x16x32_bf16 v[40:43], a[64:67], a[176:179], v[40:43]
    v_mfma_f32_16x16x32_bf16 v[40:43], a[68:71], a[192:195], v[40:43]
    s_add_u32 m0, s76, 0
    v_mfma_f32_16x16x32_bf16 v[44:47], a[68:71], a[196:199], v[44:47]
    ds_read_b128 a[68:71], v16 offset:2048
    v_mfma_f32_16x16x32_bf16 v[44:47], a[64:67], a[180:183], v[44:47]
    ds_read_b128 a[64:67], v15 offset:2048
    v_mfma_f32_16x16x32_bf16 v[60:63], a[72:75], a[180:183], v[60:63]
    v_mfma_f32_16x16x32_bf16 v[60:63], a[76:79], a[196:199], v[60:63]
    buffer_load_dwordx4 v1, s[68:71], s78 offen offset:0 lds
    v_mfma_f32_16x16x32_bf16 v[56:59], a[76:79], a[192:195], v[56:59]
    v_mfma_f32_16x16x32_bf16 v[56:59], a[72:75], a[176:179], v[56:59]
    v_mfma_f32_16x16x32_bf16 v[52:55], a[72:75], a[172:175], v[52:55]
    v_mfma_f32_16x16x32_bf16 v[52:55], a[76:79], a[188:191], v[52:55]
    buffer_load_dwordx4 v2, s[68:71], s78 offen offset:1024 lds
    v_mfma_f32_16x16x32_bf16 v[48:51], a[76:79], a[184:187], v[48:51]
    ds_read_b128 a[76:79], v16 offset:4096
    v_mfma_f32_16x16x32_bf16 v[48:51], a[72:75], a[168:171], v[48:51]
    ds_read_b128 a[72:75], v15 offset:4096
    v_mfma_f32_16x16x32_bf16 v[64:67], a[80:83], a[168:171], v[64:67]
    v_mfma_f32_16x16x32_bf16 v[64:67], a[84:87], a[184:187], v[64:67]
    buffer_load_dwordx4 v3, s[68:71], s78 offen offset:2048 lds
    v_mfma_f32_16x16x32_bf16 v[68:71], a[84:87], a[188:191], v[68:71]
    v_mfma_f32_16x16x32_bf16 v[68:71], a[80:83], a[172:175], v[68:71]
    v_mfma_f32_16x16x32_bf16 v[72:75], a[80:83], a[176:179], v[72:75]
    v_mfma_f32_16x16x32_bf16 v[72:75], a[84:87], a[192:195], v[72:75]
    buffer_load_dwordx4 v4, s[68:71], s78 offen offset:3072 lds
    v_mfma_f32_16x16x32_bf16 v[76:79], a[84:87], a[196:199], v[76:79]
    ds_read_b128 a[84:87], v16 offset:6144
    v_mfma_f32_16x16x32_bf16 v[76:79], a[80:83], a[180:183], v[76:79]
    ds_read_b128 a[80:83], v15 offset:6144
    v_mfma_f32_16x16x32_bf16 v[92:95], a[88:91], a[180:183], v[92:95]
    v_mfma_f32_16x16x32_bf16 v[92:95], a[92:95], a[196:199], v[92:95]
    s_add_u32 m0, s76, 4096
    v_mfma_f32_16x16x32_bf16 v[88:91], a[92:95], a[192:195], v[88:91]
    v_mfma_f32_16x16x32_bf16 v[88:91], a[88:91], a[176:179], v[88:91]
    v_mfma_f32_16x16x32_bf16 v[84:87], a[88:91], a[172:175], v[84:87]
    v_mfma_f32_16x16x32_bf16 v[84:87], a[92:95], a[188:191], v[84:87]
    buffer_load_dwordx4 v5, s[68:71], s78 offen offset:0 lds
    v_mfma_f32_16x16x32_bf16 v[80:83], a[92:95], a[184:187], v[80:83]
    ds_read_b128 a[92:95], v16 offset:8192
    v_mfma_f32_16x16x32_bf16 v[80:83], a[88:91], a[168:171], v[80:83]
    ds_read_b128 a[88:91], v15 offset:8192
    v_mfma_f32_16x16x32_bf16 v[96:99], a[96:99], a[168:171], v[96:99]
    v_mfma_f32_16x16x32_bf16 v[96:99], a[100:103], a[184:187], v[96:99]
    buffer_load_dwordx4 v6, s[68:71], s78 offen offset:1024 lds
    v_mfma_f32_16x16x32_bf16 v[100:103], a[100:103], a[188:191], v[100:103]
    v_mfma_f32_16x16x32_bf16 v[100:103], a[96:99], a[172:175], v[100:103]
    v_mfma_f32_16x16x32_bf16 v[104:107], a[96:99], a[176:179], v[104:107]
    v_mfma_f32_16x16x32_bf16 v[104:107], a[100:103], a[192:195], v[104:107]
    buffer_load_dwordx4 v7, s[68:71], s78 offen offset:2048 lds
    v_mfma_f32_16x16x32_bf16 v[108:111], a[100:103], a[196:199], v[108:111]
    ds_read_b128 a[100:103], v16 offset:10240
    v_mfma_f32_16x16x32_bf16 v[108:111], a[96:99], a[180:183], v[108:111]
    ds_read_b128 a[96:99], v15 offset:10240
    v_mfma_f32_16x16x32_bf16 v[124:127], a[104:107], a[180:183], v[124:127]
    v_mfma_f32_16x16x32_bf16 v[124:127], a[108:111], a[196:199], v[124:127]
    buffer_load_dwordx4 v8, s[68:71], s78 offen offset:3072 lds
    v_mfma_f32_16x16x32_bf16 v[120:123], a[108:111], a[192:195], v[120:123]
    v_mfma_f32_16x16x32_bf16 v[120:123], a[104:107], a[176:179], v[120:123]
    v_mfma_f32_16x16x32_bf16 v[116:119], a[104:107], a[172:175], v[116:119]
    v_mfma_f32_16x16x32_bf16 v[116:119], a[108:111], a[188:191], v[116:119]
    s_add_u32 s78, s77, s73
    s_xor_b32 s73, s54, 262144
    v_mfma_f32_16x16x32_bf16 v[112:115], a[108:111], a[184:187], v[112:115]
    ds_read_b128 a[108:111], v16 offset:12288
    v_mfma_f32_16x16x32_bf16 v[112:115], a[104:107], a[168:171], v[112:115]
    ds_read_b128 a[104:107], v15 offset:12288
    v_mfma_f32_16x16x32_bf16 v[128:131], a[112:115], a[168:171], v[128:131]
    v_mfma_f32_16x16x32_bf16 v[128:131], a[116:119], a[184:187], v[128:131]
    s_add_u32 m0, s76, 16384
    v_mfma_f32_16x16x32_bf16 v[132:135], a[116:119], a[188:191], v[132:135]
    v_mfma_f32_16x16x32_bf16 v[132:135], a[112:115], a[172:175], v[132:135]
    v_mfma_f32_16x16x32_bf16 v[136:139], a[112:115], a[176:179], v[136:139]
    v_mfma_f32_16x16x32_bf16 v[136:139], a[116:119], a[192:195], v[136:139]
    buffer_load_dwordx4 v1, s[68:71], s78 offen offset:0 lds
    v_mfma_f32_16x16x32_bf16 v[140:143], a[116:119], a[196:199], v[140:143]
    ds_read_b128 a[116:119], v16 offset:14336
    v_mfma_f32_16x16x32_bf16 v[140:143], a[112:115], a[180:183], v[140:143]
    ds_read_b128 a[112:115], v15 offset:14336
    s_waitcnt lgkmcnt(6)
    v_mfma_f32_16x16x32_bf16 v[156:159], a[120:123], a[180:183], v[156:159]
    v_mfma_f32_16x16x32_bf16 v[156:159], a[124:127], a[196:199], v[156:159]
    buffer_load_dwordx4 v2, s[68:71], s78 offen offset:1024 lds
    v_mfma_f32_16x16x32_bf16 v[152:155], a[124:127], a[192:195], v[152:155]
    v_mfma_f32_16x16x32_bf16 v[152:155], a[120:123], a[176:179], v[152:155]
    v_mfma_f32_16x16x32_bf16 v[148:151], a[120:123], a[172:175], v[148:151]
    v_mfma_f32_16x16x32_bf16 v[148:151], a[124:127], a[188:191], v[148:151]
    buffer_load_dwordx4 v3, s[68:71], s78 offen offset:2048 lds
    v_mfma_f32_16x16x32_bf16 v[144:147], a[124:127], a[184:187], v[144:147]
    ds_read_b128 a[124:127], v16 offset:16384
    v_mfma_f32_16x16x32_bf16 v[144:147], a[120:123], a[168:171], v[144:147]
    ds_read_b128 a[120:123], v15 offset:16384
    v_mfma_f32_16x16x32_bf16 v[160:163], a[168:171], a[128:131], v[160:163]
    v_mfma_f32_16x16x32_bf16 v[160:163], a[184:187], a[132:135], v[160:163]
    buffer_load_dwordx4 v4, s[68:71], s78 offen offset:3072 lds
    v_mfma_f32_16x16x32_bf16 v[164:167], a[188:191], a[132:135], v[164:167]
    v_mfma_f32_16x16x32_bf16 v[164:167], a[172:175], a[128:131], v[164:167]
    v_mfma_f32_16x16x32_bf16 v[168:171], a[176:179], a[128:131], v[168:171]
    v_mfma_f32_16x16x32_bf16 v[168:171], a[192:195], a[132:135], v[168:171]
    v_mfma_f32_16x16x32_bf16 v[172:175], a[196:199], a[132:135], v[172:175]
    ds_read_b128 a[132:135], v16 offset:18432
    v_mfma_f32_16x16x32_bf16 v[172:175], a[180:183], a[128:131], v[172:175]
    ds_read_b128 a[128:131], v15 offset:18432
    v_mfma_f32_16x16x32_bf16 v[176:179], a[168:171], a[64:67], v[176:179]
    v_mfma_f32_16x16x32_bf16 v[176:179], a[184:187], a[68:71], v[176:179]
    s_add_u32 m0, s76, 20480
    v_mfma_f32_16x16x32_bf16 v[180:183], a[188:191], a[68:71], v[180:183]
    v_mfma_f32_16x16x32_bf16 v[180:183], a[172:175], a[64:67], v[180:183]
    v_mfma_f32_16x16x32_bf16 v[184:187], a[176:179], a[64:67], v[184:187]
    v_mfma_f32_16x16x32_bf16 v[184:187], a[192:195], a[68:71], v[184:187]
    v_mfma_f32_16x16x32_bf16 v[188:191], a[196:199], a[68:71], v[188:191]
    v_mfma_f32_16x16x32_bf16 v[188:191], a[180:183], a[64:67], v[188:191]
    buffer_load_dwordx4 v5, s[68:71], s78 offen offset:0 lds
    v_mfma_f32_16x16x32_bf16 v[204:207], a[180:183], a[72:75], v[204:207]
    v_mfma_f32_16x16x32_bf16 v[204:207], a[196:199], a[76:79], v[204:207]
    v_mfma_f32_16x16x32_bf16 v[200:203], a[192:195], a[76:79], v[200:203]
    v_mfma_f32_16x16x32_bf16 v[200:203], a[176:179], a[72:75], v[200:203]
    v_mfma_f32_16x16x32_bf16 v[196:199], a[172:175], a[72:75], v[196:199]
    v_mfma_f32_16x16x32_bf16 v[196:199], a[188:191], a[76:79], v[196:199]
    buffer_load_dwordx4 v6, s[68:71], s78 offen offset:1024 lds
    v_mfma_f32_16x16x32_bf16 v[192:195], a[184:187], a[76:79], v[192:195]
    v_mfma_f32_16x16x32_bf16 v[192:195], a[168:171], a[72:75], v[192:195]
    v_mfma_f32_16x16x32_bf16 v[208:211], a[168:171], a[80:83], v[208:211]
    v_mfma_f32_16x16x32_bf16 v[208:211], a[184:187], a[84:87], v[208:211]
    v_mfma_f32_16x16x32_bf16 v[212:215], a[188:191], a[84:87], v[212:215]
    v_mfma_f32_16x16x32_bf16 v[212:215], a[172:175], a[80:83], v[212:215]
    buffer_load_dwordx4 v7, s[68:71], s78 offen offset:2048 lds
    v_mfma_f32_16x16x32_bf16 v[216:219], a[176:179], a[80:83], v[216:219]
    v_mfma_f32_16x16x32_bf16 v[216:219], a[192:195], a[84:87], v[216:219]
    v_mfma_f32_16x16x32_bf16 v[220:223], a[196:199], a[84:87], v[220:223]
    v_mfma_f32_16x16x32_bf16 v[220:223], a[180:183], a[80:83], v[220:223]
    v_mfma_f32_16x16x32_bf16 v[236:239], a[180:183], a[88:91], v[236:239]
    v_mfma_f32_16x16x32_bf16 v[236:239], a[196:199], a[92:95], v[236:239]
    buffer_load_dwordx4 v8, s[68:71], s78 offen offset:3072 lds
    v_mfma_f32_16x16x32_bf16 v[232:235], a[192:195], a[92:95], v[232:235]
    v_mfma_f32_16x16x32_bf16 v[232:235], a[176:179], a[88:91], v[232:235]
    v_mfma_f32_16x16x32_bf16 v[228:231], a[172:175], a[88:91], v[228:231]
    v_mfma_f32_16x16x32_bf16 v[228:231], a[188:191], a[92:95], v[228:231]
    v_mfma_f32_16x16x32_bf16 v[224:227], a[184:187], a[92:95], v[224:227]
    v_mfma_f32_16x16x32_bf16 v[224:227], a[168:171], a[88:91], v[224:227]
    s_add_u32 s78, s77, s74
    s_xor_b32 s74, s54, 524288
    s_waitcnt lgkmcnt(6)
    v_mfma_f32_16x16x32_bf16 v[240:243], a[168:171], a[96:99], v[240:243]
    v_mfma_f32_16x16x32_bf16 v[240:243], a[184:187], a[100:103], v[240:243]
    v_mfma_f32_16x16x32_bf16 v[244:247], a[188:191], a[100:103], v[244:247]
    v_mfma_f32_16x16x32_bf16 v[244:247], a[172:175], a[96:99], v[244:247]
    v_mfma_f32_16x16x32_bf16 v[248:251], a[176:179], a[96:99], v[248:251]
    v_mfma_f32_16x16x32_bf16 v[248:251], a[192:195], a[100:103], v[248:251]
    v_mfma_f32_16x16x32_bf16 v[252:255], a[196:199], a[100:103], v[252:255]
    s_add_u32 m0, s76, 32768
    v_mfma_f32_16x16x32_bf16 v[252:255], a[180:183], a[96:99], v[252:255]
    v_mfma_f32_16x16x32_bf16 a[12:15], a[180:183], a[104:107], a[12:15]
    v_mfma_f32_16x16x32_bf16 a[12:15], a[196:199], a[108:111], a[12:15]
    v_mfma_f32_16x16x32_bf16 a[8:11], a[192:195], a[108:111], a[8:11]
    v_mfma_f32_16x16x32_bf16 a[8:11], a[176:179], a[104:107], a[8:11]
    v_mfma_f32_16x16x32_bf16 a[4:7], a[172:175], a[104:107], a[4:7]
    buffer_load_dwordx4 v1, s[68:71], s78 offen offset:0 lds
    v_mfma_f32_16x16x32_bf16 a[4:7], a[188:191], a[108:111], a[4:7]
    v_mfma_f32_16x16x32_bf16 a[0:3], a[184:187], a[108:111], a[0:3]
    v_mfma_f32_16x16x32_bf16 a[0:3], a[168:171], a[104:107], a[0:3]
    s_waitcnt lgkmcnt(4)
    v_mfma_f32_16x16x32_bf16 a[16:19], a[168:171], a[112:115], a[16:19]
    v_mfma_f32_16x16x32_bf16 a[16:19], a[184:187], a[116:119], a[16:19]
    v_mfma_f32_16x16x32_bf16 a[20:23], a[188:191], a[116:119], a[20:23]
    buffer_load_dwordx4 v2, s[68:71], s78 offen offset:1024 lds
    v_mfma_f32_16x16x32_bf16 a[20:23], a[172:175], a[112:115], a[20:23]
    v_mfma_f32_16x16x32_bf16 a[24:27], a[176:179], a[112:115], a[24:27]
    v_mfma_f32_16x16x32_bf16 a[24:27], a[192:195], a[116:119], a[24:27]
    v_mfma_f32_16x16x32_bf16 a[28:31], a[196:199], a[116:119], a[28:31]
    v_mfma_f32_16x16x32_bf16 a[28:31], a[180:183], a[112:115], a[28:31]
    s_waitcnt lgkmcnt(2)
    v_mfma_f32_16x16x32_bf16 a[44:47], a[180:183], a[120:123], a[44:47]
    buffer_load_dwordx4 v3, s[68:71], s78 offen offset:2048 lds
    v_mfma_f32_16x16x32_bf16 a[44:47], a[196:199], a[124:127], a[44:47]
    v_mfma_f32_16x16x32_bf16 a[40:43], a[192:195], a[124:127], a[40:43]
    v_mfma_f32_16x16x32_bf16 a[40:43], a[176:179], a[120:123], a[40:43]
    v_mfma_f32_16x16x32_bf16 a[36:39], a[172:175], a[120:123], a[36:39]
    v_mfma_f32_16x16x32_bf16 a[36:39], a[188:191], a[124:127], a[36:39]
    v_mfma_f32_16x16x32_bf16 a[32:35], a[184:187], a[124:127], a[32:35]
    buffer_load_dwordx4 v4, s[68:71], s78 offen offset:3072 lds
    v_mfma_f32_16x16x32_bf16 a[32:35], a[168:171], a[120:123], a[32:35]
    s_waitcnt lgkmcnt(0)
    v_mfma_f32_16x16x32_bf16 a[48:51], a[168:171], a[128:131], a[48:51]
    v_mfma_f32_16x16x32_bf16 a[48:51], a[184:187], a[132:135], a[48:51]
    v_mfma_f32_16x16x32_bf16 a[52:55], a[188:191], a[132:135], a[52:55]
    v_mfma_f32_16x16x32_bf16 a[52:55], a[172:175], a[128:131], a[52:55]
    v_mfma_f32_16x16x32_bf16 a[56:59], a[176:179], a[128:131], a[56:59]
    v_mfma_f32_16x16x32_bf16 a[56:59], a[192:195], a[132:135], a[56:59]
    v_mfma_f32_16x16x32_bf16 a[60:63], a[196:199], a[132:135], a[60:63]
    v_mfma_f32_16x16x32_bf16 a[60:63], a[180:183], a[128:131], a[60:63]
L_k2_epiB:
    v_accvgpr_read_b32 v2, a200
    v_accvgpr_read_b32 v3, a201
    v_accvgpr_read_b32 v4, a206
    v_accvgpr_read_b32 v5, a207
    v_accvgpr_read_b32 v6, a212
    v_accvgpr_read_b32 v7, a213
    v_accvgpr_read_b32 v8, a218
    v_accvgpr_read_b32 v9, a219
    v_accvgpr_read_b32 v10, a224
    v_accvgpr_read_b32 v11, a225
    s_nop 7
    v_mov_b32 v12, v160
    v_mov_b32 v13, v240
    v_mov_b32 v16, v176
    v_accvgpr_read_b32 v17, a0
    v_mov_b32_e64 v20, v192
    v_accvgpr_read_b32 v21, a16
    v_mov_b32_e64 v24, v208
    v_accvgpr_read_b32 v25, a32
    v_mov_b32_e64 v28, v224
    v_accvgpr_read_b32 v29, a48
    v_mov_b32 v14, v161
    v_mov_b32 v15, v241
    v_mov_b32_e64 v18, v177
    v_accvgpr_read_b32 v19, a1
    v_mov_b32_e64 v22, v193
    v_accvgpr_read_b32 v23, a17
    v_mov_b32_e64 v26, v209
    v_accvgpr_read_b32 v27, a33
    v_mov_b32_e64 v30, v225
    v_accvgpr_read_b32 v31, a49
    v_pk_fma_f32 v[14:15], v[12:13], v[2:3], v[14:15] op_sel_hi:[1,0,1]
    v_pk_fma_f32 v[18:19], v[16:17], v[4:5], v[18:19] op_sel_hi:[1,0,1]
    v_pk_fma_f32 v[22:23], v[20:21], v[6:7], v[22:23] op_sel_hi:[1,0,1]
    v_pk_fma_f32 v[26:27], v[24:25], v[8:9], v[26:27] op_sel_hi:[1,0,1]
    v_pk_fma_f32 v[30:31], v[28:29], v[10:11], v[30:31] op_sel_hi:[1,0,1]
    v_pk_fma_f32 v[14:15], v[12:13], v[2:3], v[14:15] op_sel:[1,1,0] op_sel_hi:[0,1,1] neg_lo:[0,1,0]
    v_pk_fma_f32 v[18:19], v[16:17], v[4:5], v[18:19] op_sel:[1,1,0] op_sel_hi:[0,1,1] neg_lo:[0,1,0]
    v_pk_fma_f32 v[22:23], v[20:21], v[6:7], v[22:23] op_sel:[1,1,0] op_sel_hi:[0,1,1] neg_lo:[0,1,0]
    v_pk_fma_f32 v[26:27], v[24:25], v[8:9], v[26:27] op_sel:[1,1,0] op_sel_hi:[0,1,1] neg_lo:[0,1,0]
    v_pk_fma_f32 v[30:31], v[28:29], v[10:11], v[30:31] op_sel:[1,1,0] op_sel_hi:[0,1,1] neg_lo:[0,1,0]
    v_mov_b32 v12, v162
    v_mov_b32 v13, v242
    v_mov_b32_e64 v16, v178
    v_accvgpr_read_b32 v17, a2
    v_mov_b32_e64 v20, v194
    v_accvgpr_read_b32 v21, a18
    v_mov_b32_e64 v24, v210
    v_accvgpr_read_b32 v25, a34
    v_mov_b32_e64 v28, v226
    v_accvgpr_read_b32 v29, a50
    v_pk_fma_f32 v[12:13], v[14:15], v[2:3], v[12:13] op_sel_hi:[1,0,1]
    v_pk_fma_f32 v[16:17], v[18:19], v[4:5], v[16:17] op_sel_hi:[1,0,1]
    v_pk_fma_f32 v[20:21], v[22:23], v[6:7], v[20:21] op_sel_hi:[1,0,1]
    v_pk_fma_f32 v[24:25], v[26:27], v[8:9], v[24:25] op_sel_hi:[1,0,1]
    v_pk_fma_f32 v[28:29], v[30:31], v[10:11], v[28:29] op_sel_hi:[1,0,1]
    v_pk_fma_f32 v[12:13], v[14:15], v[2:3], v[12:13] op_sel:[1,1,0] op_sel_hi:[0,1,1] neg_lo:[0,1,0]
    v_pk_fma_f32 v[16:17], v[18:19], v[4:5], v[16:17] op_sel:[1,1,0] op_sel_hi:[0,1,1] neg_lo:[0,1,0]
    v_pk_fma_f32 v[20:21], v[22:23], v[6:7], v[20:21] op_sel:[1,1,0] op_sel_hi:[0,1,1] neg_lo:[0,1,0]
    v_pk_fma_f32 v[24:25], v[26:27], v[8:9], v[24:25] op_sel:[1,1,0] op_sel_hi:[0,1,1] neg_lo:[0,1,0]
    v_pk_fma_f32 v[28:29], v[30:31], v[10:11], v[28:29] op_sel:[1,1,0] op_sel_hi:[0,1,1] neg_lo:[0,1,0]
    v_mov_b32 v14, v163
    v_mov_b32 v15, v243
    v_mov_b32_e64 v18, v179
    v_accvgpr_read_b32 v19, a3
    v_mov_b32_e64 v22, v195
    v_accvgpr_read_b32 v23, a19
    v_mov_b32_e64 v26, v211
    v_accvgpr_read_b32 v27, a35
    v_mov_b32_e64 v30, v227
    v_accvgpr_read_b32 v31, a51
    v_pk_fma_f32 v[14:15], v[12:13], v[2:3], v[14:15] op_sel_hi:[1,0,1]
    v_pk_fma_f32 v[18:19], v[16:17], v[4:5], v[18:19] op_sel_hi:[1,0,1]
    v_pk_fma_f32 v[22:23], v[20:21], v[6:7], v[22:23] op_sel_hi:[1,0,1]
    v_pk_fma_f32 v[26:27], v[24:25], v[8:9], v[26:27] op_sel_hi:[1,0,1]
    v_pk_fma_f32 v[30:31], v[28:29], v[10:11], v[30:31] op_sel_hi:[1,0,1]
    v_pk_fma_f32 v[14:15], v[12:13], v[2:3], v[14:15] op_sel:[1,1,0] op_sel_hi:[0,1,1] neg_lo:[0,1,0]
    v_pk_fma_f32 v[18:19], v[16:17], v[4:5], v[18:19] op_sel:[1,1,0] op_sel_hi:[0,1,1] neg_lo:[0,1,0]
    v_pk_fma_f32 v[22:23], v[20:21], v[6:7], v[22:23] op_sel:[1,1,0] op_sel_hi:[0,1,1] neg_lo:[0,1,0]
    v_pk_fma_f32 v[26:27], v[24:25], v[8:9], v[26:27] op_sel:[1,1,0] op_sel_hi:[0,1,1] neg_lo:[0,1,0]
    v_pk_fma_f32 v[30:31], v[28:29], v[10:11], v[30:31] op_sel:[1,1,0] op_sel_hi:[0,1,1] neg_lo:[0,1,0]
    v_mov_b32 v12, v164
    v_mov_b32 v13, v244
    v_mov_b32_e64 v16, v180
    v_accvgpr_read_b32 v17, a4
    v_mov_b32_e64 v20, v196
    v_accvgpr_read_b32 v21, a20
    v_mov_b32_e64 v24, v212
    v_accvgpr_read_b32 v25, a36
    v_mov_b32_e64 v28, v228
    v_accvgpr_read_b32 v29, a52
    v_pk_fma_f32 v[12:13], v[14:15], v[2:3], v[12:13] op_sel_hi:[1,0,1]
    v_pk_fma_f32 v[16:17], v[18:19], v[4:5], v[16:17] op_sel_hi:[1,0,1]
    v_pk_fma_f32 v[20:21], v[22:23], v[6:7], v[20:21] op_sel_hi:[1,0,1]
    v_pk_fma_f32 v[24:25], v[26:27], v[8:9], v[24:25] op_sel_hi:[1,0,1]
    v_pk_fma_f32 v[28:29], v[30:31], v[10:11], v[28:29] op_sel_hi:[1,0,1]
    v_pk_fma_f32 v[12:13], v[14:15], v[2:3], v[12:13] op_sel:[1,1,0] op_sel_hi:[0,1,1] neg_lo:[0,1,0]
    v_pk_fma_f32 v[16:17], v[18:19], v[4:5], v[16:17] op_sel:[1,1,0] op_sel_hi:[0,1,1] neg_lo:[0,1,0]
    v_pk_fma_f32 v[20:21], v[22:23], v[6:7], v[20:21] op_sel:[1,1,0] op_sel_hi:[0,1,1] neg_lo:[0,1,0]
    v_pk_fma_f32 v[24:25], v[26:27], v[8:9], v[24:25] op_sel:[1,1,0] op_sel_hi:[0,1,1] neg_lo:[0,1,0]
    v_pk_fma_f32 v[28:29], v[30:31], v[10:11], v[28:29] op_sel:[1,1,0] op_sel_hi:[0,1,1] neg_lo:[0,1,0]
    v_mov_b32 v14, v165
    v_mov_b32 v15, v245
    v_mov_b32_e64 v18, v181
    v_accvgpr_read_b32 v19, a5
    v_mov_b32_e64 v22, v197
    v_accvgpr_read_b32 v23, a21
    v_mov_b32_e64 v26, v213
    v_accvgpr_read_b32 v27, a37
    v_mov_b32_e64 v30, v229
    v_accvgpr_read_b32 v31, a53
    v_pk_fma_f32 v[14:15], v[12:13], v[2:3], v[14:15] op_sel_hi:[1,0,1]
    v_pk_fma_f32 v[18:19], v[16:17], v[4:5], v[18:19] op_sel_hi:[1,0,1]
    v_pk_fma_f32 v[22:23], v[20:21], v[6:7], v[22:23] op_sel_hi:[1,0,1]
    v_pk_fma_f32 v[26:27], v[24:25], v[8:9], v[26:27] op_sel_hi:[1,0,1]
    v_pk_fma_f32 v[30:31], v[28:29], v[10:11], v[30:31] op_sel_hi:[1,0,1]
    v_pk_fma_f32 v[14:15], v[12:13], v[2:3], v[14:15] op_sel:[1,1,0] op_sel_hi:[0,1,1] neg_lo:[0,1,0]
    v_pk_fma_f32 v[18:19], v[16:17], v[4:5], v[18:19] op_sel:[1,1,0] op_sel_hi:[0,1,1] neg_lo:[0,1,0]
    v_pk_fma_f32 v[22:23], v[20:21], v[6:7], v[22:23] op_sel:[1,1,0] op_sel_hi:[0,1,1] neg_lo:[0,1,0]
    v_pk_fma_f32 v[26:27], v[24:25], v[8:9], v[26:27] op_sel:[1,1,0] op_sel_hi:[0,1,1] neg_lo:[0,1,0]
    v_pk_fma_f32 v[30:31], v[28:29], v[10:11], v[30:31] op_sel:[1,1,0] op_sel_hi:[0,1,1] neg_lo:[0,1,0]
    v_mov_b32 v12, v166
    v_mov_b32 v13, v246
    v_mov_b32_e64 v16, v182
    v_accvgpr_read_b32 v17, a6
    v_mov_b32_e64 v20, v198
    v_accvgpr_read_b32 v21, a22
    v_mov_b32_e64 v24, v214
    v_accvgpr_read_b32 v25, a38
    v_mov_b32_e64 v28, v230
    v_accvgpr_read_b32 v29, a54
    v_pk_fma_f32 v[12:13], v[14:15], v[2:3], v[12:13] op_sel_hi:[1,0,1]
    v_pk_fma_f32 v[16:17], v[18:19], v[4:5], v[16:17] op_sel_hi:[1,0,1]
    v_pk_fma_f32 v[20:21], v[22:23], v[6:7], v[20:21] op_sel_hi:[1,0,1]
    v_pk_fma_f32 v[24:25], v[26:27], v[8:9], v[24:25] op_sel_hi:[1,0,1]
    v_pk_fma_f32 v[28:29], v[30:31], v[10:11], v[28:29] op_sel_hi:[1,0,1]
    v_pk_fma_f32 v[12:13], v[14:15], v[2:3], v[12:13] op_sel:[1,1,0] op_sel_hi:[0,1,1] neg_lo:[0,1,0]
    v_pk_fma_f32 v[16:17], v[18:19], v[4:5], v[16:17] op_sel:[1,1,0] op_sel_hi:[0,1,1] neg_lo:[0,1,0]
    v_pk_fma_f32 v[20:21], v[22:23], v[6:7], v[20:21] op_sel:[1,1,0] op_sel_hi:[0,1,1] neg_lo:[0,1,0]
    v_pk_fma_f32 v[24:25], v[26:27], v[8:9], v[24:25] op_sel:[1,1,0] op_sel_hi:[0,1,1] neg_lo:[0,1,0]
    v_pk_fma_f32 v[28:29], v[30:31], v[10:11], v[28:29] op_sel:[1,1,0] op_sel_hi:[0,1,1] neg_lo:[0,1,0]
    v_mov_b32 v14, v167
    v_mov_b32 v15, v247
    v_mov_b32_e64 v18, v183
    v_accvgpr_read_b32 v19, a7
    v_mov_b32_e64 v22, v199
    v_accvgpr_read_b32 v23, a23
    v_mov_b32_e64 v26, v215
    v_accvgpr_read_b32 v27, a39
    v_mov_b32_e64 v30, v231
    v_accvgpr_read_b32 v31, a55
    v_pk_fma_f32 v[14:15], v[12:13], v[2:3], v[14:15] op_sel_hi:[1,0,1]
    v_pk_fma_f32 v[18:19], v[16:17], v[4:5], v[18:19] op_sel_hi:[1,0,1]
    v_pk_fma_f32 v[22:23], v[20:21], v[6:7], v[22:23] op_sel_hi:[1,0,1]
    v_pk_fma_f32 v[26:27], v[24:25], v[8:9], v[26:27] op_sel_hi:[1,0,1]
    v_pk_fma_f32 v[30:31], v[28:29], v[10:11], v[30:31] op_sel_hi:[1,0,1]
    v_pk_fma_f32 v[14:15], v[12:13], v[2:3], v[14:15] op_sel:[1,1,0] op_sel_hi:[0,1,1] neg_lo:[0,1,0]
    v_pk_fma_f32 v[18:19], v[16:17], v[4:5], v[18:19] op_sel:[1,1,0] op_sel_hi:[0,1,1] neg_lo:[0,1,0]
    v_pk_fma_f32 v[22:23], v[20:21], v[6:7], v[22:23] op_sel:[1,1,0] op_sel_hi:[0,1,1] neg_lo:[0,1,0]
    v_pk_fma_f32 v[26:27], v[24:25], v[8:9], v[26:27] op_sel:[1,1,0] op_sel_hi:[0,1,1] neg_lo:[0,1,0]
    v_pk_fma_f32 v[30:31], v[28:29], v[10:11], v[30:31] op_sel:[1,1,0] op_sel_hi:[0,1,1] neg_lo:[0,1,0]
    v_mov_b32 v12, v168
    v_mov_b32 v13, v248
    v_mov_b32_e64 v16, v184
    v_accvgpr_read_b32 v17, a8
    v_mov_b32_e64 v20, v200
    v_accvgpr_read_b32 v21, a24
    v_mov_b32_e64 v24, v216
    v_accvgpr_read_b32 v25, a40
    v_mov_b32_e64 v28, v232
    v_accvgpr_read_b32 v29, a56
    v_pk_fma_f32 v[12:13], v[14:15], v[2:3], v[12:13] op_sel_hi:[1,0,1]
    v_pk_fma_f32 v[16:17], v[18:19], v[4:5], v[16:17] op_sel_hi:[1,0,1]
    v_pk_fma_f32 v[20:21], v[22:23], v[6:7], v[20:21] op_sel_hi:[1,0,1]
    v_pk_fma_f32 v[24:25], v[26:27], v[8:9], v[24:25] op_sel_hi:[1,0,1]
    v_pk_fma_f32 v[28:29], v[30:31], v[10:11], v[28:29] op_sel_hi:[1,0,1]
    v_pk_fma_f32 v[12:13], v[14:15], v[2:3], v[12:13] op_sel:[1,1,0] op_sel_hi:[0,1,1] neg_lo:[0,1,0]
    v_pk_fma_f32 v[16:17], v[18:19], v[4:5], v[16:17] op_sel:[1,1,0] op_sel_hi:[0,1,1] neg_lo:[0,1,0]
    v_pk_fma_f32 v[20:21], v[22:23], v[6:7], v[20:21] op_sel:[1,1,0] op_sel_hi:[0,1,1] neg_lo:[0,1,0]
    v_pk_fma_f32 v[24:25], v[26:27], v[8:9], v[24:25] op_sel:[1,1,0] op_sel_hi:[0,1,1] neg_lo:[0,1,0]
    v_pk_fma_f32 v[28:29], v[30:31], v[10:11], v[28:29] op_sel:[1,1,0] op_sel_hi:[0,1,1] neg_lo:[0,1,0]
    v_mov_b32 v14, v169
    v_mov_b32 v15, v249
    v_mov_b32_e64 v18, v185
    v_accvgpr_read_b32 v19, a9
    v_mov_b32_e64 v22, v201
    v_accvgpr_read_b32 v23, a25
    v_mov_b32_e64 v26, v217
    v_accvgpr_read_b32 v27, a41
    v_mov_b32_e64 v30, v233
    v_accvgpr_read_b32 v31, a57
    v_pk_fma_f32 v[14:15], v[12:13], v[2:3], v[14:15] op_sel_hi:[1,0,1]
    v_pk_fma_f32 v[18:19], v[16:17], v[4:5], v[18:19] op_sel_hi:[1,0,1]
    v_pk_fma_f32 v[22:23], v[20:21], v[6:7], v[22:23] op_sel_hi:[1,0,1]
    v_pk_fma_f32 v[26:27], v[24:25], v[8:9], v[26:27] op_sel_hi:[1,0,1]
    v_pk_fma_f32 v[30:31], v[28:29], v[10:11], v[30:31] op_sel_hi:[1,0,1]
    v_pk_fma_f32 v[14:15], v[12:13], v[2:3], v[14:15] op_sel:[1,1,0] op_sel_hi:[0,1,1] neg_lo:[0,1,0]
    v_pk_fma_f32 v[18:19], v[16:17], v[4:5], v[18:19] op_sel:[1,1,0] op_sel_hi:[0,1,1] neg_lo:[0,1,0]
    v_pk_fma_f32 v[22:23], v[20:21], v[6:7], v[22:23] op_sel:[1,1,0] op_sel_hi:[0,1,1] neg_lo:[0,1,0]
    v_pk_fma_f32 v[26:27], v[24:25], v[8:9], v[26:27] op_sel:[1,1,0] op_sel_hi:[0,1,1] neg_lo:[0,1,0]
    v_pk_fma_f32 v[30:31], v[28:29], v[10:11], v[30:31] op_sel:[1,1,0] op_sel_hi:[0,1,1] neg_lo:[0,1,0]
    v_mov_b32 v12, v170
    v_mov_b32 v13, v250
    v_mov_b32_e64 v16, v186
    v_accvgpr_read_b32 v17, a10
    v_mov_b32_e64 v20, v202
    v_accvgpr_read_b32 v21, a26
    v_mov_b32_e64 v24, v218
    v_accvgpr_read_b32 v25, a42
    v_mov_b32_e64 v28, v234
    v_accvgpr_read_b32 v29, a58
    v_pk_fma_f32 v[12:13], v[14:15], v[2:3], v[12:13] op_sel_hi:[1,0,1]
    v_pk_fma_f32 v[16:17], v[18:19], v[4:5], v[16:17] op_sel_hi:[1,0,1]
    v_pk_fma_f32 v[20:21], v[22:23], v[6:7], v[20:21] op_sel_hi:[1,0,1]
    v_pk_fma_f32 v[24:25], v[26:27], v[8:9], v[24:25] op_sel_hi:[1,0,1]
    v_pk_fma_f32 v[28:29], v[30:31], v[10:11], v[28:29] op_sel_hi:[1,0,1]
    v_pk_fma_f32 v[12:13], v[14:15], v[2:3], v[12:13] op_sel:[1,1,0] op_sel_hi:[0,1,1] neg_lo:[0,1,0]
    v_pk_fma_f32 v[16:17], v[18:19], v[4:5], v[16:17] op_sel:[1,1,0] op_sel_hi:[0,1,1] neg_lo:[0,1,0]
    v_pk_fma_f32 v[20:21], v[22:23], v[6:7], v[20:21] op_sel:[1,1,0] op_sel_hi:[0,1,1] neg_lo:[0,1,0]
    v_pk_fma_f32 v[24:25], v[26:27], v[8:9], v[24:25] op_sel:[1,1,0] op_sel_hi:[0,1,1] neg_lo:[0,1,0]
    v_pk_fma_f32 v[28:29], v[30:31], v[10:11], v[28:29] op_sel:[1,1,0] op_sel_hi:[0,1,1] neg_lo:[0,1,0]
    v_mov_b32 v14, v171
    v_mov_b32 v15, v251
    v_mov_b32_e64 v18, v187
    v_accvgpr_read_b32 v19, a11
    v_mov_b32_e64 v22, v203
    v_accvgpr_read_b32 v23, a27
    v_mov_b32_e64 v26, v219
    v_accvgpr_read_b32 v27, a43
    v_mov_b32_e64 v30, v235
    v_accvgpr_read_b32 v31, a59
    v_pk_fma_f32 v[14:15], v[12:13], v[2:3], v[14:15] op_sel_hi:[1,0,1]
    v_pk_fma_f32 v[18:19], v[16:17], v[4:5], v[18:19] op_sel_hi:[1,0,1]
    v_pk_fma_f32 v[22:23], v[20:21], v[6:7], v[22:23] op_sel_hi:[1,0,1]
    v_pk_fma_f32 v[26:27], v[24:25], v[8:9], v[26:27] op_sel_hi:[1,0,1]
    v_pk_fma_f32 v[30:31], v[28:29], v[10:11], v[30:31] op_sel_hi:[1,0,1]
    v_pk_fma_f32 v[14:15], v[12:13], v[2:3], v[14:15] op_sel:[1,1,0] op_sel_hi:[0,1,1] neg_lo:[0,1,0]
    v_pk_fma_f32 v[18:19], v[16:17], v[4:5], v[18:19] op_sel:[1,1,0] op_sel_hi:[0,1,1] neg_lo:[0,1,0]
    v_pk_fma_f32 v[22:23], v[20:21], v[6:7], v[22:23] op_sel:[1,1,0] op_sel_hi:[0,1,1] neg_lo:[0,1,0]
    v_pk_fma_f32 v[26:27], v[24:25], v[8:9], v[26:27] op_sel:[1,1,0] op_sel_hi:[0,1,1] neg_lo:[0,1,0]
    v_pk_fma_f32 v[30:31], v[28:29], v[10:11], v[30:31] op_sel:[1,1,0] op_sel_hi:[0,1,1] neg_lo:[0,1,0]
    v_mov_b32 v12, v172
    v_mov_b32 v13, v252
    v_mov_b32_e64 v16, v188
    v_accvgpr_read_b32 v17, a12
    v_mov_b32_e64 v20, v204
    v_accvgpr_read_b32 v21, a28
    v_mov_b32_e64 v24, v220
    v_accvgpr_read_b32 v25, a44
    v_mov_b32_e64 v28, v236
    v_accvgpr_read_b32 v29, a60
    v_pk_fma_f32 v[12:13], v[14:15], v[2:3], v[12:13] op_sel_hi:[1,0,1]
    v_pk_fma_f32 v[16:17], v[18:19], v[4:5], v[16:17] op_sel_hi:[1,0,1]
    v_pk_fma_f32 v[20:21], v[22:23], v[6:7], v[20:21] op_sel_hi:[1,0,1]
    v_pk_fma_f32 v[24:25], v[26:27], v[8:9], v[24:25] op_sel_hi:[1,0,1]
    v_pk_fma_f32 v[28:29], v[30:31], v[10:11], v[28:29] op_sel_hi:[1,0,1]
    v_pk_fma_f32 v[12:13], v[14:15], v[2:3], v[12:13] op_sel:[1,1,0] op_sel_hi:[0,1,1] neg_lo:[0,1,0]
    v_pk_fma_f32 v[16:17], v[18:19], v[4:5], v[16:17] op_sel:[1,1,0] op_sel_hi:[0,1,1] neg_lo:[0,1,0]
    v_pk_fma_f32 v[20:21], v[22:23], v[6:7], v[20:21] op_sel:[1,1,0] op_sel_hi:[0,1,1] neg_lo:[0,1,0]
    v_pk_fma_f32 v[24:25], v[26:27], v[8:9], v[24:25] op_sel:[1,1,0] op_sel_hi:[0,1,1] neg_lo:[0,1,0]
    v_pk_fma_f32 v[28:29], v[30:31], v[10:11], v[28:29] op_sel:[1,1,0] op_sel_hi:[0,1,1] neg_lo:[0,1,0]
    v_mov_b32 v14, v173
    v_mov_b32 v15, v253
    v_mov_b32_e64 v18, v189
    v_accvgpr_read_b32 v19, a13
    v_mov_b32_e64 v22, v205
    v_accvgpr_read_b32 v23, a29
    v_mov_b32_e64 v26, v221
    v_accvgpr_read_b32 v27, a45
    v_mov_b32_e64 v30, v237
    v_accvgpr_read_b32 v31, a61
    v_pk_fma_f32 v[14:15], v[12:13], v[2:3], v[14:15] op_sel_hi:[1,0,1]
    v_pk_fma_f32 v[18:19], v[16:17], v[4:5], v[18:19] op_sel_hi:[1,0,1]
    v_pk_fma_f32 v[22:23], v[20:21], v[6:7], v[22:23] op_sel_hi:[1,0,1]
    v_pk_fma_f32 v[26:27], v[24:25], v[8:9], v[26:27] op_sel_hi:[1,0,1]
    v_pk_fma_f32 v[30:31], v[28:29], v[10:11], v[30:31] op_sel_hi:[1,0,1]
    v_pk_fma_f32 v[14:15], v[12:13], v[2:3], v[14:15] op_sel:[1,1,0] op_sel_hi:[0,1,1] neg_lo:[0,1,0]
    v_pk_fma_f32 v[18:19], v[16:17], v[4:5], v[18:19] op_sel:[1,1,0] op_sel_hi:[0,1,1] neg_lo:[0,1,0]
    v_pk_fma_f32 v[22:23], v[20:21], v[6:7], v[22:23] op_sel:[1,1,0] op_sel_hi:[0,1,1] neg_lo:[0,1,0]
    v_pk_fma_f32 v[26:27], v[24:25], v[8:9], v[26:27] op_sel:[1,1,0] op_sel_hi:[0,1,1] neg_lo:[0,1,0]
    v_pk_fma_f32 v[30:31], v[28:29], v[10:11], v[30:31] op_sel:[1,1,0] op_sel_hi:[0,1,1] neg_lo:[0,1,0]
    v_mov_b32 v12, v174
    v_mov_b32 v13, v254
    v_mov_b32_e64 v16, v190
    v_accvgpr_read_b32 v17, a14
    v_mov_b32_e64 v20, v206
    v_accvgpr_read_b32 v21, a30
    v_mov_b32_e64 v24, v222
    v_accvgpr_read_b32 v25, a46
    v_mov_b32_e64 v28, v238
    v_accvgpr_read_b32 v29, a62
    v_pk_fma_f32 v[12:13], v[14:15], v[2:3], v[12:13] op_sel_hi:[1,0,1]
    v_pk_fma_f32 v[16:17], v[18:19], v[4:5], v[16:17] op_sel_hi:[1,0,1]
    v_pk_fma_f32 v[20:21], v[22:23], v[6:7], v[20:21] op_sel_hi:[1,0,1]
    v_pk_fma_f32 v[24:25], v[26:27], v[8:9], v[24:25] op_sel_hi:[1,0,1]
    v_pk_fma_f32 v[28:29], v[30:31], v[10:11], v[28:29] op_sel_hi:[1,0,1]
    v_pk_fma_f32 v[12:13], v[14:15], v[2:3], v[12:13] op_sel:[1,1,0] op_sel_hi:[0,1,1] neg_lo:[0,1,0]
    v_pk_fma_f32 v[16:17], v[18:19], v[4:5], v[16:17] op_sel:[1,1,0] op_sel_hi:[0,1,1] neg_lo:[0,1,0]
    v_pk_fma_f32 v[20:21], v[22:23], v[6:7], v[20:21] op_sel:[1,1,0] op_sel_hi:[0,1,1] neg_lo:[0,1,0]
    v_pk_fma_f32 v[24:25], v[26:27], v[8:9], v[24:25] op_sel:[1,1,0] op_sel_hi:[0,1,1] neg_lo:[0,1,0]
    v_pk_fma_f32 v[28:29], v[30:31], v[10:11], v[28:29] op_sel:[1,1,0] op_sel_hi:[0,1,1] neg_lo:[0,1,0]
    v_mov_b32 v14, v175
    v_mov_b32 v15, v255
    v_mov_b32_e64 v18, v191
    v_accvgpr_read_b32 v19, a15
    v_mov_b32_e64 v22, v207
    v_accvgpr_read_b32 v23, a31
    v_mov_b32_e64 v26, v223
    v_accvgpr_read_b32 v27, a47
    v_mov_b32_e64 v30, v239
    v_accvgpr_read_b32 v31, a63
    v_pk_fma_f32 v[14:15], v[12:13], v[2:3], v[14:15] op_sel_hi:[1,0,1]
    v_pk_fma_f32 v[18:19], v[16:17], v[4:5], v[18:19] op_sel_hi:[1,0,1]
    v_pk_fma_f32 v[22:23], v[20:21], v[6:7], v[22:23] op_sel_hi:[1,0,1]
    v_pk_fma_f32 v[26:27], v[24:25], v[8:9], v[26:27] op_sel_hi:[1,0,1]
    v_pk_fma_f32 v[30:31], v[28:29], v[10:11], v[30:31] op_sel_hi:[1,0,1]
    v_pk_fma_f32 v[14:15], v[12:13], v[2:3], v[14:15] op_sel:[1,1,0] op_sel_hi:[0,1,1] neg_lo:[0,1,0]
    v_pk_fma_f32 v[18:19], v[16:17], v[4:5], v[18:19] op_sel:[1,1,0] op_sel_hi:[0,1,1] neg_lo:[0,1,0]
    v_pk_fma_f32 v[22:23], v[20:21], v[6:7], v[22:23] op_sel:[1,1,0] op_sel_hi:[0,1,1] neg_lo:[0,1,0]
    v_pk_fma_f32 v[26:27], v[24:25], v[8:9], v[26:27] op_sel:[1,1,0] op_sel_hi:[0,1,1] neg_lo:[0,1,0]
    v_pk_fma_f32 v[30:31], v[28:29], v[10:11], v[30:31] op_sel:[1,1,0] op_sel_hi:[0,1,1] neg_lo:[0,1,0]
    v_lshrrev_b32_e64 v12, 4, v0
    v_mul_u32_u24 v12, 640, v12
    v_and_b32_e64 v1, 15, v0
    v_lshl_add_u32 v1, v1, 3, v12
    ds_write_b64 v1, v[14:15] offset:45056
    ds_write_b64 v1, v[18:19] offset:45184
    ds_write_b64 v1, v[22:23] offset:45312
    ds_write_b64 v1, v[26:27] offset:45440
    ds_write_b64 v1, v[30:31] offset:45568
    s_waitcnt lgkmcnt(0)
    s_barrier
    v_and_b32 v12, 127, v0
    v_min_u32 v12, 79, v12
    v_lshlrev_b32 v12, 3, v12
    s_lshl_b32 s39, s24, 14
    s_lshl_b32 s3, s38, 4
    s_add_u32 s39, s39, s3
    s_add_u32 s39, s39, 35651584
    s_cmp_ge_u32 s26, 2
    s_cbranch_scc1 L_k2_nox1B
    ds_read_b64 a[64:65], v12 offset:45056
    ds_read_b64 a[66:67], v12 offset:45696
    ds_read_b64 a[68:69], v12 offset:46336
    ds_read_b64 a[70:71], v12 offset:46976
    ds_read_b64 a[72:73], v12 offset:47616
    ds_read_b64 a[74:75], v12 offset:48256
    ds_read_b64 a[76:77], v12 offset:48896
    ds_read_b64 a[78:79], v12 offset:49536
    ds_read_b64 a[80:81], v12 offset:50176
    ds_read_b64 a[82:83], v12 offset:50816
    ds_read_b64 a[84:85], v12 offset:51456
    ds_read_b64 a[86:87], v12 offset:52096
    ds_read_b64 a[88:89], v12 offset:52736
    ds_read_b64 a[90:91], v12 offset:53376
    ds_read_b64 a[92:93], v12 offset:54016
    ds_read_b64 a[94:95], v12 offset:54656
    v_accvgpr_read_b32 v14, a230
    v_accvgpr_read_b32 v15, a231
    v_mov_b32 v16, 0
    v_mov_b32 v17, 0
    ds_write_b64 v12, v[16:17] offset:55296
    s_waitcnt lgkmcnt(0)
    v_accvgpr_read_b32 v18, a64
    v_accvgpr_read_b32 v19, a65
    v_pk_fma_f32 v[18:19], v[16:17], v[14:15], v[18:19] op_sel_hi:[1,0,1]
    v_pk_fma_f32 v[18:19], v[16:17], v[14:15], v[18:19] op_sel:[1,1,0] op_sel_hi:[0,1,1] neg_lo:[0,1,0]
    ds_write_b64 v12, v[18:19] offset:55936
    v_accvgpr_read_b32 v20, a66
    v_accvgpr_read_b32 v21, a67
    v_pk_fma_f32 v[20:21], v[18:19], v[14:15], v[20:21] op_sel_hi:[1,0,1]
    v_pk_fma_f32 v[20:21], v[18:19], v[14:15], v[20:21] op_sel:[1,1,0] op_sel_hi:[0,1,1] neg_lo:[0,1,0]
    ds_write_b64 v12, v[20:21] offset:56576
    v_accvgpr_read_b32 v22, a68
    v_accvgpr_read_b32 v23, a69
    v_pk_fma_f32 v[22:23], v[20:21], v[14:15], v[22:23] op_sel_hi:[1,0,1]
    v_pk_fma_f32 v[22:23], v[20:21], v[14:15], v[22:23] op_sel:[1,1,0] op_sel_hi:[0,1,1] neg_lo:[0,1,0]
    ds_write_b64 v12, v[22:23] offset:57216
    v_accvgpr_read_b32 v16, a70
    v_accvgpr_read_b32 v17, a71
    v_pk_fma_f32 v[16:17], v[22:23], v[14:15], v[16:17] op_sel_hi:[1,0,1]
    v_pk_fma_f32 v[16:17], v[22:23], v[14:15], v[16:17] op_sel:[1,1,0] op_sel_hi:[0,1,1] neg_lo:[0,1,0]
    ds_write_b64 v12, v[16:17] offset:57856
    v_accvgpr_read_b32 v18, a72
    v_accvgpr_read_b32 v19, a73
    v_pk_fma_f32 v[18:19], v[16:17], v[14:15], v[18:19] op_sel_hi:[1,0,1]
    v_pk_fma_f32 v[18:19], v[16:17], v[14:15], v[18:19] op_sel:[1,1,0] op_sel_hi:[0,1,1] neg_lo:[0,1,0]
    ds_write_b64 v12, v[18:19] offset:58496
    v_accvgpr_read_b32 v20, a74
    v_accvgpr_read_b32 v21, a75
    v_pk_fma_f32 v[20:21], v[18:19], v[14:15], v[20:21] op_sel_hi:[1,0,1]
    v_pk_fma_f32 v[20:21], v[18:19], v[14:15], v[20:21] op_sel:[1,1,0] op_sel_hi:[0,1,1] neg_lo:[0,1,0]
    ds_write_b64 v12, v[20:21] offset:59136
    v_accvgpr_read_b32 v22, a76
    v_accvgpr_read_b32 v23, a77
    v_pk_fma_f32 v[22:23], v[20:21], v[14:15], v[22:23] op_sel_hi:[1,0,1]
    v_pk_fma_f32 v[22:23], v[20:21], v[14:15], v[22:23] op_sel:[1,1,0] op_sel_hi:[0,1,1] neg_lo:[0,1,0]
    ds_write_b64 v12, v[22:23] offset:59776
    v_accvgpr_read_b32 v16, a78
    v_accvgpr_read_b32 v17, a79
    v_pk_fma_f32 v[16:17], v[22:23], v[14:15], v[16:17] op_sel_hi:[1,0,1]
    v_pk_fma_f32 v[16:17], v[22:23], v[14:15], v[16:17] op_sel:[1,1,0] op_sel_hi:[0,1,1] neg_lo:[0,1,0]
    ds_write_b64 v12, v[16:17] offset:60416
    v_accvgpr_read_b32 v18, a80
    v_accvgpr_read_b32 v19, a81
    v_pk_fma_f32 v[18:19], v[16:17], v[14:15], v[18:19] op_sel_hi:[1,0,1]
    v_pk_fma_f32 v[18:19], v[16:17], v[14:15], v[18:19] op_sel:[1,1,0] op_sel_hi:[0,1,1] neg_lo:[0,1,0]
    ds_write_b64 v12, v[18:19] offset:61056
    v_accvgpr_read_b32 v20, a82
    v_accvgpr_read_b32 v21, a83
    v_pk_fma_f32 v[20:21], v[18:19], v[14:15], v[20:21] op_sel_hi:[1,0,1]
    v_pk_fma_f32 v[20:21], v[18:19], v[14:15], v[20:21] op_sel:[1,1,0] op_sel_hi:[0,1,1] neg_lo:[0,1,0]
    ds_write_b64 v12, v[20:21] offset:61696
    v_accvgpr_read_b32 v22, a84
    v_accvgpr_read_b32 v23, a85
    v_pk_fma_f32 v[22:23], v[20:21], v[14:15], v[22:23] op_sel_hi:[1,0,1]
    v_pk_fma_f32 v[22:23], v[20:21], v[14:15], v[22:23] op_sel:[1,1,0] op_sel_hi:[0,1,1] neg_lo:[0,1,0]
    ds_write_b64 v12, v[22:23] offset:62336
    v_accvgpr_read_b32 v16, a86
    v_accvgpr_read_b32 v17, a87
    v_pk_fma_f32 v[16:17], v[22:23], v[14:15], v[16:17] op_sel_hi:[1,0,1]
    v_pk_fma_f32 v[16:17], v[22:23], v[14:15], v[16:17] op_sel:[1,1,0] op_sel_hi:[0,1,1] neg_lo:[0,1,0]
    ds_write_b64 v12, v[16:17] offset:62976
    v_accvgpr_read_b32 v18, a88
    v_accvgpr_read_b32 v19, a89
    v_pk_fma_f32 v[18:19], v[16:17], v[14:15], v[18:19] op_sel_hi:[1,0,1]
    v_pk_fma_f32 v[18:19], v[16:17], v[14:15], v[18:19] op_sel:[1,1,0] op_sel_hi:[0,1,1] neg_lo:[0,1,0]
    ds_write_b64 v12, v[18:19] offset:63616
    v_accvgpr_read_b32 v20, a90
    v_accvgpr_read_b32 v21, a91
    v_pk_fma_f32 v[20:21], v[18:19], v[14:15], v[20:21] op_sel_hi:[1,0,1]
    v_pk_fma_f32 v[20:21], v[18:19], v[14:15], v[20:21] op_sel:[1,1,0] op_sel_hi:[0,1,1] neg_lo:[0,1,0]
    ds_write_b64 v12, v[20:21] offset:64256
    v_accvgpr_read_b32 v22, a92
    v_accvgpr_read_b32 v23, a93
    v_pk_fma_f32 v[22:23], v[20:21], v[14:15], v[22:23] op_sel_hi:[1,0,1]
    v_pk_fma_f32 v[22:23], v[20:21], v[14:15], v[22:23] op_sel:[1,1,0] op_sel_hi:[0,1,1] neg_lo:[0,1,0]
    ds_write_b64 v12, v[22:23] offset:64896
    v_accvgpr_read_b32 v16, a94
    v_accvgpr_read_b32 v17, a95
    v_pk_fma_f32 v[16:17], v[22:23], v[14:15], v[16:17] op_sel_hi:[1,0,1]
    v_pk_fma_f32 v[16:17], v[22:23], v[14:15], v[16:17] op_sel:[1,1,0] op_sel_hi:[0,1,1] neg_lo:[0,1,0]
    s_add_u32 s4, s48, s49
    v_mov_b32 v24, v16
    v_mov_b32 v25, s48
    v_mov_b32 v26, v17
    v_mov_b32 v27, s4
    v_lshlrev_b32_e64 v13, 1, v12
    s_add_u32 s3, s39, 114688
    buffer_store_dwordx4 v[24:27], v13, s[20:23], s3 offen sc1
L_k2_nox1B:
    s_mov_b32 s4, 0xc0135761
    s_mov_b32 s6, 0xbdd2d3e8
    s_mov_b32 s7, s6
    v_bfe_u32 v16, v0, 4, 1
    v_bfe_u32 v17, v0, 5, 1
    v_and_b32 v18, 15, v0
    v_lshlrev_b32_e64 v30, 10, v16
    v_lshl_add_u32 v30, v17, 8, v30
    v_lshl_add_u32 v30, v18, 4, v30
    v_mov_b32 v16, s4
    v_lshlrev_b32 v13, 1, v12
    v_mov_b32_e64 v31, v1
    s_mul_i32 s40, s36, 458752
    s_add_u32 s40, s40, 4194304
    s_lshl_b32 s41, s37, 7
    s_add_u32 s40, s40, s41
    s_add_u32 s41, s40, 4096
    s_lshl_b32 s42, s45, 6
    s_add_u32 s42, s42, s40
    s_add_u32 s43, s42, 4096
    v_pk_mul_f32 v[18:19], v[32:33], v[32:33]
    v_pk_mul_f32 v[20:21], v[34:35], v[34:35]
    v_pk_mul_f32 v[22:23], v[36:37], v[36:37]
    v_pk_mul_f32 v[28:29], v[38:39], v[38:39]
    v_pk_mul_f32 v[48:49], v[48:49], v[32:33]
    v_pk_mul_f32 v[50:51], v[50:51], v[34:35]
    v_pk_mul_f32 v[52:53], v[52:53], v[36:37]
    v_pk_mul_f32 v[54:55], v[54:55], v[38:39]
    v_pk_fma_f32 v[18:19], v[18:19], s[6:7], v[16:17] op_sel_hi:[1,1,0]
    v_pk_fma_f32 v[20:21], v[20:21], s[6:7], v[16:17] op_sel_hi:[1,1,0]
    v_pk_fma_f32 v[22:23], v[22:23], s[6:7], v[16:17] op_sel_hi:[1,1,0]
    v_pk_fma_f32 v[28:29], v[28:29], s[6:7], v[16:17] op_sel_hi:[1,1,0]
    v_pk_mul_f32 v[32:33], v[32:33], v[18:19]
    v_pk_mul_f32 v[34:35], v[34:35], v[20:21]
    v_pk_mul_f32 v[36:37], v[36:37], v[22:23]
    v_pk_mul_f32 v[38:39], v[38:39], v[28:29]
    v_exp_f32 v32, v32
    v_exp_f32 v33, v33
    v_exp_f32 v34, v34
    v_exp_f32 v35, v35
    v_exp_f32 v36, v36
    v_exp_f32 v37, v37
    v_exp_f32 v38, v38
    v_exp_f32 v39, v39
    v_pk_add_f32 v[32:33], v[32:33], 1.0 op_sel_hi:[1,0]
    v_pk_add_f32 v[34:35], v[34:35], 1.0 op_sel_hi:[1,0]
    v_pk_add_f32 v[36:37], v[36:37], 1.0 op_sel_hi:[1,0]
    v_pk_add_f32 v[38:39], v[38:39], 1.0 op_sel_hi:[1,0]
    v_rcp_f32 v32, v32
    v_rcp_f32 v33, v33
    v_rcp_f32 v34, v34
    v_rcp_f32 v35, v35
    v_rcp_f32 v36, v36
    v_rcp_f32 v37, v37
    v_rcp_f32 v38, v38
    v_rcp_f32 v39, v39
    v_pk_mul_f32 v[48:49], v[48:49], v[32:33]
    v_pk_mul_f32 v[50:51], v[50:51], v[34:35]
    v_pk_mul_f32 v[52:53], v[52:53], v[36:37]
    v_pk_mul_f32 v[54:55], v[54:55], v[38:39]
    v_cvt_pk_bf16_f32 v32, v48, v49
    v_cvt_pk_bf16_f32 v34, v52, v53
    v_cvt_pk_bf16_f32 v33, v50, v51
    v_cvt_pk_bf16_f32 v35, v54, v55
    v_permlane16_swap_b32 v32, v34
    s_nop 0
    v_permlane16_swap_b32 v33, v35
    buffer_store_dwordx4 v[32:35], v30, s[20:23], s40 offen offset:0 sc1
    v_pk_mul_f32 v[18:19], v[40:41], v[40:41]
    v_pk_mul_f32 v[20:21], v[42:43], v[42:43]
    v_pk_mul_f32 v[22:23], v[44:45], v[44:45]
    v_pk_mul_f32 v[28:29], v[46:47], v[46:47]
    v_pk_mul_f32 v[56:57], v[56:57], v[40:41]
    v_pk_mul_f32 v[58:59], v[58:59], v[42:43]
    v_pk_mul_f32 v[60:61], v[60:61], v[44:45]
    v_pk_mul_f32 v[62:63], v[62:63], v[46:47]
    v_pk_fma_f32 v[18:19], v[18:19], s[6:7], v[16:17] op_sel_hi:[1,1,0]
    v_pk_fma_f32 v[20:21], v[20:21], s[6:7], v[16:17] op_sel_hi:[1,1,0]
    v_pk_fma_f32 v[22:23], v[22:23], s[6:7], v[16:17] op_sel_hi:[1,1,0]
    v_pk_fma_f32 v[28:29], v[28:29], s[6:7], v[16:17] op_sel_hi:[1,1,0]
    v_pk_mul_f32 v[40:41], v[40:41], v[18:19]
    v_pk_mul_f32 v[42:43], v[42:43], v[20:21]
    v_pk_mul_f32 v[44:45], v[44:45], v[22:23]
    v_pk_mul_f32 v[46:47], v[46:47], v[28:29]
    v_exp_f32 v40, v40
    v_exp_f32 v41, v41
    v_exp_f32 v42, v42
    v_exp_f32 v43, v43
    v_exp_f32 v44, v44
    v_exp_f32 v45, v45
    v_exp_f32 v46, v46
    v_exp_f32_e64 v47, v47
    v_pk_add_f32 v[40:41], v[40:41], 1.0 op_sel_hi:[1,0]
    v_pk_add_f32 v[42:43], v[42:43], 1.0 op_sel_hi:[1,0]
    v_pk_add_f32 v[44:45], v[44:45], 1.0 op_sel_hi:[1,0]
    v_pk_add_f32 v[46:47], v[46:47], 1.0 op_sel_hi:[1,0]
    v_rcp_f32 v40, v40
    v_rcp_f32 v41, v41
    v_rcp_f32 v42, v42
    v_rcp_f32 v43, v43
    v_rcp_f32 v44, v44
    v_rcp_f32 v45, v45
    v_rcp_f32 v46, v46
    v_rcp_f32 v47, v47
    v_pk_mul_f32 v[56:57], v[56:57], v[40:41]
    v_pk_mul_f32 v[58:59], v[58:59], v[42:43]
    v_pk_mul_f32 v[60:61], v[60:61], v[44:45]
    v_pk_mul_f32 v[62:63], v[62:63], v[46:47]
    v_cvt_pk_bf16_f32 v40, v56, v57
    v_cvt_pk_bf16_f32 v42, v60, v61
    v_cvt_pk_bf16_f32 v41, v58, v59
    v_cvt_pk_bf16_f32 v43, v62, v63
    v_permlane16_swap_b32 v40, v42
    s_nop 0
    v_permlane16_swap_b32 v41, v43
    buffer_store_dwordx4 v[40:43], v30, s[20:23], s40 offen offset:2048 sc1
    v_pk_mul_f32 v[18:19], v[64:65], v[64:65]
    v_pk_mul_f32 v[20:21], v[66:67], v[66:67]
    v_pk_mul_f32 v[22:23], v[68:69], v[68:69]
    v_pk_mul_f32 v[28:29], v[70:71], v[70:71]
    v_pk_mul_f32 v[80:81], v[80:81], v[64:65]
    v_pk_mul_f32 v[82:83], v[82:83], v[66:67]
    v_pk_mul_f32 v[84:85], v[84:85], v[68:69]
    v_pk_mul_f32 v[86:87], v[86:87], v[70:71]
    v_pk_fma_f32 v[18:19], v[18:19], s[6:7], v[16:17] op_sel_hi:[1,1,0]
    v_pk_fma_f32 v[20:21], v[20:21], s[6:7], v[16:17] op_sel_hi:[1,1,0]
    v_pk_fma_f32 v[22:23], v[22:23], s[6:7], v[16:17] op_sel_hi:[1,1,0]
    v_pk_fma_f32 v[28:29], v[28:29], s[6:7], v[16:17] op_sel_hi:[1,1,0]
    v_pk_mul_f32 v[64:65], v[64:65], v[18:19]
    v_pk_mul_f32 v[66:67], v[66:67], v[20:21]
    v_pk_mul_f32 v[68:69], v[68:69], v[22:23]
    v_pk_mul_f32 v[70:71], v[70:71], v[28:29]
    v_exp_f32 v64, v64
    v_exp_f32 v65, v65
    v_exp_f32 v66, v66
    v_exp_f32 v67, v67
    v_exp_f32 v68, v68
    v_exp_f32 v69, v69
    v_exp_f32 v70, v70
    v_exp_f32_e64 v71, v71
    v_pk_add_f32 v[64:65], v[64:65], 1.0 op_sel_hi:[1,0]
    v_pk_add_f32 v[66:67], v[66:67], 1.0 op_sel_hi:[1,0]
    v_pk_add_f32 v[68:69], v[68:69], 1.0 op_sel_hi:[1,0]
    v_pk_add_f32 v[70:71], v[70:71], 1.0 op_sel_hi:[1,0]
    v_rcp_f32 v64, v64
    v_rcp_f32 v65, v65
    v_rcp_f32 v66, v66
    v_rcp_f32 v67, v67
    v_rcp_f32 v68, v68
    v_rcp_f32 v69, v69
    v_rcp_f32 v70, v70
    v_rcp_f32 v71, v71
    v_pk_mul_f32 v[80:81], v[80:81], v[64:65]
    v_pk_mul_f32 v[82:83], v[82:83], v[66:67]
    v_pk_mul_f32 v[84:85], v[84:85], v[68:69]
    v_pk_mul_f32 v[86:87], v[86:87], v[70:71]
    v_cvt_pk_bf16_f32 v64, v80, v81
    v_cvt_pk_bf16_f32 v66, v84, v85
    v_cvt_pk_bf16_f32 v65, v82, v83
    v_cvt_pk_bf16_f32 v67, v86, v87
    v_permlane16_swap_b32 v64, v66
    s_nop 0
    v_permlane16_swap_b32 v65, v67
    buffer_store_dwordx4 v[64:67], v30, s[20:23], s40 offen offset:512 sc1
    v_pk_mul_f32 v[18:19], v[72:73], v[72:73]
    v_pk_mul_f32 v[20:21], v[74:75], v[74:75]
    v_pk_mul_f32 v[22:23], v[76:77], v[76:77]
    v_pk_mul_f32 v[28:29], v[78:79], v[78:79]
    v_pk_mul_f32 v[88:89], v[88:89], v[72:73]
    v_pk_mul_f32 v[90:91], v[90:91], v[74:75]
    v_pk_mul_f32 v[92:93], v[92:93], v[76:77]
    v_pk_mul_f32 v[94:95], v[94:95], v[78:79]
    v_pk_fma_f32 v[18:19], v[18:19], s[6:7], v[16:17] op_sel_hi:[1,1,0]
    v_pk_fma_f32 v[20:21], v[20:21], s[6:7], v[16:17] op_sel_hi:[1,1,0]
    v_pk_fma_f32 v[22:23], v[22:23], s[6:7], v[16:17] op_sel_hi:[1,1,0]
    v_pk_fma_f32 v[28:29], v[28:29], s[6:7], v[16:17] op_sel_hi:[1,1,0]
    v_pk_mul_f32 v[72:73], v[72:73], v[18:19]
    v_pk_mul_f32 v[74:75], v[74:75], v[20:21]
    v_pk_mul_f32 v[76:77], v[76:77], v[22:23]
    v_pk_mul_f32 v[78:79], v[78:79], v[28:29]
    v_exp_f32 v72, v72
    v_exp_f32 v73, v73
    v_exp_f32 v74, v74
    v_exp_f32 v75, v75
    v_exp_f32 v76, v76
    v_exp_f32 v77, v77
    v_exp_f32 v78, v78
    v_exp_f32_e64 v79, v79
    v_pk_add_f32 v[72:73], v[72:73], 1.0 op_sel_hi:[1,0]
    v_pk_add_f32 v[74:75], v[74:75], 1.0 op_sel_hi:[1,0]
    v_pk_add_f32 v[76:77], v[76:77], 1.0 op_sel_hi:[1,0]
    v_pk_add_f32 v[78:79], v[78:79], 1.0 op_sel_hi:[1,0]
    v_rcp_f32 v72, v72
    v_rcp_f32 v73, v73
    v_rcp_f32 v74, v74
    v_rcp_f32 v75, v75
    v_rcp_f32 v76, v76
    v_rcp_f32 v77, v77
    v_rcp_f32 v78, v78
    v_rcp_f32 v79, v79
    v_pk_mul_f32 v[88:89], v[88:89], v[72:73]
    v_pk_mul_f32 v[90:91], v[90:91], v[74:75]
    v_pk_mul_f32 v[92:93], v[92:93], v[76:77]
    v_pk_mul_f32 v[94:95], v[94:95], v[78:79]
    v_cvt_pk_bf16_f32 v72, v88, v89
    v_cvt_pk_bf16_f32 v74, v92, v93
    v_cvt_pk_bf16_f32 v73, v90, v91
    v_cvt_pk_bf16_f32 v75, v94, v95
    v_permlane16_swap_b32 v72, v74
    s_nop 0
    v_permlane16_swap_b32 v73, v75
    buffer_store_dwordx4 v[72:75], v30, s[20:23], s40 offen offset:2560 sc1
    s_lshr_b32 s3, s26, 1
    s_cmp_lg_u32 s3, 1
    s_cbranch_scc1 L_k2_noelB
    s_add_u32 s3, s39, 0
    s_cmp_ge_u32 s24, 7
    s_cselect_b32 s3, s3, 0x7f000000
    buffer_load_dwordx4 v[32:35], v13, s[20:23], s3 offen sc1
    s_add_u32 s3, s39, 16384
    s_cmp_ge_u32 s24, 6
    s_cselect_b32 s3, s3, 0x7f000000
    buffer_load_dwordx4 v[36:39], v13, s[20:23], s3 offen sc1
    s_add_u32 s3, s39, 32768
    s_cmp_ge_u32 s24, 5
    s_cselect_b32 s3, s3, 0x7f000000
    buffer_load_dwordx4 v[40:43], v13, s[20:23], s3 offen sc1
    s_add_u32 s3, s39, 49152
    s_cmp_ge_u32 s24, 4
    s_cselect_b32 s3, s3, 0x7f000000
    buffer_load_dwordx4 v[44:47], v13, s[20:23], s3 offen sc1
    s_add_u32 s3, s39, 65536
    s_cmp_ge_u32 s24, 3
    s_cselect_b32 s3, s3, 0x7f000000
    buffer_load_dwordx4 v[48:51], v13, s[20:23], s3 offen sc1
    s_add_u32 s3, s39, 81920
    s_cmp_ge_u32 s24, 2
    s_cselect_b32 s3, s3, 0x7f000000
    buffer_load_dwordx4 v[52:55], v13, s[20:23], s3 offen sc1
    s_add_u32 s3, s39, 98304
    s_cmp_ge_u32 s24, 1
    s_cselect_b32 s3, s3, 0x7f000000
    buffer_load_dwordx4 v[56:59], v13, s[20:23], s3 offen sc1
L_k2_noelB:
    v_pk_mul_f32 v[18:19], v[96:97], v[96:97]
    v_pk_mul_f32 v[20:21], v[98:99], v[98:99]
    v_pk_mul_f32 v[22:23], v[100:101], v[100:101]
    v_pk_mul_f32 v[28:29], v[102:103], v[102:103]
    v_pk_mul_f32 v[112:113], v[112:113], v[96:97]
    v_pk_mul_f32 v[114:115], v[114:115], v[98:99]
    v_pk_mul_f32 v[116:117], v[116:117], v[100:101]
    v_pk_mul_f32 v[118:119], v[118:119], v[102:103]
    v_pk_fma_f32 v[18:19], v[18:19], s[6:7], v[16:17] op_sel_hi:[1,1,0]
    v_pk_fma_f32 v[20:21], v[20:21], s[6:7], v[16:17] op_sel_hi:[1,1,0]
    v_pk_fma_f32 v[22:23], v[22:23], s[6:7], v[16:17] op_sel_hi:[1,1,0]
    v_pk_fma_f32 v[28:29], v[28:29], s[6:7], v[16:17] op_sel_hi:[1,1,0]
    v_pk_mul_f32 v[96:97], v[96:97], v[18:19]
    v_pk_mul_f32 v[98:99], v[98:99], v[20:21]
    v_pk_mul_f32 v[100:101], v[100:101], v[22:23]
    v_pk_mul_f32 v[102:103], v[102:103], v[28:29]
    v_exp_f32 v96, v96
    v_exp_f32 v97, v97
    v_exp_f32 v98, v98
    v_exp_f32 v99, v99
    v_exp_f32 v100, v100
    v_exp_f32 v101, v101
    v_exp_f32 v102, v102
    v_exp_f32 v103, v103
    v_pk_add_f32 v[96:97], v[96:97], 1.0 op_sel_hi:[1,0]
    v_pk_add_f32 v[98:99], v[98:99], 1.0 op_sel_hi:[1,0]
    v_pk_add_f32 v[100:101], v[100:101], 1.0 op_sel_hi:[1,0]
    v_pk_add_f32 v[102:103], v[102:103], 1.0 op_sel_hi:[1,0]
    v_rcp_f32 v96, v96
    v_rcp_f32 v97, v97
    v_rcp_f32 v98, v98
    v_rcp_f32 v99, v99
    v_rcp_f32 v100, v100
    v_rcp_f32 v101, v101
    v_rcp_f32 v102, v102
    v_rcp_f32 v103, v103
    v_pk_mul_f32 v[112:113], v[112:113], v[96:97]
    v_pk_mul_f32 v[114:115], v[114:115], v[98:99]
    v_pk_mul_f32 v[116:117], v[116:117], v[100:101]
    v_pk_mul_f32 v[118:119], v[118:119], v[102:103]
    v_cvt_pk_bf16_f32 v96, v112, v113
    v_cvt_pk_bf16_f32 v98, v116, v117
    v_cvt_pk_bf16_f32 v97, v114, v115
    v_cvt_pk_bf16_f32 v99, v118, v119
    v_permlane16_swap_b32 v96, v98
    s_nop 0
    v_permlane16_swap_b32 v97, v99
    buffer_store_dwordx4 v[96:99], v30, s[20:23], s41 offen offset:0 sc1
    v_pk_mul_f32 v[18:19], v[104:105], v[104:105]
    v_pk_mul_f32 v[20:21], v[106:107], v[106:107]
    v_pk_mul_f32 v[22:23], v[108:109], v[108:109]
    v_pk_mul_f32 v[28:29], v[110:111], v[110:111]
    v_pk_mul_f32 v[120:121], v[120:121], v[104:105]
    v_pk_mul_f32 v[122:123], v[122:123], v[106:107]
    v_pk_mul_f32 v[124:125], v[124:125], v[108:109]
    v_pk_mul_f32 v[126:127], v[126:127], v[110:111]
    v_pk_fma_f32 v[18:19], v[18:19], s[6:7], v[16:17] op_sel_hi:[1,1,0]
    v_pk_fma_f32 v[20:21], v[20:21], s[6:7], v[16:17] op_sel_hi:[1,1,0]
    v_pk_fma_f32 v[22:23], v[22:23], s[6:7], v[16:17] op_sel_hi:[1,1,0]
    v_pk_fma_f32 v[28:29], v[28:29], s[6:7], v[16:17] op_sel_hi:[1,1,0]
    v_pk_mul_f32 v[104:105], v[104:105], v[18:19]
    v_pk_mul_f32 v[106:107], v[106:107], v[20:21]
    v_pk_mul_f32 v[108:109], v[108:109], v[22:23]
    v_pk_mul_f32 v[110:111], v[110:111], v[28:29]
    v_exp_f32 v104, v104
    v_exp_f32 v105, v105
    v_exp_f32 v106, v106
    v_exp_f32 v107, v107
    v_exp_f32 v108, v108
    v_exp_f32 v109, v109
    v_exp_f32 v110, v110
    v_exp_f32_e64 v111, v111
    v_pk_add_f32 v[104:105], v[104:105], 1.0 op_sel_hi:[1,0]
    v_pk_add_f32 v[106:107], v[106:107], 1.0 op_sel_hi:[1,0]
    v_pk_add_f32 v[108:109], v[108:109], 1.0 op_sel_hi:[1,0]
    v_pk_add_f32 v[110:111], v[110:111], 1.0 op_sel_hi:[1,0]
    v_rcp_f32 v104, v104
    v_rcp_f32 v105, v105
    v_rcp_f32 v106, v106
    v_rcp_f32 v107, v107
    v_rcp_f32 v108, v108
    v_rcp_f32 v109, v109
    v_rcp_f32 v110, v110
    v_rcp_f32 v111, v111
    v_pk_mul_f32 v[120:121], v[120:121], v[104:105]
    v_pk_mul_f32 v[122:123], v[122:123], v[106:107]
    v_pk_mul_f32 v[124:125], v[124:125], v[108:109]
    v_pk_mul_f32 v[126:127], v[126:127], v[110:111]
    v_cvt_pk_bf16_f32 v104, v120, v121
    v_cvt_pk_bf16_f32 v106, v124, v125
    v_cvt_pk_bf16_f32 v105, v122, v123
    v_cvt_pk_bf16_f32 v107, v126, v127
    v_permlane16_swap_b32 v104, v106
    s_nop 0
    v_permlane16_swap_b32 v105, v107
    buffer_store_dwordx4 v[104:107], v30, s[20:23], s41 offen offset:2048 sc1
    v_pk_mul_f32 v[18:19], v[128:129], v[128:129]
    v_pk_mul_f32 v[20:21], v[130:131], v[130:131]
    v_pk_mul_f32 v[22:23], v[132:133], v[132:133]
    v_pk_mul_f32 v[28:29], v[134:135], v[134:135]
    v_pk_mul_f32 v[144:145], v[144:145], v[128:129]
    v_pk_mul_f32 v[146:147], v[146:147], v[130:131]
    v_pk_mul_f32 v[148:149], v[148:149], v[132:133]
    v_pk_mul_f32 v[150:151], v[150:151], v[134:135]
    v_pk_fma_f32 v[18:19], v[18:19], s[6:7], v[16:17] op_sel_hi:[1,1,0]
    v_pk_fma_f32 v[20:21], v[20:21], s[6:7], v[16:17] op_sel_hi:[1,1,0]
    v_pk_fma_f32 v[22:23], v[22:23], s[6:7], v[16:17] op_sel_hi:[1,1,0]
    v_pk_fma_f32 v[28:29], v[28:29], s[6:7], v[16:17] op_sel_hi:[1,1,0]
    v_pk_mul_f32 v[128:129], v[128:129], v[18:19]
    v_pk_mul_f32 v[130:131], v[130:131], v[20:21]
    v_pk_mul_f32 v[132:133], v[132:133], v[22:23]
    v_pk_mul_f32 v[134:135], v[134:135], v[28:29]
    v_exp_f32 v128, v128
    v_exp_f32 v129, v129
    v_exp_f32 v130, v130
    v_exp_f32 v131, v131
    v_exp_f32 v132, v132
    v_exp_f32 v133, v133
    v_exp_f32 v134, v134
    v_exp_f32_e64 v135, v135
    v_pk_add_f32 v[128:129], v[128:129], 1.0 op_sel_hi:[1,0]
    v_pk_add_f32 v[130:131], v[130:131], 1.0 op_sel_hi:[1,0]
    v_pk_add_f32 v[132:133], v[132:133], 1.0 op_sel_hi:[1,0]
    v_pk_add_f32 v[134:135], v[134:135], 1.0 op_sel_hi:[1,0]
    v_rcp_f32 v128, v128
    v_rcp_f32 v129, v129
    v_rcp_f32 v130, v130
    v_rcp_f32 v131, v131
    v_rcp_f32 v132, v132
    v_rcp_f32 v133, v133
    v_rcp_f32 v134, v134
    v_rcp_f32 v135, v135
    v_pk_mul_f32 v[144:145], v[144:145], v[128:129]
    v_pk_mul_f32 v[146:147], v[146:147], v[130:131]
    v_pk_mul_f32 v[148:149], v[148:149], v[132:133]
    v_pk_mul_f32 v[150:151], v[150:151], v[134:135]
    v_cvt_pk_bf16_f32 v128, v144, v145
    v_cvt_pk_bf16_f32 v130, v148, v149
    v_cvt_pk_bf16_f32 v129, v146, v147
    v_cvt_pk_bf16_f32 v131, v150, v151
    v_permlane16_swap_b32 v128, v130
    s_nop 0
    v_permlane16_swap_b32 v129, v131
    buffer_store_dwordx4 v[128:131], v30, s[20:23], s41 offen offset:512 sc1
    v_pk_mul_f32 v[18:19], v[136:137], v[136:137]
    v_pk_mul_f32 v[20:21], v[138:139], v[138:139]
    v_pk_mul_f32 v[22:23], v[140:141], v[140:141]
    v_pk_mul_f32 v[28:29], v[142:143], v[142:143]
    v_pk_mul_f32 v[152:153], v[152:153], v[136:137]
    v_pk_mul_f32 v[154:155], v[154:155], v[138:139]
    v_pk_mul_f32 v[156:157], v[156:157], v[140:141]
    v_pk_mul_f32 v[158:159], v[158:159], v[142:143]
    v_pk_fma_f32 v[18:19], v[18:19], s[6:7], v[16:17] op_sel_hi:[1,1,0]
    v_pk_fma_f32 v[20:21], v[20:21], s[6:7], v[16:17] op_sel_hi:[1,1,0]
    v_pk_fma_f32 v[22:23], v[22:23], s[6:7], v[16:17] op_sel_hi:[1,1,0]
    v_pk_fma_f32 v[28:29], v[28:29], s[6:7], v[16:17] op_sel_hi:[1,1,0]
    v_pk_mul_f32 v[136:137], v[136:137], v[18:19]
    v_pk_mul_f32 v[138:139], v[138:139], v[20:21]
    v_pk_mul_f32 v[140:141], v[140:141], v[22:23]
    v_pk_mul_f32 v[142:143], v[142:143], v[28:29]
    v_exp_f32 v136, v136
    v_exp_f32 v137, v137
    v_exp_f32 v138, v138
    v_exp_f32 v139, v139
    v_exp_f32 v140, v140
    v_exp_f32 v141, v141
    v_exp_f32 v142, v142
    v_exp_f32_e64 v143, v143
    v_pk_add_f32 v[136:137], v[136:137], 1.0 op_sel_hi:[1,0]
    v_pk_add_f32 v[138:139], v[138:139], 1.0 op_sel_hi:[1,0]
    v_pk_add_f32 v[140:141], v[140:141], 1.0 op_sel_hi:[1,0]
    v_pk_add_f32 v[142:143], v[142:143], 1.0 op_sel_hi:[1,0]
    v_rcp_f32 v136, v136
    v_rcp_f32 v137, v137
    v_rcp_f32 v138, v138
    v_rcp_f32 v139, v139
    v_rcp_f32 v140, v140
    v_rcp_f32 v141, v141
    v_rcp_f32 v142, v142
    v_rcp_f32 v143, v143
    v_pk_mul_f32 v[152:153], v[152:153], v[136:137]
    v_pk_mul_f32 v[154:155], v[154:155], v[138:139]
    v_pk_mul_f32 v[156:157], v[156:157], v[140:141]
    v_pk_mul_f32 v[158:159], v[158:159], v[142:143]
    v_cvt_pk_bf16_f32 v136, v152, v153
    v_cvt_pk_bf16_f32 v138, v156, v157
    v_cvt_pk_bf16_f32 v137, v154, v155
    v_cvt_pk_bf16_f32 v139, v158, v159
    v_permlane16_swap_b32 v136, v138
    s_nop 0
    v_permlane16_swap_b32 v137, v139
    buffer_store_dwordx4 v[136:139], v30, s[20:23], s41 offen offset:2560 sc1
    s_lshr_b32 s3, s26, 1
    s_cmp_lg_u32 s3, 1
    s_cbranch_scc1 L_k2_nox2B
    s_mov_b32 s55, 0x40000
    s_waitcnt vmcnt(4)
L_k2_pollB:
    v_mov_b32 v18, 0
    s_add_u32 s6, s48, s49
    s_cmp_ge_u32 s24, 7
    s_cselect_b32 s4, s48, 0
    s_cselect_b32 s5, s6, 0
    v_xor_b32 v19, s4, v33
    v_xor_b32 v20, s5, v35
    v_or3_b32 v18, v18, v19, v20
    s_cmp_ge_u32 s24, 6
    s_cselect_b32 s4, s48, 0
    s_cselect_b32 s5, s6, 0
    v_xor_b32 v19, s4, v37
    v_xor_b32_e64 v20, s5, v39
    v_or3_b32 v18, v18, v19, v20
    s_cmp_ge_u32 s24, 5
    s_cselect_b32 s4, s48, 0
    s_cselect_b32 s5, s6, 0
    v_xor_b32 v19, s4, v41
    v_xor_b32_e64 v20, s5, v43
    v_or3_b32 v18, v18, v19, v20
    s_cmp_ge_u32 s24, 4
    s_cselect_b32 s4, s48, 0
    s_cselect_b32 s5, s6, 0
    v_xor_b32 v19, s4, v45
    v_xor_b32_e64 v20, s5, v47
    v_or3_b32 v18, v18, v19, v20
    s_cmp_ge_u32 s24, 3
    s_cselect_b32 s4, s48, 0
    s_cselect_b32 s5, s6, 0
    v_xor_b32 v19, s4, v49
    v_xor_b32_e64 v20, s5, v51
    v_or3_b32 v18, v18, v19, v20
    s_cmp_ge_u32 s24, 2
    s_cselect_b32 s4, s48, 0
    s_cselect_b32 s5, s6, 0
    v_xor_b32 v19, s4, v53
    v_xor_b32_e64 v20, s5, v55
    v_or3_b32 v18, v18, v19, v20
    s_cmp_ge_u32 s24, 1
    s_cselect_b32 s4, s48, 0
    s_cselect_b32 s5, s6, 0
    v_xor_b32 v19, s4, v57
    v_xor_b32_e64 v20, s5, v59
    v_or3_b32 v18, v18, v19, v20
    v_cmp_ne_u32 vcc, 0, v18
    s_cbranch_vccz L_k2_gotB
    s_sleep 1
    s_add_u32 s3, s39, 0
    s_cmp_ge_u32 s24, 7
    s_cselect_b32 s3, s3, 0x7f000000
    buffer_load_dwordx4 v[32:35], v13, s[20:23], s3 offen sc1
    s_add_u32 s3, s39, 16384
    s_cmp_ge_u32 s24, 6
    s_cselect_b32 s3, s3, 0x7f000000
    buffer_load_dwordx4 v[36:39], v13, s[20:23], s3 offen sc1
    s_add_u32 s3, s39, 32768
    s_cmp_ge_u32 s24, 5
    s_cselect_b32 s3, s3, 0x7f000000
    buffer_load_dwordx4 v[40:43], v13, s[20:23], s3 offen sc1
    s_add_u32 s3, s39, 49152
    s_cmp_ge_u32 s24, 4
    s_cselect_b32 s3, s3, 0x7f000000
    buffer_load_dwordx4 v[44:47], v13, s[20:23], s3 offen sc1
    s_add_u32 s3, s39, 65536
    s_cmp_ge_u32 s24, 3
    s_cselect_b32 s3, s3, 0x7f000000
    buffer_load_dwordx4 v[48:51], v13, s[20:23], s3 offen sc1
    s_add_u32 s3, s39, 81920
    s_cmp_ge_u32 s24, 2
    s_cselect_b32 s3, s3, 0x7f000000
    buffer_load_dwordx4 v[52:55], v13, s[20:23], s3 offen sc1
    s_add_u32 s3, s39, 98304
    s_cmp_ge_u32 s24, 1
    s_cselect_b32 s3, s3, 0x7f000000
    buffer_load_dwordx4 v[56:59], v13, s[20:23], s3 offen sc1
    s_waitcnt vmcnt(0)
    s_sub_u32 s55, s55, 1
    s_cmp_lg_u32 s55, 0
    s_cbranch_scc1 L_k2_pollB
L_k2_gotB:
    v_accvgpr_read_b32 v18, a232
    v_accvgpr_read_b32 v19, a233
    v_mov_b32 v33, v34
    v_mov_b32 v37, v38
    v_mov_b32 v41, v42
    v_mov_b32 v45, v46
    v_mov_b32 v49, v50
    v_mov_b32 v53, v54
    v_mov_b32 v57, v58
    v_pk_fma_f32 v[36:37], v[32:33], v[18:19], v[36:37] op_sel_hi:[1,0,1]
    v_pk_fma_f32 v[36:37], v[32:33], v[18:19], v[36:37] op_sel:[1,1,0] op_sel_hi:[0,1,1] neg_lo:[0,1,0]
    v_pk_fma_f32 v[40:41], v[36:37], v[18:19], v[40:41] op_sel_hi:[1,0,1]
    v_pk_fma_f32 v[40:41], v[36:37], v[18:19], v[40:41] op_sel:[1,1,0] op_sel_hi:[0,1,1] neg_lo:[0,1,0]
    v_pk_fma_f32 v[44:45], v[40:41], v[18:19], v[44:45] op_sel_hi:[1,0,1]
    v_pk_fma_f32 v[44:45], v[40:41], v[18:19], v[44:45] op_sel:[1,1,0] op_sel_hi:[0,1,1] neg_lo:[0,1,0]
    v_pk_fma_f32 v[48:49], v[44:45], v[18:19], v[48:49] op_sel_hi:[1,0,1]
    v_pk_fma_f32 v[48:49], v[44:45], v[18:19], v[48:49] op_sel:[1,1,0] op_sel_hi:[0,1,1] neg_lo:[0,1,0]
    v_pk_fma_f32 v[52:53], v[48:49], v[18:19], v[52:53] op_sel_hi:[1,0,1]
    v_pk_fma_f32 v[52:53], v[48:49], v[18:19], v[52:53] op_sel:[1,1,0] op_sel_hi:[0,1,1] neg_lo:[0,1,0]
    v_pk_fma_f32 v[56:57], v[52:53], v[18:19], v[56:57] op_sel_hi:[1,0,1]
    v_pk_fma_f32 v[56:57], v[52:53], v[18:19], v[56:57] op_sel:[1,1,0] op_sel_hi:[0,1,1] neg_lo:[0,1,0]
    ds_write_b64 v12, v[56:57] offset:36864
    s_waitcnt lgkmcnt(0)
L_k2_nox2B:
    s_load_dwordx2 s[44:45], s[0:1], 64
    s_load_dwordx2 s[46:47], s[0:1], 104
    s_load_dwordx2 s[58:59], s[0:1], 0
    v_accvgpr_read_b32 v1, a240
    v_accvgpr_read_b32 v2, a241
    v_accvgpr_read_b32 v3, a242
    v_accvgpr_read_b32 v4, a243
    v_accvgpr_read_b32 v5, a244
    v_accvgpr_read_b32 v6, a245
    v_accvgpr_read_b32 v7, a246
    v_accvgpr_read_b32 v8, a247
    v_and_b32 v18, 63, v0
    v_lshlrev_b32 v9, 4, v18
    s_xor_b32 s80, s79, 0
    s_lshl_b32 s80, s80, 13
    s_xor_b32 s81, s79, 1
    s_lshl_b32 s81, s81, 13
    s_xor_b32 s82, s79, 2
    s_lshl_b32 s82, s82, 13
    s_xor_b32 s83, s79, 3
    s_lshl_b32 s83, s83, 13
    s_lshl_b32 s3, s60, 3
    s_add_u32 s3, s3, s61
    s_lshl_b32 s86, s2, 7
    s_add_u32 s86, s86, 35913728
    s_lshl_b32 s87, s3, 16
    s_lshl_b32 s3, s26, 14
    s_add_u32 s87, s87, s3
    s_add_u32 s87, s87, 27262976
    s_lshr_b32 s90, s60, 1
    s_lshl_b32 s90, s90, 12
    s_add_u32 s93, s90, 35979264
    s_add_u32 s28, s90, 35946496
    s_and_b32 s3, s2, 1
    s_lshl_b32 s3, s3, 7
    s_add_u32 s90, s90, s3
    s_add_u32 s90, s90, 35913792
    s_and_b32 s3, s65, 3
    s_lshl_b32 s3, s3, 3
    s_add_u32 s90, s90, s3
    s_add_u32 s93, s93, s3
    s_lshl_b32 s33, s2, 7
    s_lshl_b32 s3, s26, 3
    s_add_u32 s33, s33, s3
    s_add_u32 s33, s33, 35979264
    s_lshl_b32 s89, s26, 13
    s_add_u32 s89, s89, 131072
    s_mul_i32 s92, s65, 458752
    s_add_u32 s92, s92, 4194304
    s_mul_i32 s84, s62, 196608
    s_add_u32 s84, s84, s92
    v_bfe_u32 v19, v18, 2, 2
    v_lshrrev_b32 v20, 4, v18
    v_lshl_add_u32 v21, v20, 3, v19
    v_lshlrev_b32 v21, 8, v21
    v_and_b32 v22, 3, v18
    v_lshl_add_u32 v21, v22, 3, v21
    s_lshl_b32 s3, s62, 16
    v_add_u32 v21, s3, v21
    v_bfe_u32 v19, v18, 2, 3
    s_lshl_b32 s3, s62, 2
    v_xor_b32 v19, s3, v19
    v_xor_b32_e64 v20, 0, v19
    v_lshl_add_u32 v10, v20, 5, v21
    v_xor_b32_e64 v20, 1, v19
    v_lshl_add_u32 v11, v20, 5, v21
    v_xor_b32_e64 v20, 2, v19
    v_lshl_add_u32 v12, v20, 5, v21
    v_xor_b32_e64 v20, 3, v19
    v_lshl_add_u32 v13, v20, 5, v21
    v_xor_b32_e64 v20, 4, v19
    v_lshl_add_u32 v14, v20, 5, v21
    v_xor_b32_e64 v20, 5, v19
    v_lshl_add_u32 v15, v20, 5, v21
    v_xor_b32_e64 v20, 6, v19
    v_lshl_add_u32 v16, v20, 5, v21
    v_xor_b32_e64 v20, 7, v19
    v_lshl_add_u32 v17, v20, 5, v21
    s_lshl_b32 s88, s65, 5
    s_lshl_b32 s3, s61, 2
    s_add_u32 s88, s88, s3
    s_lshl_b32 s3, s62, 1
    s_add_u32 s88, s88, s3
    s_lshl_b32 s88, s88, 12
    s_add_u32 s88, s88, 4096
    s_lshl_b32 s3, s61, 8
    s_lshl_b32 s4, s62, 7
    s_add_u32 s3, s3, s4
    s_add_u32 s3, s3, 64
    s_lshl_b32 s39, s65, 17
    s_add_u32 s39, s39, s3
    v_and_b32 v19, 15, v18
    v_lshrrev_b32 v26, 4, v18
    v_lshlrev_b32_e64 v26, 16, v26
    v_lshl_add_u32 v23, v19, 2, v26
    v_add_u32_e64 v20, s89, v9
    v_xor_b32 v21, 0x4000, v20
    v_bfe_u32 v19, v18, 1, 1
    v_lshlrev_b32 v19, 8, v19
    v_lshrrev_b32 v26, 2, v18
    v_lshl_add_u32 v19, v26, 4, v19
    v_lshlrev_b32 v24, 11, v26
    v_and_b32 v26, 1, v18
    v_lshl_add_u32 v19, v26, 3, v19
    v_add_u32 v22, s89, v19
    v_and_b32 v26, 3, v18
    v_lshl_add_u32 v24, v26, 4, v24
    v_lshrrev_b32 v19, 4, v18
    v_lshlrev_b32 v19, 10, v19
    v_lshl_add_u32 v19, v26, 3, v19
    v_bfe_u32 v26, v18, 2, 2
    v_lshl_add_u32 v19, v26, 6, v19
    v_add_u32 v25, s89, v19
    s_mov_b32 s80, 0
    s_mov_b32 s81, 16384
    s_mov_b32 s82, 32768
    s_mov_b32 s83, 49152
    s_lshl_b32 s27, s79, 13
    s_add_u32 s66, s87, 9437184
    s_xor_b32 s67, s86, 0
    s_add_u32 s67, s67, 98304
    s_waitcnt lgkmcnt(0)
    s_mov_b32 s12, s58
    s_mov_b32 s13, s59
    s_mov_b32 s14, 4194304
    s_mov_b32 s15, 0x00020000
    v_and_b32 v92, 7, v0
    v_lshlrev_b32_e64 v92, 8, v92
    buffer_load_dwordx2 v[26:27], v92, s[20:23], s90 offen sc1
    s_waitcnt vmcnt(0) lgkmcnt(0)
    s_barrier
    s_cmp_lg_u32 s26, 0
    s_cbranch_scc1 L_sighB
    s_lshl_b32 s3, s2, 7
    s_add_u32 s3, s3, 35946496
    s_mov_b64 exec, 1
    buffer_store_dwordx2 a[248:249], off, s[20:23], s3 sc1
    s_mov_b64 exec, -1
L_sighB:
    v_cmp_ne_u64 vcc, s[48:49], v[26:27]
    s_nop 1
    s_mov_b64 s[30:31], vcc
    s_cbranch_vccnz L_noflB
    s_add_u32 s85, s84, s80
    s_xor_b32 s80, s27, 0
    buffer_load_dwordx4 a[64:67], v9, s[20:23], s85 offen offset:0 sc1
    buffer_load_dwordx4 a[68:71], v9, s[20:23], s85 offen offset:1024 sc1
    buffer_load_dwordx4 a[72:75], v9, s[20:23], s85 offen offset:2048 sc1
    buffer_load_dwordx4 a[76:79], v9, s[20:23], s85 offen offset:3072 sc1
    s_add_u32 s85, s85, 4096
    buffer_load_dwordx4 a[80:83], v9, s[20:23], s85 offen offset:0 sc1
    buffer_load_dwordx4 a[84:87], v9, s[20:23], s85 offen offset:1024 sc1
    buffer_load_dwordx4 a[88:91], v9, s[20:23], s85 offen offset:2048 sc1
    buffer_load_dwordx4 a[92:95], v9, s[20:23], s85 offen offset:3072 sc1
    s_add_u32 s85, s84, s81
    s_xor_b32 s81, s27, 8192
    buffer_load_dwordx4 a[96:99], v9, s[20:23], s85 offen offset:0 sc1
    buffer_load_dwordx4 a[100:103], v9, s[20:23], s85 offen offset:1024 sc1
    buffer_load_dwordx4 a[104:107], v9, s[20:23], s85 offen offset:2048 sc1
    buffer_load_dwordx4 a[108:111], v9, s[20:23], s85 offen offset:3072 sc1
L_noflB:
    v_and_b32 v90, 15, v0
    v_lshlrev_b32 v90, 3, v90
    ds_read_b64 v[32:33], v31 offset:55296
    ds_read_b64 v[44:45], v90 offset:36864
    ds_read_b64 v[34:35], v31 offset:55424
    ds_read_b64 v[46:47], v90 offset:36992
    ds_read_b64 v[36:37], v31 offset:55552
    ds_read_b64 v[48:49], v90 offset:37120
    ds_read_b64 v[38:39], v31 offset:55680
    ds_read_b64 v[50:51], v90 offset:37248
    ds_read_b64 v[40:41], v31 offset:55808
    ds_read_b64 v[52:53], v90 offset:37376
    v_accvgpr_read_b32 v56, a204
    v_accvgpr_read_b32 v68, a202
    v_accvgpr_read_b32 v80, a200
    v_accvgpr_read_b32 v57, a205
    v_accvgpr_read_b32 v69, a203
    v_accvgpr_read_b32 v81, a201
    v_accvgpr_read_b32 v58, a210
    v_accvgpr_read_b32 v70, a208
    v_accvgpr_read_b32 v82, a206
    v_accvgpr_read_b32 v59, a211
    v_accvgpr_read_b32 v71, a209
    v_accvgpr_read_b32 v83, a207
    v_accvgpr_read_b32 v60, a216
    v_accvgpr_read_b32 v72, a214
    v_accvgpr_read_b32 v84, a212
    v_accvgpr_read_b32 v61, a217
    v_accvgpr_read_b32 v73, a215
    v_accvgpr_read_b32 v85, a213
    v_accvgpr_read_b32 v62, a222
    v_accvgpr_read_b32 v74, a220
    v_accvgpr_read_b32 v86, a218
    v_accvgpr_read_b32 v63, a223
    v_accvgpr_read_b32 v75, a221
    v_accvgpr_read_b32 v87, a219
    v_accvgpr_read_b32 v64, a228
    v_accvgpr_read_b32 v76, a226
    v_accvgpr_read_b32 v88, a224
    v_accvgpr_read_b32 v65, a229
    v_accvgpr_read_b32 v77, a227
    v_accvgpr_read_b32 v89, a225
    s_mul_i32 s3, s26, 9216
    s_add_u32 s3, s3, 110592
    v_and_b32_e64 v28, 15, v0
    v_mul_u32_u24 v28, 144, v28
    v_bfe_u32 v91, v0, 4, 2
    v_lshl_add_u32 v28, v91, 5, v28
    v_add_u32_e64 v28, s3, v28
    v_bfe_u32 v29, v0, 5, 1
    v_bfe_u32 v91, v0, 2, 2
    v_lshl_add_u32 v29, v29, 3, v91
    v_mul_u32_u24 v29, 144, v29
    v_and_b32_e64 v91, 3, v0
    v_lshl_add_u32 v29, v91, 5, v29
    v_bfe_u32 v91, v0, 4, 1
    v_lshl_add_u32 v29, v91, 3, v29
    v_add_u32 v29, s3, v29
    s_lshl_b32 s40, s36, 18
    s_add_u32 s40, s40, 18874368
    s_lshr_b32 s41, s38, 4
    s_waitcnt lgkmcnt(0)
    v_pk_fma_f32 v[32:33], v[44:45], v[56:57], v[32:33] op_sel_hi:[1,0,1]
    v_pk_fma_f32 v[34:35], v[46:47], v[58:59], v[34:35] op_sel_hi:[1,0,1]
    v_pk_fma_f32 v[36:37], v[48:49], v[60:61], v[36:37] op_sel_hi:[1,0,1]
    v_pk_fma_f32 v[38:39], v[50:51], v[62:63], v[38:39] op_sel_hi:[1,0,1]
    v_pk_fma_f32 v[40:41], v[52:53], v[64:65], v[40:41] op_sel_hi:[1,0,1]
    v_pk_fma_f32 v[32:33], v[44:45], v[56:57], v[32:33] op_sel:[1,1,0] op_sel_hi:[0,1,1] neg_lo:[0,1,0]
    v_pk_fma_f32 v[34:35], v[46:47], v[58:59], v[34:35] op_sel:[1,1,0] op_sel_hi:[0,1,1] neg_lo:[0,1,0]
    v_pk_fma_f32 v[36:37], v[48:49], v[60:61], v[36:37] op_sel:[1,1,0] op_sel_hi:[0,1,1] neg_lo:[0,1,0]
    v_pk_fma_f32 v[38:39], v[50:51], v[62:63], v[38:39] op_sel:[1,1,0] op_sel_hi:[0,1,1] neg_lo:[0,1,0]
    v_pk_fma_f32 v[40:41], v[52:53], v[64:65], v[40:41] op_sel:[1,1,0] op_sel_hi:[0,1,1] neg_lo:[0,1,0]
    v_mov_b32 v44, v160
    v_mov_b32 v45, v240
    v_pk_fma_f32 v[44:45], v[32:33], v[80:81], v[44:45] op_sel_hi:[1,0,1]
    v_pk_fma_f32 v[44:45], v[32:33], v[80:81], v[44:45] op_sel:[1,1,0] op_sel_hi:[0,1,1] neg_lo:[0,1,0]
    v_pk_mul_f32 v[48:49], v[44:45], v[68:69] op_sel_hi:[1,0]
    v_pk_fma_f32 v[48:49], v[44:45], v[68:69], v[48:49] op_sel:[1,1,0] op_sel_hi:[0,1,1] neg_lo:[0,1,0]
    v_mov_b32 v46, v161
    v_mov_b32 v47, v241
    v_pk_fma_f32 v[46:47], v[44:45], v[80:81], v[46:47] op_sel_hi:[1,0,1]
    v_pk_fma_f32 v[46:47], v[44:45], v[80:81], v[46:47] op_sel:[1,1,0] op_sel_hi:[0,1,1] neg_lo:[0,1,0]
    v_pk_mul_f32 v[50:51], v[46:47], v[68:69] op_sel_hi:[1,0]
    v_pk_fma_f32 v[50:51], v[46:47], v[68:69], v[50:51] op_sel:[1,1,0] op_sel_hi:[0,1,1] neg_lo:[0,1,0]
    v_cvt_pk_bf16_f32 v96, v48, v50
    v_cvt_pk_bf16_f32 v104, v49, v51
    v_mov_b32 v44, v162
    v_mov_b32 v45, v242
    v_pk_fma_f32 v[44:45], v[46:47], v[80:81], v[44:45] op_sel_hi:[1,0,1]
    v_pk_fma_f32 v[44:45], v[46:47], v[80:81], v[44:45] op_sel:[1,1,0] op_sel_hi:[0,1,1] neg_lo:[0,1,0]
    v_pk_mul_f32 v[48:49], v[44:45], v[68:69] op_sel_hi:[1,0]
    v_pk_fma_f32 v[48:49], v[44:45], v[68:69], v[48:49] op_sel:[1,1,0] op_sel_hi:[0,1,1] neg_lo:[0,1,0]
    v_mov_b32 v46, v163
    v_mov_b32 v47, v243
    v_pk_fma_f32 v[46:47], v[44:45], v[80:81], v[46:47] op_sel_hi:[1,0,1]
    v_pk_fma_f32 v[46:47], v[44:45], v[80:81], v[46:47] op_sel:[1,1,0] op_sel_hi:[0,1,1] neg_lo:[0,1,0]
    v_pk_mul_f32 v[50:51], v[46:47], v[68:69] op_sel_hi:[1,0]
    v_pk_fma_f32 v[50:51], v[46:47], v[68:69], v[50:51] op_sel:[1,1,0] op_sel_hi:[0,1,1] neg_lo:[0,1,0]
    v_cvt_pk_bf16_f32 v97, v48, v50
    v_cvt_pk_bf16_f32 v105, v49, v51
    v_mov_b32 v44, v164
    v_mov_b32 v45, v244
    v_pk_fma_f32 v[44:45], v[46:47], v[80:81], v[44:45] op_sel_hi:[1,0,1]
    v_pk_fma_f32 v[44:45], v[46:47], v[80:81], v[44:45] op_sel:[1,1,0] op_sel_hi:[0,1,1] neg_lo:[0,1,0]
    v_pk_mul_f32 v[48:49], v[44:45], v[68:69] op_sel_hi:[1,0]
    v_pk_fma_f32 v[48:49], v[44:45], v[68:69], v[48:49] op_sel:[1,1,0] op_sel_hi:[0,1,1] neg_lo:[0,1,0]
    v_mov_b32 v46, v165
    v_mov_b32 v47, v245
    v_pk_fma_f32 v[46:47], v[44:45], v[80:81], v[46:47] op_sel_hi:[1,0,1]
    v_pk_fma_f32 v[46:47], v[44:45], v[80:81], v[46:47] op_sel:[1,1,0] op_sel_hi:[0,1,1] neg_lo:[0,1,0]
    v_pk_mul_f32 v[50:51], v[46:47], v[68:69] op_sel_hi:[1,0]
    v_pk_fma_f32 v[50:51], v[46:47], v[68:69], v[50:51] op_sel:[1,1,0] op_sel_hi:[0,1,1] neg_lo:[0,1,0]
    v_cvt_pk_bf16_f32 v98, v48, v50
    v_cvt_pk_bf16_f32 v106, v49, v51
    v_mov_b32 v44, v166
    v_mov_b32 v45, v246
    v_pk_fma_f32 v[44:45], v[46:47], v[80:81], v[44:45] op_sel_hi:[1,0,1]
    v_pk_fma_f32 v[44:45], v[46:47], v[80:81], v[44:45] op_sel:[1,1,0] op_sel_hi:[0,1,1] neg_lo:[0,1,0]
    v_pk_mul_f32 v[48:49], v[44:45], v[68:69] op_sel_hi:[1,0]
    v_pk_fma_f32 v[48:49], v[44:45], v[68:69], v[48:49] op_sel:[1,1,0] op_sel_hi:[0,1,1] neg_lo:[0,1,0]
    v_mov_b32 v46, v167
    v_mov_b32 v47, v247
    v_pk_fma_f32 v[46:47], v[44:45], v[80:81], v[46:47] op_sel_hi:[1,0,1]
    v_pk_fma_f32 v[46:47], v[44:45], v[80:81], v[46:47] op_sel:[1,1,0] op_sel_hi:[0,1,1] neg_lo:[0,1,0]
    v_pk_mul_f32 v[50:51], v[46:47], v[68:69] op_sel_hi:[1,0]
    v_pk_fma_f32 v[50:51], v[46:47], v[68:69], v[50:51] op_sel:[1,1,0] op_sel_hi:[0,1,1] neg_lo:[0,1,0]
    v_cvt_pk_bf16_f32 v99, v48, v50
    v_cvt_pk_bf16_f32 v107, v49, v51
    v_mov_b32 v44, v168
    v_mov_b32 v45, v248
    v_pk_fma_f32 v[44:45], v[46:47], v[80:81], v[44:45] op_sel_hi:[1,0,1]
    v_pk_fma_f32 v[44:45], v[46:47], v[80:81], v[44:45] op_sel:[1,1,0] op_sel_hi:[0,1,1] neg_lo:[0,1,0]
    v_pk_mul_f32 v[48:49], v[44:45], v[68:69] op_sel_hi:[1,0]
    v_pk_fma_f32 v[48:49], v[44:45], v[68:69], v[48:49] op_sel:[1,1,0] op_sel_hi:[0,1,1] neg_lo:[0,1,0]
    v_mov_b32 v46, v169
    v_mov_b32 v47, v249
    v_pk_fma_f32 v[46:47], v[44:45], v[80:81], v[46:47] op_sel_hi:[1,0,1]
    v_pk_fma_f32 v[46:47], v[44:45], v[80:81], v[46:47] op_sel:[1,1,0] op_sel_hi:[0,1,1] neg_lo:[0,1,0]
    v_pk_mul_f32 v[50:51], v[46:47], v[68:69] op_sel_hi:[1,0]
    v_pk_fma_f32 v[50:51], v[46:47], v[68:69], v[50:51] op_sel:[1,1,0] op_sel_hi:[0,1,1] neg_lo:[0,1,0]
    v_cvt_pk_bf16_f32 v100, v48, v50
    v_cvt_pk_bf16_f32 v108, v49, v51
    v_mov_b32 v44, v170
    v_mov_b32 v45, v250
    v_pk_fma_f32 v[44:45], v[46:47], v[80:81], v[44:45] op_sel_hi:[1,0,1]
    v_pk_fma_f32 v[44:45], v[46:47], v[80:81], v[44:45] op_sel:[1,1,0] op_sel_hi:[0,1,1] neg_lo:[0,1,0]
    v_pk_mul_f32 v[48:49], v[44:45], v[68:69] op_sel_hi:[1,0]
    v_pk_fma_f32 v[48:49], v[44:45], v[68:69], v[48:49] op_sel:[1,1,0] op_sel_hi:[0,1,1] neg_lo:[0,1,0]
    v_mov_b32 v46, v171
    v_mov_b32 v47, v251
    v_pk_fma_f32 v[46:47], v[44:45], v[80:81], v[46:47] op_sel_hi:[1,0,1]
    v_pk_fma_f32 v[46:47], v[44:45], v[80:81], v[46:47] op_sel:[1,1,0] op_sel_hi:[0,1,1] neg_lo:[0,1,0]
    v_pk_mul_f32 v[50:51], v[46:47], v[68:69] op_sel_hi:[1,0]
    v_pk_fma_f32 v[50:51], v[46:47], v[68:69], v[50:51] op_sel:[1,1,0] op_sel_hi:[0,1,1] neg_lo:[0,1,0]
    v_cvt_pk_bf16_f32 v101, v48, v50
    v_cvt_pk_bf16_f32 v109, v49, v51
    v_mov_b32 v44, v172
    v_mov_b32 v45, v252
    v_pk_fma_f32 v[44:45], v[46:47], v[80:81], v[44:45] op_sel_hi:[1,0,1]
    v_pk_fma_f32 v[44:45], v[46:47], v[80:81], v[44:45] op_sel:[1,1,0] op_sel_hi:[0,1,1] neg_lo:[0,1,0]
    v_pk_mul_f32 v[48:49], v[44:45], v[68:69] op_sel_hi:[1,0]
    v_pk_fma_f32 v[48:49], v[44:45], v[68:69], v[48:49] op_sel:[1,1,0] op_sel_hi:[0,1,1] neg_lo:[0,1,0]
    v_mov_b32 v46, v173
    v_mov_b32 v47, v253
    v_pk_fma_f32 v[46:47], v[44:45], v[80:81], v[46:47] op_sel_hi:[1,0,1]
    v_pk_fma_f32 v[46:47], v[44:45], v[80:81], v[46:47] op_sel:[1,1,0] op_sel_hi:[0,1,1] neg_lo:[0,1,0]
    v_pk_mul_f32 v[50:51], v[46:47], v[68:69] op_sel_hi:[1,0]
    v_pk_fma_f32 v[50:51], v[46:47], v[68:69], v[50:51] op_sel:[1,1,0] op_sel_hi:[0,1,1] neg_lo:[0,1,0]
    v_cvt_pk_bf16_f32 v102, v48, v50
    v_cvt_pk_bf16_f32 v110, v49, v51
    v_mov_b32 v44, v174
    v_mov_b32 v45, v254
    v_pk_fma_f32 v[44:45], v[46:47], v[80:81], v[44:45] op_sel_hi:[1,0,1]
    v_pk_fma_f32 v[44:45], v[46:47], v[80:81], v[44:45] op_sel:[1,1,0] op_sel_hi:[0,1,1] neg_lo:[0,1,0]
    v_pk_mul_f32 v[48:49], v[44:45], v[68:69] op_sel_hi:[1,0]
    v_pk_fma_f32 v[48:49], v[44:45], v[68:69], v[48:49] op_sel:[1,1,0] op_sel_hi:[0,1,1] neg_lo:[0,1,0]
    v_mov_b32 v46, v175
    v_mov_b32 v47, v255
    v_pk_fma_f32 v[46:47], v[44:45], v[80:81], v[46:47] op_sel_hi:[1,0,1]
    v_pk_fma_f32 v[46:47], v[44:45], v[80:81], v[46:47] op_sel:[1,1,0] op_sel_hi:[0,1,1] neg_lo:[0,1,0]
    v_pk_mul_f32 v[50:51], v[46:47], v[68:69] op_sel_hi:[1,0]
    v_pk_fma_f32 v[50:51], v[46:47], v[68:69], v[50:51] op_sel:[1,1,0] op_sel_hi:[0,1,1] neg_lo:[0,1,0]
    v_cvt_pk_bf16_f32 v103, v48, v50
    v_cvt_pk_bf16_f32 v111, v49, v51
    v_mov_b32_e64 v44, v176
    v_accvgpr_read_b32 v45, a0
    v_pk_fma_f32 v[44:45], v[34:35], v[82:83], v[44:45] op_sel_hi:[1,0,1]
    v_pk_fma_f32 v[44:45], v[34:35], v[82:83], v[44:45] op_sel:[1,1,0] op_sel_hi:[0,1,1] neg_lo:[0,1,0]
    v_pk_mul_f32 v[48:49], v[44:45], v[70:71] op_sel_hi:[1,0]
    v_pk_fma_f32 v[48:49], v[44:45], v[70:71], v[48:49] op_sel:[1,1,0] op_sel_hi:[0,1,1] neg_lo:[0,1,0]
    ds_write_b128 v28, v[96:99] offset:0
    v_mov_b32_e64 v46, v177
    v_accvgpr_read_b32 v47, a1
    v_pk_fma_f32 v[46:47], v[44:45], v[82:83], v[46:47] op_sel_hi:[1,0,1]
    v_pk_fma_f32 v[46:47], v[44:45], v[82:83], v[46:47] op_sel:[1,1,0] op_sel_hi:[0,1,1] neg_lo:[0,1,0]
    v_pk_mul_f32 v[50:51], v[46:47], v[70:71] op_sel_hi:[1,0]
    v_pk_fma_f32 v[50:51], v[46:47], v[70:71], v[50:51] op_sel:[1,1,0] op_sel_hi:[0,1,1] neg_lo:[0,1,0]
    ds_write_b128 v28, v[100:103] offset:16
    v_cvt_pk_bf16_f32 v128, v48, v50
    v_cvt_pk_bf16_f32 v136, v49, v51
    v_mov_b32_e64 v44, v178
    v_accvgpr_read_b32 v45, a2
    v_pk_fma_f32 v[44:45], v[46:47], v[82:83], v[44:45] op_sel_hi:[1,0,1]
    v_pk_fma_f32 v[44:45], v[46:47], v[82:83], v[44:45] op_sel:[1,1,0] op_sel_hi:[0,1,1] neg_lo:[0,1,0]
    ds_write_b128 v28, v[104:107] offset:2304
    v_pk_mul_f32 v[48:49], v[44:45], v[70:71] op_sel_hi:[1,0]
    v_pk_fma_f32 v[48:49], v[44:45], v[70:71], v[48:49] op_sel:[1,1,0] op_sel_hi:[0,1,1] neg_lo:[0,1,0]
    v_mov_b32_e64 v46, v179
    v_accvgpr_read_b32 v47, a3
    v_pk_fma_f32 v[46:47], v[44:45], v[82:83], v[46:47] op_sel_hi:[1,0,1]
    v_pk_fma_f32 v[46:47], v[44:45], v[82:83], v[46:47] op_sel:[1,1,0] op_sel_hi:[0,1,1] neg_lo:[0,1,0]
    ds_write_b128 v28, v[108:111] offset:2320
    v_pk_mul_f32 v[50:51], v[46:47], v[70:71] op_sel_hi:[1,0]
    v_pk_fma_f32 v[50:51], v[46:47], v[70:71], v[50:51] op_sel:[1,1,0] op_sel_hi:[0,1,1] neg_lo:[0,1,0]
    v_cvt_pk_bf16_f32 v129, v48, v50
    v_cvt_pk_bf16_f32 v137, v49, v51
    v_mov_b32_e64 v44, v180
    v_accvgpr_read_b32 v45, a4
    ds_read_b64_tr_b16 v[112:113], v29 offset:0
    v_pk_fma_f32 v[44:45], v[46:47], v[82:83], v[44:45] op_sel_hi:[1,0,1]
    v_pk_fma_f32 v[44:45], v[46:47], v[82:83], v[44:45] op_sel:[1,1,0] op_sel_hi:[0,1,1] neg_lo:[0,1,0]
    v_pk_mul_f32 v[48:49], v[44:45], v[70:71] op_sel_hi:[1,0]
    v_pk_fma_f32 v[48:49], v[44:45], v[70:71], v[48:49] op_sel:[1,1,0] op_sel_hi:[0,1,1] neg_lo:[0,1,0]
    v_mov_b32_e64 v46, v181
    v_accvgpr_read_b32 v47, a5
    ds_read_b64_tr_b16 v[114:115], v29 offset:576
    v_pk_fma_f32 v[46:47], v[44:45], v[82:83], v[46:47] op_sel_hi:[1,0,1]
    v_pk_fma_f32 v[46:47], v[44:45], v[82:83], v[46:47] op_sel:[1,1,0] op_sel_hi:[0,1,1] neg_lo:[0,1,0]
    v_pk_mul_f32 v[50:51], v[46:47], v[70:71] op_sel_hi:[1,0]
    v_pk_fma_f32 v[50:51], v[46:47], v[70:71], v[50:51] op_sel:[1,1,0] op_sel_hi:[0,1,1] neg_lo:[0,1,0]
    v_cvt_pk_bf16_f32 v130, v48, v50
    v_cvt_pk_bf16_f32 v138, v49, v51
    ds_read_b64_tr_b16 v[116:117], v29 offset:16
    v_mov_b32_e64 v44, v182
    v_accvgpr_read_b32 v45, a6
    v_pk_fma_f32 v[44:45], v[46:47], v[82:83], v[44:45] op_sel_hi:[1,0,1]
    v_pk_fma_f32 v[44:45], v[46:47], v[82:83], v[44:45] op_sel:[1,1,0] op_sel_hi:[0,1,1] neg_lo:[0,1,0]
    v_pk_mul_f32 v[48:49], v[44:45], v[70:71] op_sel_hi:[1,0]
    v_pk_fma_f32 v[48:49], v[44:45], v[70:71], v[48:49] op_sel:[1,1,0] op_sel_hi:[0,1,1] neg_lo:[0,1,0]
    ds_read_b64_tr_b16 v[118:119], v29 offset:592
    v_mov_b32_e64 v46, v183
    v_accvgpr_read_b32 v47, a7
    v_pk_fma_f32 v[46:47], v[44:45], v[82:83], v[46:47] op_sel_hi:[1,0,1]
    v_pk_fma_f32 v[46:47], v[44:45], v[82:83], v[46:47] op_sel:[1,1,0] op_sel_hi:[0,1,1] neg_lo:[0,1,0]
    v_pk_mul_f32 v[50:51], v[46:47], v[70:71] op_sel_hi:[1,0]
    v_pk_fma_f32 v[50:51], v[46:47], v[70:71], v[50:51] op_sel:[1,1,0] op_sel_hi:[0,1,1] neg_lo:[0,1,0]
    ds_read_b64_tr_b16 v[120:121], v29 offset:2304
    v_cvt_pk_bf16_f32 v131, v48, v50
    v_cvt_pk_bf16_f32 v139, v49, v51
    v_mov_b32_e64 v44, v184
    v_accvgpr_read_b32 v45, a8
    v_pk_fma_f32 v[44:45], v[46:47], v[82:83], v[44:45] op_sel_hi:[1,0,1]
    v_pk_fma_f32 v[44:45], v[46:47], v[82:83], v[44:45] op_sel:[1,1,0] op_sel_hi:[0,1,1] neg_lo:[0,1,0]
    ds_read_b64_tr_b16 v[122:123], v29 offset:2880
    v_pk_mul_f32 v[48:49], v[44:45], v[70:71] op_sel_hi:[1,0]
    v_pk_fma_f32 v[48:49], v[44:45], v[70:71], v[48:49] op_sel:[1,1,0] op_sel_hi:[0,1,1] neg_lo:[0,1,0]
    v_mov_b32_e64 v46, v185
    v_accvgpr_read_b32 v47, a9
    v_pk_fma_f32 v[46:47], v[44:45], v[82:83], v[46:47] op_sel_hi:[1,0,1]
    v_pk_fma_f32 v[46:47], v[44:45], v[82:83], v[46:47] op_sel:[1,1,0] op_sel_hi:[0,1,1] neg_lo:[0,1,0]
    ds_read_b64_tr_b16 v[124:125], v29 offset:2320
    v_pk_mul_f32 v[50:51], v[46:47], v[70:71] op_sel_hi:[1,0]
    v_pk_fma_f32 v[50:51], v[46:47], v[70:71], v[50:51] op_sel:[1,1,0] op_sel_hi:[0,1,1] neg_lo:[0,1,0]
    v_cvt_pk_bf16_f32 v132, v48, v50
    v_cvt_pk_bf16_f32 v140, v49, v51
    v_mov_b32_e64 v44, v186
    v_accvgpr_read_b32 v45, a10
    ds_read_b64_tr_b16 v[126:127], v29 offset:2896
    v_pk_fma_f32 v[44:45], v[46:47], v[82:83], v[44:45] op_sel_hi:[1,0,1]
    v_pk_fma_f32 v[44:45], v[46:47], v[82:83], v[44:45] op_sel:[1,1,0] op_sel_hi:[0,1,1] neg_lo:[0,1,0]
    v_pk_mul_f32 v[48:49], v[44:45], v[70:71] op_sel_hi:[1,0]
    v_pk_fma_f32 v[48:49], v[44:45], v[70:71], v[48:49] op_sel:[1,1,0] op_sel_hi:[0,1,1] neg_lo:[0,1,0]
    v_mov_b32_e64 v46, v187
    v_accvgpr_read_b32 v47, a11
    s_add_u32 s42, s41, 0
    s_lshr_b32 s43, s42, 1
    s_lshl_b32 s43, s43, 12
    s_and_b32 s42, s42, 1
    s_lshl_b32 s42, s42, 9
    s_add_u32 s43, s43, s42
    s_add_u32 s43, s43, s40
    s_add_u32 s42, s43, 131072
    s_waitcnt lgkmcnt(0)
    v_pk_fma_f32 v[46:47], v[44:45], v[82:83], v[46:47] op_sel_hi:[1,0,1]
    v_pk_fma_f32 v[46:47], v[44:45], v[82:83], v[46:47] op_sel:[1,1,0] op_sel_hi:[0,1,1] neg_lo:[0,1,0]
    v_pk_mul_f32 v[50:51], v[46:47], v[70:71] op_sel_hi:[1,0]
    v_pk_fma_f32 v[50:51], v[46:47], v[70:71], v[50:51] op_sel:[1,1,0] op_sel_hi:[0,1,1] neg_lo:[0,1,0]
    v_cvt_pk_bf16_f32 v133, v48, v50
    v_cvt_pk_bf16_f32 v141, v49, v51
    buffer_store_dwordx4 v[112:115], v30, s[20:23], s43 offen offset:0 sc1
    v_mov_b32_e64 v44, v188
    v_accvgpr_read_b32 v45, a12
    v_pk_fma_f32 v[44:45], v[46:47], v[82:83], v[44:45] op_sel_hi:[1,0,1]
    v_pk_fma_f32 v[44:45], v[46:47], v[82:83], v[44:45] op_sel:[1,1,0] op_sel_hi:[0,1,1] neg_lo:[0,1,0]
    v_pk_mul_f32 v[48:49], v[44:45], v[70:71] op_sel_hi:[1,0]
    v_pk_fma_f32 v[48:49], v[44:45], v[70:71], v[48:49] op_sel:[1,1,0] op_sel_hi:[0,1,1] neg_lo:[0,1,0]
    buffer_store_dwordx4 v[116:119], v30, s[20:23], s43 offen offset:2048 sc1
    v_mov_b32_e64 v46, v189
    v_accvgpr_read_b32 v47, a13
    v_pk_fma_f32 v[46:47], v[44:45], v[82:83], v[46:47] op_sel_hi:[1,0,1]
    v_pk_fma_f32 v[46:47], v[44:45], v[82:83], v[46:47] op_sel:[1,1,0] op_sel_hi:[0,1,1] neg_lo:[0,1,0]
    v_pk_mul_f32 v[50:51], v[46:47], v[70:71] op_sel_hi:[1,0]
    v_pk_fma_f32 v[50:51], v[46:47], v[70:71], v[50:51] op_sel:[1,1,0] op_sel_hi:[0,1,1] neg_lo:[0,1,0]
    buffer_store_dwordx4 v[120:123], v30, s[20:23], s42 offen offset:0 sc1
    v_cvt_pk_bf16_f32 v134, v48, v50
    v_cvt_pk_bf16_f32 v142, v49, v51
    v_mov_b32_e64 v44, v190
    v_accvgpr_read_b32 v45, a14
    v_pk_fma_f32 v[44:45], v[46:47], v[82:83], v[44:45] op_sel_hi:[1,0,1]
    v_pk_fma_f32 v[44:45], v[46:47], v[82:83], v[44:45] op_sel:[1,1,0] op_sel_hi:[0,1,1] neg_lo:[0,1,0]
    buffer_store_dwordx4 v[124:127], v30, s[20:23], s42 offen offset:2048 sc1
    v_pk_mul_f32 v[48:49], v[44:45], v[70:71] op_sel_hi:[1,0]
    v_pk_fma_f32 v[48:49], v[44:45], v[70:71], v[48:49] op_sel:[1,1,0] op_sel_hi:[0,1,1] neg_lo:[0,1,0]
    v_mov_b32_e64 v46, v191
    v_accvgpr_read_b32 v47, a15
    v_pk_fma_f32 v[46:47], v[44:45], v[82:83], v[46:47] op_sel_hi:[1,0,1]
    v_pk_fma_f32 v[46:47], v[44:45], v[82:83], v[46:47] op_sel:[1,1,0] op_sel_hi:[0,1,1] neg_lo:[0,1,0]
    v_pk_mul_f32 v[50:51], v[46:47], v[70:71] op_sel_hi:[1,0]
    v_pk_fma_f32 v[50:51], v[46:47], v[70:71], v[50:51] op_sel:[1,1,0] op_sel_hi:[0,1,1] neg_lo:[0,1,0]
    v_cvt_pk_bf16_f32 v135, v48, v50
    v_cvt_pk_bf16_f32 v143, v49, v51
    buffer_load_dwordx2 v[26:27], v92, s[20:23], s90 offen sc1
    v_mov_b32_e64 v44, v192
    v_accvgpr_read_b32 v45, a16
    v_pk_fma_f32 v[44:45], v[36:37], v[84:85], v[44:45] op_sel_hi:[1,0,1]
    v_pk_fma_f32 v[44:45], v[36:37], v[84:85], v[44:45] op_sel:[1,1,0] op_sel_hi:[0,1,1] neg_lo:[0,1,0]
    v_pk_mul_f32 v[48:49], v[44:45], v[72:73] op_sel_hi:[1,0]
    v_pk_fma_f32 v[48:49], v[44:45], v[72:73], v[48:49] op_sel:[1,1,0] op_sel_hi:[0,1,1] neg_lo:[0,1,0]
    ds_write_b128 v28, v[128:131] offset:4608
    v_mov_b32_e64 v46, v193
    v_accvgpr_read_b32 v47, a17
    v_pk_fma_f32 v[46:47], v[44:45], v[84:85], v[46:47] op_sel_hi:[1,0,1]
    v_pk_fma_f32 v[46:47], v[44:45], v[84:85], v[46:47] op_sel:[1,1,0] op_sel_hi:[0,1,1] neg_lo:[0,1,0]
    v_pk_mul_f32 v[50:51], v[46:47], v[72:73] op_sel_hi:[1,0]
    v_pk_fma_f32 v[50:51], v[46:47], v[72:73], v[50:51] op_sel:[1,1,0] op_sel_hi:[0,1,1] neg_lo:[0,1,0]
    ds_write_b128 v28, v[132:135] offset:4624
    v_cvt_pk_bf16_f32 v96, v48, v50
    v_cvt_pk_bf16_f32 v104, v49, v51
    v_mov_b32_e64 v44, v194
    v_accvgpr_read_b32 v45, a18
    v_pk_fma_f32 v[44:45], v[46:47], v[84:85], v[44:45] op_sel_hi:[1,0,1]
    v_pk_fma_f32 v[44:45], v[46:47], v[84:85], v[44:45] op_sel:[1,1,0] op_sel_hi:[0,1,1] neg_lo:[0,1,0]
    ds_write_b128 v28, v[136:139] offset:6912
    v_pk_mul_f32 v[48:49], v[44:45], v[72:73] op_sel_hi:[1,0]
    v_pk_fma_f32 v[48:49], v[44:45], v[72:73], v[48:49] op_sel:[1,1,0] op_sel_hi:[0,1,1] neg_lo:[0,1,0]
    v_mov_b32_e64 v46, v195
    v_accvgpr_read_b32 v47, a19
    v_pk_fma_f32 v[46:47], v[44:45], v[84:85], v[46:47] op_sel_hi:[1,0,1]
    v_pk_fma_f32 v[46:47], v[44:45], v[84:85], v[46:47] op_sel:[1,1,0] op_sel_hi:[0,1,1] neg_lo:[0,1,0]
    ds_write_b128 v28, v[140:143] offset:6928
    v_pk_mul_f32 v[50:51], v[46:47], v[72:73] op_sel_hi:[1,0]
    v_pk_fma_f32 v[50:51], v[46:47], v[72:73], v[50:51] op_sel:[1,1,0] op_sel_hi:[0,1,1] neg_lo:[0,1,0]
    v_cvt_pk_bf16_f32 v97, v48, v50
    v_cvt_pk_bf16_f32 v105, v49, v51
    v_mov_b32_e64 v44, v196
    v_accvgpr_read_b32 v45, a20
    ds_read_b64_tr_b16 v[144:145], v29 offset:4608
    v_pk_fma_f32 v[44:45], v[46:47], v[84:85], v[44:45] op_sel_hi:[1,0,1]
    v_pk_fma_f32 v[44:45], v[46:47], v[84:85], v[44:45] op_sel:[1,1,0] op_sel_hi:[0,1,1] neg_lo:[0,1,0]
    v_pk_mul_f32 v[48:49], v[44:45], v[72:73] op_sel_hi:[1,0]
    v_pk_fma_f32 v[48:49], v[44:45], v[72:73], v[48:49] op_sel:[1,1,0] op_sel_hi:[0,1,1] neg_lo:[0,1,0]
    v_mov_b32_e64 v46, v197
    v_accvgpr_read_b32 v47, a21
    ds_read_b64_tr_b16 v[146:147], v29 offset:5184
    v_pk_fma_f32 v[46:47], v[44:45], v[84:85], v[46:47] op_sel_hi:[1,0,1]
    v_pk_fma_f32 v[46:47], v[44:45], v[84:85], v[46:47] op_sel:[1,1,0] op_sel_hi:[0,1,1] neg_lo:[0,1,0]
    v_pk_mul_f32 v[50:51], v[46:47], v[72:73] op_sel_hi:[1,0]
    v_pk_fma_f32 v[50:51], v[46:47], v[72:73], v[50:51] op_sel:[1,1,0] op_sel_hi:[0,1,1] neg_lo:[0,1,0]
    v_cvt_pk_bf16_f32 v98, v48, v50
    v_cvt_pk_bf16_f32 v106, v49, v51
    ds_read_b64_tr_b16 v[148:149], v29 offset:4624
    v_mov_b32_e64 v44, v198
    v_accvgpr_read_b32 v45, a22
    v_pk_fma_f32 v[44:45], v[46:47], v[84:85], v[44:45] op_sel_hi:[1,0,1]
    v_pk_fma_f32 v[44:45], v[46:47], v[84:85], v[44:45] op_sel:[1,1,0] op_sel_hi:[0,1,1] neg_lo:[0,1,0]
    v_pk_mul_f32 v[48:49], v[44:45], v[72:73] op_sel_hi:[1,0]
    v_pk_fma_f32 v[48:49], v[44:45], v[72:73], v[48:49] op_sel:[1,1,0] op_sel_hi:[0,1,1] neg_lo:[0,1,0]
    ds_read_b64_tr_b16 v[150:151], v29 offset:5200
    v_mov_b32_e64 v46, v199
    v_accvgpr_read_b32 v47, a23
    v_pk_fma_f32 v[46:47], v[44:45], v[84:85], v[46:47] op_sel_hi:[1,0,1]
    v_pk_fma_f32 v[46:47], v[44:45], v[84:85], v[46:47] op_sel:[1,1,0] op_sel_hi:[0,1,1] neg_lo:[0,1,0]
    v_pk_mul_f32 v[50:51], v[46:47], v[72:73] op_sel_hi:[1,0]
    v_pk_fma_f32 v[50:51], v[46:47], v[72:73], v[50:51] op_sel:[1,1,0] op_sel_hi:[0,1,1] neg_lo:[0,1,0]
    ds_read_b64_tr_b16 v[152:153], v29 offset:6912
    v_cvt_pk_bf16_f32 v99, v48, v50
    v_cvt_pk_bf16_f32 v107, v49, v51
    v_mov_b32_e64 v44, v200
    v_accvgpr_read_b32 v45, a24
    v_pk_fma_f32 v[44:45], v[46:47], v[84:85], v[44:45] op_sel_hi:[1,0,1]
    v_pk_fma_f32 v[44:45], v[46:47], v[84:85], v[44:45] op_sel:[1,1,0] op_sel_hi:[0,1,1] neg_lo:[0,1,0]
    ds_read_b64_tr_b16 v[154:155], v29 offset:7488
    v_pk_mul_f32 v[48:49], v[44:45], v[72:73] op_sel_hi:[1,0]
    v_pk_fma_f32 v[48:49], v[44:45], v[72:73], v[48:49] op_sel:[1,1,0] op_sel_hi:[0,1,1] neg_lo:[0,1,0]
    v_mov_b32_e64 v46, v201
    v_accvgpr_read_b32 v47, a25
    v_pk_fma_f32 v[46:47], v[44:45], v[84:85], v[46:47] op_sel_hi:[1,0,1]
    v_pk_fma_f32 v[46:47], v[44:45], v[84:85], v[46:47] op_sel:[1,1,0] op_sel_hi:[0,1,1] neg_lo:[0,1,0]
    ds_read_b64_tr_b16 v[156:157], v29 offset:6928
    v_pk_mul_f32 v[50:51], v[46:47], v[72:73] op_sel_hi:[1,0]
    v_pk_fma_f32 v[50:51], v[46:47], v[72:73], v[50:51] op_sel:[1,1,0] op_sel_hi:[0,1,1] neg_lo:[0,1,0]
    v_cvt_pk_bf16_f32 v100, v48, v50
    v_cvt_pk_bf16_f32 v108, v49, v51
    v_mov_b32_e64 v44, v202
    v_accvgpr_read_b32 v45, a26
    ds_read_b64_tr_b16 v[158:159], v29 offset:7504
    v_pk_fma_f32 v[44:45], v[46:47], v[84:85], v[44:45] op_sel_hi:[1,0,1]
    v_pk_fma_f32 v[44:45], v[46:47], v[84:85], v[44:45] op_sel:[1,1,0] op_sel_hi:[0,1,1] neg_lo:[0,1,0]
    v_pk_mul_f32 v[48:49], v[44:45], v[72:73] op_sel_hi:[1,0]
    v_pk_fma_f32 v[48:49], v[44:45], v[72:73], v[48:49] op_sel:[1,1,0] op_sel_hi:[0,1,1] neg_lo:[0,1,0]
    v_mov_b32_e64 v46, v203
    v_accvgpr_read_b32 v47, a27
    s_add_u32 s42, s41, 1
    s_lshr_b32 s43, s42, 1
    s_lshl_b32 s43, s43, 12
    s_and_b32 s42, s42, 1
    s_lshl_b32 s42, s42, 9
    s_add_u32 s43, s43, s42
    s_add_u32 s43, s43, s40
    s_add_u32 s42, s43, 131072
    s_waitcnt lgkmcnt(0)
    v_pk_fma_f32 v[46:47], v[44:45], v[84:85], v[46:47] op_sel_hi:[1,0,1]
    v_pk_fma_f32 v[46:47], v[44:45], v[84:85], v[46:47] op_sel:[1,1,0] op_sel_hi:[0,1,1] neg_lo:[0,1,0]
    v_pk_mul_f32 v[50:51], v[46:47], v[72:73] op_sel_hi:[1,0]
    v_pk_fma_f32 v[50:51], v[46:47], v[72:73], v[50:51] op_sel:[1,1,0] op_sel_hi:[0,1,1] neg_lo:[0,1,0]
    v_cvt_pk_bf16_f32 v101, v48, v50
    v_cvt_pk_bf16_f32 v109, v49, v51
    buffer_store_dwordx4 v[144:147], v30, s[20:23], s43 offen offset:0 sc1
    v_mov_b32_e64 v44, v204
    v_accvgpr_read_b32 v45, a28
    v_pk_fma_f32 v[44:45], v[46:47], v[84:85], v[44:45] op_sel_hi:[1,0,1]
    v_pk_fma_f32 v[44:45], v[46:47], v[84:85], v[44:45] op_sel:[1,1,0] op_sel_hi:[0,1,1] neg_lo:[0,1,0]
    v_pk_mul_f32 v[48:49], v[44:45], v[72:73] op_sel_hi:[1,0]
    v_pk_fma_f32 v[48:49], v[44:45], v[72:73], v[48:49] op_sel:[1,1,0] op_sel_hi:[0,1,1] neg_lo:[0,1,0]
    buffer_store_dwordx4 v[148:151], v30, s[20:23], s43 offen offset:2048 sc1
    v_mov_b32_e64 v46, v205
    v_accvgpr_read_b32 v47, a29
    v_pk_fma_f32 v[46:47], v[44:45], v[84:85], v[46:47] op_sel_hi:[1,0,1]
    v_pk_fma_f32 v[46:47], v[44:45], v[84:85], v[46:47] op_sel:[1,1,0] op_sel_hi:[0,1,1] neg_lo:[0,1,0]
    v_pk_mul_f32 v[50:51], v[46:47], v[72:73] op_sel_hi:[1,0]
    v_pk_fma_f32 v[50:51], v[46:47], v[72:73], v[50:51] op_sel:[1,1,0] op_sel_hi:[0,1,1] neg_lo:[0,1,0]
    buffer_store_dwordx4 v[152:155], v30, s[20:23], s42 offen offset:0 sc1
    v_cvt_pk_bf16_f32 v102, v48, v50
    v_cvt_pk_bf16_f32 v110, v49, v51
    v_mov_b32_e64 v44, v206
    v_accvgpr_read_b32 v45, a30
    v_pk_fma_f32 v[44:45], v[46:47], v[84:85], v[44:45] op_sel_hi:[1,0,1]
    v_pk_fma_f32 v[44:45], v[46:47], v[84:85], v[44:45] op_sel:[1,1,0] op_sel_hi:[0,1,1] neg_lo:[0,1,0]
    buffer_store_dwordx4 v[156:159], v30, s[20:23], s42 offen offset:2048 sc1
    v_pk_mul_f32 v[48:49], v[44:45], v[72:73] op_sel_hi:[1,0]
    v_pk_fma_f32 v[48:49], v[44:45], v[72:73], v[48:49] op_sel:[1,1,0] op_sel_hi:[0,1,1] neg_lo:[0,1,0]
    v_mov_b32_e64 v46, v207
    v_accvgpr_read_b32 v47, a31
    v_pk_fma_f32 v[46:47], v[44:45], v[84:85], v[46:47] op_sel_hi:[1,0,1]
    v_pk_fma_f32 v[46:47], v[44:45], v[84:85], v[46:47] op_sel:[1,1,0] op_sel_hi:[0,1,1] neg_lo:[0,1,0]
    v_pk_mul_f32 v[50:51], v[46:47], v[72:73] op_sel_hi:[1,0]
    v_pk_fma_f32 v[50:51], v[46:47], v[72:73], v[50:51] op_sel:[1,1,0] op_sel_hi:[0,1,1] neg_lo:[0,1,0]
    v_cvt_pk_bf16_f32 v103, v48, v50
    v_cvt_pk_bf16_f32 v111, v49, v51
    v_mov_b32_e64 v44, v208
    v_accvgpr_read_b32 v45, a32
    v_pk_fma_f32 v[44:45], v[38:39], v[86:87], v[44:45] op_sel_hi:[1,0,1]
    v_pk_fma_f32 v[44:45], v[38:39], v[86:87], v[44:45] op_sel:[1,1,0] op_sel_hi:[0,1,1] neg_lo:[0,1,0]
    v_pk_mul_f32 v[48:49], v[44:45], v[74:75] op_sel_hi:[1,0]
    v_pk_fma_f32 v[48:49], v[44:45], v[74:75], v[48:49] op_sel:[1,1,0] op_sel_hi:[0,1,1] neg_lo:[0,1,0]
    ds_write_b128 v28, v[96:99] offset:0
    v_mov_b32_e64 v46, v209
    v_accvgpr_read_b32 v47, a33
    v_pk_fma_f32 v[46:47], v[44:45], v[86:87], v[46:47] op_sel_hi:[1,0,1]
    v_pk_fma_f32 v[46:47], v[44:45], v[86:87], v[46:47] op_sel:[1,1,0] op_sel_hi:[0,1,1] neg_lo:[0,1,0]
    v_pk_mul_f32 v[50:51], v[46:47], v[74:75] op_sel_hi:[1,0]
    v_pk_fma_f32 v[50:51], v[46:47], v[74:75], v[50:51] op_sel:[1,1,0] op_sel_hi:[0,1,1] neg_lo:[0,1,0]
    ds_write_b128 v28, v[100:103] offset:16
    v_cvt_pk_bf16_f32 v128, v48, v50
    v_cvt_pk_bf16_f32 v136, v49, v51
    v_mov_b32_e64 v44, v210
    v_accvgpr_read_b32 v45, a34
    v_pk_fma_f32 v[44:45], v[46:47], v[86:87], v[44:45] op_sel_hi:[1,0,1]
    v_pk_fma_f32 v[44:45], v[46:47], v[86:87], v[44:45] op_sel:[1,1,0] op_sel_hi:[0,1,1] neg_lo:[0,1,0]
    ds_write_b128 v28, v[104:107] offset:2304
    v_pk_mul_f32 v[48:49], v[44:45], v[74:75] op_sel_hi:[1,0]
    v_pk_fma_f32 v[48:49], v[44:45], v[74:75], v[48:49] op_sel:[1,1,0] op_sel_hi:[0,1,1] neg_lo:[0,1,0]
    v_mov_b32_e64 v46, v211
    v_accvgpr_read_b32 v47, a35
    v_pk_fma_f32 v[46:47], v[44:45], v[86:87], v[46:47] op_sel_hi:[1,0,1]
    v_pk_fma_f32 v[46:47], v[44:45], v[86:87], v[46:47] op_sel:[1,1,0] op_sel_hi:[0,1,1] neg_lo:[0,1,0]
    ds_write_b128 v28, v[108:111] offset:2320
    v_pk_mul_f32 v[50:51], v[46:47], v[74:75] op_sel_hi:[1,0]
    v_pk_fma_f32 v[50:51], v[46:47], v[74:75], v[50:51] op_sel:[1,1,0] op_sel_hi:[0,1,1] neg_lo:[0,1,0]
    v_cvt_pk_bf16_f32 v129, v48, v50
    v_cvt_pk_bf16_f32 v137, v49, v51
    v_mov_b32_e64 v44, v212
    v_accvgpr_read_b32 v45, a36
    ds_read_b64_tr_b16 v[112:113], v29 offset:0
    v_pk_fma_f32 v[44:45], v[46:47], v[86:87], v[44:45] op_sel_hi:[1,0,1]
    v_pk_fma_f32 v[44:45], v[46:47], v[86:87], v[44:45] op_sel:[1,1,0] op_sel_hi:[0,1,1] neg_lo:[0,1,0]
    v_pk_mul_f32 v[48:49], v[44:45], v[74:75] op_sel_hi:[1,0]
    v_pk_fma_f32 v[48:49], v[44:45], v[74:75], v[48:49] op_sel:[1,1,0] op_sel_hi:[0,1,1] neg_lo:[0,1,0]
    v_mov_b32_e64 v46, v213
    v_accvgpr_read_b32 v47, a37
    ds_read_b64_tr_b16 v[114:115], v29 offset:576
    v_pk_fma_f32 v[46:47], v[44:45], v[86:87], v[46:47] op_sel_hi:[1,0,1]
    v_pk_fma_f32 v[46:47], v[44:45], v[86:87], v[46:47] op_sel:[1,1,0] op_sel_hi:[0,1,1] neg_lo:[0,1,0]
    v_pk_mul_f32 v[50:51], v[46:47], v[74:75] op_sel_hi:[1,0]
    v_pk_fma_f32 v[50:51], v[46:47], v[74:75], v[50:51] op_sel:[1,1,0] op_sel_hi:[0,1,1] neg_lo:[0,1,0]
    v_cvt_pk_bf16_f32 v130, v48, v50
    v_cvt_pk_bf16_f32 v138, v49, v51
    ds_read_b64_tr_b16 v[116:117], v29 offset:16
    v_mov_b32_e64 v44, v214
    v_accvgpr_read_b32 v45, a38
    v_pk_fma_f32 v[44:45], v[46:47], v[86:87], v[44:45] op_sel_hi:[1,0,1]
    v_pk_fma_f32 v[44:45], v[46:47], v[86:87], v[44:45] op_sel:[1,1,0] op_sel_hi:[0,1,1] neg_lo:[0,1,0]
    v_pk_mul_f32 v[48:49], v[44:45], v[74:75] op_sel_hi:[1,0]
    v_pk_fma_f32 v[48:49], v[44:45], v[74:75], v[48:49] op_sel:[1,1,0] op_sel_hi:[0,1,1] neg_lo:[0,1,0]
    ds_read_b64_tr_b16 v[118:119], v29 offset:592
    v_mov_b32_e64 v46, v215
    v_accvgpr_read_b32 v47, a39
    v_pk_fma_f32 v[46:47], v[44:45], v[86:87], v[46:47] op_sel_hi:[1,0,1]
    v_pk_fma_f32 v[46:47], v[44:45], v[86:87], v[46:47] op_sel:[1,1,0] op_sel_hi:[0,1,1] neg_lo:[0,1,0]
    v_pk_mul_f32 v[50:51], v[46:47], v[74:75] op_sel_hi:[1,0]
    v_pk_fma_f32 v[50:51], v[46:47], v[74:75], v[50:51] op_sel:[1,1,0] op_sel_hi:[0,1,1] neg_lo:[0,1,0]
    ds_read_b64_tr_b16 v[120:121], v29 offset:2304
    v_cvt_pk_bf16_f32 v131, v48, v50
    v_cvt_pk_bf16_f32 v139, v49, v51
    v_mov_b32_e64 v44, v216
    v_accvgpr_read_b32 v45, a40
    v_pk_fma_f32 v[44:45], v[46:47], v[86:87], v[44:45] op_sel_hi:[1,0,1]
    v_pk_fma_f32 v[44:45], v[46:47], v[86:87], v[44:45] op_sel:[1,1,0] op_sel_hi:[0,1,1] neg_lo:[0,1,0]
    ds_read_b64_tr_b16 v[122:123], v29 offset:2880
    v_pk_mul_f32 v[48:49], v[44:45], v[74:75] op_sel_hi:[1,0]
    v_pk_fma_f32 v[48:49], v[44:45], v[74:75], v[48:49] op_sel:[1,1,0] op_sel_hi:[0,1,1] neg_lo:[0,1,0]
    v_mov_b32_e64 v46, v217
    v_accvgpr_read_b32 v47, a41
    v_pk_fma_f32 v[46:47], v[44:45], v[86:87], v[46:47] op_sel_hi:[1,0,1]
    v_pk_fma_f32 v[46:47], v[44:45], v[86:87], v[46:47] op_sel:[1,1,0] op_sel_hi:[0,1,1] neg_lo:[0,1,0]
    ds_read_b64_tr_b16 v[124:125], v29 offset:2320
    v_pk_mul_f32 v[50:51], v[46:47], v[74:75] op_sel_hi:[1,0]
    v_pk_fma_f32 v[50:51], v[46:47], v[74:75], v[50:51] op_sel:[1,1,0] op_sel_hi:[0,1,1] neg_lo:[0,1,0]
    v_cvt_pk_bf16_f32 v132, v48, v50
    v_cvt_pk_bf16_f32 v140, v49, v51
    v_mov_b32_e64 v44, v218
    v_accvgpr_read_b32 v45, a42
    ds_read_b64_tr_b16 v[126:127], v29 offset:2896
    v_pk_fma_f32 v[44:45], v[46:47], v[86:87], v[44:45] op_sel_hi:[1,0,1]
    v_pk_fma_f32 v[44:45], v[46:47], v[86:87], v[44:45] op_sel:[1,1,0] op_sel_hi:[0,1,1] neg_lo:[0,1,0]
    v_pk_mul_f32 v[48:49], v[44:45], v[74:75] op_sel_hi:[1,0]
    v_pk_fma_f32 v[48:49], v[44:45], v[74:75], v[48:49] op_sel:[1,1,0] op_sel_hi:[0,1,1] neg_lo:[0,1,0]
    v_mov_b32_e64 v46, v219
    v_accvgpr_read_b32 v47, a43
    s_add_u32 s42, s41, 2
    s_lshr_b32 s43, s42, 1
    s_lshl_b32 s43, s43, 12
    s_and_b32 s42, s42, 1
    s_lshl_b32 s42, s42, 9
    s_add_u32 s43, s43, s42
    s_add_u32 s43, s43, s40
    s_add_u32 s42, s43, 131072
    s_waitcnt lgkmcnt(0)
    v_pk_fma_f32 v[46:47], v[44:45], v[86:87], v[46:47] op_sel_hi:[1,0,1]
    v_pk_fma_f32 v[46:47], v[44:45], v[86:87], v[46:47] op_sel:[1,1,0] op_sel_hi:[0,1,1] neg_lo:[0,1,0]
    v_pk_mul_f32 v[50:51], v[46:47], v[74:75] op_sel_hi:[1,0]
    v_pk_fma_f32 v[50:51], v[46:47], v[74:75], v[50:51] op_sel:[1,1,0] op_sel_hi:[0,1,1] neg_lo:[0,1,0]
    v_cvt_pk_bf16_f32 v133, v48, v50
    v_cvt_pk_bf16_f32 v141, v49, v51
    buffer_store_dwordx4 v[112:115], v30, s[20:23], s43 offen offset:0 sc1
    v_mov_b32_e64 v44, v220
    v_accvgpr_read_b32 v45, a44
    v_pk_fma_f32 v[44:45], v[46:47], v[86:87], v[44:45] op_sel_hi:[1,0,1]
    v_pk_fma_f32 v[44:45], v[46:47], v[86:87], v[44:45] op_sel:[1,1,0] op_sel_hi:[0,1,1] neg_lo:[0,1,0]
    v_pk_mul_f32 v[48:49], v[44:45], v[74:75] op_sel_hi:[1,0]
    v_pk_fma_f32 v[48:49], v[44:45], v[74:75], v[48:49] op_sel:[1,1,0] op_sel_hi:[0,1,1] neg_lo:[0,1,0]
    buffer_store_dwordx4 v[116:119], v30, s[20:23], s43 offen offset:2048 sc1
    v_mov_b32_e64 v46, v221
    v_accvgpr_read_b32 v47, a45
    v_pk_fma_f32 v[46:47], v[44:45], v[86:87], v[46:47] op_sel_hi:[1,0,1]
    v_pk_fma_f32 v[46:47], v[44:45], v[86:87], v[46:47] op_sel:[1,1,0] op_sel_hi:[0,1,1] neg_lo:[0,1,0]
    v_pk_mul_f32 v[50:51], v[46:47], v[74:75] op_sel_hi:[1,0]
    v_pk_fma_f32 v[50:51], v[46:47], v[74:75], v[50:51] op_sel:[1,1,0] op_sel_hi:[0,1,1] neg_lo:[0,1,0]
    buffer_store_dwordx4 v[120:123], v30, s[20:23], s42 offen offset:0 sc1
    v_cvt_pk_bf16_f32 v134, v48, v50
    v_cvt_pk_bf16_f32 v142, v49, v51
    v_mov_b32_e64 v44, v222
    v_accvgpr_read_b32 v45, a46
    v_pk_fma_f32 v[44:45], v[46:47], v[86:87], v[44:45] op_sel_hi:[1,0,1]
    v_pk_fma_f32 v[44:45], v[46:47], v[86:87], v[44:45] op_sel:[1,1,0] op_sel_hi:[0,1,1] neg_lo:[0,1,0]
    buffer_store_dwordx4 v[124:127], v30, s[20:23], s42 offen offset:2048 sc1
    v_pk_mul_f32 v[48:49], v[44:45], v[74:75] op_sel_hi:[1,0]
    v_pk_fma_f32 v[48:49], v[44:45], v[74:75], v[48:49] op_sel:[1,1,0] op_sel_hi:[0,1,1] neg_lo:[0,1,0]
    v_mov_b32_e64 v46, v223
    v_accvgpr_read_b32 v47, a47
    v_pk_fma_f32 v[46:47], v[44:45], v[86:87], v[46:47] op_sel_hi:[1,0,1]
    v_pk_fma_f32 v[46:47], v[44:45], v[86:87], v[46:47] op_sel:[1,1,0] op_sel_hi:[0,1,1] neg_lo:[0,1,0]
    v_pk_mul_f32 v[50:51], v[46:47], v[74:75] op_sel_hi:[1,0]
    v_pk_fma_f32 v[50:51], v[46:47], v[74:75], v[50:51] op_sel:[1,1,0] op_sel_hi:[0,1,1] neg_lo:[0,1,0]
    v_cvt_pk_bf16_f32 v135, v48, v50
    v_cvt_pk_bf16_f32 v143, v49, v51
    s_cmp_eq_u64 s[30:31], 0
    s_cbranch_scc1 L_mid
    s_waitcnt vmcnt(8)
    v_cmp_ne_u64 vcc, s[48:49], v[26:27]
    s_nop 1
    s_mov_b64 s[30:31], vcc
    s_cbranch_vccnz L_mid
    s_add_u32 s85, s84, s80
    s_xor_b32 s80, s27, 0
    buffer_load_dwordx4 a[64:67], v9, s[20:23], s85 offen offset:0 sc1
    buffer_load_dwordx4 a[68:71], v9, s[20:23], s85 offen offset:1024 sc1
    buffer_load_dwordx4 a[72:75], v9, s[20:23], s85 offen offset:2048 sc1
    buffer_load_dwordx4 a[76:79], v9, s[20:23], s85 offen offset:3072 sc1
    s_add_u32 s85, s85, 4096
    buffer_load_dwordx4 a[80:83], v9, s[20:23], s85 offen offset:0 sc1
    buffer_load_dwordx4 a[84:87], v9, s[20:23], s85 offen offset:1024 sc1
    buffer_load_dwordx4 a[88:91], v9, s[20:23], s85 offen offset:2048 sc1
    buffer_load_dwordx4 a[92:95], v9, s[20:23], s85 offen offset:3072 sc1
    s_add_u32 s85, s84, s81
    s_xor_b32 s81, s27, 8192
    buffer_load_dwordx4 a[96:99], v9, s[20:23], s85 offen offset:0 sc1
    buffer_load_dwordx4 a[100:103], v9, s[20:23], s85 offen offset:1024 sc1
    buffer_load_dwordx4 a[104:107], v9, s[20:23], s85 offen offset:2048 sc1
    buffer_load_dwordx4 a[108:111], v9, s[20:23], s85 offen offset:3072 sc1
L_mid:
    v_mov_b32_e64 v44, v224
    v_accvgpr_read_b32 v45, a48
    v_pk_fma_f32 v[44:45], v[40:41], v[88:89], v[44:45] op_sel_hi:[1,0,1]
    v_pk_fma_f32 v[44:45], v[40:41], v[88:89], v[44:45] op_sel:[1,1,0] op_sel_hi:[0,1,1] neg_lo:[0,1,0]
    v_pk_mul_f32 v[48:49], v[44:45], v[76:77] op_sel_hi:[1,0]
    v_pk_fma_f32 v[48:49], v[44:45], v[76:77], v[48:49] op_sel:[1,1,0] op_sel_hi:[0,1,1] neg_lo:[0,1,0]
    ds_write_b128 v28, v[128:131] offset:4608
    v_mov_b32_e64 v46, v225
    v_accvgpr_read_b32 v47, a49
    v_pk_fma_f32 v[46:47], v[44:45], v[88:89], v[46:47] op_sel_hi:[1,0,1]
    v_pk_fma_f32 v[46:47], v[44:45], v[88:89], v[46:47] op_sel:[1,1,0] op_sel_hi:[0,1,1] neg_lo:[0,1,0]
    v_pk_mul_f32 v[50:51], v[46:47], v[76:77] op_sel_hi:[1,0]
    v_pk_fma_f32 v[50:51], v[46:47], v[76:77], v[50:51] op_sel:[1,1,0] op_sel_hi:[0,1,1] neg_lo:[0,1,0]
    ds_write_b128 v28, v[132:135] offset:4624
    v_cvt_pk_bf16_f32 v96, v48, v50
    v_cvt_pk_bf16_f32 v104, v49, v51
    v_mov_b32_e64 v44, v226
    v_accvgpr_read_b32 v45, a50
    v_pk_fma_f32 v[44:45], v[46:47], v[88:89], v[44:45] op_sel_hi:[1,0,1]
    v_pk_fma_f32 v[44:45], v[46:47], v[88:89], v[44:45] op_sel:[1,1,0] op_sel_hi:[0,1,1] neg_lo:[0,1,0]
    ds_write_b128 v28, v[136:139] offset:6912
    v_pk_mul_f32 v[48:49], v[44:45], v[76:77] op_sel_hi:[1,0]
    v_pk_fma_f32 v[48:49], v[44:45], v[76:77], v[48:49] op_sel:[1,1,0] op_sel_hi:[0,1,1] neg_lo:[0,1,0]
    v_mov_b32_e64 v46, v227
    v_accvgpr_read_b32 v47, a51
    v_pk_fma_f32 v[46:47], v[44:45], v[88:89], v[46:47] op_sel_hi:[1,0,1]
    v_pk_fma_f32 v[46:47], v[44:45], v[88:89], v[46:47] op_sel:[1,1,0] op_sel_hi:[0,1,1] neg_lo:[0,1,0]
    ds_write_b128 v28, v[140:143] offset:6928
    v_pk_mul_f32 v[50:51], v[46:47], v[76:77] op_sel_hi:[1,0]
    v_pk_fma_f32 v[50:51], v[46:47], v[76:77], v[50:51] op_sel:[1,1,0] op_sel_hi:[0,1,1] neg_lo:[0,1,0]
    v_cvt_pk_bf16_f32 v97, v48, v50
    v_cvt_pk_bf16_f32 v105, v49, v51
    v_mov_b32_e64 v44, v228
    v_accvgpr_read_b32 v45, a52
    ds_read_b64_tr_b16 v[144:145], v29 offset:4608
    v_pk_fma_f32 v[44:45], v[46:47], v[88:89], v[44:45] op_sel_hi:[1,0,1]
    v_pk_fma_f32 v[44:45], v[46:47], v[88:89], v[44:45] op_sel:[1,1,0] op_sel_hi:[0,1,1] neg_lo:[0,1,0]
    v_pk_mul_f32 v[48:49], v[44:45], v[76:77] op_sel_hi:[1,0]
    v_pk_fma_f32 v[48:49], v[44:45], v[76:77], v[48:49] op_sel:[1,1,0] op_sel_hi:[0,1,1] neg_lo:[0,1,0]
    v_mov_b32_e64 v46, v229
    v_accvgpr_read_b32 v47, a53
    ds_read_b64_tr_b16 v[146:147], v29 offset:5184
    v_pk_fma_f32 v[46:47], v[44:45], v[88:89], v[46:47] op_sel_hi:[1,0,1]
    v_pk_fma_f32 v[46:47], v[44:45], v[88:89], v[46:47] op_sel:[1,1,0] op_sel_hi:[0,1,1] neg_lo:[0,1,0]
    v_pk_mul_f32 v[50:51], v[46:47], v[76:77] op_sel_hi:[1,0]
    v_pk_fma_f32 v[50:51], v[46:47], v[76:77], v[50:51] op_sel:[1,1,0] op_sel_hi:[0,1,1] neg_lo:[0,1,0]
    v_cvt_pk_bf16_f32 v98, v48, v50
    v_cvt_pk_bf16_f32 v106, v49, v51
    ds_read_b64_tr_b16 v[148:149], v29 offset:4624
    v_mov_b32_e64 v44, v230
    v_accvgpr_read_b32 v45, a54
    v_pk_fma_f32 v[44:45], v[46:47], v[88:89], v[44:45] op_sel_hi:[1,0,1]
    v_pk_fma_f32 v[44:45], v[46:47], v[88:89], v[44:45] op_sel:[1,1,0] op_sel_hi:[0,1,1] neg_lo:[0,1,0]
    v_pk_mul_f32 v[48:49], v[44:45], v[76:77] op_sel_hi:[1,0]
    v_pk_fma_f32 v[48:49], v[44:45], v[76:77], v[48:49] op_sel:[1,1,0] op_sel_hi:[0,1,1] neg_lo:[0,1,0]
    ds_read_b64_tr_b16 v[150:151], v29 offset:5200
    v_mov_b32_e64 v46, v231
    v_accvgpr_read_b32 v47, a55
    v_pk_fma_f32 v[46:47], v[44:45], v[88:89], v[46:47] op_sel_hi:[1,0,1]
    v_pk_fma_f32 v[46:47], v[44:45], v[88:89], v[46:47] op_sel:[1,1,0] op_sel_hi:[0,1,1] neg_lo:[0,1,0]
    v_pk_mul_f32 v[50:51], v[46:47], v[76:77] op_sel_hi:[1,0]
    v_pk_fma_f32 v[50:51], v[46:47], v[76:77], v[50:51] op_sel:[1,1,0] op_sel_hi:[0,1,1] neg_lo:[0,1,0]
    ds_read_b64_tr_b16 v[152:153], v29 offset:6912
    v_cvt_pk_bf16_f32 v99, v48, v50
    v_cvt_pk_bf16_f32 v107, v49, v51
    v_mov_b32_e64 v44, v232
    v_accvgpr_read_b32 v45, a56
    v_pk_fma_f32 v[44:45], v[46:47], v[88:89], v[44:45] op_sel_hi:[1,0,1]
    v_pk_fma_f32 v[44:45], v[46:47], v[88:89], v[44:45] op_sel:[1,1,0] op_sel_hi:[0,1,1] neg_lo:[0,1,0]
    ds_read_b64_tr_b16 v[154:155], v29 offset:7488
    v_pk_mul_f32 v[48:49], v[44:45], v[76:77] op_sel_hi:[1,0]
    v_pk_fma_f32 v[48:49], v[44:45], v[76:77], v[48:49] op_sel:[1,1,0] op_sel_hi:[0,1,1] neg_lo:[0,1,0]
    v_mov_b32_e64 v46, v233
    v_accvgpr_read_b32 v47, a57
    v_pk_fma_f32 v[46:47], v[44:45], v[88:89], v[46:47] op_sel_hi:[1,0,1]
    v_pk_fma_f32 v[46:47], v[44:45], v[88:89], v[46:47] op_sel:[1,1,0] op_sel_hi:[0,1,1] neg_lo:[0,1,0]
    ds_read_b64_tr_b16 v[156:157], v29 offset:6928
    v_pk_mul_f32 v[50:51], v[46:47], v[76:77] op_sel_hi:[1,0]
    v_pk_fma_f32 v[50:51], v[46:47], v[76:77], v[50:51] op_sel:[1,1,0] op_sel_hi:[0,1,1] neg_lo:[0,1,0]
    v_cvt_pk_bf16_f32 v100, v48, v50
    v_cvt_pk_bf16_f32 v108, v49, v51
    v_mov_b32_e64 v44, v234
    v_accvgpr_read_b32 v45, a58
    ds_read_b64_tr_b16 v[158:159], v29 offset:7504
    v_pk_fma_f32 v[44:45], v[46:47], v[88:89], v[44:45] op_sel_hi:[1,0,1]
    v_pk_fma_f32 v[44:45], v[46:47], v[88:89], v[44:45] op_sel:[1,1,0] op_sel_hi:[0,1,1] neg_lo:[0,1,0]
    v_pk_mul_f32 v[48:49], v[44:45], v[76:77] op_sel_hi:[1,0]
    v_pk_fma_f32 v[48:49], v[44:45], v[76:77], v[48:49] op_sel:[1,1,0] op_sel_hi:[0,1,1] neg_lo:[0,1,0]
    v_mov_b32_e64 v46, v235
    v_accvgpr_read_b32 v47, a59
    s_add_u32 s42, s41, 3
    s_lshr_b32 s43, s42, 1
    s_lshl_b32 s43, s43, 12
    s_and_b32 s42, s42, 1
    s_lshl_b32 s42, s42, 9
    s_add_u32 s43, s43, s42
    s_add_u32 s43, s43, s40
    s_add_u32 s42, s43, 131072
    s_waitcnt lgkmcnt(0)
    v_pk_fma_f32 v[46:47], v[44:45], v[88:89], v[46:47] op_sel_hi:[1,0,1]
    v_pk_fma_f32 v[46:47], v[44:45], v[88:89], v[46:47] op_sel:[1,1,0] op_sel_hi:[0,1,1] neg_lo:[0,1,0]
    v_pk_mul_f32 v[50:51], v[46:47], v[76:77] op_sel_hi:[1,0]
    v_pk_fma_f32 v[50:51], v[46:47], v[76:77], v[50:51] op_sel:[1,1,0] op_sel_hi:[0,1,1] neg_lo:[0,1,0]
    v_cvt_pk_bf16_f32 v101, v48, v50
    v_cvt_pk_bf16_f32 v109, v49, v51
    buffer_store_dwordx4 v[144:147], v30, s[20:23], s43 offen offset:0 sc1
    v_mov_b32_e64 v44, v236
    v_accvgpr_read_b32 v45, a60
    v_pk_fma_f32 v[44:45], v[46:47], v[88:89], v[44:45] op_sel_hi:[1,0,1]
    v_pk_fma_f32 v[44:45], v[46:47], v[88:89], v[44:45] op_sel:[1,1,0] op_sel_hi:[0,1,1] neg_lo:[0,1,0]
    v_pk_mul_f32 v[48:49], v[44:45], v[76:77] op_sel_hi:[1,0]
    v_pk_fma_f32 v[48:49], v[44:45], v[76:77], v[48:49] op_sel:[1,1,0] op_sel_hi:[0,1,1] neg_lo:[0,1,0]
    buffer_store_dwordx4 v[148:151], v30, s[20:23], s43 offen offset:2048 sc1
    v_mov_b32_e64 v46, v237
    v_accvgpr_read_b32 v47, a61
    v_pk_fma_f32 v[46:47], v[44:45], v[88:89], v[46:47] op_sel_hi:[1,0,1]
    v_pk_fma_f32 v[46:47], v[44:45], v[88:89], v[46:47] op_sel:[1,1,0] op_sel_hi:[0,1,1] neg_lo:[0,1,0]
    v_pk_mul_f32 v[50:51], v[46:47], v[76:77] op_sel_hi:[1,0]
    v_pk_fma_f32 v[50:51], v[46:47], v[76:77], v[50:51] op_sel:[1,1,0] op_sel_hi:[0,1,1] neg_lo:[0,1,0]
    buffer_store_dwordx4 v[152:155], v30, s[20:23], s42 offen offset:0 sc1
    v_cvt_pk_bf16_f32 v102, v48, v50
    v_cvt_pk_bf16_f32 v110, v49, v51
    v_mov_b32_e64 v44, v238
    v_accvgpr_read_b32 v45, a62
    v_pk_fma_f32 v[44:45], v[46:47], v[88:89], v[44:45] op_sel_hi:[1,0,1]
    v_pk_fma_f32 v[44:45], v[46:47], v[88:89], v[44:45] op_sel:[1,1,0] op_sel_hi:[0,1,1] neg_lo:[0,1,0]
    buffer_store_dwordx4 v[156:159], v30, s[20:23], s42 offen offset:2048 sc1
    v_pk_mul_f32 v[48:49], v[44:45], v[76:77] op_sel_hi:[1,0]
    v_pk_fma_f32 v[48:49], v[44:45], v[76:77], v[48:49] op_sel:[1,1,0] op_sel_hi:[0,1,1] neg_lo:[0,1,0]
    v_mov_b32_e64 v46, v239
    v_accvgpr_read_b32 v47, a63
    v_pk_fma_f32 v[46:47], v[44:45], v[88:89], v[46:47] op_sel_hi:[1,0,1]
    v_pk_fma_f32 v[46:47], v[44:45], v[88:89], v[46:47] op_sel:[1,1,0] op_sel_hi:[0,1,1] neg_lo:[0,1,0]
    v_pk_mul_f32 v[50:51], v[46:47], v[76:77] op_sel_hi:[1,0]
    v_pk_fma_f32 v[50:51], v[46:47], v[76:77], v[50:51] op_sel:[1,1,0] op_sel_hi:[0,1,1] neg_lo:[0,1,0]
    v_cvt_pk_bf16_f32 v103, v48, v50
    v_cvt_pk_bf16_f32 v111, v49, v51
    ds_write_b128 v28, v[96:99] offset:0
    ds_write_b128 v28, v[100:103] offset:16
    ds_write_b128 v28, v[104:107] offset:2304
    ds_write_b128 v28, v[108:111] offset:2320
    ds_read_b64_tr_b16 v[112:113], v29 offset:0
    ds_read_b64_tr_b16 v[114:115], v29 offset:576
    ds_read_b64_tr_b16 v[116:117], v29 offset:16
    ds_read_b64_tr_b16 v[118:119], v29 offset:592
    ds_read_b64_tr_b16 v[120:121], v29 offset:2304
    ds_read_b64_tr_b16 v[122:123], v29 offset:2880
    ds_read_b64_tr_b16 v[124:125], v29 offset:2320
    ds_read_b64_tr_b16 v[126:127], v29 offset:2896
    s_add_u32 s42, s41, 4
    s_lshr_b32 s43, s42, 1
    s_lshl_b32 s43, s43, 12
    s_and_b32 s42, s42, 1
    s_lshl_b32 s42, s42, 9
    s_add_u32 s43, s43, s42
    s_add_u32 s43, s43, s40
    s_add_u32 s42, s43, 131072
    s_waitcnt lgkmcnt(0)
    buffer_store_dwordx4 v[112:115], v30, s[20:23], s43 offen offset:0 sc1
    buffer_store_dwordx4 v[116:119], v30, s[20:23], s43 offen offset:2048 sc1
    buffer_store_dwordx4 v[120:123], v30, s[20:23], s42 offen offset:0 sc1
    buffer_store_dwordx4 v[124:127], v30, s[20:23], s42 offen offset:2048 sc1
    s_xor_b32 s16, s79, 0
    s_lshl_b32 s16, s16, 7
    s_xor_b32 s17, s79, 1
    s_lshl_b32 s17, s17, 7
    s_xor_b32 s18, s79, 2
    s_lshl_b32 s18, s18, 7
    s_xor_b32 s19, s79, 3
    s_lshl_b32 s19, s19, 7
    s_lshl_b32 s3, s61, 18
    s_lshl_b32 s4, s63, 17
    s_add_u32 s3, s3, s4
    v_lshrrev_b32 v44, 4, v18
    v_and_b32 v45, 7, v18
    v_xor_b32 v45, v45, v44
    v_lshrrev_b32 v46, 3, v18
    v_lshlrev_b32 v46, 11, v46
    v_add_u32_e64 v46, s3, v46
    v_lshl_add_u32 v44, v45, 4, v46
    v_xor_b32_e64 v45, 4, v45
    v_lshl_add_u32 v45, v45, 4, v46
    v_add_u32_e64 v32, 0, v44
    v_add_u32 v33, 15360, v45
    v_add_u32 v34, 30720, v44
    v_add_u32 v35, 46080, v45
    v_add_u32 v36, 65536, v44
    v_add_u32 v37, 80896, v45
    v_add_u32 v38, 96256, v44
    v_add_u32 v39, 111616, v45
    s_mov_b32 s91, 0
    s_mov_b32 s8, s52
    s_mov_b32 s9, s53
    s_mov_b32 s10, 2097152
    s_mov_b32 s11, 0x00020000
    s_lshl_b32 s92, s65, 1
    s_add_u32 s92, s92, s62
    s_lshl_b32 s92, s92, 17
    s_add_u32 s92, s92, 18874368
    v_and_b32 v44, 15, v18
    v_lshrrev_b32 v45, 1, v44
    v_lshrrev_b32 v46, 4, v18
    v_xor_b32 v45, v45, v46
    v_lshlrev_b32_e64 v45, 4, v45
    v_lshl_add_u32 v44, v44, 7, v45
    s_mul_i32 s3, s62, 73728
    v_add_u32 v40, s3, v44
    v_xor_b32 v41, 64, v40
    v_xor_b32 v42, 8192, v40
    v_xor_b32 v43, 8192, v41
    ds_read_b64_tr_b16 a[0:1], v10 offset:0
    ds_read_b64_tr_b16 a[2:3], v10 offset:1024
    ds_read_b64_tr_b16 a[4:5], v10 offset:8192
    ds_read_b64_tr_b16 a[6:7], v10 offset:9216
    ds_read_b64_tr_b16 a[8:9], v11 offset:0
    ds_read_b64_tr_b16 a[10:11], v11 offset:1024
    ds_read_b64_tr_b16 a[12:13], v11 offset:8192
    ds_read_b64_tr_b16 a[14:15], v11 offset:9216
    ds_read_b64_tr_b16 a[16:17], v12 offset:0
    ds_read_b64_tr_b16 a[18:19], v12 offset:1024
    ds_read_b64_tr_b16 a[20:21], v12 offset:8192
    ds_read_b64_tr_b16 a[22:23], v12 offset:9216
    ds_read_b64_tr_b16 a[24:25], v13 offset:0
    ds_read_b64_tr_b16 a[26:27], v13 offset:1024
    ds_read_b64_tr_b16 a[28:29], v13 offset:8192
    ds_read_b64_tr_b16 a[30:31], v13 offset:9216
    s_cmp_eq_u64 s[30:31], 0
    s_cbranch_scc1 L_haveflB
    buffer_load_dwordx2 v[26:27], v92, s[20:23], s90 offen sc1
    s_mov_b32 s55, 0x40000
    s_waitcnt vmcnt(0)
L_wchB:
    v_cmp_ne_u64 vcc, s[48:49], v[26:27]
    s_cbranch_vccz L_gchB
    s_sleep 1
    buffer_load_dwordx2 v[26:27], v92, s[20:23], s90 offen sc1
    s_waitcnt vmcnt(0)
    s_sub_u32 s55, s55, 1
    s_cmp_lg_u32 s55, 0
    s_cbranch_scc1 L_wchB
L_gchB:
    s_add_u32 s85, s84, s80
    s_xor_b32 s80, s27, 0
    buffer_load_dwordx4 a[64:67], v9, s[20:23], s85 offen offset:0 sc1
    buffer_load_dwordx4 a[68:71], v9, s[20:23], s85 offen offset:1024 sc1
    buffer_load_dwordx4 a[72:75], v9, s[20:23], s85 offen offset:2048 sc1
    buffer_load_dwordx4 a[76:79], v9, s[20:23], s85 offen offset:3072 sc1
    s_add_u32 s85, s85, 4096
    buffer_load_dwordx4 a[80:83], v9, s[20:23], s85 offen offset:0 sc1
    buffer_load_dwordx4 a[84:87], v9, s[20:23], s85 offen offset:1024 sc1
    buffer_load_dwordx4 a[88:91], v9, s[20:23], s85 offen offset:2048 sc1
    buffer_load_dwordx4 a[92:95], v9, s[20:23], s85 offen offset:3072 sc1
    s_add_u32 s85, s84, s81
    s_xor_b32 s81, s27, 8192
    buffer_load_dwordx4 a[96:99], v9, s[20:23], s85 offen offset:0 sc1
    buffer_load_dwordx4 a[100:103], v9, s[20:23], s85 offen offset:1024 sc1
    buffer_load_dwordx4 a[104:107], v9, s[20:23], s85 offen offset:2048 sc1
    buffer_load_dwordx4 a[108:111], v9, s[20:23], s85 offen offset:3072 sc1
    s_waitcnt vmcnt(0)
L_haveflB:
    s_waitcnt vmcnt(8)
    s_branch L_k3_ssm
L_k3_code:
L_k3_ffn:
    s_mov_b32 s90, s28
    s_mov_b32 s35, 0
    s_waitcnt lgkmcnt(0)
    s_barrier
    s_waitcnt vmcnt(12) lgkmcnt(4)
    v_mfma_f32_16x16x32_bf16 v[128:131], a[64:67], a[0:3], 0
    s_add_u32 s85, s85, 4096
    v_mfma_f32_16x16x32_bf16 v[128:131], a[80:83], a[4:7], v[128:131]
    buffer_load_dwordx4 a[112:115], v9, s[20:23], s85 offen offset:0 sc1
    v_mfma_f32_16x16x32_bf16 v[132:135], a[84:87], a[4:7], 0
    v_mfma_f32_16x16x32_bf16 v[132:135], a[68:71], a[0:3], v[132:135]
    v_mfma_f32_16x16x32_bf16 v[136:139], a[72:75], a[0:3], 0
    v_mfma_f32_16x16x32_bf16 v[136:139], a[88:91], a[4:7], v[136:139]
    buffer_load_dwordx4 a[116:119], v9, s[20:23], s85 offen offset:1024 sc1
    v_mfma_f32_16x16x32_bf16 v[140:143], a[92:95], a[4:7], 0
    ds_read_b64_tr_b16 a[4:5], v14 offset:8192
    v_mfma_f32_16x16x32_bf16 v[140:143], a[76:79], a[0:3], v[140:143]
    ds_read_b64_tr_b16 a[6:7], v14 offset:9216
    v_mfma_f32_16x16x32_bf16 v[156:159], a[76:79], a[8:11], 0
    ds_read_b64_tr_b16 a[0:1], v14 offset:0
    v_mfma_f32_16x16x32_bf16 v[156:159], a[92:95], a[12:15], v[156:159]
    ds_read_b64_tr_b16 a[2:3], v14 offset:1024
    buffer_load_dwordx4 a[120:123], v9, s[20:23], s85 offen offset:2048 sc1
    v_mfma_f32_16x16x32_bf16 v[152:155], a[88:91], a[12:15], 0
    v_mfma_f32_16x16x32_bf16 v[152:155], a[72:75], a[8:11], v[152:155]
    v_mfma_f32_16x16x32_bf16 v[148:151], a[68:71], a[8:11], 0
    v_mfma_f32_16x16x32_bf16 v[148:151], a[84:87], a[12:15], v[148:151]
    buffer_load_dwordx4 a[124:127], v9, s[20:23], s85 offen offset:3072 sc1
    v_mfma_f32_16x16x32_bf16 v[144:147], a[80:83], a[12:15], 0
    ds_read_b64_tr_b16 a[12:13], v15 offset:8192
    v_mfma_f32_16x16x32_bf16 v[144:147], a[64:67], a[8:11], v[144:147]
    ds_read_b64_tr_b16 a[14:15], v15 offset:9216
    v_mfma_f32_16x16x32_bf16 v[160:163], a[64:67], a[16:19], 0
    ds_read_b64_tr_b16 a[8:9], v15 offset:0
    s_add_u32 m0, s76, 36864
    v_mfma_f32_16x16x32_bf16 v[160:163], a[80:83], a[20:23], v[160:163]
    ds_read_b64_tr_b16 a[10:11], v15 offset:1024
    buffer_load_dwordx4 v5, s[68:71], s78 offen offset:0 lds
    v_mfma_f32_16x16x32_bf16 v[164:167], a[84:87], a[20:23], 0
    v_mfma_f32_16x16x32_bf16 v[164:167], a[68:71], a[16:19], v[164:167]
    v_mfma_f32_16x16x32_bf16 v[168:171], a[72:75], a[16:19], 0
    v_mfma_f32_16x16x32_bf16 v[168:171], a[88:91], a[20:23], v[168:171]
    buffer_load_dwordx4 v6, s[68:71], s78 offen offset:1024 lds
    v_mfma_f32_16x16x32_bf16 v[172:175], a[92:95], a[20:23], 0
    ds_read_b64_tr_b16 a[20:21], v16 offset:8192
    v_mfma_f32_16x16x32_bf16 v[172:175], a[76:79], a[16:19], v[172:175]
    ds_read_b64_tr_b16 a[22:23], v16 offset:9216
    s_waitcnt lgkmcnt(4)
    v_mfma_f32_16x16x32_bf16 v[188:191], a[76:79], a[24:27], 0
    ds_read_b64_tr_b16 a[16:17], v16 offset:0
    v_mfma_f32_16x16x32_bf16 v[188:191], a[92:95], a[28:31], v[188:191]
    ds_read_b64_tr_b16 a[18:19], v16 offset:1024
    buffer_load_dwordx4 v7, s[68:71], s78 offen offset:2048 lds
    v_mfma_f32_16x16x32_bf16 v[184:187], a[88:91], a[28:31], 0
    v_mfma_f32_16x16x32_bf16 v[184:187], a[72:75], a[24:27], v[184:187]
    v_mfma_f32_16x16x32_bf16 v[180:183], a[68:71], a[24:27], 0
    v_mfma_f32_16x16x32_bf16 v[180:183], a[84:87], a[28:31], v[180:183]
    buffer_load_dwordx4 v8, s[68:71], s78 offen offset:3072 lds
    v_mfma_f32_16x16x32_bf16 v[176:179], a[80:83], a[28:31], 0
    ds_read_b64_tr_b16 a[28:29], v17 offset:8192
    v_mfma_f32_16x16x32_bf16 v[176:179], a[64:67], a[24:27], v[176:179]
    ds_read_b64_tr_b16 a[30:31], v17 offset:9216
    ds_read_b64_tr_b16 a[24:25], v17 offset:0
    ds_read_b64_tr_b16 a[26:27], v17 offset:1024
    v_mfma_f32_16x16x32_bf16 v[192:195], a[64:67], a[0:3], 0
    s_add_u32 s85, s84, s82
    s_xor_b32 s82, s27, 32768
    v_mfma_f32_16x16x32_bf16 v[192:195], a[80:83], a[4:7], v[192:195]
    buffer_load_dwordx4 a[128:131], v9, s[20:23], s85 offen offset:0 sc1
    v_mfma_f32_16x16x32_bf16 v[196:199], a[84:87], a[4:7], 0
    v_mfma_f32_16x16x32_bf16 v[196:199], a[68:71], a[0:3], v[196:199]
    v_mfma_f32_16x16x32_bf16 v[200:203], a[72:75], a[0:3], 0
    v_mfma_f32_16x16x32_bf16 v[200:203], a[88:91], a[4:7], v[200:203]
    buffer_load_dwordx4 a[132:135], v9, s[20:23], s85 offen offset:1024 sc1
    v_mfma_f32_16x16x32_bf16 v[204:207], a[92:95], a[4:7], 0
    v_mfma_f32_16x16x32_bf16 v[204:207], a[76:79], a[0:3], v[204:207]
    s_waitcnt vmcnt(18)
    s_waitcnt lgkmcnt(0)
    s_barrier
    ds_read_b64_tr_b16 a[4:5], v10 offset:24576
    v_mfma_f32_16x16x32_bf16 v[220:223], a[76:79], a[8:11], 0
    ds_read_b64_tr_b16 a[6:7], v10 offset:25600
    v_mfma_f32_16x16x32_bf16 v[220:223], a[92:95], a[12:15], v[220:223]
    ds_read_b64_tr_b16 a[0:1], v10 offset:16384
    buffer_load_dwordx4 a[136:139], v9, s[20:23], s85 offen offset:2048 sc1
    v_mfma_f32_16x16x32_bf16 v[216:219], a[88:91], a[12:15], 0
    ds_read_b64_tr_b16 a[2:3], v10 offset:17408
    v_mfma_f32_16x16x32_bf16 v[216:219], a[72:75], a[8:11], v[216:219]
    v_mfma_f32_16x16x32_bf16 v[212:215], a[68:71], a[8:11], 0
    v_mfma_f32_16x16x32_bf16 v[212:215], a[84:87], a[12:15], v[212:215]
    buffer_load_dwordx4 a[140:143], v9, s[20:23], s85 offen offset:3072 sc1
    v_mfma_f32_16x16x32_bf16 v[208:211], a[80:83], a[12:15], 0
    ds_read_b64_tr_b16 a[12:13], v11 offset:24576
    v_mfma_f32_16x16x32_bf16 v[208:211], a[64:67], a[8:11], v[208:211]
    ds_read_b64_tr_b16 a[14:15], v11 offset:25600
    v_mfma_f32_16x16x32_bf16 v[224:227], a[64:67], a[16:19], 0
    ds_read_b64_tr_b16 a[8:9], v11 offset:16384
    s_add_u32 s78, s77, s75
    s_xor_b32 s75, s54, 786432
    s_add_u32 m0, s76, 49152
    v_mfma_f32_16x16x32_bf16 v[224:227], a[80:83], a[20:23], v[224:227]
    ds_read_b64_tr_b16 a[10:11], v11 offset:17408
    buffer_load_dwordx4 v1, s[68:71], s78 offen offset:0 lds
    v_mfma_f32_16x16x32_bf16 v[228:231], a[84:87], a[20:23], 0
    v_mfma_f32_16x16x32_bf16 v[228:231], a[68:71], a[16:19], v[228:231]
    v_mfma_f32_16x16x32_bf16 v[232:235], a[72:75], a[16:19], 0
    v_mfma_f32_16x16x32_bf16 v[232:235], a[88:91], a[20:23], v[232:235]
    buffer_load_dwordx4 v2, s[68:71], s78 offen offset:1024 lds
    v_mfma_f32_16x16x32_bf16 v[236:239], a[92:95], a[20:23], 0
    ds_read_b64_tr_b16 a[20:21], v12 offset:24576
    v_mfma_f32_16x16x32_bf16 v[236:239], a[76:79], a[16:19], v[236:239]
    ds_read_b64_tr_b16 a[22:23], v12 offset:25600
    v_mfma_f32_16x16x32_bf16 v[252:255], a[76:79], a[24:27], 0
    ds_read_b64_tr_b16 a[16:17], v12 offset:16384
    v_mfma_f32_16x16x32_bf16 v[252:255], a[92:95], a[28:31], v[252:255]
    ds_read_b64_tr_b16 a[18:19], v12 offset:17408
    buffer_load_dwordx4 v3, s[68:71], s78 offen offset:2048 lds
    v_mfma_f32_16x16x32_bf16 v[248:251], a[88:91], a[28:31], 0
    v_mfma_f32_16x16x32_bf16 v[248:251], a[72:75], a[24:27], v[248:251]
    v_mfma_f32_16x16x32_bf16 v[244:247], a[68:71], a[24:27], 0
    v_mfma_f32_16x16x32_bf16 v[244:247], a[84:87], a[28:31], v[244:247]
    buffer_load_dwordx4 v4, s[68:71], s78 offen offset:3072 lds
    v_mfma_f32_16x16x32_bf16 v[240:243], a[80:83], a[28:31], 0
    ds_read_b64_tr_b16 a[28:29], v13 offset:24576
    v_mfma_f32_16x16x32_bf16 v[240:243], a[64:67], a[24:27], v[240:243]
    ds_read_b64_tr_b16 a[30:31], v13 offset:25600
    ds_read_b64_tr_b16 a[24:25], v13 offset:16384
    ds_read_b64_tr_b16 a[26:27], v13 offset:17408
    s_waitcnt vmcnt(12) lgkmcnt(4)
    v_mfma_f32_16x16x32_bf16 v[128:131], a[96:99], a[0:3], v[128:131]
    v_mfma_f32_16x16x32_bf16 v[128:131], a[112:115], a[4:7], v[128:131]
    s_mov_b64 exec, 1
    buffer_store_dwordx2 a[248:249], off, s[20:23], s33 sc1
    s_mov_b64 exec, -1
    v_mfma_f32_16x16x32_bf16 v[132:135], a[116:119], a[4:7], v[132:135]
    v_mfma_f32_16x16x32_bf16 v[132:135], a[100:103], a[0:3], v[132:135]
    s_add_u32 s85, s85, 4096
    v_mfma_f32_16x16x32_bf16 v[136:139], a[104:107], a[0:3], v[136:139]
    buffer_load_dwordx4 a[144:147], v9, s[20:23], s85 offen offset:0 sc1
    v_mfma_f32_16x16x32_bf16 v[136:139], a[120:123], a[4:7], v[136:139]
    v_mfma_f32_16x16x32_bf16 v[140:143], a[124:127], a[4:7], v[140:143]
    ds_read_b64_tr_b16 a[4:5], v14 offset:24576
    v_mfma_f32_16x16x32_bf16 v[140:143], a[108:111], a[0:3], v[140:143]
    ds_read_b64_tr_b16 a[6:7], v14 offset:25600
    v_mfma_f32_16x16x32_bf16 v[156:159], a[108:111], a[8:11], v[156:159]
    ds_read_b64_tr_b16 a[0:1], v14 offset:16384
    buffer_load_dwordx4 a[148:151], v9, s[20:23], s85 offen offset:1024 sc1
    v_mfma_f32_16x16x32_bf16 v[156:159], a[124:127], a[12:15], v[156:159]
    ds_read_b64_tr_b16 a[2:3], v14 offset:17408
    v_mfma_f32_16x16x32_bf16 v[152:155], a[120:123], a[12:15], v[152:155]
    v_mfma_f32_16x16x32_bf16 v[152:155], a[104:107], a[8:11], v[152:155]
    buffer_load_dwordx4 a[152:155], v9, s[20:23], s85 offen offset:2048 sc1
    v_mfma_f32_16x16x32_bf16 v[148:151], a[100:103], a[8:11], v[148:151]
    v_mfma_f32_16x16x32_bf16 v[148:151], a[116:119], a[12:15], v[148:151]
    v_mfma_f32_16x16x32_bf16 v[144:147], a[112:115], a[12:15], v[144:147]
    ds_read_b64_tr_b16 a[12:13], v15 offset:24576
    v_mfma_f32_16x16x32_bf16 v[144:147], a[96:99], a[8:11], v[144:147]
    ds_read_b64_tr_b16 a[14:15], v15 offset:25600
    buffer_load_dwordx4 a[156:159], v9, s[20:23], s85 offen offset:3072 sc1
    v_mfma_f32_16x16x32_bf16 v[160:163], a[96:99], a[16:19], v[160:163]
    ds_read_b64_tr_b16 a[8:9], v15 offset:16384
    v_mfma_f32_16x16x32_bf16 v[160:163], a[112:115], a[20:23], v[160:163]
    ds_read_b64_tr_b16 a[10:11], v15 offset:17408
    s_add_u32 m0, s76, 53248
    v_mfma_f32_16x16x32_bf16 v[164:167], a[116:119], a[20:23], v[164:167]
    buffer_load_dwordx4 v5, s[68:71], s78 offen offset:0 lds
    v_mfma_f32_16x16x32_bf16 v[164:167], a[100:103], a[16:19], v[164:167]
    v_mfma_f32_16x16x32_bf16 v[168:171], a[104:107], a[16:19], v[168:171]
    v_mfma_f32_16x16x32_bf16 v[168:171], a[120:123], a[20:23], v[168:171]
    v_mfma_f32_16x16x32_bf16 v[172:175], a[124:127], a[20:23], v[172:175]
    ds_read_b64_tr_b16 a[20:21], v16 offset:24576
    buffer_load_dwordx4 v6, s[68:71], s78 offen offset:1024 lds
    v_mfma_f32_16x16x32_bf16 v[172:175], a[108:111], a[16:19], v[172:175]
    ds_read_b64_tr_b16 a[22:23], v16 offset:25600
    s_waitcnt lgkmcnt(4)
    v_mfma_f32_16x16x32_bf16 v[188:191], a[108:111], a[24:27], v[188:191]
    ds_read_b64_tr_b16 a[16:17], v16 offset:16384
    v_mfma_f32_16x16x32_bf16 v[188:191], a[124:127], a[28:31], v[188:191]
    ds_read_b64_tr_b16 a[18:19], v16 offset:17408
    buffer_load_dwordx4 v7, s[68:71], s78 offen offset:2048 lds
    v_mfma_f32_16x16x32_bf16 v[184:187], a[120:123], a[28:31], v[184:187]
    v_mfma_f32_16x16x32_bf16 v[184:187], a[104:107], a[24:27], v[184:187]
    v_mfma_f32_16x16x32_bf16 v[180:183], a[100:103], a[24:27], v[180:183]
    v_mfma_f32_16x16x32_bf16 v[180:183], a[116:119], a[28:31], v[180:183]
    buffer_load_dwordx4 v8, s[68:71], s78 offen offset:3072 lds
    v_mfma_f32_16x16x32_bf16 v[176:179], a[112:115], a[28:31], v[176:179]
    ds_read_b64_tr_b16 a[28:29], v17 offset:24576
    s_and_b32 s77, s32, 63
    s_lshl_b32 s77, s77, 17
    s_lshr_b32 s32, s32, 6
    v_mfma_f32_16x16x32_bf16 v[176:179], a[96:99], a[24:27], v[176:179]
    ds_read_b64_tr_b16 a[30:31], v17 offset:25600
    ds_read_b64_tr_b16 a[24:25], v17 offset:16384
    ds_read_b64_tr_b16 a[26:27], v17 offset:17408
    v_mfma_f32_16x16x32_bf16 v[192:195], a[96:99], a[0:3], v[192:195]
    s_add_u32 s85, s84, s83
    s_xor_b32 s83, s27, 49152
    v_mfma_f32_16x16x32_bf16 v[192:195], a[112:115], a[4:7], v[192:195]
    buffer_load_dwordx4 a[32:35], v9, s[20:23], s85 offen offset:0 sc1
    v_mfma_f32_16x16x32_bf16 v[196:199], a[116:119], a[4:7], v[196:199]
    v_mfma_f32_16x16x32_bf16 v[196:199], a[100:103], a[0:3], v[196:199]
    v_mfma_f32_16x16x32_bf16 v[200:203], a[104:107], a[0:3], v[200:203]
    v_mfma_f32_16x16x32_bf16 v[200:203], a[120:123], a[4:7], v[200:203]
    buffer_load_dwordx4 a[36:39], v9, s[20:23], s85 offen offset:1024 sc1
    v_mfma_f32_16x16x32_bf16 v[204:207], a[124:127], a[4:7], v[204:207]
    v_mfma_f32_16x16x32_bf16 v[204:207], a[108:111], a[0:3], v[204:207]
    s_waitcnt vmcnt(19)
    s_waitcnt lgkmcnt(0)
    s_barrier
    ds_read_b64_tr_b16 a[4:5], v10 offset:40960
    v_mfma_f32_16x16x32_bf16 v[220:223], a[108:111], a[8:11], v[220:223]
    ds_read_b64_tr_b16 a[6:7], v10 offset:41984
    v_mfma_f32_16x16x32_bf16 v[220:223], a[124:127], a[12:15], v[220:223]
    ds_read_b64_tr_b16 a[0:1], v10 offset:32768
    buffer_load_dwordx4 a[40:43], v9, s[20:23], s85 offen offset:2048 sc1
    v_mfma_f32_16x16x32_bf16 v[216:219], a[120:123], a[12:15], v[216:219]
    ds_read_b64_tr_b16 a[2:3], v10 offset:33792
    v_mfma_f32_16x16x32_bf16 v[216:219], a[104:107], a[8:11], v[216:219]
    v_mfma_f32_16x16x32_bf16 v[212:215], a[100:103], a[8:11], v[212:215]
    v_mfma_f32_16x16x32_bf16 v[212:215], a[116:119], a[12:15], v[212:215]
    buffer_load_dwordx4 a[44:47], v9, s[20:23], s85 offen offset:3072 sc1
    v_mfma_f32_16x16x32_bf16 v[208:211], a[112:115], a[12:15], v[208:211]
    ds_read_b64_tr_b16 a[12:13], v11 offset:40960
    v_mfma_f32_16x16x32_bf16 v[208:211], a[96:99], a[8:11], v[208:211]
    ds_read_b64_tr_b16 a[14:15], v11 offset:41984
    v_mfma_f32_16x16x32_bf16 v[224:227], a[96:99], a[16:19], v[224:227]
    ds_read_b64_tr_b16 a[8:9], v11 offset:32768
    s_add_u32 s78, s77, s72
    s_xor_b32 s72, s54, 0
    s_add_u32 m0, s76, 0
    v_mfma_f32_16x16x32_bf16 v[224:227], a[112:115], a[20:23], v[224:227]
    ds_read_b64_tr_b16 a[10:11], v11 offset:33792
    buffer_load_dwordx4 v1, s[68:71], s78 offen offset:0 lds
    v_mfma_f32_16x16x32_bf16 v[228:231], a[116:119], a[20:23], v[228:231]
    v_mfma_f32_16x16x32_bf16 v[228:231], a[100:103], a[16:19], v[228:231]
    v_mfma_f32_16x16x32_bf16 v[232:235], a[104:107], a[16:19], v[232:235]
    v_mfma_f32_16x16x32_bf16 v[232:235], a[120:123], a[20:23], v[232:235]
    buffer_load_dwordx4 v2, s[68:71], s78 offen offset:1024 lds
    v_mfma_f32_16x16x32_bf16 v[236:239], a[124:127], a[20:23], v[236:239]
    ds_read_b64_tr_b16 a[20:21], v12 offset:40960
    v_mfma_f32_16x16x32_bf16 v[236:239], a[108:111], a[16:19], v[236:239]
    ds_read_b64_tr_b16 a[22:23], v12 offset:41984
    v_mfma_f32_16x16x32_bf16 v[252:255], a[108:111], a[24:27], v[252:255]
    ds_read_b64_tr_b16 a[16:17], v12 offset:32768
    v_mfma_f32_16x16x32_bf16 v[252:255], a[124:127], a[28:31], v[252:255]
    ds_read_b64_tr_b16 a[18:19], v12 offset:33792
    buffer_load_dwordx4 v3, s[68:71], s78 offen offset:2048 lds
    v_mfma_f32_16x16x32_bf16 v[248:251], a[120:123], a[28:31], v[248:251]
    v_mfma_f32_16x16x32_bf16 v[248:251], a[104:107], a[24:27], v[248:251]
    v_mfma_f32_16x16x32_bf16 v[244:247], a[100:103], a[24:27], v[244:247]
    v_mfma_f32_16x16x32_bf16 v[244:247], a[116:119], a[28:31], v[244:247]
    buffer_load_dwordx4 v4, s[68:71], s78 offen offset:3072 lds
    v_mfma_f32_16x16x32_bf16 v[240:243], a[112:115], a[28:31], v[240:243]
    ds_read_b64_tr_b16 a[28:29], v13 offset:40960
    v_mfma_f32_16x16x32_bf16 v[240:243], a[96:99], a[24:27], v[240:243]
    ds_read_b64_tr_b16 a[30:31], v13 offset:41984
    ds_read_b64_tr_b16 a[24:25], v13 offset:32768
    ds_read_b64_tr_b16 a[26:27], v13 offset:33792
    s_waitcnt vmcnt(12) lgkmcnt(4)
    v_mfma_f32_16x16x32_bf16 v[128:131], a[128:131], a[0:3], v[128:131]
    s_add_u32 s85, s85, 4096
    v_mfma_f32_16x16x32_bf16 v[128:131], a[144:147], a[4:7], v[128:131]
    buffer_load_dwordx4 a[48:51], v9, s[20:23], s85 offen offset:0 sc1
    v_mfma_f32_16x16x32_bf16 v[132:135], a[148:151], a[4:7], v[132:135]
    v_mfma_f32_16x16x32_bf16 v[132:135], a[132:135], a[0:3], v[132:135]
    v_mfma_f32_16x16x32_bf16 v[136:139], a[136:139], a[0:3], v[136:139]
    v_mfma_f32_16x16x32_bf16 v[136:139], a[152:155], a[4:7], v[136:139]
    buffer_load_dwordx4 a[52:55], v9, s[20:23], s85 offen offset:1024 sc1
    v_mfma_f32_16x16x32_bf16 v[140:143], a[156:159], a[4:7], v[140:143]
    ds_read_b64_tr_b16 a[4:5], v14 offset:40960
    v_mfma_f32_16x16x32_bf16 v[140:143], a[140:143], a[0:3], v[140:143]
    ds_read_b64_tr_b16 a[6:7], v14 offset:41984
    v_mfma_f32_16x16x32_bf16 v[156:159], a[140:143], a[8:11], v[156:159]
    ds_read_b64_tr_b16 a[0:1], v14 offset:32768
    v_mfma_f32_16x16x32_bf16 v[156:159], a[156:159], a[12:15], v[156:159]
    ds_read_b64_tr_b16 a[2:3], v14 offset:33792
    buffer_load_dwordx4 a[56:59], v9, s[20:23], s85 offen offset:2048 sc1
    v_mfma_f32_16x16x32_bf16 v[152:155], a[152:155], a[12:15], v[152:155]
    v_mfma_f32_16x16x32_bf16 v[152:155], a[136:139], a[8:11], v[152:155]
    v_mfma_f32_16x16x32_bf16 v[148:151], a[132:135], a[8:11], v[148:151]
    v_mfma_f32_16x16x32_bf16 v[148:151], a[148:151], a[12:15], v[148:151]
    buffer_load_dwordx4 a[60:63], v9, s[20:23], s85 offen offset:3072 sc1
    v_mfma_f32_16x16x32_bf16 v[144:147], a[144:147], a[12:15], v[144:147]
    ds_read_b64_tr_b16 a[12:13], v15 offset:40960
    v_mfma_f32_16x16x32_bf16 v[144:147], a[128:131], a[8:11], v[144:147]
    ds_read_b64_tr_b16 a[14:15], v15 offset:41984
    v_mfma_f32_16x16x32_bf16 v[160:163], a[128:131], a[16:19], v[160:163]
    ds_read_b64_tr_b16 a[8:9], v15 offset:32768
    s_and_b32 s84, s29, 63
    s_lshl_b32 s84, s84, 13
    s_add_u32 s84, s84, s92
    s_lshr_b32 s29, s29, 6
    s_add_u32 m0, s76, 4096
    v_mfma_f32_16x16x32_bf16 v[160:163], a[144:147], a[20:23], v[160:163]
    ds_read_b64_tr_b16 a[10:11], v15 offset:33792
    buffer_load_dwordx4 v5, s[68:71], s78 offen offset:0 lds
    v_mfma_f32_16x16x32_bf16 v[164:167], a[148:151], a[20:23], v[164:167]
    v_mfma_f32_16x16x32_bf16 v[164:167], a[132:135], a[16:19], v[164:167]
    v_mfma_f32_16x16x32_bf16 v[168:171], a[136:139], a[16:19], v[168:171]
    v_mfma_f32_16x16x32_bf16 v[168:171], a[152:155], a[20:23], v[168:171]
    buffer_load_dwordx4 v6, s[68:71], s78 offen offset:1024 lds
    v_mfma_f32_16x16x32_bf16 v[172:175], a[156:159], a[20:23], v[172:175]
    ds_read_b64_tr_b16 a[20:21], v16 offset:40960
    v_mfma_f32_16x16x32_bf16 v[172:175], a[140:143], a[16:19], v[172:175]
    ds_read_b64_tr_b16 a[22:23], v16 offset:41984
    s_waitcnt lgkmcnt(4)
    v_mfma_f32_16x16x32_bf16 v[188:191], a[140:143], a[24:27], v[188:191]
    ds_read_b64_tr_b16 a[16:17], v16 offset:32768
    v_mfma_f32_16x16x32_bf16 v[188:191], a[156:159], a[28:31], v[188:191]
    ds_read_b64_tr_b16 a[18:19], v16 offset:33792
    buffer_load_dwordx4 v7, s[68:71], s78 offen offset:2048 lds
    v_mfma_f32_16x16x32_bf16 v[184:187], a[152:155], a[28:31], v[184:187]
    v_mfma_f32_16x16x32_bf16 v[184:187], a[136:139], a[24:27], v[184:187]
    v_mfma_f32_16x16x32_bf16 v[180:183], a[132:135], a[24:27], v[180:183]
    v_mfma_f32_16x16x32_bf16 v[180:183], a[148:151], a[28:31], v[180:183]
    buffer_load_dwordx4 v8, s[68:71], s78 offen offset:3072 lds
    v_mfma_f32_16x16x32_bf16 v[176:179], a[144:147], a[28:31], v[176:179]
    ds_read_b64_tr_b16 a[28:29], v17 offset:40960
    v_mfma_f32_16x16x32_bf16 v[176:179], a[128:131], a[24:27], v[176:179]
    ds_read_b64_tr_b16 a[30:31], v17 offset:41984
    ds_read_b64_tr_b16 a[24:25], v17 offset:32768
    ds_read_b64_tr_b16 a[26:27], v17 offset:33792
    v_mfma_f32_16x16x32_bf16 v[192:195], a[128:131], a[0:3], v[192:195]
    s_add_u32 s85, s84, s80
    s_xor_b32 s80, s27, 0
    v_mfma_f32_16x16x32_bf16 v[192:195], a[144:147], a[4:7], v[192:195]
    buffer_load_dwordx4 a[64:67], v9, s[20:23], s85 offen offset:0 sc1
    v_mfma_f32_16x16x32_bf16 v[196:199], a[148:151], a[4:7], v[196:199]
    v_mfma_f32_16x16x32_bf16 v[196:199], a[132:135], a[0:3], v[196:199]
    v_mfma_f32_16x16x32_bf16 v[200:203], a[136:139], a[0:3], v[200:203]
    buffer_load_dwordx4 a[68:71], v9, s[20:23], s85 offen offset:1024 sc1
    v_mfma_f32_16x16x32_bf16 v[200:203], a[152:155], a[4:7], v[200:203]
    v_mfma_f32_16x16x32_bf16 v[204:207], a[156:159], a[4:7], v[204:207]
    v_mfma_f32_16x16x32_bf16 v[204:207], a[140:143], a[0:3], v[204:207]
    s_waitcnt vmcnt(18)
    s_waitcnt lgkmcnt(0)
    s_barrier
    ds_read_b64_tr_b16 a[4:5], v10 offset:57344
    v_mfma_f32_16x16x32_bf16 v[220:223], a[140:143], a[8:11], v[220:223]
    ds_read_b64_tr_b16 a[6:7], v10 offset:58368
    buffer_load_dwordx4 a[72:75], v9, s[20:23], s85 offen offset:2048 sc1
    v_mfma_f32_16x16x32_bf16 v[220:223], a[156:159], a[12:15], v[220:223]
    ds_read_b64_tr_b16 a[0:1], v10 offset:49152
    v_mfma_f32_16x16x32_bf16 v[216:219], a[152:155], a[12:15], v[216:219]
    ds_read_b64_tr_b16 a[2:3], v10 offset:50176
    v_mfma_f32_16x16x32_bf16 v[216:219], a[136:139], a[8:11], v[216:219]
    buffer_load_dwordx4 a[76:79], v9, s[20:23], s85 offen offset:3072 sc1
    v_mfma_f32_16x16x32_bf16 v[212:215], a[132:135], a[8:11], v[212:215]
    v_mfma_f32_16x16x32_bf16 v[212:215], a[148:151], a[12:15], v[212:215]
    v_mfma_f32_16x16x32_bf16 v[208:211], a[144:147], a[12:15], v[208:211]
    ds_read_b64_tr_b16 a[12:13], v11 offset:57344
    s_add_u32 s78, s77, s73
    s_xor_b32 s73, s54, 262144
    s_add_u32 m0, s76, 16384
    v_mfma_f32_16x16x32_bf16 v[208:211], a[128:131], a[8:11], v[208:211]
    ds_read_b64_tr_b16 a[14:15], v11 offset:58368
    buffer_load_dwordx4 v1, s[68:71], s78 offen offset:0 lds
    v_mfma_f32_16x16x32_bf16 v[224:227], a[128:131], a[16:19], v[224:227]
    ds_read_b64_tr_b16 a[8:9], v11 offset:49152
    v_mfma_f32_16x16x32_bf16 v[224:227], a[144:147], a[20:23], v[224:227]
    ds_read_b64_tr_b16 a[10:11], v11 offset:50176
    v_mfma_f32_16x16x32_bf16 v[228:231], a[148:151], a[20:23], v[228:231]
    buffer_load_dwordx4 v2, s[68:71], s78 offen offset:1024 lds
    v_mfma_f32_16x16x32_bf16 v[228:231], a[132:135], a[16:19], v[228:231]
    v_mfma_f32_16x16x32_bf16 v[232:235], a[136:139], a[16:19], v[232:235]
    v_mfma_f32_16x16x32_bf16 v[232:235], a[152:155], a[20:23], v[232:235]
    v_mfma_f32_16x16x32_bf16 v[236:239], a[156:159], a[20:23], v[236:239]
    ds_read_b64_tr_b16 a[20:21], v12 offset:57344
    buffer_load_dwordx4 v3, s[68:71], s78 offen offset:2048 lds
    v_mfma_f32_16x16x32_bf16 v[236:239], a[140:143], a[16:19], v[236:239]
    ds_read_b64_tr_b16 a[22:23], v12 offset:58368
    v_mfma_f32_16x16x32_bf16 v[252:255], a[140:143], a[24:27], v[252:255]
    ds_read_b64_tr_b16 a[16:17], v12 offset:49152
    v_mfma_f32_16x16x32_bf16 v[252:255], a[156:159], a[28:31], v[252:255]
    ds_read_b64_tr_b16 a[18:19], v12 offset:50176
    buffer_load_dwordx4 v4, s[68:71], s78 offen offset:3072 lds
    v_mfma_f32_16x16x32_bf16 v[248:251], a[152:155], a[28:31], v[248:251]
    v_mfma_f32_16x16x32_bf16 v[248:251], a[136:139], a[24:27], v[248:251]
    v_mfma_f32_16x16x32_bf16 v[244:247], a[132:135], a[24:27], v[244:247]
    v_mfma_f32_16x16x32_bf16 v[244:247], a[148:151], a[28:31], v[244:247]
    buffer_load_dwordx2 v[46:47], v92, s[20:23], s90 offen sc1
    v_mfma_f32_16x16x32_bf16 v[240:243], a[144:147], a[28:31], v[240:243]
    ds_read_b64_tr_b16 a[28:29], v13 offset:57344
    v_mfma_f32_16x16x32_bf16 v[240:243], a[128:131], a[24:27], v[240:243]
    ds_read_b64_tr_b16 a[30:31], v13 offset:58368
    ds_read_b64_tr_b16 a[24:25], v13 offset:49152
    ds_read_b64_tr_b16 a[26:27], v13 offset:50176
    s_waitcnt vmcnt(13) lgkmcnt(4)
    v_mfma_f32_16x16x32_bf16 v[128:131], a[32:35], a[0:3], v[128:131]
    s_add_u32 s85, s85, 4096
    v_mfma_f32_16x16x32_bf16 v[128:131], a[48:51], a[4:7], v[128:131]
    buffer_load_dwordx4 a[80:83], v9, s[20:23], s85 offen offset:0 sc1
    v_mfma_f32_16x16x32_bf16 v[132:135], a[52:55], a[4:7], v[132:135]
    v_mfma_f32_16x16x32_bf16 v[132:135], a[36:39], a[0:3], v[132:135]
    v_mfma_f32_16x16x32_bf16 v[136:139], a[40:43], a[0:3], v[136:139]
    v_mfma_f32_16x16x32_bf16 v[136:139], a[56:59], a[4:7], v[136:139]
    buffer_load_dwordx4 a[84:87], v9, s[20:23], s85 offen offset:1024 sc1
    v_mfma_f32_16x16x32_bf16 v[140:143], a[60:63], a[4:7], v[140:143]
    ds_read_b64_tr_b16 a[4:5], v14 offset:57344
    v_mfma_f32_16x16x32_bf16 v[140:143], a[44:47], a[0:3], v[140:143]
    ds_read_b64_tr_b16 a[6:7], v14 offset:58368
    v_mfma_f32_16x16x32_bf16 v[156:159], a[44:47], a[8:11], v[156:159]
    ds_read_b64_tr_b16 a[0:1], v14 offset:49152
    v_mfma_f32_16x16x32_bf16 v[156:159], a[60:63], a[12:15], v[156:159]
    ds_read_b64_tr_b16 a[2:3], v14 offset:50176
    buffer_load_dwordx4 a[88:91], v9, s[20:23], s85 offen offset:2048 sc1
    v_mfma_f32_16x16x32_bf16 v[152:155], a[56:59], a[12:15], v[152:155]
    v_mfma_f32_16x16x32_bf16 v[152:155], a[40:43], a[8:11], v[152:155]
    v_mfma_f32_16x16x32_bf16 v[148:151], a[36:39], a[8:11], v[148:151]
    v_mfma_f32_16x16x32_bf16 v[148:151], a[52:55], a[12:15], v[148:151]
    buffer_load_dwordx4 a[92:95], v9, s[20:23], s85 offen offset:3072 sc1
    v_mfma_f32_16x16x32_bf16 v[144:147], a[48:51], a[12:15], v[144:147]
    ds_read_b64_tr_b16 a[12:13], v15 offset:57344
    v_mfma_f32_16x16x32_bf16 v[144:147], a[32:35], a[8:11], v[144:147]
    ds_read_b64_tr_b16 a[14:15], v15 offset:58368
    v_mfma_f32_16x16x32_bf16 v[160:163], a[32:35], a[16:19], v[160:163]
    ds_read_b64_tr_b16 a[8:9], v15 offset:49152
    s_add_u32 m0, s76, 20480
    v_mfma_f32_16x16x32_bf16 v[160:163], a[48:51], a[20:23], v[160:163]
    ds_read_b64_tr_b16 a[10:11], v15 offset:50176
    buffer_load_dwordx4 v5, s[68:71], s78 offen offset:0 lds
    v_mfma_f32_16x16x32_bf16 v[164:167], a[52:55], a[20:23], v[164:167]
    v_mfma_f32_16x16x32_bf16 v[164:167], a[36:39], a[16:19], v[164:167]
    v_mfma_f32_16x16x32_bf16 v[168:171], a[40:43], a[16:19], v[168:171]
    v_mfma_f32_16x16x32_bf16 v[168:171], a[56:59], a[20:23], v[168:171]
    buffer_load_dwordx4 v6, s[68:71], s78 offen offset:1024 lds
    v_mfma_f32_16x16x32_bf16 v[172:175], a[60:63], a[20:23], v[172:175]
    ds_read_b64_tr_b16 a[20:21], v16 offset:57344
    v_mfma_f32_16x16x32_bf16 v[172:175], a[44:47], a[16:19], v[172:175]
    ds_read_b64_tr_b16 a[22:23], v16 offset:58368
    s_waitcnt lgkmcnt(4)
    v_mfma_f32_16x16x32_bf16 v[188:191], a[44:47], a[24:27], v[188:191]
    ds_read_b64_tr_b16 a[16:17], v16 offset:49152
    v_mfma_f32_16x16x32_bf16 v[188:191], a[60:63], a[28:31], v[188:191]
    ds_read_b64_tr_b16 a[18:19], v16 offset:50176
    buffer_load_dwordx4 v7, s[68:71], s78 offen offset:2048 lds
    v_mfma_f32_16x16x32_bf16 v[184:187], a[56:59], a[28:31], v[184:187]
    v_mfma_f32_16x16x32_bf16 v[184:187], a[40:43], a[24:27], v[184:187]
    v_mfma_f32_16x16x32_bf16 v[180:183], a[36:39], a[24:27], v[180:183]
    v_mfma_f32_16x16x32_bf16 v[180:183], a[52:55], a[28:31], v[180:183]
    buffer_load_dwordx4 v8, s[68:71], s78 offen offset:3072 lds
    v_mfma_f32_16x16x32_bf16 v[176:179], a[48:51], a[28:31], v[176:179]
    ds_read_b64_tr_b16 a[28:29], v17 offset:57344
    v_mfma_f32_16x16x32_bf16 v[176:179], a[32:35], a[24:27], v[176:179]
    ds_read_b64_tr_b16 a[30:31], v17 offset:58368
    ds_read_b64_tr_b16 a[24:25], v17 offset:49152
    ds_read_b64_tr_b16 a[26:27], v17 offset:50176
    v_mfma_f32_16x16x32_bf16 v[192:195], a[32:35], a[0:3], v[192:195]
    s_add_u32 s85, s84, s81
    s_xor_b32 s81, s27, 16384
    v_mfma_f32_16x16x32_bf16 v[192:195], a[48:51], a[4:7], v[192:195]
    buffer_load_dwordx4 a[96:99], v9, s[20:23], s85 offen offset:0 sc1
    v_mfma_f32_16x16x32_bf16 v[196:199], a[52:55], a[4:7], v[196:199]
    v_mfma_f32_16x16x32_bf16 v[196:199], a[36:39], a[0:3], v[196:199]
    v_mfma_f32_16x16x32_bf16 v[200:203], a[40:43], a[0:3], v[200:203]
    v_mfma_f32_16x16x32_bf16 v[200:203], a[56:59], a[4:7], v[200:203]
    buffer_load_dwordx4 a[100:103], v9, s[20:23], s85 offen offset:1024 sc1
    v_mfma_f32_16x16x32_bf16 v[204:207], a[60:63], a[4:7], v[204:207]
    v_mfma_f32_16x16x32_bf16 v[204:207], a[44:47], a[0:3], v[204:207]
    s_waitcnt vmcnt(19)
    s_waitcnt lgkmcnt(0)
    s_barrier
    ds_read_b64_tr_b16 a[4:5], v10 offset:8192
    v_mfma_f32_16x16x32_bf16 v[220:223], a[44:47], a[8:11], v[220:223]
    ds_read_b64_tr_b16 a[6:7], v10 offset:9216
    v_mfma_f32_16x16x32_bf16 v[220:223], a[60:63], a[12:15], v[220:223]
    ds_read_b64_tr_b16 a[0:1], v10 offset:0
    buffer_load_dwordx4 a[104:107], v9, s[20:23], s85 offen offset:2048 sc1
    v_mfma_f32_16x16x32_bf16 v[216:219], a[56:59], a[12:15], v[216:219]
    ds_read_b64_tr_b16 a[2:3], v10 offset:1024
    v_mfma_f32_16x16x32_bf16 v[216:219], a[40:43], a[8:11], v[216:219]
    v_mfma_f32_16x16x32_bf16 v[212:215], a[36:39], a[8:11], v[212:215]
    v_mfma_f32_16x16x32_bf16 v[212:215], a[52:55], a[12:15], v[212:215]
    buffer_load_dwordx4 a[108:111], v9, s[20:23], s85 offen offset:3072 sc1
    v_mfma_f32_16x16x32_bf16 v[208:211], a[48:51], a[12:15], v[208:211]
    ds_read_b64_tr_b16 a[12:13], v11 offset:8192
    v_mfma_f32_16x16x32_bf16 v[208:211], a[32:35], a[8:11], v[208:211]
    ds_read_b64_tr_b16 a[14:15], v11 offset:9216
    v_mfma_f32_16x16x32_bf16 v[224:227], a[32:35], a[16:19], v[224:227]
    ds_read_b64_tr_b16 a[8:9], v11 offset:0
    s_add_u32 s78, s77, s74
    s_xor_b32 s74, s54, 524288
    s_add_u32 m0, s76, 32768
    v_mfma_f32_16x16x32_bf16 v[224:227], a[48:51], a[20:23], v[224:227]
    ds_read_b64_tr_b16 a[10:11], v11 offset:1024
    buffer_load_dwordx4 v1, s[68:71], s78 offen offset:0 lds
    v_mfma_f32_16x16x32_bf16 v[228:231], a[52:55], a[20:23], v[228:231]
    v_mfma_f32_16x16x32_bf16 v[228:231], a[36:39], a[16:19], v[228:231]
    v_mfma_f32_16x16x32_bf16 v[232:235], a[40:43], a[16:19], v[232:235]
    v_mfma_f32_16x16x32_bf16 v[232:235], a[56:59], a[20:23], v[232:235]
    buffer_load_dwordx4 v2, s[68:71], s78 offen offset:1024 lds
    v_mfma_f32_16x16x32_bf16 v[236:239], a[60:63], a[20:23], v[236:239]
    ds_read_b64_tr_b16 a[20:21], v12 offset:8192
    v_mfma_f32_16x16x32_bf16 v[236:239], a[44:47], a[16:19], v[236:239]
    ds_read_b64_tr_b16 a[22:23], v12 offset:9216
    v_mfma_f32_16x16x32_bf16 v[252:255], a[44:47], a[24:27], v[252:255]
    ds_read_b64_tr_b16 a[16:17], v12 offset:0
    v_mfma_f32_16x16x32_bf16 v[252:255], a[60:63], a[28:31], v[252:255]
    ds_read_b64_tr_b16 a[18:19], v12 offset:1024
    buffer_load_dwordx4 v3, s[68:71], s78 offen offset:2048 lds
    v_mfma_f32_16x16x32_bf16 v[248:251], a[56:59], a[28:31], v[248:251]
    v_mfma_f32_16x16x32_bf16 v[248:251], a[40:43], a[24:27], v[248:251]
    v_mfma_f32_16x16x32_bf16 v[244:247], a[36:39], a[24:27], v[244:247]
    v_mfma_f32_16x16x32_bf16 v[244:247], a[52:55], a[28:31], v[244:247]
    buffer_load_dwordx4 v4, s[68:71], s78 offen offset:3072 lds
    v_mfma_f32_16x16x32_bf16 v[240:243], a[48:51], a[28:31], v[240:243]
    ds_read_b64_tr_b16 a[28:29], v13 offset:8192
    v_mfma_f32_16x16x32_bf16 v[240:243], a[32:35], a[24:27], v[240:243]
    ds_read_b64_tr_b16 a[30:31], v13 offset:9216
    ds_read_b64_tr_b16 a[24:25], v13 offset:0
    ds_read_b64_tr_b16 a[26:27], v13 offset:1024
    s_mov_b32 s35, 1
    s_mov_b32 s55, 0x40000
    s_waitcnt vmcnt(16)
L_k3_o3:
    v_cmp_ne_u64 vcc, s[48:49], v[46:47]
    s_cbranch_vccnz L_k3_o2
    .p2align 6
L_k3_ffn_loop:
    s_waitcnt vmcnt(12) lgkmcnt(4)
    v_mfma_f32_16x16x32_bf16 v[128:131], a[64:67], a[0:3], v[128:131]
    s_add_u32 s85, s85, 4096
    v_mfma_f32_16x16x32_bf16 v[128:131], a[80:83], a[4:7], v[128:131]
    buffer_load_dwordx4 a[112:115], v9, s[20:23], s85 offen offset:0 sc1
    v_mfma_f32_16x16x32_bf16 v[132:135], a[84:87], a[4:7], v[132:135]
    v_mfma_f32_16x16x32_bf16 v[132:135], a[68:71], a[0:3], v[132:135]
    v_mfma_f32_16x16x32_bf16 v[136:139], a[72:75], a[0:3], v[136:139]
    v_mfma_f32_16x16x32_bf16 v[136:139], a[88:91], a[4:7], v[136:139]
    buffer_load_dwordx4 a[116:119], v9, s[20:23], s85 offen offset:1024 sc1
    v_mfma_f32_16x16x32_bf16 v[140:143], a[92:95], a[4:7], v[140:143]
    ds_read_b64_tr_b16 a[4:5], v14 offset:8192
    v_mfma_f32_16x16x32_bf16 v[140:143], a[76:79], a[0:3], v[140:143]
    ds_read_b64_tr_b16 a[6:7], v14 offset:9216
    v_mfma_f32_16x16x32_bf16 v[156:159], a[76:79], a[8:11], v[156:159]
    ds_read_b64_tr_b16 a[0:1], v14 offset:0
    v_mfma_f32_16x16x32_bf16 v[156:159], a[92:95], a[12:15], v[156:159]
    ds_read_b64_tr_b16 a[2:3], v14 offset:1024
    buffer_load_dwordx4 a[120:123], v9, s[20:23], s85 offen offset:2048 sc1
    v_mfma_f32_16x16x32_bf16 v[152:155], a[88:91], a[12:15], v[152:155]
    v_mfma_f32_16x16x32_bf16 v[152:155], a[72:75], a[8:11], v[152:155]
    v_mfma_f32_16x16x32_bf16 v[148:151], a[68:71], a[8:11], v[148:151]
    v_mfma_f32_16x16x32_bf16 v[148:151], a[84:87], a[12:15], v[148:151]
    buffer_load_dwordx4 a[124:127], v9, s[20:23], s85 offen offset:3072 sc1
    v_mfma_f32_16x16x32_bf16 v[144:147], a[80:83], a[12:15], v[144:147]
    ds_read_b64_tr_b16 a[12:13], v15 offset:8192
    v_mfma_f32_16x16x32_bf16 v[144:147], a[64:67], a[8:11], v[144:147]
    ds_read_b64_tr_b16 a[14:15], v15 offset:9216
    v_mfma_f32_16x16x32_bf16 v[160:163], a[64:67], a[16:19], v[160:163]
    ds_read_b64_tr_b16 a[8:9], v15 offset:0
    s_add_u32 m0, s76, 36864
    v_mfma_f32_16x16x32_bf16 v[160:163], a[80:83], a[20:23], v[160:163]
    ds_read_b64_tr_b16 a[10:11], v15 offset:1024
    buffer_load_dwordx4 v5, s[68:71], s78 offen offset:0 lds
    v_mfma_f32_16x16x32_bf16 v[164:167], a[84:87], a[20:23], v[164:167]
    v_mfma_f32_16x16x32_bf16 v[164:167], a[68:71], a[16:19], v[164:167]
    v_mfma_f32_16x16x32_bf16 v[168:171], a[72:75], a[16:19], v[168:171]
    v_mfma_f32_16x16x32_bf16 v[168:171], a[88:91], a[20:23], v[168:171]
    buffer_load_dwordx4 v6, s[68:71], s78 offen offset:1024 lds
    v_mfma_f32_16x16x32_bf16 v[172:175], a[92:95], a[20:23], v[172:175]
    ds_read_b64_tr_b16 a[20:21], v16 offset:8192
    v_mfma_f32_16x16x32_bf16 v[172:175], a[76:79], a[16:19], v[172:175]
    ds_read_b64_tr_b16 a[22:23], v16 offset:9216
    s_waitcnt lgkmcnt(4)
    v_mfma_f32_16x16x32_bf16 v[188:191], a[76:79], a[24:27], v[188:191]
    ds_read_b64_tr_b16 a[16:17], v16 offset:0
    v_mfma_f32_16x16x32_bf16 v[188:191], a[92:95], a[28:31], v[188:191]
    ds_read_b64_tr_b16 a[18:19], v16 offset:1024
    buffer_load_dwordx4 v7, s[68:71], s78 offen offset:2048 lds
    v_mfma_f32_16x16x32_bf16 v[184:187], a[88:91], a[28:31], v[184:187]
    v_mfma_f32_16x16x32_bf16 v[184:187], a[72:75], a[24:27], v[184:187]
    v_mfma_f32_16x16x32_bf16 v[180:183], a[68:71], a[24:27], v[180:183]
    v_mfma_f32_16x16x32_bf16 v[180:183], a[84:87], a[28:31], v[180:183]
    buffer_load_dwordx4 v8, s[68:71], s78 offen offset:3072 lds
    v_mfma_f32_16x16x32_bf16 v[176:179], a[80:83], a[28:31], v[176:179]
    ds_read_b64_tr_b16 a[28:29], v17 offset:8192
    v_mfma_f32_16x16x32_bf16 v[176:179], a[64:67], a[24:27], v[176:179]
    ds_read_b64_tr_b16 a[30:31], v17 offset:9216
    ds_read_b64_tr_b16 a[24:25], v17 offset:0
    ds_read_b64_tr_b16 a[26:27], v17 offset:1024
    v_mfma_f32_16x16x32_bf16 v[192:195], a[64:67], a[0:3], v[192:195]
    s_add_u32 s85, s84, s82
    s_xor_b32 s82, s27, 32768
    v_mfma_f32_16x16x32_bf16 v[192:195], a[80:83], a[4:7], v[192:195]
    buffer_load_dwordx4 a[128:131], v9, s[20:23], s85 offen offset:0 sc1
    v_mfma_f32_16x16x32_bf16 v[196:199], a[84:87], a[4:7], v[196:199]
    v_mfma_f32_16x16x32_bf16 v[196:199], a[68:71], a[0:3], v[196:199]
    v_mfma_f32_16x16x32_bf16 v[200:203], a[72:75], a[0:3], v[200:203]
    v_mfma_f32_16x16x32_bf16 v[200:203], a[88:91], a[4:7], v[200:203]
    buffer_load_dwordx4 a[132:135], v9, s[20:23], s85 offen offset:1024 sc1
    v_mfma_f32_16x16x32_bf16 v[204:207], a[92:95], a[4:7], v[204:207]
    v_mfma_f32_16x16x32_bf16 v[204:207], a[76:79], a[0:3], v[204:207]
    s_waitcnt vmcnt(18)
    s_waitcnt lgkmcnt(0)
    s_barrier
    ds_read_b64_tr_b16 a[4:5], v10 offset:24576
    v_mfma_f32_16x16x32_bf16 v[220:223], a[76:79], a[8:11], v[220:223]
    ds_read_b64_tr_b16 a[6:7], v10 offset:25600
    v_mfma_f32_16x16x32_bf16 v[220:223], a[92:95], a[12:15], v[220:223]
    ds_read_b64_tr_b16 a[0:1], v10 offset:16384
    buffer_load_dwordx4 a[136:139], v9, s[20:23], s85 offen offset:2048 sc1
    v_mfma_f32_16x16x32_bf16 v[216:219], a[88:91], a[12:15], v[216:219]
    ds_read_b64_tr_b16 a[2:3], v10 offset:17408
    v_mfma_f32_16x16x32_bf16 v[216:219], a[72:75], a[8:11], v[216:219]
    v_mfma_f32_16x16x32_bf16 v[212:215], a[68:71], a[8:11], v[212:215]
    v_mfma_f32_16x16x32_bf16 v[212:215], a[84:87], a[12:15], v[212:215]
    buffer_load_dwordx4 a[140:143], v9, s[20:23], s85 offen offset:3072 sc1
    v_mfma_f32_16x16x32_bf16 v[208:211], a[80:83], a[12:15], v[208:211]
    ds_read_b64_tr_b16 a[12:13], v11 offset:24576
    v_mfma_f32_16x16x32_bf16 v[208:211], a[64:67], a[8:11], v[208:211]
    ds_read_b64_tr_b16 a[14:15], v11 offset:25600
    v_mfma_f32_16x16x32_bf16 v[224:227], a[64:67], a[16:19], v[224:227]
    ds_read_b64_tr_b16 a[8:9], v11 offset:16384
    s_add_u32 s78, s77, s75
    s_xor_b32 s75, s54, 786432
    s_add_u32 m0, s76, 49152
    v_mfma_f32_16x16x32_bf16 v[224:227], a[80:83], a[20:23], v[224:227]
    ds_read_b64_tr_b16 a[10:11], v11 offset:17408
    buffer_load_dwordx4 v1, s[68:71], s78 offen offset:0 lds
    v_mfma_f32_16x16x32_bf16 v[228:231], a[84:87], a[20:23], v[228:231]
    v_mfma_f32_16x16x32_bf16 v[228:231], a[68:71], a[16:19], v[228:231]
    v_mfma_f32_16x16x32_bf16 v[232:235], a[72:75], a[16:19], v[232:235]
    v_mfma_f32_16x16x32_bf16 v[232:235], a[88:91], a[20:23], v[232:235]
    buffer_load_dwordx4 v2, s[68:71], s78 offen offset:1024 lds
    v_mfma_f32_16x16x32_bf16 v[236:239], a[92:95], a[20:23], v[236:239]
    ds_read_b64_tr_b16 a[20:21], v12 offset:24576
    v_mfma_f32_16x16x32_bf16 v[236:239], a[76:79], a[16:19], v[236:239]
    ds_read_b64_tr_b16 a[22:23], v12 offset:25600
    v_mfma_f32_16x16x32_bf16 v[252:255], a[76:79], a[24:27], v[252:255]
    ds_read_b64_tr_b16 a[16:17], v12 offset:16384
    v_mfma_f32_16x16x32_bf16 v[252:255], a[92:95], a[28:31], v[252:255]
    ds_read_b64_tr_b16 a[18:19], v12 offset:17408
    buffer_load_dwordx4 v3, s[68:71], s78 offen offset:2048 lds
    v_mfma_f32_16x16x32_bf16 v[248:251], a[88:91], a[28:31], v[248:251]
    v_mfma_f32_16x16x32_bf16 v[248:251], a[72:75], a[24:27], v[248:251]
    v_mfma_f32_16x16x32_bf16 v[244:247], a[68:71], a[24:27], v[244:247]
    v_mfma_f32_16x16x32_bf16 v[244:247], a[84:87], a[28:31], v[244:247]
    buffer_load_dwordx4 v4, s[68:71], s78 offen offset:3072 lds
    v_mfma_f32_16x16x32_bf16 v[240:243], a[80:83], a[28:31], v[240:243]
    ds_read_b64_tr_b16 a[28:29], v13 offset:24576
    v_mfma_f32_16x16x32_bf16 v[240:243], a[64:67], a[24:27], v[240:243]
    ds_read_b64_tr_b16 a[30:31], v13 offset:25600
    ds_read_b64_tr_b16 a[24:25], v13 offset:16384
    ds_read_b64_tr_b16 a[26:27], v13 offset:17408
    s_waitcnt vmcnt(12) lgkmcnt(4)
    v_mfma_f32_16x16x32_bf16 v[128:131], a[96:99], a[0:3], v[128:131]
    s_add_u32 s85, s85, 4096
    v_mfma_f32_16x16x32_bf16 v[128:131], a[112:115], a[4:7], v[128:131]
    buffer_load_dwordx4 a[144:147], v9, s[20:23], s85 offen offset:0 sc1
    v_mfma_f32_16x16x32_bf16 v[132:135], a[116:119], a[4:7], v[132:135]
    v_mfma_f32_16x16x32_bf16 v[132:135], a[100:103], a[0:3], v[132:135]
    v_mfma_f32_16x16x32_bf16 v[136:139], a[104:107], a[0:3], v[136:139]
    v_mfma_f32_16x16x32_bf16 v[136:139], a[120:123], a[4:7], v[136:139]
    buffer_load_dwordx4 a[148:151], v9, s[20:23], s85 offen offset:1024 sc1
    v_mfma_f32_16x16x32_bf16 v[140:143], a[124:127], a[4:7], v[140:143]
    ds_read_b64_tr_b16 a[4:5], v14 offset:24576
    v_mfma_f32_16x16x32_bf16 v[140:143], a[108:111], a[0:3], v[140:143]
    ds_read_b64_tr_b16 a[6:7], v14 offset:25600
    v_mfma_f32_16x16x32_bf16 v[156:159], a[108:111], a[8:11], v[156:159]
    ds_read_b64_tr_b16 a[0:1], v14 offset:16384
    v_mfma_f32_16x16x32_bf16 v[156:159], a[124:127], a[12:15], v[156:159]
    ds_read_b64_tr_b16 a[2:3], v14 offset:17408
    buffer_load_dwordx4 a[152:155], v9, s[20:23], s85 offen offset:2048 sc1
    v_mfma_f32_16x16x32_bf16 v[152:155], a[120:123], a[12:15], v[152:155]
    v_mfma_f32_16x16x32_bf16 v[152:155], a[104:107], a[8:11], v[152:155]
    v_mfma_f32_16x16x32_bf16 v[148:151], a[100:103], a[8:11], v[148:151]
    v_mfma_f32_16x16x32_bf16 v[148:151], a[116:119], a[12:15], v[148:151]
    buffer_load_dwordx4 a[156:159], v9, s[20:23], s85 offen offset:3072 sc1
    v_mfma_f32_16x16x32_bf16 v[144:147], a[112:115], a[12:15], v[144:147]
    ds_read_b64_tr_b16 a[12:13], v15 offset:24576
    v_mfma_f32_16x16x32_bf16 v[144:147], a[96:99], a[8:11], v[144:147]
    ds_read_b64_tr_b16 a[14:15], v15 offset:25600
    v_mfma_f32_16x16x32_bf16 v[160:163], a[96:99], a[16:19], v[160:163]
    ds_read_b64_tr_b16 a[8:9], v15 offset:16384
    s_add_u32 m0, s76, 53248
    v_mfma_f32_16x16x32_bf16 v[160:163], a[112:115], a[20:23], v[160:163]
    ds_read_b64_tr_b16 a[10:11], v15 offset:17408
    buffer_load_dwordx4 v5, s[68:71], s78 offen offset:0 lds
    v_mfma_f32_16x16x32_bf16 v[164:167], a[116:119], a[20:23], v[164:167]
    v_mfma_f32_16x16x32_bf16 v[164:167], a[100:103], a[16:19], v[164:167]
    v_mfma_f32_16x16x32_bf16 v[168:171], a[104:107], a[16:19], v[168:171]
    v_mfma_f32_16x16x32_bf16 v[168:171], a[120:123], a[20:23], v[168:171]
    buffer_load_dwordx4 v6, s[68:71], s78 offen offset:1024 lds
    v_mfma_f32_16x16x32_bf16 v[172:175], a[124:127], a[20:23], v[172:175]
    ds_read_b64_tr_b16 a[20:21], v16 offset:24576
    v_mfma_f32_16x16x32_bf16 v[172:175], a[108:111], a[16:19], v[172:175]
    ds_read_b64_tr_b16 a[22:23], v16 offset:25600
    s_waitcnt lgkmcnt(4)
    v_mfma_f32_16x16x32_bf16 v[188:191], a[108:111], a[24:27], v[188:191]
    ds_read_b64_tr_b16 a[16:17], v16 offset:16384
    v_mfma_f32_16x16x32_bf16 v[188:191], a[124:127], a[28:31], v[188:191]
    ds_read_b64_tr_b16 a[18:19], v16 offset:17408
    buffer_load_dwordx4 v7, s[68:71], s78 offen offset:2048 lds
    v_mfma_f32_16x16x32_bf16 v[184:187], a[120:123], a[28:31], v[184:187]
    v_mfma_f32_16x16x32_bf16 v[184:187], a[104:107], a[24:27], v[184:187]
    v_mfma_f32_16x16x32_bf16 v[180:183], a[100:103], a[24:27], v[180:183]
    v_mfma_f32_16x16x32_bf16 v[180:183], a[116:119], a[28:31], v[180:183]
    buffer_load_dwordx4 v8, s[68:71], s78 offen offset:3072 lds
    v_mfma_f32_16x16x32_bf16 v[176:179], a[112:115], a[28:31], v[176:179]
    ds_read_b64_tr_b16 a[28:29], v17 offset:24576
    s_and_b32 s77, s32, 63
    s_lshl_b32 s77, s77, 17
    s_lshr_b32 s32, s32, 6
    v_mfma_f32_16x16x32_bf16 v[176:179], a[96:99], a[24:27], v[176:179]
    ds_read_b64_tr_b16 a[30:31], v17 offset:25600
    ds_read_b64_tr_b16 a[24:25], v17 offset:16384
    ds_read_b64_tr_b16 a[26:27], v17 offset:17408
    v_mfma_f32_16x16x32_bf16 v[192:195], a[96:99], a[0:3], v[192:195]
    s_add_u32 s85, s84, s83
    s_xor_b32 s83, s27, 49152
    v_mfma_f32_16x16x32_bf16 v[192:195], a[112:115], a[4:7], v[192:195]
    buffer_load_dwordx4 a[32:35], v9, s[20:23], s85 offen offset:0 sc1
    v_mfma_f32_16x16x32_bf16 v[196:199], a[116:119], a[4:7], v[196:199]
    v_mfma_f32_16x16x32_bf16 v[196:199], a[100:103], a[0:3], v[196:199]
    v_mfma_f32_16x16x32_bf16 v[200:203], a[104:107], a[0:3], v[200:203]
    v_mfma_f32_16x16x32_bf16 v[200:203], a[120:123], a[4:7], v[200:203]
    buffer_load_dwordx4 a[36:39], v9, s[20:23], s85 offen offset:1024 sc1
    v_mfma_f32_16x16x32_bf16 v[204:207], a[124:127], a[4:7], v[204:207]
    v_mfma_f32_16x16x32_bf16 v[204:207], a[108:111], a[0:3], v[204:207]
    s_waitcnt vmcnt(18)
    s_waitcnt lgkmcnt(0)
    s_barrier
    ds_read_b64_tr_b16 a[4:5], v10 offset:40960
    v_mfma_f32_16x16x32_bf16 v[220:223], a[108:111], a[8:11], v[220:223]
    ds_read_b64_tr_b16 a[6:7], v10 offset:41984
    v_mfma_f32_16x16x32_bf16 v[220:223], a[124:127], a[12:15], v[220:223]
    ds_read_b64_tr_b16 a[0:1], v10 offset:32768
    buffer_load_dwordx4 a[40:43], v9, s[20:23], s85 offen offset:2048 sc1
    v_mfma_f32_16x16x32_bf16 v[216:219], a[120:123], a[12:15], v[216:219]
    ds_read_b64_tr_b16 a[2:3], v10 offset:33792
    v_mfma_f32_16x16x32_bf16 v[216:219], a[104:107], a[8:11], v[216:219]
    v_mfma_f32_16x16x32_bf16 v[212:215], a[100:103], a[8:11], v[212:215]
    v_mfma_f32_16x16x32_bf16 v[212:215], a[116:119], a[12:15], v[212:215]
    buffer_load_dwordx4 a[44:47], v9, s[20:23], s85 offen offset:3072 sc1
    v_mfma_f32_16x16x32_bf16 v[208:211], a[112:115], a[12:15], v[208:211]
    ds_read_b64_tr_b16 a[12:13], v11 offset:40960
    v_mfma_f32_16x16x32_bf16 v[208:211], a[96:99], a[8:11], v[208:211]
    ds_read_b64_tr_b16 a[14:15], v11 offset:41984
    v_mfma_f32_16x16x32_bf16 v[224:227], a[96:99], a[16:19], v[224:227]
    ds_read_b64_tr_b16 a[8:9], v11 offset:32768
    s_add_u32 s78, s77, s72
    s_xor_b32 s72, s54, 0
    s_add_u32 m0, s76, 0
    v_mfma_f32_16x16x32_bf16 v[224:227], a[112:115], a[20:23], v[224:227]
    ds_read_b64_tr_b16 a[10:11], v11 offset:33792
    buffer_load_dwordx4 v1, s[68:71], s78 offen offset:0 lds
    v_mfma_f32_16x16x32_bf16 v[228:231], a[116:119], a[20:23], v[228:231]
    v_mfma_f32_16x16x32_bf16 v[228:231], a[100:103], a[16:19], v[228:231]
    v_mfma_f32_16x16x32_bf16 v[232:235], a[104:107], a[16:19], v[232:235]
    v_mfma_f32_16x16x32_bf16 v[232:235], a[120:123], a[20:23], v[232:235]
    buffer_load_dwordx4 v2, s[68:71], s78 offen offset:1024 lds
    v_mfma_f32_16x16x32_bf16 v[236:239], a[124:127], a[20:23], v[236:239]
    ds_read_b64_tr_b16 a[20:21], v12 offset:40960
    v_mfma_f32_16x16x32_bf16 v[236:239], a[108:111], a[16:19], v[236:239]
    ds_read_b64_tr_b16 a[22:23], v12 offset:41984
    v_mfma_f32_16x16x32_bf16 v[252:255], a[108:111], a[24:27], v[252:255]
    ds_read_b64_tr_b16 a[16:17], v12 offset:32768
    v_mfma_f32_16x16x32_bf16 v[252:255], a[124:127], a[28:31], v[252:255]
    ds_read_b64_tr_b16 a[18:19], v12 offset:33792
    buffer_load_dwordx4 v3, s[68:71], s78 offen offset:2048 lds
    v_mfma_f32_16x16x32_bf16 v[248:251], a[120:123], a[28:31], v[248:251]
    v_mfma_f32_16x16x32_bf16 v[248:251], a[104:107], a[24:27], v[248:251]
    v_mfma_f32_16x16x32_bf16 v[244:247], a[100:103], a[24:27], v[244:247]
    v_mfma_f32_16x16x32_bf16 v[244:247], a[116:119], a[28:31], v[244:247]
    buffer_load_dwordx4 v4, s[68:71], s78 offen offset:3072 lds
    v_mfma_f32_16x16x32_bf16 v[240:243], a[112:115], a[28:31], v[240:243]
    ds_read_b64_tr_b16 a[28:29], v13 offset:40960
    v_mfma_f32_16x16x32_bf16 v[240:243], a[96:99], a[24:27], v[240:243]
    ds_read_b64_tr_b16 a[30:31], v13 offset:41984
    ds_read_b64_tr_b16 a[24:25], v13 offset:32768
    ds_read_b64_tr_b16 a[26:27], v13 offset:33792
    s_waitcnt vmcnt(12) lgkmcnt(4)
    v_mfma_f32_16x16x32_bf16 v[128:131], a[128:131], a[0:3], v[128:131]
    s_add_u32 s85, s85, 4096
    v_mfma_f32_16x16x32_bf16 v[128:131], a[144:147], a[4:7], v[128:131]
    buffer_load_dwordx4 a[48:51], v9, s[20:23], s85 offen offset:0 sc1
    v_mfma_f32_16x16x32_bf16 v[132:135], a[148:151], a[4:7], v[132:135]
    v_mfma_f32_16x16x32_bf16 v[132:135], a[132:135], a[0:3], v[132:135]
    v_mfma_f32_16x16x32_bf16 v[136:139], a[136:139], a[0:3], v[136:139]
    buffer_load_dwordx4 a[52:55], v9, s[20:23], s85 offen offset:1024 sc1
    v_mfma_f32_16x16x32_bf16 v[136:139], a[152:155], a[4:7], v[136:139]
    v_mfma_f32_16x16x32_bf16 v[140:143], a[156:159], a[4:7], v[140:143]
    ds_read_b64_tr_b16 a[4:5], v14 offset:40960
    v_mfma_f32_16x16x32_bf16 v[140:143], a[140:143], a[0:3], v[140:143]
    ds_read_b64_tr_b16 a[6:7], v14 offset:41984
    v_mfma_f32_16x16x32_bf16 v[156:159], a[140:143], a[8:11], v[156:159]
    ds_read_b64_tr_b16 a[0:1], v14 offset:32768
    buffer_load_dwordx4 a[56:59], v9, s[20:23], s85 offen offset:2048 sc1
    v_mfma_f32_16x16x32_bf16 v[156:159], a[156:159], a[12:15], v[156:159]
    ds_read_b64_tr_b16 a[2:3], v14 offset:33792
    v_mfma_f32_16x16x32_bf16 v[152:155], a[152:155], a[12:15], v[152:155]
    v_mfma_f32_16x16x32_bf16 v[152:155], a[136:139], a[8:11], v[152:155]
    buffer_load_dwordx4 a[60:63], v9, s[20:23], s85 offen offset:3072 sc1
    v_mfma_f32_16x16x32_bf16 v[148:151], a[132:135], a[8:11], v[148:151]
    v_mfma_f32_16x16x32_bf16 v[148:151], a[148:151], a[12:15], v[148:151]
    v_mfma_f32_16x16x32_bf16 v[144:147], a[144:147], a[12:15], v[144:147]
    ds_read_b64_tr_b16 a[12:13], v15 offset:40960
    s_and_b32 s84, s29, 63
    s_lshl_b32 s84, s84, 13
    s_add_u32 s84, s84, s92
    s_lshr_b32 s29, s29, 6
    s_add_u32 m0, s76, 4096
    v_mfma_f32_16x16x32_bf16 v[144:147], a[128:131], a[8:11], v[144:147]
    ds_read_b64_tr_b16 a[14:15], v15 offset:41984
    buffer_load_dwordx4 v5, s[68:71], s78 offen offset:0 lds
    v_mfma_f32_16x16x32_bf16 v[160:163], a[128:131], a[16:19], v[160:163]
    ds_read_b64_tr_b16 a[8:9], v15 offset:32768
    v_mfma_f32_16x16x32_bf16 v[160:163], a[144:147], a[20:23], v[160:163]
    ds_read_b64_tr_b16 a[10:11], v15 offset:33792
    v_mfma_f32_16x16x32_bf16 v[164:167], a[148:151], a[20:23], v[164:167]
    buffer_load_dwordx4 v6, s[68:71], s78 offen offset:1024 lds
    v_mfma_f32_16x16x32_bf16 v[164:167], a[132:135], a[16:19], v[164:167]
    v_mfma_f32_16x16x32_bf16 v[168:171], a[136:139], a[16:19], v[168:171]
    v_mfma_f32_16x16x32_bf16 v[168:171], a[152:155], a[20:23], v[168:171]
    v_mfma_f32_16x16x32_bf16 v[172:175], a[156:159], a[20:23], v[172:175]
    ds_read_b64_tr_b16 a[20:21], v16 offset:40960
    buffer_load_dwordx4 v7, s[68:71], s78 offen offset:2048 lds
    v_mfma_f32_16x16x32_bf16 v[172:175], a[140:143], a[16:19], v[172:175]
    ds_read_b64_tr_b16 a[22:23], v16 offset:41984
    s_waitcnt lgkmcnt(4)
    v_mfma_f32_16x16x32_bf16 v[188:191], a[140:143], a[24:27], v[188:191]
    ds_read_b64_tr_b16 a[16:17], v16 offset:32768
    v_mfma_f32_16x16x32_bf16 v[188:191], a[156:159], a[28:31], v[188:191]
    ds_read_b64_tr_b16 a[18:19], v16 offset:33792
    buffer_load_dwordx4 v8, s[68:71], s78 offen offset:3072 lds
    v_mfma_f32_16x16x32_bf16 v[184:187], a[152:155], a[28:31], v[184:187]
    v_mfma_f32_16x16x32_bf16 v[184:187], a[136:139], a[24:27], v[184:187]
    v_mfma_f32_16x16x32_bf16 v[180:183], a[132:135], a[24:27], v[180:183]
    v_mfma_f32_16x16x32_bf16 v[180:183], a[148:151], a[28:31], v[180:183]
    buffer_load_dwordx2 v[26:27], off, s[20:23], s67 sc1
    v_mfma_f32_16x16x32_bf16 v[176:179], a[144:147], a[28:31], v[176:179]
    ds_read_b64_tr_b16 a[28:29], v17 offset:40960
    v_mfma_f32_16x16x32_bf16 v[176:179], a[128:131], a[24:27], v[176:179]
    ds_read_b64_tr_b16 a[30:31], v17 offset:41984
    ds_read_b64_tr_b16 a[24:25], v17 offset:32768
    ds_read_b64_tr_b16 a[26:27], v17 offset:33792
    v_mfma_f32_16x16x32_bf16 v[192:195], a[128:131], a[0:3], v[192:195]
    s_add_u32 s85, s84, s80
    s_xor_b32 s80, s27, 0
    v_mfma_f32_16x16x32_bf16 v[192:195], a[144:147], a[4:7], v[192:195]
    buffer_load_dwordx4 a[64:67], v9, s[20:23], s85 offen offset:0 sc1
    v_mfma_f32_16x16x32_bf16 v[196:199], a[148:151], a[4:7], v[196:199]
    v_mfma_f32_16x16x32_bf16 v[196:199], a[132:135], a[0:3], v[196:199]
    v_mfma_f32_16x16x32_bf16 v[200:203], a[136:139], a[0:3], v[200:203]
    v_mfma_f32_16x16x32_bf16 v[200:203], a[152:155], a[4:7], v[200:203]
    buffer_load_dwordx4 a[68:71], v9, s[20:23], s85 offen offset:1024 sc1
    v_mfma_f32_16x16x32_bf16 v[204:207], a[156:159], a[4:7], v[204:207]
    v_mfma_f32_16x16x32_bf16 v[204:207], a[140:143], a[0:3], v[204:207]
    s_waitcnt vmcnt(19)
    s_waitcnt lgkmcnt(0)
    s_barrier
    ds_read_b64_tr_b16 a[4:5], v10 offset:57344
    v_mfma_f32_16x16x32_bf16 v[220:223], a[140:143], a[8:11], v[220:223]
    ds_read_b64_tr_b16 a[6:7], v10 offset:58368
    v_mfma_f32_16x16x32_bf16 v[220:223], a[156:159], a[12:15], v[220:223]
    ds_read_b64_tr_b16 a[0:1], v10 offset:49152
    buffer_load_dwordx4 a[72:75], v9, s[20:23], s85 offen offset:2048 sc1
    v_mfma_f32_16x16x32_bf16 v[216:219], a[152:155], a[12:15], v[216:219]
    ds_read_b64_tr_b16 a[2:3], v10 offset:50176
    v_mfma_f32_16x16x32_bf16 v[216:219], a[136:139], a[8:11], v[216:219]
    v_mfma_f32_16x16x32_bf16 v[212:215], a[132:135], a[8:11], v[212:215]
    v_mfma_f32_16x16x32_bf16 v[212:215], a[148:151], a[12:15], v[212:215]
    buffer_load_dwordx4 a[76:79], v9, s[20:23], s85 offen offset:3072 sc1
    v_mfma_f32_16x16x32_bf16 v[208:211], a[144:147], a[12:15], v[208:211]
    ds_read_b64_tr_b16 a[12:13], v11 offset:57344
    v_mfma_f32_16x16x32_bf16 v[208:211], a[128:131], a[8:11], v[208:211]
    ds_read_b64_tr_b16 a[14:15], v11 offset:58368
    v_mfma_f32_16x16x32_bf16 v[224:227], a[128:131], a[16:19], v[224:227]
    ds_read_b64_tr_b16 a[8:9], v11 offset:49152
    s_add_u32 s78, s77, s73
    s_xor_b32 s73, s54, 262144
    s_add_u32 m0, s76, 16384
    v_mfma_f32_16x16x32_bf16 v[224:227], a[144:147], a[20:23], v[224:227]
    ds_read_b64_tr_b16 a[10:11], v11 offset:50176
    buffer_load_dwordx4 v1, s[68:71], s78 offen offset:0 lds
    v_mfma_f32_16x16x32_bf16 v[228:231], a[148:151], a[20:23], v[228:231]
    v_mfma_f32_16x16x32_bf16 v[228:231], a[132:135], a[16:19], v[228:231]
    v_mfma_f32_16x16x32_bf16 v[232:235], a[136:139], a[16:19], v[232:235]
    v_mfma_f32_16x16x32_bf16 v[232:235], a[152:155], a[20:23], v[232:235]
    buffer_load_dwordx4 v2, s[68:71], s78 offen offset:1024 lds
    v_mfma_f32_16x16x32_bf16 v[236:239], a[156:159], a[20:23], v[236:239]
    ds_read_b64_tr_b16 a[20:21], v12 offset:57344
    v_mfma_f32_16x16x32_bf16 v[236:239], a[140:143], a[16:19], v[236:239]
    ds_read_b64_tr_b16 a[22:23], v12 offset:58368
    v_mfma_f32_16x16x32_bf16 v[252:255], a[140:143], a[24:27], v[252:255]
    ds_read_b64_tr_b16 a[16:17], v12 offset:49152
    v_mfma_f32_16x16x32_bf16 v[252:255], a[156:159], a[28:31], v[252:255]
    ds_read_b64_tr_b16 a[18:19], v12 offset:50176
    buffer_load_dwordx4 v3, s[68:71], s78 offen offset:2048 lds
    v_mfma_f32_16x16x32_bf16 v[248:251], a[152:155], a[28:31], v[248:251]
    v_mfma_f32_16x16x32_bf16 v[248:251], a[136:139], a[24:27], v[248:251]
    v_mfma_f32_16x16x32_bf16 v[244:247], a[132:135], a[24:27], v[244:247]
    v_mfma_f32_16x16x32_bf16 v[244:247], a[148:151], a[28:31], v[244:247]
    buffer_load_dwordx4 v4, s[68:71], s78 offen offset:3072 lds
    v_mfma_f32_16x16x32_bf16 v[240:243], a[144:147], a[28:31], v[240:243]
    ds_read_b64_tr_b16 a[28:29], v13 offset:57344
    v_mfma_f32_16x16x32_bf16 v[240:243], a[128:131], a[24:27], v[240:243]
    ds_read_b64_tr_b16 a[30:31], v13 offset:58368
    ds_read_b64_tr_b16 a[24:25], v13 offset:49152
    ds_read_b64_tr_b16 a[26:27], v13 offset:50176
    s_waitcnt vmcnt(13) lgkmcnt(4)
    v_mfma_f32_16x16x32_bf16 v[128:131], a[32:35], a[0:3], v[128:131]
    s_add_u32 s85, s85, 4096
    v_mfma_f32_16x16x32_bf16 v[128:131], a[48:51], a[4:7], v[128:131]
    buffer_load_dwordx4 a[80:83], v9, s[20:23], s85 offen offset:0 sc1
    v_mfma_f32_16x16x32_bf16 v[132:135], a[52:55], a[4:7], v[132:135]
    v_mfma_f32_16x16x32_bf16 v[132:135], a[36:39], a[0:3], v[132:135]
    v_mfma_f32_16x16x32_bf16 v[136:139], a[40:43], a[0:3], v[136:139]
    v_mfma_f32_16x16x32_bf16 v[136:139], a[56:59], a[4:7], v[136:139]
    buffer_load_dwordx4 a[84:87], v9, s[20:23], s85 offen offset:1024 sc1
    v_mfma_f32_16x16x32_bf16 v[140:143], a[60:63], a[4:7], v[140:143]
    ds_read_b64_tr_b16 a[4:5], v14 offset:57344
    v_mfma_f32_16x16x32_bf16 v[140:143], a[44:47], a[0:3], v[140:143]
    ds_read_b64_tr_b16 a[6:7], v14 offset:58368
    v_mfma_f32_16x16x32_bf16 v[156:159], a[44:47], a[8:11], v[156:159]
    ds_read_b64_tr_b16 a[0:1], v14 offset:49152
    v_mfma_f32_16x16x32_bf16 v[156:159], a[60:63], a[12:15], v[156:159]
    ds_read_b64_tr_b16 a[2:3], v14 offset:50176
    buffer_load_dwordx4 a[88:91], v9, s[20:23], s85 offen offset:2048 sc1
    v_mfma_f32_16x16x32_bf16 v[152:155], a[56:59], a[12:15], v[152:155]
    v_mfma_f32_16x16x32_bf16 v[152:155], a[40:43], a[8:11], v[152:155]
    v_mfma_f32_16x16x32_bf16 v[148:151], a[36:39], a[8:11], v[148:151]
    v_mfma_f32_16x16x32_bf16 v[148:151], a[52:55], a[12:15], v[148:151]
    buffer_load_dwordx4 a[92:95], v9, s[20:23], s85 offen offset:3072 sc1
    v_mfma_f32_16x16x32_bf16 v[144:147], a[48:51], a[12:15], v[144:147]
    ds_read_b64_tr_b16 a[12:13], v15 offset:57344
    v_mfma_f32_16x16x32_bf16 v[144:147], a[32:35], a[8:11], v[144:147]
    ds_read_b64_tr_b16 a[14:15], v15 offset:58368
    v_mfma_f32_16x16x32_bf16 v[160:163], a[32:35], a[16:19], v[160:163]
    ds_read_b64_tr_b16 a[8:9], v15 offset:49152
    s_add_u32 m0, s76, 20480
    v_mfma_f32_16x16x32_bf16 v[160:163], a[48:51], a[20:23], v[160:163]
    ds_read_b64_tr_b16 a[10:11], v15 offset:50176
    buffer_load_dwordx4 v5, s[68:71], s78 offen offset:0 lds
    v_mfma_f32_16x16x32_bf16 v[164:167], a[52:55], a[20:23], v[164:167]
    v_mfma_f32_16x16x32_bf16 v[164:167], a[36:39], a[16:19], v[164:167]
    v_mfma_f32_16x16x32_bf16 v[168:171], a[40:43], a[16:19], v[168:171]
    v_mfma_f32_16x16x32_bf16 v[168:171], a[56:59], a[20:23], v[168:171]
    buffer_load_dwordx4 v6, s[68:71], s78 offen offset:1024 lds
    v_mfma_f32_16x16x32_bf16 v[172:175], a[60:63], a[20:23], v[172:175]
    ds_read_b64_tr_b16 a[20:21], v16 offset:57344
    v_mfma_f32_16x16x32_bf16 v[172:175], a[44:47], a[16:19], v[172:175]
    ds_read_b64_tr_b16 a[22:23], v16 offset:58368
    s_waitcnt lgkmcnt(4)
    v_mfma_f32_16x16x32_bf16 v[188:191], a[44:47], a[24:27], v[188:191]
    ds_read_b64_tr_b16 a[16:17], v16 offset:49152
    v_mfma_f32_16x16x32_bf16 v[188:191], a[60:63], a[28:31], v[188:191]
    ds_read_b64_tr_b16 a[18:19], v16 offset:50176
    buffer_load_dwordx4 v7, s[68:71], s78 offen offset:2048 lds
    v_mfma_f32_16x16x32_bf16 v[184:187], a[56:59], a[28:31], v[184:187]
    v_mfma_f32_16x16x32_bf16 v[184:187], a[40:43], a[24:27], v[184:187]
    v_mfma_f32_16x16x32_bf16 v[180:183], a[36:39], a[24:27], v[180:183]
    v_mfma_f32_16x16x32_bf16 v[180:183], a[52:55], a[28:31], v[180:183]
    buffer_load_dwordx4 v8, s[68:71], s78 offen offset:3072 lds
    v_mfma_f32_16x16x32_bf16 v[176:179], a[48:51], a[28:31], v[176:179]
    ds_read_b64_tr_b16 a[28:29], v17 offset:57344
    v_mfma_f32_16x16x32_bf16 v[176:179], a[32:35], a[24:27], v[176:179]
    ds_read_b64_tr_b16 a[30:31], v17 offset:58368
    ds_read_b64_tr_b16 a[24:25], v17 offset:49152
    ds_read_b64_tr_b16 a[26:27], v17 offset:50176
    v_mfma_f32_16x16x32_bf16 v[192:195], a[32:35], a[0:3], v[192:195]
    s_add_u32 s85, s84, s81
    s_xor_b32 s81, s27, 16384
    v_mfma_f32_16x16x32_bf16 v[192:195], a[48:51], a[4:7], v[192:195]
    buffer_load_dwordx4 a[96:99], v9, s[20:23], s85 offen offset:0 sc1
    v_mfma_f32_16x16x32_bf16 v[196:199], a[52:55], a[4:7], v[196:199]
    v_mfma_f32_16x16x32_bf16 v[196:199], a[36:39], a[0:3], v[196:199]
    v_mfma_f32_16x16x32_bf16 v[200:203], a[40:43], a[0:3], v[200:203]
    v_mfma_f32_16x16x32_bf16 v[200:203], a[56:59], a[4:7], v[200:203]
    buffer_load_dwordx4 a[100:103], v9, s[20:23], s85 offen offset:1024 sc1
    v_mfma_f32_16x16x32_bf16 v[204:207], a[60:63], a[4:7], v[204:207]
    v_mfma_f32_16x16x32_bf16 v[204:207], a[44:47], a[0:3], v[204:207]
    s_waitcnt vmcnt(19)
    s_waitcnt lgkmcnt(0)
    s_barrier
    ds_read_b64_tr_b16 a[4:5], v10 offset:8192
    v_mfma_f32_16x16x32_bf16 v[220:223], a[44:47], a[8:11], v[220:223]
    ds_read_b64_tr_b16 a[6:7], v10 offset:9216
    v_mfma_f32_16x16x32_bf16 v[220:223], a[60:63], a[12:15], v[220:223]
    ds_read_b64_tr_b16 a[0:1], v10 offset:0
    buffer_load_dwordx4 a[104:107], v9, s[20:23], s85 offen offset:2048 sc1
    v_mfma_f32_16x16x32_bf16 v[216:219], a[56:59], a[12:15], v[216:219]
    ds_read_b64_tr_b16 a[2:3], v10 offset:1024
    v_mfma_f32_16x16x32_bf16 v[216:219], a[40:43], a[8:11], v[216:219]
    v_mfma_f32_16x16x32_bf16 v[212:215], a[36:39], a[8:11], v[212:215]
    v_mfma_f32_16x16x32_bf16 v[212:215], a[52:55], a[12:15], v[212:215]
    buffer_load_dwordx4 a[108:111], v9, s[20:23], s85 offen offset:3072 sc1
    v_mfma_f32_16x16x32_bf16 v[208:211], a[48:51], a[12:15], v[208:211]
    ds_read_b64_tr_b16 a[12:13], v11 offset:8192
    v_mfma_f32_16x16x32_bf16 v[208:211], a[32:35], a[8:11], v[208:211]
    ds_read_b64_tr_b16 a[14:15], v11 offset:9216
    v_mfma_f32_16x16x32_bf16 v[224:227], a[32:35], a[16:19], v[224:227]
    ds_read_b64_tr_b16 a[8:9], v11 offset:0
    s_add_u32 s78, s77, s74
    s_xor_b32 s74, s54, 524288
    s_add_u32 m0, s76, 32768
    v_mfma_f32_16x16x32_bf16 v[224:227], a[48:51], a[20:23], v[224:227]
    ds_read_b64_tr_b16 a[10:11], v11 offset:1024
    buffer_load_dwordx4 v1, s[68:71], s78 offen offset:0 lds
    v_mfma_f32_16x16x32_bf16 v[228:231], a[52:55], a[20:23], v[228:231]
    v_mfma_f32_16x16x32_bf16 v[228:231], a[36:39], a[16:19], v[228:231]
    v_mfma_f32_16x16x32_bf16 v[232:235], a[40:43], a[16:19], v[232:235]
    v_mfma_f32_16x16x32_bf16 v[232:235], a[56:59], a[20:23], v[232:235]
    buffer_load_dwordx4 v2, s[68:71], s78 offen offset:1024 lds
    v_mfma_f32_16x16x32_bf16 v[236:239], a[60:63], a[20:23], v[236:239]
    ds_read_b64_tr_b16 a[20:21], v12 offset:8192
    v_mfma_f32_16x16x32_bf16 v[236:239], a[44:47], a[16:19], v[236:239]
    ds_read_b64_tr_b16 a[22:23], v12 offset:9216
    v_mfma_f32_16x16x32_bf16 v[252:255], a[44:47], a[24:27], v[252:255]
    ds_read_b64_tr_b16 a[16:17], v12 offset:0
    v_mfma_f32_16x16x32_bf16 v[252:255], a[60:63], a[28:31], v[252:255]
    ds_read_b64_tr_b16 a[18:19], v12 offset:1024
    buffer_load_dwordx4 v3, s[68:71], s78 offen offset:2048 lds
    v_mfma_f32_16x16x32_bf16 v[248:251], a[56:59], a[28:31], v[248:251]
    v_mfma_f32_16x16x32_bf16 v[248:251], a[40:43], a[24:27], v[248:251]
    v_mfma_f32_16x16x32_bf16 v[244:247], a[36:39], a[24:27], v[244:247]
    v_mfma_f32_16x16x32_bf16 v[244:247], a[52:55], a[28:31], v[244:247]
    buffer_load_dwordx4 v4, s[68:71], s78 offen offset:3072 lds
    v_mfma_f32_16x16x32_bf16 v[240:243], a[48:51], a[28:31], v[240:243]
    ds_read_b64_tr_b16 a[28:29], v13 offset:8192
    v_mfma_f32_16x16x32_bf16 v[240:243], a[32:35], a[24:27], v[240:243]
    ds_read_b64_tr_b16 a[30:31], v13 offset:9216
    ds_read_b64_tr_b16 a[24:25], v13 offset:0
    ds_read_b64_tr_b16 a[26:27], v13 offset:1024
    s_add_u32 s35, s35, 1
    s_cmp_lg_u32 s35, 4
    s_cbranch_scc1 L_k3_nocp
    s_getpc_b64 s[58:59]
L_pc3ffn:
    s_add_u32 s58, s58, L_k3_lastffn-L_pc3ffn
    s_addc_u32 s59, s59, 0
    v_lshlrev_b32 v19, 6, v0
    v_min_u32 v19, 0+L_k3_stopffn-L_k3_lastffn-4, v19
    global_load_dword a238, v19, s[58:59]
L_k3_nocp:
    s_cmp_lt_u32 s35, 5
    s_cbranch_scc1 L_k3_ffn_loop
    s_mov_b32 s55, 0x40000
    s_waitcnt vmcnt(24)
L_wfp:
    v_cmp_ne_u64 vcc, s[48:49], v[26:27]
    s_cbranch_vccz L_gfp
    s_sleep 1
    buffer_load_dwordx2 v[26:27], off, s[20:23], s67 sc1
    s_waitcnt vmcnt(0)
    s_sub_u32 s55, s55, 1
    s_cmp_lg_u32 s55, 0
    s_cbranch_scc1 L_wfp
L_gfp:
L_k3_lastffn:
    s_lshl_b32 s3, s26, 15
    s_add_u32 s86, s86, s3
    s_add_u32 s86, s86, 131072
    s_xor_b32 s67, s86, 128
    s_add_u32 s42, s87, 8192
    s_add_u32 s43, s42, 4096
    s_add_u32 s54, s87, 4096
    s_cmp_eq_u32 s62, 0
    s_cselect_b32 s40, 2.0, -2.0
    s_mov_b32 s41, s40
    s_and_b32 s3, s39, 2047
    v_and_b32 v30, 15, v18
    v_lshl_add_u32 v30, v30, 1, s3
    v_add_u32_e64 v20, s76, v9
    v_xor_b32 v21, 0x10000, v20
    s_waitcnt vmcnt(12) lgkmcnt(4)
    v_mfma_f32_16x16x32_bf16 v[160:163], a[64:67], a[16:19], v[160:163]
    s_add_u32 s85, s85, 4096
    v_mfma_f32_16x16x32_bf16 v[160:163], a[80:83], a[20:23], v[160:163]
    ds_read_b64_tr_b16 a[0:1], v16 offset:0
    buffer_load_dwordx4 a[112:115], v9, s[20:23], s85 offen offset:0 sc1
    v_mfma_f32_16x16x32_bf16 v[164:167], a[84:87], a[20:23], v[164:167]
    ds_read_b64_tr_b16 a[2:3], v16 offset:1024
    v_mfma_f32_16x16x32_bf16 v[164:167], a[68:71], a[16:19], v[164:167]
    ds_read_b64_tr_b16 a[4:5], v16 offset:8192
    buffer_load_dwordx4 a[116:119], v9, s[20:23], s85 offen offset:1024 sc1
    v_mfma_f32_16x16x32_bf16 v[168:171], a[72:75], a[16:19], v[168:171]
    ds_read_b64_tr_b16 a[6:7], v16 offset:9216
    v_mfma_f32_16x16x32_bf16 v[168:171], a[88:91], a[20:23], v[168:171]
    ds_read_b64_tr_b16 a[8:9], v17 offset:0
    buffer_load_dwordx4 a[120:123], v9, s[20:23], s85 offen offset:2048 sc1
    v_mfma_f32_16x16x32_bf16 v[172:175], a[92:95], a[20:23], v[172:175]
    ds_read_b64_tr_b16 a[10:11], v17 offset:1024
    buffer_load_dwordx4 a[124:127], v9, s[20:23], s85 offen offset:3072 sc1
    v_mfma_f32_16x16x32_bf16 v[172:175], a[76:79], a[16:19], v[172:175]
    ds_read_b64_tr_b16 a[12:13], v17 offset:8192
    s_waitcnt lgkmcnt(4)
    v_mfma_f32_16x16x32_bf16 v[188:191], a[76:79], a[24:27], v[188:191]
    ds_read_b64_tr_b16 a[14:15], v17 offset:9216
    s_add_u32 m0, s76, 36864
    v_mfma_f32_16x16x32_bf16 v[188:191], a[92:95], a[28:31], v[188:191]
    v_mfma_f32_16x16x32_bf16 v[184:187], a[88:91], a[28:31], v[184:187]
    buffer_load_dwordx4 v5, s[68:71], s78 offen offset:0 lds
    v_mfma_f32_16x16x32_bf16 v[184:187], a[72:75], a[24:27], v[184:187]
    buffer_load_dwordx4 v6, s[68:71], s78 offen offset:1024 lds
    v_mfma_f32_16x16x32_bf16 v[180:183], a[68:71], a[24:27], v[180:183]
    v_mfma_f32_16x16x32_bf16 v[180:183], a[84:87], a[28:31], v[180:183]
    buffer_load_dwordx4 v7, s[68:71], s78 offen offset:2048 lds
    v_mfma_f32_16x16x32_bf16 v[176:179], a[80:83], a[28:31], v[176:179]
    v_mfma_f32_16x16x32_bf16 v[176:179], a[64:67], a[24:27], v[176:179]
    v_mfma_f32_16x16x32_bf16 v[224:227], a[64:67], a[0:3], v[224:227]
    s_waitcnt vmcnt(15)
    s_waitcnt lgkmcnt(0)
    s_barrier
    buffer_load_dwordx4 v8, s[68:71], s78 offen offset:3072 lds
    v_mfma_f32_16x16x32_bf16 v[224:227], a[80:83], a[4:7], v[224:227]
    ds_read_b64_tr_b16 a[16:17], v12 offset:16384
    s_add_u32 s85, s84, s82
    s_xor_b32 s82, s27, 32768
    v_mfma_f32_16x16x32_bf16 v[228:231], a[84:87], a[4:7], v[228:231]
    ds_read_b64_tr_b16 a[18:19], v12 offset:17408
    v_mfma_f32_16x16x32_bf16 v[228:231], a[68:71], a[0:3], v[228:231]
    ds_read_b64_tr_b16 a[20:21], v12 offset:24576
    buffer_load_dwordx4 a[128:131], v9, s[20:23], s85 offen offset:0 sc1
    v_mfma_f32_16x16x32_bf16 v[232:235], a[72:75], a[0:3], v[232:235]
    ds_read_b64_tr_b16 a[22:23], v12 offset:25600
    v_mfma_f32_16x16x32_bf16 v[232:235], a[88:91], a[4:7], v[232:235]
    ds_read_b64_tr_b16 a[24:25], v13 offset:16384
    buffer_load_dwordx4 a[132:135], v9, s[20:23], s85 offen offset:1024 sc1
    v_mfma_f32_16x16x32_bf16 v[236:239], a[92:95], a[4:7], v[236:239]
    ds_read_b64_tr_b16 a[26:27], v13 offset:17408
    buffer_load_dwordx4 a[136:139], v9, s[20:23], s85 offen offset:2048 sc1
    v_mfma_f32_16x16x32_bf16 v[236:239], a[76:79], a[0:3], v[236:239]
    ds_read_b64_tr_b16 a[28:29], v13 offset:24576
    v_mfma_f32_16x16x32_bf16 v[252:255], a[76:79], a[8:11], v[252:255]
    ds_read_b64_tr_b16 a[30:31], v13 offset:25600
    buffer_load_dwordx4 a[140:143], v9, s[20:23], s85 offen offset:3072 sc1
    v_mfma_f32_16x16x32_bf16 v[252:255], a[92:95], a[12:15], v[252:255]
    v_mfma_f32_16x16x32_bf16 v[248:251], a[88:91], a[12:15], v[248:251]
    s_add_u32 s85, s85, 4096
    v_mfma_f32_16x16x32_bf16 v[248:251], a[72:75], a[8:11], v[248:251]
    buffer_load_dwordx4 a[144:147], v9, s[20:23], s85 offen offset:0 sc1
    v_mfma_f32_16x16x32_bf16 v[244:247], a[68:71], a[8:11], v[244:247]
    v_mfma_f32_16x16x32_bf16 v[244:247], a[84:87], a[12:15], v[244:247]
    buffer_load_dwordx4 a[148:151], v9, s[20:23], s85 offen offset:1024 sc1
    v_mfma_f32_16x16x32_bf16 v[240:243], a[80:83], a[12:15], v[240:243]
    v_mfma_f32_16x16x32_bf16 v[240:243], a[64:67], a[8:11], v[240:243]
    s_waitcnt vmcnt(10) lgkmcnt(4)
    v_mfma_f32_16x16x32_bf16 v[160:163], a[96:99], a[16:19], v[160:163]
    buffer_load_dwordx4 a[152:155], v9, s[20:23], s85 offen offset:2048 sc1
    v_mfma_f32_16x16x32_bf16 v[160:163], a[112:115], a[20:23], v[160:163]
    ds_read_b64_tr_b16 a[0:1], v16 offset:16384
    buffer_load_dwordx4 a[156:159], v9, s[20:23], s85 offen offset:3072 sc1
    v_mfma_f32_16x16x32_bf16 v[164:167], a[116:119], a[20:23], v[164:167]
    ds_read_b64_tr_b16 a[2:3], v16 offset:17408
    v_mfma_f32_16x16x32_bf16 v[164:167], a[100:103], a[16:19], v[164:167]
    ds_read_b64_tr_b16 a[4:5], v16 offset:24576
    s_add_u32 s78, s77, s75
    s_xor_b32 s75, s54, 786432
    v_mfma_f32_16x16x32_bf16 v[168:171], a[104:107], a[16:19], v[168:171]
    ds_read_b64_tr_b16 a[6:7], v16 offset:25600
    s_add_u32 m0, s76, 49152
    v_mfma_f32_16x16x32_bf16 v[168:171], a[120:123], a[20:23], v[168:171]
    ds_read_b64_tr_b16 a[8:9], v17 offset:16384
    v_mfma_f32_16x16x32_bf16 v[172:175], a[124:127], a[20:23], v[172:175]
    ds_read_b64_tr_b16 a[10:11], v17 offset:17408
    buffer_load_dwordx4 v1, s[68:71], s78 offen offset:0 lds
    v_mfma_f32_16x16x32_bf16 v[172:175], a[108:111], a[16:19], v[172:175]
    ds_read_b64_tr_b16 a[12:13], v17 offset:24576
    buffer_load_dwordx4 v2, s[68:71], s78 offen offset:1024 lds
    s_waitcnt lgkmcnt(4)
    v_mfma_f32_16x16x32_bf16 v[188:191], a[108:111], a[24:27], v[188:191]
    ds_read_b64_tr_b16 a[14:15], v17 offset:25600
    v_mfma_f32_16x16x32_bf16 v[188:191], a[124:127], a[28:31], v[188:191]
    buffer_load_dwordx4 v3, s[68:71], s78 offen offset:2048 lds
    v_mfma_f32_16x16x32_bf16 v[184:187], a[120:123], a[28:31], v[184:187]
    buffer_load_dwordx4 v4, s[68:71], s78 offen offset:3072 lds
    v_mfma_f32_16x16x32_bf16 v[184:187], a[104:107], a[24:27], v[184:187]
    v_mfma_f32_16x16x32_bf16 v[180:183], a[100:103], a[24:27], v[180:183]
    s_add_u32 m0, s76, 53248
    v_mfma_f32_16x16x32_bf16 v[180:183], a[116:119], a[28:31], v[180:183]
    buffer_load_dwordx4 v5, s[68:71], s78 offen offset:0 lds
    v_mfma_f32_16x16x32_bf16 v[176:179], a[112:115], a[28:31], v[176:179]
    v_mfma_f32_16x16x32_bf16 v[176:179], a[96:99], a[24:27], v[176:179]
    v_mfma_f32_16x16x32_bf16 v[224:227], a[96:99], a[0:3], v[224:227]
    s_waitcnt vmcnt(13)
    s_waitcnt lgkmcnt(0)
    s_barrier
    buffer_load_dwordx4 v6, s[68:71], s78 offen offset:1024 lds
    v_mfma_f32_16x16x32_bf16 v[224:227], a[112:115], a[4:7], v[224:227]
    ds_read_b64_tr_b16 a[16:17], v12 offset:32768
    buffer_load_dwordx4 v7, s[68:71], s78 offen offset:2048 lds
    v_mfma_f32_16x16x32_bf16 v[228:231], a[116:119], a[4:7], v[228:231]
    ds_read_b64_tr_b16 a[18:19], v12 offset:33792
    v_mfma_f32_16x16x32_bf16 v[228:231], a[100:103], a[0:3], v[228:231]
    ds_read_b64_tr_b16 a[20:21], v12 offset:40960
    buffer_load_dwordx4 v8, s[68:71], s78 offen offset:3072 lds
    v_mfma_f32_16x16x32_bf16 v[232:235], a[104:107], a[0:3], v[232:235]
    ds_read_b64_tr_b16 a[22:23], v12 offset:41984
    v_mfma_f32_16x16x32_bf16 v[232:235], a[120:123], a[4:7], v[232:235]
    ds_read_b64_tr_b16 a[24:25], v13 offset:32768
    s_and_b32 s77, s32, 63
    s_lshl_b32 s77, s77, 17
    s_lshr_b32 s32, s32, 6
    v_mfma_f32_16x16x32_bf16 v[236:239], a[124:127], a[4:7], v[236:239]
    ds_read_b64_tr_b16 a[26:27], v13 offset:33792
    s_add_u32 s85, s84, s83
    s_xor_b32 s83, s27, 49152
    v_mfma_f32_16x16x32_bf16 v[236:239], a[108:111], a[0:3], v[236:239]
    ds_read_b64_tr_b16 a[28:29], v13 offset:40960
    v_mfma_f32_16x16x32_bf16 v[252:255], a[108:111], a[8:11], v[252:255]
    ds_read_b64_tr_b16 a[30:31], v13 offset:41984
    buffer_load_dwordx4 a[32:35], v9, s[20:23], s85 offen offset:0 sc1
    v_mfma_f32_16x16x32_bf16 v[252:255], a[124:127], a[12:15], v[252:255]
    v_mfma_f32_16x16x32_bf16 v[248:251], a[120:123], a[12:15], v[248:251]
    buffer_load_dwordx4 a[36:39], v9, s[20:23], s85 offen offset:1024 sc1
    v_mfma_f32_16x16x32_bf16 v[248:251], a[104:107], a[8:11], v[248:251]
    buffer_load_dwordx4 a[40:43], v9, s[20:23], s85 offen offset:2048 sc1
    v_mfma_f32_16x16x32_bf16 v[244:247], a[100:103], a[8:11], v[244:247]
    v_mfma_f32_16x16x32_bf16 v[244:247], a[116:119], a[12:15], v[244:247]
    buffer_load_dwordx4 a[44:47], v9, s[20:23], s85 offen offset:3072 sc1
    v_mfma_f32_16x16x32_bf16 v[240:243], a[112:115], a[12:15], v[240:243]
    v_mfma_f32_16x16x32_bf16 v[240:243], a[96:99], a[8:11], v[240:243]
    s_waitcnt vmcnt(12) lgkmcnt(4)
    v_mfma_f32_16x16x32_bf16 v[160:163], a[128:131], a[16:19], v[160:163]
    s_add_u32 s85, s85, 4096
    v_mfma_f32_16x16x32_bf16 v[160:163], a[144:147], a[20:23], v[160:163]
    ds_read_b64_tr_b16 a[0:1], v16 offset:32768
    buffer_load_dwordx4 a[48:51], v9, s[20:23], s85 offen offset:0 sc1
    v_mfma_f32_16x16x32_bf16 v[164:167], a[148:151], a[20:23], v[164:167]
    ds_read_b64_tr_b16 a[2:3], v16 offset:33792
    v_mfma_f32_16x16x32_bf16 v[164:167], a[132:135], a[16:19], v[164:167]
    ds_read_b64_tr_b16 a[4:5], v16 offset:40960
    buffer_load_dwordx4 a[52:55], v9, s[20:23], s85 offen offset:1024 sc1
    v_mfma_f32_16x16x32_bf16 v[168:171], a[136:139], a[16:19], v[168:171]
    ds_read_b64_tr_b16 a[6:7], v16 offset:41984
    v_mfma_f32_16x16x32_bf16 v[168:171], a[152:155], a[20:23], v[168:171]
    ds_read_b64_tr_b16 a[8:9], v17 offset:32768
    buffer_load_dwordx4 a[56:59], v9, s[20:23], s85 offen offset:2048 sc1
    v_mfma_f32_16x16x32_bf16 v[172:175], a[156:159], a[20:23], v[172:175]
    ds_read_b64_tr_b16 a[10:11], v17 offset:33792
    buffer_load_dwordx4 a[60:63], v9, s[20:23], s85 offen offset:3072 sc1
    v_mfma_f32_16x16x32_bf16 v[172:175], a[140:143], a[16:19], v[172:175]
    ds_read_b64_tr_b16 a[12:13], v17 offset:40960
    s_waitcnt lgkmcnt(4)
    v_mfma_f32_16x16x32_bf16 v[188:191], a[140:143], a[24:27], v[188:191]
    ds_read_b64_tr_b16 a[14:15], v17 offset:41984
    s_and_b32 s84, s29, 63
    s_lshl_b32 s84, s84, 13
    s_add_u32 s84, s84, s92
    s_lshr_b32 s29, s29, 6
    v_mfma_f32_16x16x32_bf16 v[188:191], a[156:159], a[28:31], v[188:191]
    v_mfma_f32_16x16x32_bf16 v[184:187], a[152:155], a[28:31], v[184:187]
    global_load_ushort v28, v30, s[44:45] offset:0
    v_mfma_f32_16x16x32_bf16 v[184:187], a[136:139], a[24:27], v[184:187]
    global_load_ushort v29, v30, s[44:45] offset:32
    v_mfma_f32_16x16x32_bf16 v[180:183], a[132:135], a[24:27], v[180:183]
    v_mfma_f32_16x16x32_bf16 v[180:183], a[148:151], a[28:31], v[180:183]
    buffer_load_dwordx4 v[64:67], v9, s[20:23], s66 offen offset:0 sc1
    v_mfma_f32_16x16x32_bf16 v[176:179], a[144:147], a[28:31], v[176:179]
    v_mfma_f32_16x16x32_bf16 v[176:179], a[128:131], a[24:27], v[176:179]
    v_mfma_f32_16x16x32_bf16 v[224:227], a[128:131], a[0:3], v[224:227]
    s_waitcnt vmcnt(11)
    s_waitcnt lgkmcnt(0)
    s_barrier
    buffer_load_dwordx4 v[68:71], v9, s[20:23], s66 offen offset:1024 sc1
    v_mfma_f32_16x16x32_bf16 v[224:227], a[144:147], a[4:7], v[224:227]
    ds_read_b64_tr_b16 a[16:17], v12 offset:49152
    v_mfma_f32_16x16x32_bf16 v[228:231], a[148:151], a[4:7], v[228:231]
    ds_read_b64_tr_b16 a[18:19], v12 offset:50176
    v_mfma_f32_16x16x32_bf16 v[228:231], a[132:135], a[0:3], v[228:231]
    ds_read_b64_tr_b16 a[20:21], v12 offset:57344
    buffer_load_dwordx4 v[72:75], v9, s[20:23], s66 offen offset:2048 sc1
    v_mfma_f32_16x16x32_bf16 v[232:235], a[136:139], a[0:3], v[232:235]
    ds_read_b64_tr_b16 a[22:23], v12 offset:58368
    v_mfma_f32_16x16x32_bf16 v[232:235], a[152:155], a[4:7], v[232:235]
    ds_read_b64_tr_b16 a[24:25], v13 offset:49152
    v_mfma_f32_16x16x32_bf16 v[236:239], a[156:159], a[4:7], v[236:239]
    ds_read_b64_tr_b16 a[26:27], v13 offset:50176
    buffer_load_dwordx4 v[76:79], v9, s[20:23], s66 offen offset:3072 sc1
    v_mfma_f32_16x16x32_bf16 v[236:239], a[140:143], a[0:3], v[236:239]
    ds_read_b64_tr_b16 a[28:29], v13 offset:57344
    v_mfma_f32_16x16x32_bf16 v[252:255], a[140:143], a[8:11], v[252:255]
    ds_read_b64_tr_b16 a[30:31], v13 offset:58368
    v_mfma_f32_16x16x32_bf16 v[252:255], a[156:159], a[12:15], v[252:255]
    s_add_u32 s66, s66, 4096
    v_mfma_f32_16x16x32_bf16 v[248:251], a[152:155], a[12:15], v[248:251]
    v_mfma_f32_16x16x32_bf16 v[248:251], a[136:139], a[8:11], v[248:251]
    v_mfma_f32_16x16x32_bf16 v[244:247], a[132:135], a[8:11], v[244:247]
    buffer_load_dwordx4 v[80:83], v9, s[20:23], s66 offen offset:0 sc1
    v_mfma_f32_16x16x32_bf16 v[244:247], a[148:151], a[12:15], v[244:247]
    v_mfma_f32_16x16x32_bf16 v[240:243], a[144:147], a[12:15], v[240:243]
    v_mfma_f32_16x16x32_bf16 v[240:243], a[128:131], a[8:11], v[240:243]
    s_waitcnt vmcnt(7) lgkmcnt(4)
    v_mfma_f32_16x16x32_bf16 v[160:163], a[32:35], a[16:19], v[160:163]
    buffer_load_dwordx4 v[84:87], v9, s[20:23], s66 offen offset:1024 sc1
    v_mfma_f32_16x16x32_bf16 v[160:163], a[48:51], a[20:23], v[160:163]
    ds_read_b64_tr_b16 a[0:1], v16 offset:49152
    v_mfma_f32_16x16x32_bf16 v[164:167], a[52:55], a[20:23], v[164:167]
    ds_read_b64_tr_b16 a[2:3], v16 offset:50176
    v_mfma_f32_16x16x32_bf16 v[164:167], a[36:39], a[16:19], v[164:167]
    ds_read_b64_tr_b16 a[4:5], v16 offset:57344
    v_mfma_f32_16x16x32_bf16 v[168:171], a[40:43], a[16:19], v[168:171]
    ds_read_b64_tr_b16 a[6:7], v16 offset:58368
    v_mfma_f32_16x16x32_bf16 v[168:171], a[56:59], a[20:23], v[168:171]
    ds_read_b64_tr_b16 a[8:9], v17 offset:49152
    buffer_load_dwordx4 v[88:91], v9, s[20:23], s66 offen offset:2048 sc1
    v_mfma_f32_16x16x32_bf16 v[172:175], a[60:63], a[20:23], v[172:175]
    ds_read_b64_tr_b16 a[10:11], v17 offset:50176
    v_mfma_f32_16x16x32_bf16 v[172:175], a[44:47], a[16:19], v[172:175]
    ds_read_b64_tr_b16 a[12:13], v17 offset:57344
    s_waitcnt lgkmcnt(4)
    v_mfma_f32_16x16x32_bf16 v[188:191], a[44:47], a[24:27], v[188:191]
    ds_read_b64_tr_b16 a[14:15], v17 offset:58368
    v_mfma_f32_16x16x32_bf16 v[188:191], a[60:63], a[28:31], v[188:191]
    v_mfma_f32_16x16x32_bf16 v[184:187], a[56:59], a[28:31], v[184:187]
    buffer_load_dwordx4 v[92:95], v9, s[20:23], s66 offen offset:3072 sc1
    v_mfma_f32_16x16x32_bf16 v[184:187], a[40:43], a[24:27], v[184:187]
    v_mfma_f32_16x16x32_bf16 v[180:183], a[36:39], a[24:27], v[180:183]
    v_mfma_f32_16x16x32_bf16 v[180:183], a[52:55], a[28:31], v[180:183]
    v_mfma_f32_16x16x32_bf16 v[176:179], a[48:51], a[28:31], v[176:179]
    v_mfma_f32_16x16x32_bf16 v[176:179], a[32:35], a[24:27], v[176:179]
    v_mfma_f32_16x16x32_bf16 v[224:227], a[32:35], a[0:3], v[224:227]
    s_waitcnt lgkmcnt(4)
    v_mfma_f32_16x16x32_bf16 v[224:227], a[48:51], a[4:7], v[224:227]
    ds_read_b64_tr_b16 a[16:17], v10 offset:0
    v_mfma_f32_16x16x32_bf16 v[228:231], a[52:55], a[4:7], v[228:231]
    ds_read_b64_tr_b16 a[18:19], v10 offset:1024
    v_mfma_f32_16x16x32_bf16 v[228:231], a[36:39], a[0:3], v[228:231]
    ds_read_b64_tr_b16 a[20:21], v10 offset:8192
    v_mfma_f32_16x16x32_bf16 v[232:235], a[40:43], a[0:3], v[232:235]
    ds_read_b64_tr_b16 a[22:23], v10 offset:9216
    v_mfma_f32_16x16x32_bf16 v[232:235], a[56:59], a[4:7], v[232:235]
    ds_read_b64_tr_b16 a[24:25], v11 offset:0
    v_mfma_f32_16x16x32_bf16 v[236:239], a[60:63], a[4:7], v[236:239]
    ds_read_b64_tr_b16 a[26:27], v11 offset:1024
    v_mfma_f32_16x16x32_bf16 v[236:239], a[44:47], a[0:3], v[236:239]
    ds_read_b64_tr_b16 a[28:29], v11 offset:8192
    s_waitcnt lgkmcnt(4)
    v_mfma_f32_16x16x32_bf16 v[252:255], a[44:47], a[8:11], v[252:255]
    ds_read_b64_tr_b16 a[30:31], v11 offset:9216
    v_mfma_f32_16x16x32_bf16 v[252:255], a[60:63], a[12:15], v[252:255]
    v_mfma_f32_16x16x32_bf16 v[248:251], a[56:59], a[12:15], v[248:251]
    v_mfma_f32_16x16x32_bf16 v[248:251], a[40:43], a[8:11], v[248:251]
    v_mfma_f32_16x16x32_bf16 v[244:247], a[36:39], a[8:11], v[244:247]
    v_mfma_f32_16x16x32_bf16 v[244:247], a[52:55], a[12:15], v[244:247]
    v_mfma_f32_16x16x32_bf16 v[240:243], a[48:51], a[12:15], v[240:243]
    v_mfma_f32_16x16x32_bf16 v[240:243], a[32:35], a[8:11], v[240:243]
    v_mfma_f32_16x16x32_bf16 v[128:131], a[64:67], a[16:19], v[128:131]
    s_waitcnt lgkmcnt(4)
    v_mfma_f32_16x16x32_bf16 v[128:131], a[80:83], a[20:23], v[128:131]
    ds_read_b64_tr_b16 a[0:1], v14 offset:0
    v_mfma_f32_16x16x32_bf16 v[132:135], a[84:87], a[20:23], v[132:135]
    ds_read_b64_tr_b16 a[2:3], v14 offset:1024
    v_mfma_f32_16x16x32_bf16 v[132:135], a[68:71], a[16:19], v[132:135]
    ds_read_b64_tr_b16 a[4:5], v14 offset:8192
    v_mfma_f32_16x16x32_bf16 v[136:139], a[72:75], a[16:19], v[136:139]
    ds_read_b64_tr_b16 a[6:7], v14 offset:9216
    v_mfma_f32_16x16x32_bf16 v[136:139], a[88:91], a[20:23], v[136:139]
    ds_read_b64_tr_b16 a[8:9], v15 offset:0
    v_mfma_f32_16x16x32_bf16 v[140:143], a[92:95], a[20:23], v[140:143]
    ds_read_b64_tr_b16 a[10:11], v15 offset:1024
    v_mfma_f32_16x16x32_bf16 v[140:143], a[76:79], a[16:19], v[140:143]
    ds_read_b64_tr_b16 a[12:13], v15 offset:8192
    s_waitcnt lgkmcnt(4)
    v_mfma_f32_16x16x32_bf16 v[156:159], a[76:79], a[24:27], v[156:159]
    ds_read_b64_tr_b16 a[14:15], v15 offset:9216
    v_mfma_f32_16x16x32_bf16 v[156:159], a[92:95], a[28:31], v[156:159]
    v_mfma_f32_16x16x32_bf16 v[152:155], a[88:91], a[28:31], v[152:155]
    v_mfma_f32_16x16x32_bf16 v[152:155], a[72:75], a[24:27], v[152:155]
    v_mfma_f32_16x16x32_bf16 v[148:151], a[68:71], a[24:27], v[148:151]
    v_mfma_f32_16x16x32_bf16 v[148:151], a[84:87], a[28:31], v[148:151]
    v_mfma_f32_16x16x32_bf16 v[144:147], a[80:83], a[28:31], v[144:147]
    v_mfma_f32_16x16x32_bf16 v[144:147], a[64:67], a[24:27], v[144:147]
    v_mfma_f32_16x16x32_bf16 v[192:195], a[64:67], a[0:3], v[192:195]
    s_waitcnt lgkmcnt(4)
    v_mfma_f32_16x16x32_bf16 v[192:195], a[80:83], a[4:7], v[192:195]
    ds_read_b64_tr_b16 a[16:17], v10 offset:16384
    s_waitcnt lgkmcnt(0)
    s_barrier
    v_mfma_f32_16x16x32_bf16 v[196:199], a[84:87], a[4:7], v[196:199]
    ds_read_b64_tr_b16 a[18:19], v10 offset:17408
    ds_write_b128 v20, v[224:227] offset:0
    v_mfma_f32_16x16x32_bf16 v[196:199], a[68:71], a[0:3], v[196:199]
    ds_read_b64_tr_b16 a[20:21], v10 offset:24576
    v_mfma_f32_16x16x32_bf16 v[200:203], a[72:75], a[0:3], v[200:203]
    ds_read_b64_tr_b16 a[22:23], v10 offset:25600
    ds_write_b128 v20, v[228:231] offset:1024
    v_mfma_f32_16x16x32_bf16 v[200:203], a[88:91], a[4:7], v[200:203]
    ds_read_b64_tr_b16 a[24:25], v11 offset:16384
    v_mfma_f32_16x16x32_bf16 v[204:207], a[92:95], a[4:7], v[204:207]
    ds_read_b64_tr_b16 a[26:27], v11 offset:17408
    ds_write_b128 v20, v[232:235] offset:2048
    v_mfma_f32_16x16x32_bf16 v[204:207], a[76:79], a[0:3], v[204:207]
    ds_read_b64_tr_b16 a[28:29], v11 offset:24576
    v_mfma_f32_16x16x32_bf16 v[220:223], a[76:79], a[8:11], v[220:223]
    ds_read_b64_tr_b16 a[30:31], v11 offset:25600
    ds_write_b128 v20, v[236:239] offset:3072
    v_mfma_f32_16x16x32_bf16 v[220:223], a[92:95], a[12:15], v[220:223]
    v_mfma_f32_16x16x32_bf16 v[216:219], a[88:91], a[12:15], v[216:219]
    ds_write_b128 v20, v[240:243] offset:4096
    v_mfma_f32_16x16x32_bf16 v[216:219], a[72:75], a[8:11], v[216:219]
    v_mfma_f32_16x16x32_bf16 v[212:215], a[68:71], a[8:11], v[212:215]
    ds_write_b128 v20, v[244:247] offset:5120
    v_mfma_f32_16x16x32_bf16 v[212:215], a[84:87], a[12:15], v[212:215]
    v_mfma_f32_16x16x32_bf16 v[208:211], a[80:83], a[12:15], v[208:211]
    ds_write_b128 v20, v[248:251] offset:6144
    v_mfma_f32_16x16x32_bf16 v[208:211], a[64:67], a[8:11], v[208:211]
    s_waitcnt lgkmcnt(4)
    v_mfma_f32_16x16x32_bf16 v[128:131], a[96:99], a[16:19], v[128:131]
    ds_write_b128 v20, v[252:255] offset:7168
    v_mfma_f32_16x16x32_bf16 v[128:131], a[112:115], a[20:23], v[128:131]
    ds_read_b64_tr_b16 a[0:1], v14 offset:16384
    v_mfma_f32_16x16x32_bf16 v[132:135], a[116:119], a[20:23], v[132:135]
    ds_read_b64_tr_b16 a[2:3], v14 offset:17408
    v_mfma_f32_16x16x32_bf16 v[132:135], a[100:103], a[16:19], v[132:135]
    ds_read_b64_tr_b16 a[4:5], v14 offset:24576
    v_mfma_f32_16x16x32_bf16 v[136:139], a[104:107], a[16:19], v[136:139]
    ds_read_b64_tr_b16 a[6:7], v14 offset:25600
    s_waitcnt lgkmcnt(0)
    s_barrier
    v_mfma_f32_16x16x32_bf16 v[136:139], a[120:123], a[20:23], v[136:139]
    ds_read_b64_tr_b16 a[8:9], v15 offset:16384
    ds_read_b128 v[224:227], v21 offset:0
    v_mfma_f32_16x16x32_bf16 v[140:143], a[124:127], a[20:23], v[140:143]
    ds_read_b64_tr_b16 a[10:11], v15 offset:17408
    ds_read_b128 v[228:231], v21 offset:1024
    v_mfma_f32_16x16x32_bf16 v[140:143], a[108:111], a[16:19], v[140:143]
    ds_read_b64_tr_b16 a[12:13], v15 offset:24576
    ds_read_b128 v[232:235], v21 offset:2048
    v_mfma_f32_16x16x32_bf16 v[156:159], a[108:111], a[24:27], v[156:159]
    ds_read_b64_tr_b16 a[14:15], v15 offset:25600
    ds_read_b128 v[236:239], v21 offset:3072
    v_mfma_f32_16x16x32_bf16 v[156:159], a[124:127], a[28:31], v[156:159]
    ds_read_b128 v[240:243], v21 offset:4096
    v_mfma_f32_16x16x32_bf16 v[152:155], a[120:123], a[28:31], v[152:155]
    ds_read_b128 v[244:247], v21 offset:5120
    v_mfma_f32_16x16x32_bf16 v[152:155], a[104:107], a[24:27], v[152:155]
    ds_read_b128 v[248:251], v21 offset:6144
    v_mfma_f32_16x16x32_bf16 v[148:151], a[100:103], a[24:27], v[148:151]
    ds_read_b128 v[252:255], v21 offset:7168
    v_mfma_f32_16x16x32_bf16 v[148:151], a[116:119], a[28:31], v[148:151]
    v_mfma_f32_16x16x32_bf16 v[144:147], a[112:115], a[28:31], v[144:147]
    v_mfma_f32_16x16x32_bf16 v[144:147], a[96:99], a[24:27], v[144:147]
    v_mfma_f32_16x16x32_bf16 v[192:195], a[96:99], a[0:3], v[192:195]
    s_waitcnt lgkmcnt(4)
    v_add_f32 v160, v160, v224
    v_add_f32 v161, v161, v225
    v_add_f32 v162, v162, v226
    v_add_f32 v163, v163, v227
    v_mfma_f32_16x16x32_bf16 v[192:195], a[112:115], a[4:7], v[192:195]
    ds_read_b64_tr_b16 a[16:17], v10 offset:32768
    buffer_store_dwordx4 v[160:163], v9, s[20:23], s42 offen offset:0 sc1
    v_mfma_f32_16x16x32_bf16 v[196:199], a[116:119], a[4:7], v[196:199]
    ds_read_b64_tr_b16 a[18:19], v10 offset:33792
    v_mfma_f32_16x16x32_bf16 v[196:199], a[100:103], a[0:3], v[196:199]
    ds_read_b64_tr_b16 a[20:21], v10 offset:40960
    v_add_f32 v164, v164, v228
    v_add_f32 v165, v165, v229
    v_add_f32 v166, v166, v230
    v_add_f32 v167, v167, v231
    v_mfma_f32_16x16x32_bf16 v[200:203], a[104:107], a[0:3], v[200:203]
    ds_read_b64_tr_b16 a[22:23], v10 offset:41984
    buffer_store_dwordx4 v[164:167], v9, s[20:23], s42 offen offset:1024 sc1
    v_mfma_f32_16x16x32_bf16 v[200:203], a[120:123], a[4:7], v[200:203]
    ds_read_b64_tr_b16 a[24:25], v11 offset:32768
    v_mfma_f32_16x16x32_bf16 v[204:207], a[124:127], a[4:7], v[204:207]
    ds_read_b64_tr_b16 a[26:27], v11 offset:33792
    v_add_f32 v168, v168, v232
    v_add_f32 v169, v169, v233
    v_add_f32 v170, v170, v234
    v_add_f32 v171, v171, v235
    v_mfma_f32_16x16x32_bf16 v[204:207], a[108:111], a[0:3], v[204:207]
    ds_read_b64_tr_b16 a[28:29], v11 offset:40960
    buffer_store_dwordx4 v[168:171], v9, s[20:23], s42 offen offset:2048 sc1
    v_mfma_f32_16x16x32_bf16 v[220:223], a[108:111], a[8:11], v[220:223]
    ds_read_b64_tr_b16 a[30:31], v11 offset:41984
    v_mfma_f32_16x16x32_bf16 v[220:223], a[124:127], a[12:15], v[220:223]
    v_add_f32 v172, v172, v236
    v_add_f32 v173, v173, v237
    v_add_f32 v174, v174, v238
    v_add_f32 v175, v175, v239
    v_mfma_f32_16x16x32_bf16 v[216:219], a[120:123], a[12:15], v[216:219]
    buffer_store_dwordx4 v[172:175], v9, s[20:23], s42 offen offset:3072 sc1
    v_mfma_f32_16x16x32_bf16 v[216:219], a[104:107], a[8:11], v[216:219]
    v_mfma_f32_16x16x32_bf16 v[212:215], a[100:103], a[8:11], v[212:215]
    s_waitcnt lgkmcnt(4)
    v_add_f32 v176, v176, v240
    v_add_f32 v177, v177, v241
    v_add_f32 v178, v178, v242
    v_add_f32_e64 v179, v179, v243
    v_mfma_f32_16x16x32_bf16 v[212:215], a[116:119], a[12:15], v[212:215]
    buffer_store_dwordx4 v[176:179], v9, s[20:23], s43 offen offset:0 sc1
    v_mfma_f32_16x16x32_bf16 v[208:211], a[112:115], a[12:15], v[208:211]
    v_mfma_f32_16x16x32_bf16 v[208:211], a[96:99], a[8:11], v[208:211]
    v_add_f32 v180, v180, v244
    v_add_f32 v181, v181, v245
    v_add_f32 v182, v182, v246
    v_add_f32 v183, v183, v247
    v_mfma_f32_16x16x32_bf16 v[128:131], a[128:131], a[16:19], v[128:131]
    buffer_store_dwordx4 v[180:183], v9, s[20:23], s43 offen offset:1024 sc1
    v_mfma_f32_16x16x32_bf16 v[128:131], a[144:147], a[20:23], v[128:131]
    ds_read_b64_tr_b16 a[0:1], v14 offset:32768
    v_mfma_f32_16x16x32_bf16 v[132:135], a[148:151], a[20:23], v[132:135]
    ds_read_b64_tr_b16 a[2:3], v14 offset:33792
    v_add_f32 v184, v184, v248
    v_add_f32 v185, v185, v249
    v_add_f32 v186, v186, v250
    v_add_f32 v187, v187, v251
    v_mfma_f32_16x16x32_bf16 v[132:135], a[132:135], a[16:19], v[132:135]
    ds_read_b64_tr_b16 a[4:5], v14 offset:40960
    buffer_store_dwordx4 v[184:187], v9, s[20:23], s43 offen offset:2048 sc1
    v_mfma_f32_16x16x32_bf16 v[136:139], a[136:139], a[16:19], v[136:139]
    ds_read_b64_tr_b16 a[6:7], v14 offset:41984
    v_mfma_f32_16x16x32_bf16 v[136:139], a[152:155], a[20:23], v[136:139]
    ds_read_b64_tr_b16 a[8:9], v15 offset:32768
    v_add_f32 v188, v188, v252
    v_add_f32 v189, v189, v253
    v_add_f32 v190, v190, v254
    v_add_f32 v191, v191, v255
    v_mfma_f32_16x16x32_bf16 v[140:143], a[156:159], a[20:23], v[140:143]
    ds_read_b64_tr_b16 a[10:11], v15 offset:33792
    buffer_store_dwordx4 v[188:191], v9, s[20:23], s43 offen offset:3072 sc1
    v_mfma_f32_16x16x32_bf16 v[140:143], a[140:143], a[16:19], v[140:143]
    ds_read_b64_tr_b16 a[12:13], v15 offset:40960
    s_waitcnt lgkmcnt(4)
    v_mfma_f32_16x16x32_bf16 v[156:159], a[140:143], a[24:27], v[156:159]
    ds_read_b64_tr_b16 a[14:15], v15 offset:41984
    s_waitcnt lgkmcnt(0)
    s_barrier
    v_mfma_f32_16x16x32_bf16 v[156:159], a[156:159], a[28:31], v[156:159]
    v_mfma_f32_16x16x32_bf16 v[152:155], a[152:155], a[28:31], v[152:155]
    ds_read_b64_tr_b16 v[48:49], v22 offset:4096
    v_mfma_f32_16x16x32_bf16 v[152:155], a[136:139], a[24:27], v[152:155]
    ds_read_b64_tr_b16 v[50:51], v22 offset:5120
    v_mfma_f32_16x16x32_bf16 v[148:151], a[132:135], a[24:27], v[148:151]
    ds_read_b64_tr_b16 v[52:53], v22 offset:6144
    v_mfma_f32_16x16x32_bf16 v[148:151], a[148:151], a[28:31], v[148:151]
    ds_read_b64_tr_b16 v[54:55], v22 offset:7168
    v_mfma_f32_16x16x32_bf16 v[144:147], a[144:147], a[28:31], v[144:147]
    ds_read_b64_tr_b16 v[56:57], v22 offset:4608
    v_mfma_f32_16x16x32_bf16 v[144:147], a[128:131], a[24:27], v[144:147]
    ds_read_b64_tr_b16 v[58:59], v22 offset:5632
    v_mfma_f32_16x16x32_bf16 v[192:195], a[128:131], a[0:3], v[192:195]
    ds_read_b64_tr_b16 v[60:61], v22 offset:6656
    v_mfma_f32_16x16x32_bf16 v[192:195], a[144:147], a[4:7], v[192:195]
    ds_read_b64_tr_b16 a[16:17], v10 offset:49152
    ds_read_b64_tr_b16 v[62:63], v22 offset:7680
    v_mfma_f32_16x16x32_bf16 v[196:199], a[148:151], a[4:7], v[196:199]
    ds_read_b64_tr_b16 a[18:19], v10 offset:50176
    v_mfma_f32_16x16x32_bf16 v[196:199], a[132:135], a[0:3], v[196:199]
    ds_read_b64_tr_b16 a[20:21], v10 offset:57344
    v_mfma_f32_16x16x32_bf16 v[200:203], a[136:139], a[0:3], v[200:203]
    ds_read_b64_tr_b16 a[22:23], v10 offset:58368
    v_mfma_f32_16x16x32_bf16 v[200:203], a[152:155], a[4:7], v[200:203]
    ds_read_b64_tr_b16 a[24:25], v11 offset:49152
    v_mfma_f32_16x16x32_bf16 v[204:207], a[156:159], a[4:7], v[204:207]
    ds_read_b64_tr_b16 a[26:27], v11 offset:50176
    v_mfma_f32_16x16x32_bf16 v[204:207], a[140:143], a[0:3], v[204:207]
    ds_read_b64_tr_b16 a[28:29], v11 offset:57344
    v_mfma_f32_16x16x32_bf16 v[220:223], a[140:143], a[8:11], v[220:223]
    ds_read_b64_tr_b16 a[30:31], v11 offset:58368
    v_mfma_f32_16x16x32_bf16 v[220:223], a[156:159], a[12:15], v[220:223]
    v_mfma_f32_16x16x32_bf16 v[216:219], a[152:155], a[12:15], v[216:219]
    v_mfma_f32_16x16x32_bf16 v[216:219], a[136:139], a[8:11], v[216:219]
    v_mfma_f32_16x16x32_bf16 v[212:215], a[132:135], a[8:11], v[212:215]
    v_mfma_f32_16x16x32_bf16 v[212:215], a[148:151], a[12:15], v[212:215]
    v_mfma_f32_16x16x32_bf16 v[208:211], a[144:147], a[12:15], v[208:211]
    v_mfma_f32_16x16x32_bf16 v[208:211], a[128:131], a[8:11], v[208:211]
    s_waitcnt lgkmcnt(4)
    v_mfma_f32_16x16x32_bf16 v[128:131], a[32:35], a[16:19], v[128:131]
    v_mfma_f32_16x16x32_bf16 v[128:131], a[48:51], a[20:23], v[128:131]
    ds_read_b64_tr_b16 a[0:1], v14 offset:49152
    v_mfma_f32_16x16x32_bf16 v[132:135], a[52:55], a[20:23], v[132:135]
    ds_read_b64_tr_b16 a[2:3], v14 offset:50176
    v_mfma_f32_16x16x32_bf16 v[132:135], a[36:39], a[16:19], v[132:135]
    ds_read_b64_tr_b16 a[4:5], v14 offset:57344
    v_mfma_f32_16x16x32_bf16 v[136:139], a[40:43], a[16:19], v[136:139]
    ds_read_b64_tr_b16 a[6:7], v14 offset:58368
    v_mfma_f32_16x16x32_bf16 v[136:139], a[56:59], a[20:23], v[136:139]
    ds_read_b64_tr_b16 a[8:9], v15 offset:49152
    v_mfma_f32_16x16x32_bf16 v[140:143], a[60:63], a[20:23], v[140:143]
    ds_read_b64_tr_b16 a[10:11], v15 offset:50176
    v_mfma_f32_16x16x32_bf16 v[140:143], a[44:47], a[16:19], v[140:143]
    ds_read_b64_tr_b16 a[12:13], v15 offset:57344
    s_waitcnt lgkmcnt(4)
    v_mfma_f32_16x16x32_bf16 v[156:159], a[44:47], a[24:27], v[156:159]
    ds_read_b64_tr_b16 a[14:15], v15 offset:58368
    v_mfma_f32_16x16x32_bf16 v[156:159], a[60:63], a[28:31], v[156:159]
    v_mfma_f32_16x16x32_bf16 v[152:155], a[56:59], a[28:31], v[152:155]
    v_mfma_f32_16x16x32_bf16 v[152:155], a[40:43], a[24:27], v[152:155]
    v_mfma_f32_16x16x32_bf16 v[148:151], a[36:39], a[24:27], v[148:151]
    v_mfma_f32_16x16x32_bf16 v[148:151], a[52:55], a[28:31], v[148:151]
    v_mfma_f32_16x16x32_bf16 v[144:147], a[48:51], a[28:31], v[144:147]
    v_mfma_f32_16x16x32_bf16 v[144:147], a[32:35], a[24:27], v[144:147]
    v_mfma_f32_16x16x32_bf16 v[192:195], a[32:35], a[0:3], v[192:195]
    s_waitcnt lgkmcnt(4)
    v_mfma_f32_16x16x32_bf16 v[192:195], a[48:51], a[4:7], v[192:195]
    ds_read_b64_tr_b16 v[32:33], v25 offset:0
    v_mfma_f32_16x16x32_bf16 v[196:199], a[52:55], a[4:7], v[196:199]
    ds_read_b64_tr_b16 v[34:35], v25 offset:256
    v_mfma_f32_16x16x32_bf16 v[196:199], a[36:39], a[0:3], v[196:199]
    ds_read_b64_tr_b16 v[36:37], v25 offset:512
    v_mfma_f32_16x16x32_bf16 v[200:203], a[40:43], a[0:3], v[200:203]
    ds_read_b64_tr_b16 v[38:39], v25 offset:768
    v_mfma_f32_16x16x32_bf16 v[200:203], a[56:59], a[4:7], v[200:203]
    ds_read_b64_tr_b16 v[40:41], v25 offset:32
    v_mfma_f32_16x16x32_bf16 v[204:207], a[60:63], a[4:7], v[204:207]
    ds_read_b64_tr_b16 v[42:43], v25 offset:288
    v_mfma_f32_16x16x32_bf16 v[204:207], a[44:47], a[0:3], v[204:207]
    ds_read_b64_tr_b16 v[44:45], v25 offset:544
    s_waitcnt lgkmcnt(4)
    v_mfma_f32_16x16x32_bf16 v[220:223], a[44:47], a[8:11], v[220:223]
    ds_read_b64_tr_b16 v[46:47], v25 offset:800
    v_mfma_f32_16x16x32_bf16 v[220:223], a[60:63], a[12:15], v[220:223]
    v_mfma_f32_16x16x32_bf16 v[216:219], a[56:59], a[12:15], v[216:219]
    v_mfma_f32_16x16x32_bf16 v[216:219], a[40:43], a[8:11], v[216:219]
    v_mfma_f32_16x16x32_bf16 v[212:215], a[36:39], a[8:11], v[212:215]
    v_mfma_f32_16x16x32_bf16 v[212:215], a[52:55], a[12:15], v[212:215]
    v_mfma_f32_16x16x32_bf16 v[208:211], a[48:51], a[12:15], v[208:211]
    v_mfma_f32_16x16x32_bf16 v[208:211], a[32:35], a[8:11], v[208:211]
L_k3_epiffn:
    v_add_u32 v2, 16384, v20
    v_add_u32 v3, 16384, v21
    s_mov_b32 s12, s46
    s_mov_b32 s13, s47
    s_mov_b32 s14, 8388608
    s_mov_b32 s15, 0x00020000
    s_lshl_b32 s60, s39, 1
    s_mov_b32 s4, 0xbfb8aa3b
    s_mov_b32 s5, s4
    ds_write_b128 v2, v[192:195] offset:0
    ds_write_b128 v2, v[196:199] offset:1024
    ds_write_b128 v2, v[200:203] offset:2048
    ds_write_b128 v2, v[204:207] offset:3072
    ds_write_b128 v2, v[208:211] offset:4096
    ds_write_b128 v2, v[212:215] offset:5120
    ds_write_b128 v2, v[216:219] offset:6144
    ds_write_b128 v2, v[220:223] offset:7168
    s_waitcnt vmcnt(0)
    buffer_store_dwordx2 a[248:249], off, s[20:23], s86 sc1
    s_waitcnt lgkmcnt(0)
    s_barrier
    ds_read_b128 v[192:195], v3 offset:0
    ds_read_b128 v[196:199], v3 offset:1024
    ds_read_b128 v[200:203], v3 offset:2048
    ds_read_b128 v[204:207], v3 offset:3072
    ds_read_b128 v[208:211], v3 offset:4096
    ds_read_b128 v[212:215], v3 offset:5120
    ds_read_b128 v[216:219], v3 offset:6144
    ds_read_b128 v[220:223], v3 offset:7168
    s_add_u32 s68, s60, 0
    s_add_u32 s69, s60, 4096
    s_add_u32 s70, s60, 8192
    s_add_u32 s71, s60, 12288
    s_add_u32 s72, s60, 16384
    s_add_u32 s73, s60, 20480
    s_add_u32 s74, s60, 24576
    s_add_u32 s75, s60, 28672
    s_add_u32 s76, s60, 32768
    s_add_u32 s77, s60, 36864
    s_add_u32 s78, s60, 40960
    s_add_u32 s79, s60, 45056
    s_add_u32 s80, s60, 49152
    s_add_u32 s81, s60, 53248
    s_add_u32 s82, s60, 57344
    s_add_u32 s83, s60, 61440
    v_lshlrev_b32 v10, 16, v28
    v_lshlrev_b32 v12, 16, v29
    v_lshlrev_b32 v160, 16, v48
    v_and_b32 v161, 0xffff0000, v48
    v_lshlrev_b32_e64 v162, 16, v49
    v_and_b32 v163, 0xffff0000, v49
    v_pk_mul_f32 v[160:161], v[160:161], v[10:11] op_sel_hi:[1,0]
    v_pk_mul_f32 v[162:163], v[162:163], v[10:11] op_sel_hi:[1,0]
    v_cvt_pk_bf16_f32 v48, v160, v161
    v_cvt_pk_bf16_f32 v49, v162, v163
    v_lshlrev_b32_e64 v160, 16, v48
    v_and_b32 v161, 0xffff0000, v48
    v_lshlrev_b32_e64 v162, 16, v49
    v_and_b32 v163, 0xffff0000, v49
    v_lshlrev_b32_e64 v224, 16, v32
    v_and_b32 v225, 0xffff0000, v32
    v_lshlrev_b32_e64 v226, 16, v33
    v_and_b32 v227, 0xffff0000, v33
    v_lshlrev_b32_e64 v164, 16, v50
    v_and_b32 v165, 0xffff0000, v50
    v_lshlrev_b32_e64 v166, 16, v51
    v_and_b32 v167, 0xffff0000, v51
    v_pk_mul_f32 v[164:165], v[164:165], v[10:11] op_sel_hi:[1,0]
    v_pk_mul_f32 v[166:167], v[166:167], v[10:11] op_sel_hi:[1,0]
    v_cvt_pk_bf16_f32 v50, v164, v165
    v_cvt_pk_bf16_f32 v51, v166, v167
    v_lshlrev_b32_e64 v164, 16, v50
    v_and_b32 v165, 0xffff0000, v50
    v_lshlrev_b32_e64 v166, 16, v51
    v_and_b32 v167, 0xffff0000, v51
    v_lshlrev_b32_e64 v228, 16, v34
    v_and_b32 v229, 0xffff0000, v34
    v_lshlrev_b32_e64 v230, 16, v35
    v_and_b32 v231, 0xffff0000, v35
    v_lshlrev_b32_e64 v168, 16, v52
    v_and_b32 v169, 0xffff0000, v52
    v_lshlrev_b32_e64 v170, 16, v53
    v_and_b32 v171, 0xffff0000, v53
    v_pk_mul_f32 v[168:169], v[168:169], v[10:11] op_sel_hi:[1,0]
    v_pk_mul_f32 v[170:171], v[170:171], v[10:11] op_sel_hi:[1,0]
    v_cvt_pk_bf16_f32 v52, v168, v169
    v_cvt_pk_bf16_f32 v53, v170, v171
    v_lshlrev_b32_e64 v168, 16, v52
    v_and_b32 v169, 0xffff0000, v52
    v_lshlrev_b32_e64 v170, 16, v53
    v_and_b32 v171, 0xffff0000, v53
    v_lshlrev_b32_e64 v232, 16, v36
    v_and_b32 v233, 0xffff0000, v36
    v_lshlrev_b32_e64 v234, 16, v37
    v_and_b32 v235, 0xffff0000, v37
    v_lshlrev_b32_e64 v172, 16, v54
    v_and_b32 v173, 0xffff0000, v54
    v_lshlrev_b32_e64 v174, 16, v55
    v_and_b32 v175, 0xffff0000, v55
    v_pk_mul_f32 v[172:173], v[172:173], v[10:11] op_sel_hi:[1,0]
    v_pk_mul_f32 v[174:175], v[174:175], v[10:11] op_sel_hi:[1,0]
    v_cvt_pk_bf16_f32 v54, v172, v173
    v_cvt_pk_bf16_f32 v55, v174, v175
    v_lshlrev_b32_e64 v172, 16, v54
    v_and_b32 v173, 0xffff0000, v54
    v_lshlrev_b32_e64 v174, 16, v55
    v_and_b32 v175, 0xffff0000, v55
    v_lshlrev_b32_e64 v236, 16, v38
    v_and_b32 v237, 0xffff0000, v38
    v_lshlrev_b32_e64 v238, 16, v39
    v_and_b32 v239, 0xffff0000, v39
    buffer_load_dwordx2 v[26:27], off, s[20:23], s67 sc1
    v_lshlrev_b32_e64 v176, 16, v56
    v_and_b32 v177, 0xffff0000, v56
    v_lshlrev_b32_e64 v178, 16, v57
    v_and_b32 v179, 0xffff0000, v57
    v_pk_mul_f32 v[176:177], v[176:177], v[12:13] op_sel_hi:[1,0]
    v_pk_mul_f32 v[178:179], v[178:179], v[12:13] op_sel_hi:[1,0]
    v_cvt_pk_bf16_f32 v56, v176, v177
    v_cvt_pk_bf16_f32 v57, v178, v179
    v_lshlrev_b32_e64 v176, 16, v56
    v_and_b32 v177, 0xffff0000, v56
    v_lshlrev_b32_e64 v178, 16, v57
    v_and_b32 v179, 0xffff0000, v57
    v_lshlrev_b32_e64 v240, 16, v40
    v_and_b32 v241, 0xffff0000, v40
    v_lshlrev_b32_e64 v242, 16, v41
    v_and_b32 v243, 0xffff0000, v41
    v_lshlrev_b32_e64 v180, 16, v58
    v_and_b32 v181, 0xffff0000, v58
    v_lshlrev_b32_e64 v182, 16, v59
    v_and_b32 v183, 0xffff0000, v59
    v_pk_mul_f32 v[180:181], v[180:181], v[12:13] op_sel_hi:[1,0]
    v_pk_mul_f32 v[182:183], v[182:183], v[12:13] op_sel_hi:[1,0]
    v_cvt_pk_bf16_f32 v58, v180, v181
    v_cvt_pk_bf16_f32 v59, v182, v183
    v_lshlrev_b32_e64 v180, 16, v58
    v_and_b32 v181, 0xffff0000, v58
    v_lshlrev_b32_e64 v182, 16, v59
    v_and_b32 v183, 0xffff0000, v59
    v_lshlrev_b32_e64 v244, 16, v42
    v_and_b32 v245, 0xffff0000, v42
    v_lshlrev_b32_e64 v246, 16, v43
    v_and_b32 v247, 0xffff0000, v43
    v_lshlrev_b32_e64 v184, 16, v60
    v_and_b32 v185, 0xffff0000, v60
    v_lshlrev_b32_e64 v186, 16, v61
    v_and_b32 v187, 0xffff0000, v61
    v_pk_mul_f32 v[184:185], v[184:185], v[12:13] op_sel_hi:[1,0]
    v_pk_mul_f32 v[186:187], v[186:187], v[12:13] op_sel_hi:[1,0]
    v_cvt_pk_bf16_f32 v60, v184, v185
    v_cvt_pk_bf16_f32 v61, v186, v187
    v_lshlrev_b32_e64 v184, 16, v60
    v_and_b32 v185, 0xffff0000, v60
    v_lshlrev_b32_e64 v186, 16, v61
    v_and_b32 v187, 0xffff0000, v61
    v_lshlrev_b32_e64 v248, 16, v44
    v_and_b32 v249, 0xffff0000, v44
    v_lshlrev_b32_e64 v250, 16, v45
    v_and_b32 v251, 0xffff0000, v45
    v_lshlrev_b32_e64 v188, 16, v62
    v_and_b32 v189, 0xffff0000, v62
    v_lshlrev_b32_e64 v190, 16, v63
    v_and_b32 v191, 0xffff0000, v63
    v_pk_mul_f32 v[188:189], v[188:189], v[12:13] op_sel_hi:[1,0]
    v_pk_mul_f32 v[190:191], v[190:191], v[12:13] op_sel_hi:[1,0]
    v_cvt_pk_bf16_f32 v62, v188, v189
    v_cvt_pk_bf16_f32 v63, v190, v191
    v_lshlrev_b32_e64 v188, 16, v62
    v_and_b32 v189, 0xffff0000, v62
    v_lshlrev_b32_e64 v190, 16, v63
    v_and_b32 v191, 0xffff0000, v63
    v_lshlrev_b32_e64 v252, 16, v46
    v_and_b32 v253, 0xffff0000, v46
    v_lshlrev_b32_e64 v254, 16, v47
    v_and_b32 v255, 0xffff0000, v47
    s_waitcnt lgkmcnt(0)
    v_pk_add_f32 v[128:129], v[128:129], v[192:193]
    v_pk_add_f32 v[130:131], v[130:131], v[194:195]
    v_pk_add_f32 v[128:129], v[128:129], v[64:65]
    v_pk_add_f32 v[130:131], v[130:131], v[66:67]
    v_pk_mul_f32 v[192:193], v[128:129], s[4:5]
    v_pk_mul_f32 v[194:195], v[130:131], s[4:5]
    v_exp_f32 v192, v192
    v_exp_f32 v193, v193
    v_exp_f32 v194, v194
    v_exp_f32 v195, v195
    s_nop 0
    v_pk_add_f32 v[192:193], v[192:193], 1.0 op_sel_hi:[1,0]
    v_pk_add_f32 v[194:195], v[194:195], 1.0 op_sel_hi:[1,0]
    v_rcp_f32 v192, v192
    v_rcp_f32 v193, v193
    v_rcp_f32 v194, v194
    v_rcp_f32_e64 v195, v195
    s_nop 0
    v_pk_mul_f32 v[128:129], v[128:129], v[192:193]
    v_pk_mul_f32 v[130:131], v[130:131], v[194:195]
    v_pk_add_f32 v[132:133], v[132:133], v[196:197]
    v_pk_add_f32 v[134:135], v[134:135], v[198:199]
    v_pk_add_f32 v[132:133], v[132:133], v[68:69]
    v_pk_add_f32 v[134:135], v[134:135], v[70:71]
    v_pk_mul_f32 v[196:197], v[132:133], s[4:5]
    v_pk_mul_f32 v[198:199], v[134:135], s[4:5]
    v_exp_f32 v196, v196
    v_exp_f32 v197, v197
    v_exp_f32 v198, v198
    v_exp_f32_e64 v199, v199
    s_nop 0
    v_pk_add_f32 v[196:197], v[196:197], 1.0 op_sel_hi:[1,0]
    v_pk_add_f32 v[198:199], v[198:199], 1.0 op_sel_hi:[1,0]
    v_rcp_f32 v196, v196
    v_rcp_f32 v197, v197
    v_rcp_f32 v198, v198
    v_rcp_f32_e64 v199, v199
    s_nop 0
    v_pk_mul_f32 v[132:133], v[132:133], v[196:197]
    v_pk_mul_f32 v[134:135], v[134:135], v[198:199]
    v_pk_add_f32 v[136:137], v[136:137], v[200:201]
    v_pk_add_f32 v[138:139], v[138:139], v[202:203]
    v_pk_add_f32 v[136:137], v[136:137], v[72:73]
    v_pk_add_f32 v[138:139], v[138:139], v[74:75]
    v_pk_mul_f32 v[200:201], v[136:137], s[4:5]
    v_pk_mul_f32 v[202:203], v[138:139], s[4:5]
    v_exp_f32 v200, v200
    v_exp_f32 v201, v201
    v_exp_f32 v202, v202
    v_exp_f32_e64 v203, v203
    s_nop 0
    v_pk_add_f32 v[200:201], v[200:201], 1.0 op_sel_hi:[1,0]
    v_pk_add_f32 v[202:203], v[202:203], 1.0 op_sel_hi:[1,0]
    v_rcp_f32 v200, v200
    v_rcp_f32 v201, v201
    v_rcp_f32 v202, v202
    v_rcp_f32_e64 v203, v203
    s_nop 0
    v_pk_mul_f32 v[136:137], v[136:137], v[200:201]
    v_pk_mul_f32 v[138:139], v[138:139], v[202:203]
    s_mov_b32 s55, 0x40000
    s_waitcnt vmcnt(0)
L_wrffn:
    v_cmp_ne_u64 vcc, s[48:49], v[26:27]
    s_cbranch_vccz L_grffn
    s_sleep 1
    buffer_load_dwordx2 v[26:27], off, s[20:23], s67 sc1
    s_waitcnt vmcnt(0)
    s_sub_u32 s55, s55, 1
    s_cmp_lg_u32 s55, 0
    s_cbranch_scc1 L_wrffn
L_grffn:
    buffer_load_dwordx4 v[96:99], v9, s[20:23], s87 offen offset:0 sc1
    buffer_load_dwordx4 v[100:103], v9, s[20:23], s87 offen offset:1024 sc1
    buffer_load_dwordx4 v[104:107], v9, s[20:23], s87 offen offset:2048 sc1
    buffer_load_dwordx4 v[108:111], v9, s[20:23], s87 offen offset:3072 sc1
    buffer_load_dwordx4 v[112:115], v9, s[20:23], s54 offen offset:0 sc1
    buffer_load_dwordx4 v[116:119], v9, s[20:23], s54 offen offset:1024 sc1
    buffer_load_dwordx4 v[120:123], v9, s[20:23], s54 offen offset:2048 sc1
    buffer_load_dwordx4 v[124:127], v9, s[20:23], s54 offen offset:3072 sc1
    v_pk_add_f32 v[140:141], v[140:141], v[204:205]
    v_pk_add_f32 v[142:143], v[142:143], v[206:207]
    v_pk_add_f32 v[140:141], v[140:141], v[76:77]
    v_pk_add_f32 v[142:143], v[142:143], v[78:79]
    v_pk_mul_f32 v[204:205], v[140:141], s[4:5]
    v_pk_mul_f32 v[206:207], v[142:143], s[4:5]
    v_exp_f32 v204, v204
    v_exp_f32 v205, v205
    v_exp_f32 v206, v206
    v_exp_f32_e64 v207, v207
    s_nop 0
    v_pk_add_f32 v[204:205], v[204:205], 1.0 op_sel_hi:[1,0]
    v_pk_add_f32 v[206:207], v[206:207], 1.0 op_sel_hi:[1,0]
    v_rcp_f32 v204, v204
    v_rcp_f32 v205, v205
    v_rcp_f32 v206, v206
    v_rcp_f32_e64 v207, v207
    s_nop 0
    v_pk_mul_f32 v[140:141], v[140:141], v[204:205]
    v_pk_mul_f32 v[142:143], v[142:143], v[206:207]
    s_waitcnt vmcnt(7)
    v_pk_add_f32 v[96:97], v[96:97], v[160:161]
    v_pk_add_f32 v[98:99], v[98:99], v[162:163]
    v_pk_fma_f32 v[224:225], v[128:129], v[96:97], v[224:225]
    v_pk_fma_f32 v[226:227], v[130:131], v[98:99], v[226:227]
    v_pk_add_f32 v[144:145], v[144:145], v[208:209]
    v_pk_add_f32 v[146:147], v[146:147], v[210:211]
    v_pk_add_f32 v[144:145], v[144:145], v[80:81]
    v_pk_add_f32 v[146:147], v[146:147], v[82:83]
    v_pk_mul_f32 v[208:209], v[144:145], s[4:5]
    v_pk_mul_f32 v[210:211], v[146:147], s[4:5]
    buffer_store_dword v224, v23, s[12:15], s68 offen offset:0 sc1
    v_exp_f32 v208, v208
    v_exp_f32 v209, v209
    v_exp_f32 v210, v210
    v_exp_f32 v211, v211
    s_nop 0
    v_pk_add_f32 v[208:209], v[208:209], 1.0 op_sel_hi:[1,0]
    buffer_store_dword v225, v23, s[12:15], s69 offen offset:0 sc1
    v_pk_add_f32 v[210:211], v[210:211], 1.0 op_sel_hi:[1,0]
    v_rcp_f32 v208, v208
    v_rcp_f32 v209, v209
    v_rcp_f32 v210, v210
    v_rcp_f32_e64 v211, v211
    s_nop 0
    buffer_store_dword v226, v23, s[12:15], s70 offen offset:0 sc1
    v_pk_mul_f32 v[144:145], v[144:145], v[208:209]
    v_pk_mul_f32 v[146:147], v[146:147], v[210:211]
    s_waitcnt vmcnt(9)
    v_pk_add_f32 v[100:101], v[100:101], v[164:165]
    v_pk_add_f32 v[102:103], v[102:103], v[166:167]
    v_pk_fma_f32 v[228:229], v[132:133], v[100:101], v[228:229]
    buffer_store_dword v227, v23, s[12:15], s71 offen offset:0 sc1
    v_pk_fma_f32 v[230:231], v[134:135], v[102:103], v[230:231]
    v_pk_add_f32 v[148:149], v[148:149], v[212:213]
    v_pk_add_f32 v[150:151], v[150:151], v[214:215]
    v_pk_add_f32 v[148:149], v[148:149], v[84:85]
    v_pk_add_f32 v[150:151], v[150:151], v[86:87]
    v_pk_mul_f32 v[212:213], v[148:149], s[4:5]
    v_pk_mul_f32 v[214:215], v[150:151], s[4:5]
    buffer_store_dword v228, v23, s[12:15], s72 offen offset:0 sc1
    v_exp_f32 v212, v212
    v_exp_f32 v213, v213
    v_exp_f32 v214, v214
    v_exp_f32 v215, v215
    s_nop 0
    v_pk_add_f32 v[212:213], v[212:213], 1.0 op_sel_hi:[1,0]
    buffer_store_dword v229, v23, s[12:15], s73 offen offset:0 sc1
    v_pk_add_f32 v[214:215], v[214:215], 1.0 op_sel_hi:[1,0]
    v_rcp_f32 v212, v212
    v_rcp_f32 v213, v213
    v_rcp_f32 v214, v214
    v_rcp_f32_e64 v215, v215
    s_nop 0
    buffer_store_dword v230, v23, s[12:15], s74 offen offset:0 sc1
    v_pk_mul_f32 v[148:149], v[148:149], v[212:213]
    v_pk_mul_f32 v[150:151], v[150:151], v[214:215]
    s_waitcnt vmcnt(12)
    v_pk_add_f32 v[104:105], v[104:105], v[168:169]
    v_pk_add_f32 v[106:107], v[106:107], v[170:171]
    v_pk_fma_f32 v[232:233], v[136:137], v[104:105], v[232:233]
    buffer_store_dword v231, v23, s[12:15], s75 offen offset:0 sc1
    v_pk_fma_f32 v[234:235], v[138:139], v[106:107], v[234:235]
    v_pk_add_f32 v[152:153], v[152:153], v[216:217]
    v_pk_add_f32 v[154:155], v[154:155], v[218:219]
    v_pk_add_f32 v[152:153], v[152:153], v[88:89]
    v_pk_add_f32 v[154:155], v[154:155], v[90:91]
    v_pk_mul_f32 v[216:217], v[152:153], s[4:5]
    v_pk_mul_f32 v[218:219], v[154:155], s[4:5]
    buffer_store_dword v232, v23, s[12:15], s76 offen offset:0 sc1
    v_exp_f32 v216, v216
    v_exp_f32 v217, v217
    v_exp_f32 v218, v218
    v_exp_f32 v219, v219
    s_nop 0
    v_pk_add_f32 v[216:217], v[216:217], 1.0 op_sel_hi:[1,0]
    buffer_store_dword v233, v23, s[12:15], s77 offen offset:0 sc1
    v_pk_add_f32 v[218:219], v[218:219], 1.0 op_sel_hi:[1,0]
    v_rcp_f32 v216, v216
    v_rcp_f32 v217, v217
    v_rcp_f32 v218, v218
    v_rcp_f32_e64 v219, v219
    s_nop 0
    buffer_store_dword v234, v23, s[12:15], s78 offen offset:0 sc1
    v_pk_mul_f32 v[152:153], v[152:153], v[216:217]
    v_pk_mul_f32 v[154:155], v[154:155], v[218:219]
    s_waitcnt vmcnt(15)
    v_pk_add_f32 v[108:109], v[108:109], v[172:173]
    v_pk_add_f32 v[110:111], v[110:111], v[174:175]
    v_pk_fma_f32 v[236:237], v[140:141], v[108:109], v[236:237]
    buffer_store_dword v235, v23, s[12:15], s79 offen offset:0 sc1
    v_pk_fma_f32 v[238:239], v[142:143], v[110:111], v[238:239]
    v_pk_add_f32 v[156:157], v[156:157], v[220:221]
    v_pk_add_f32 v[158:159], v[158:159], v[222:223]
    v_pk_add_f32 v[156:157], v[156:157], v[92:93]
    v_pk_add_f32 v[158:159], v[158:159], v[94:95]
    v_pk_mul_f32 v[220:221], v[156:157], s[4:5]
    v_pk_mul_f32 v[222:223], v[158:159], s[4:5]
    buffer_store_dword v236, v23, s[12:15], s80 offen offset:0 sc1
    v_exp_f32 v220, v220
    v_exp_f32 v221, v221
    v_exp_f32 v222, v222
    v_exp_f32 v223, v223
    s_nop 0
    v_pk_add_f32 v[220:221], v[220:221], 1.0 op_sel_hi:[1,0]
    buffer_store_dword v237, v23, s[12:15], s81 offen offset:0 sc1
    v_pk_add_f32 v[222:223], v[222:223], 1.0 op_sel_hi:[1,0]
    v_rcp_f32 v220, v220
    v_rcp_f32 v221, v221
    v_rcp_f32 v222, v222
    v_rcp_f32_e64 v223, v223
    s_nop 0
    buffer_store_dword v238, v23, s[12:15], s82 offen offset:0 sc1
    v_pk_mul_f32 v[156:157], v[156:157], v[220:221]
    v_pk_mul_f32 v[158:159], v[158:159], v[222:223]
    s_waitcnt vmcnt(18)
    v_pk_add_f32 v[112:113], v[112:113], v[176:177]
    v_pk_add_f32 v[114:115], v[114:115], v[178:179]
    v_pk_fma_f32 v[240:241], v[144:145], v[112:113], v[240:241]
    buffer_store_dword v239, v23, s[12:15], s83 offen offset:0 sc1
    v_pk_fma_f32 v[242:243], v[146:147], v[114:115], v[242:243]
    s_waitcnt vmcnt(18)
    buffer_store_dword v240, v23, s[12:15], s68 offen offset:64 sc1
    v_pk_add_f32 v[116:117], v[116:117], v[180:181]
    buffer_store_dword v241, v23, s[12:15], s69 offen offset:64 sc1
    v_pk_add_f32 v[118:119], v[118:119], v[182:183]
    buffer_store_dword v242, v23, s[12:15], s70 offen offset:64 sc1
    v_pk_fma_f32 v[244:245], v[148:149], v[116:117], v[244:245]
    buffer_store_dword v243, v23, s[12:15], s71 offen offset:64 sc1
    v_pk_fma_f32 v[246:247], v[150:151], v[118:119], v[246:247]
    s_waitcnt vmcnt(21)
    buffer_store_dword v244, v23, s[12:15], s72 offen offset:64 sc1
    v_pk_add_f32 v[120:121], v[120:121], v[184:185]
    buffer_store_dword v245, v23, s[12:15], s73 offen offset:64 sc1
    v_pk_add_f32 v[122:123], v[122:123], v[186:187]
    buffer_store_dword v246, v23, s[12:15], s74 offen offset:64 sc1
    v_pk_fma_f32 v[248:249], v[152:153], v[120:121], v[248:249]
    buffer_store_dword v247, v23, s[12:15], s75 offen offset:64 sc1
    v_pk_fma_f32 v[250:251], v[154:155], v[122:123], v[250:251]
    s_waitcnt vmcnt(24)
    buffer_store_dword v248, v23, s[12:15], s76 offen offset:64 sc1
    v_pk_add_f32 v[124:125], v[124:125], v[188:189]
    buffer_store_dword v249, v23, s[12:15], s77 offen offset:64 sc1
    v_pk_add_f32 v[126:127], v[126:127], v[190:191]
    buffer_store_dword v250, v23, s[12:15], s78 offen offset:64 sc1
    v_pk_fma_f32 v[252:253], v[156:157], v[124:125], v[252:253]
    buffer_store_dword v251, v23, s[12:15], s79 offen offset:64 sc1
    v_pk_fma_f32 v[254:255], v[158:159], v[126:127], v[254:255]
    buffer_store_dword v252, v23, s[12:15], s80 offen offset:64 sc1
    buffer_store_dword v253, v23, s[12:15], s81 offen offset:64 sc1
    buffer_store_dword v254, v23, s[12:15], s82 offen offset:64 sc1
    buffer_store_dword v255, v23, s[12:15], s83 offen offset:64 sc1
    s_endpgm
L_k3_stopffn:
L_k3_o2:
    s_sleep 1
    buffer_load_dwordx2 v[46:47], v92, s[20:23], s90 offen sc1
    s_waitcnt vmcnt(0)
    s_sub_u32 s55, s55, 1
    s_cmp_lg_u32 s55, 0
    s_cbranch_scc1 L_k3_o3
    s_branch L_k3_ffn_loop
L_k3_ssm:
    s_mov_b32 s35, 0
    s_waitcnt lgkmcnt(0)
    s_barrier
    v_and_b32 v60, 15, v0
    v_lshlrev_b32_e64 v60, 8, v60
    s_and_b32 s3, s2, 1
    s_xor_b32 s3, s3, 1
    s_lshl_b32 s3, s3, 7
    s_add_u32 s93, s93, s3
    s_waitcnt vmcnt(12) lgkmcnt(4)
    v_mfma_f32_16x16x32_bf16 v[64:67], a[64:67], a[0:3], 0
    s_add_u32 s85, s85, 4096
    v_mfma_f32_16x16x32_bf16 v[64:67], a[80:83], a[4:7], v[64:67]
    buffer_load_dwordx4 a[112:115], v9, s[20:23], s85 offen offset:0 sc1
    v_mfma_f32_16x16x32_bf16 v[68:71], a[84:87], a[4:7], 0
    v_mfma_f32_16x16x32_bf16 v[68:71], a[68:71], a[0:3], v[68:71]
    v_mfma_f32_16x16x32_bf16 v[72:75], a[72:75], a[0:3], 0
    v_mfma_f32_16x16x32_bf16 v[72:75], a[88:91], a[4:7], v[72:75]
    buffer_load_dwordx4 a[116:119], v9, s[20:23], s85 offen offset:1024 sc1
    v_mfma_f32_16x16x32_bf16 v[76:79], a[92:95], a[4:7], 0
    ds_read_b64_tr_b16 a[4:5], v14 offset:8192
    v_mfma_f32_16x16x32_bf16 v[76:79], a[76:79], a[0:3], v[76:79]
    ds_read_b64_tr_b16 a[6:7], v14 offset:9216
    v_mfma_f32_16x16x32_bf16 v[92:95], a[76:79], a[8:11], 0
    ds_read_b64_tr_b16 a[0:1], v14 offset:0
    v_mfma_f32_16x16x32_bf16 v[92:95], a[92:95], a[12:15], v[92:95]
    ds_read_b64_tr_b16 a[2:3], v14 offset:1024
    buffer_load_dwordx4 a[120:123], v9, s[20:23], s85 offen offset:2048 sc1
    v_mfma_f32_16x16x32_bf16 v[88:91], a[88:91], a[12:15], 0
    v_mfma_f32_16x16x32_bf16 v[88:91], a[72:75], a[8:11], v[88:91]
    v_mfma_f32_16x16x32_bf16 v[84:87], a[68:71], a[8:11], 0
    v_mfma_f32_16x16x32_bf16 v[84:87], a[84:87], a[12:15], v[84:87]
    buffer_load_dwordx4 a[124:127], v9, s[20:23], s85 offen offset:3072 sc1
    v_mfma_f32_16x16x32_bf16 v[80:83], a[80:83], a[12:15], 0
    ds_read_b64_tr_b16 a[12:13], v15 offset:8192
    v_mfma_f32_16x16x32_bf16 v[80:83], a[64:67], a[8:11], v[80:83]
    ds_read_b64_tr_b16 a[14:15], v15 offset:9216
    v_mfma_f32_16x16x32_bf16 v[96:99], a[64:67], a[16:19], 0
    ds_read_b64_tr_b16 a[8:9], v15 offset:0
    s_add_u32 m0, s76, 36864
    v_mfma_f32_16x16x32_bf16 v[96:99], a[80:83], a[20:23], v[96:99]
    ds_read_b64_tr_b16 a[10:11], v15 offset:1024
    buffer_load_dwordx4 v5, s[68:71], s78 offen offset:0 lds
    v_mfma_f32_16x16x32_bf16 v[100:103], a[84:87], a[20:23], 0
    v_mfma_f32_16x16x32_bf16 v[100:103], a[68:71], a[16:19], v[100:103]
    v_mfma_f32_16x16x32_bf16 v[104:107], a[72:75], a[16:19], 0
    v_mfma_f32_16x16x32_bf16 v[104:107], a[88:91], a[20:23], v[104:107]
    buffer_load_dwordx4 v6, s[68:71], s78 offen offset:1024 lds
    v_mfma_f32_16x16x32_bf16 v[108:111], a[92:95], a[20:23], 0
    ds_read_b64_tr_b16 a[20:21], v16 offset:8192
    v_mfma_f32_16x16x32_bf16 v[108:111], a[76:79], a[16:19], v[108:111]
    ds_read_b64_tr_b16 a[22:23], v16 offset:9216
    s_waitcnt lgkmcnt(4)
    v_mfma_f32_16x16x32_bf16 v[124:127], a[76:79], a[24:27], 0
    ds_read_b64_tr_b16 a[16:17], v16 offset:0
    v_mfma_f32_16x16x32_bf16 v[124:127], a[92:95], a[28:31], v[124:127]
    ds_read_b64_tr_b16 a[18:19], v16 offset:1024
    buffer_load_dwordx4 v7, s[68:71], s78 offen offset:2048 lds
    v_mfma_f32_16x16x32_bf16 v[120:123], a[88:91], a[28:31], 0
    v_mfma_f32_16x16x32_bf16 v[120:123], a[72:75], a[24:27], v[120:123]
    v_mfma_f32_16x16x32_bf16 v[116:119], a[68:71], a[24:27], 0
    v_mfma_f32_16x16x32_bf16 v[116:119], a[84:87], a[28:31], v[116:119]
    buffer_load_dwordx4 v8, s[68:71], s78 offen offset:3072 lds
    v_mfma_f32_16x16x32_bf16 v[112:115], a[80:83], a[28:31], 0
    ds_read_b64_tr_b16 a[28:29], v17 offset:8192
    v_mfma_f32_16x16x32_bf16 v[112:115], a[64:67], a[24:27], v[112:115]
    ds_read_b64_tr_b16 a[30:31], v17 offset:9216
    ds_read_b64_tr_b16 a[24:25], v17 offset:0
    ds_read_b64_tr_b16 a[26:27], v17 offset:1024
    v_mfma_f32_16x16x32_bf16 a[160:163], a[64:67], a[0:3], 0
    s_add_u32 s85, s84, s82
    s_xor_b32 s82, s27, 16384
    v_mfma_f32_16x16x32_bf16 a[160:163], a[80:83], a[4:7], a[160:163]
    buffer_load_dwordx4 a[128:131], v9, s[20:23], s85 offen offset:0 sc1
    v_mfma_f32_16x16x32_bf16 a[164:167], a[84:87], a[4:7], 0
    v_mfma_f32_16x16x32_bf16 a[164:167], a[68:71], a[0:3], a[164:167]
    v_mfma_f32_16x16x32_bf16 a[168:171], a[72:75], a[0:3], 0
    v_mfma_f32_16x16x32_bf16 a[168:171], a[88:91], a[4:7], a[168:171]
    buffer_load_dwordx4 a[132:135], v9, s[20:23], s85 offen offset:1024 sc1
    v_mfma_f32_16x16x32_bf16 a[172:175], a[92:95], a[4:7], 0
    v_mfma_f32_16x16x32_bf16 a[172:175], a[76:79], a[0:3], a[172:175]
    s_waitcnt vmcnt(18)
    s_waitcnt lgkmcnt(0)
    s_barrier
    ds_read_b64_tr_b16 a[4:5], v10 offset:24576
    v_mfma_f32_16x16x32_bf16 a[188:191], a[76:79], a[8:11], 0
    ds_read_b64_tr_b16 a[6:7], v10 offset:25600
    v_mfma_f32_16x16x32_bf16 a[188:191], a[92:95], a[12:15], a[188:191]
    ds_read_b64_tr_b16 a[0:1], v10 offset:16384
    buffer_load_dwordx4 a[136:139], v9, s[20:23], s85 offen offset:2048 sc1
    v_mfma_f32_16x16x32_bf16 a[184:187], a[88:91], a[12:15], 0
    ds_read_b64_tr_b16 a[2:3], v10 offset:17408
    v_mfma_f32_16x16x32_bf16 a[184:187], a[72:75], a[8:11], a[184:187]
    v_mfma_f32_16x16x32_bf16 a[180:183], a[68:71], a[8:11], 0
    v_mfma_f32_16x16x32_bf16 a[180:183], a[84:87], a[12:15], a[180:183]
    buffer_load_dwordx4 a[140:143], v9, s[20:23], s85 offen offset:3072 sc1
    v_mfma_f32_16x16x32_bf16 a[176:179], a[80:83], a[12:15], 0
    ds_read_b64_tr_b16 a[12:13], v11 offset:24576
    v_mfma_f32_16x16x32_bf16 a[176:179], a[64:67], a[8:11], a[176:179]
    ds_read_b64_tr_b16 a[14:15], v11 offset:25600
    v_mfma_f32_16x16x32_bf16 a[192:195], a[64:67], a[16:19], 0
    ds_read_b64_tr_b16 a[8:9], v11 offset:16384
    s_add_u32 s78, s77, s75
    s_xor_b32 s75, s54, 786432
    s_add_u32 m0, s76, 49152
    v_mfma_f32_16x16x32_bf16 a[192:195], a[80:83], a[20:23], a[192:195]
    ds_read_b64_tr_b16 a[10:11], v11 offset:17408
    buffer_load_dwordx4 v1, s[68:71], s78 offen offset:0 lds
    v_mfma_f32_16x16x32_bf16 a[196:199], a[84:87], a[20:23], 0
    v_mfma_f32_16x16x32_bf16 a[196:199], a[68:71], a[16:19], a[196:199]
    v_mfma_f32_16x16x32_bf16 a[200:203], a[72:75], a[16:19], 0
    v_mfma_f32_16x16x32_bf16 a[200:203], a[88:91], a[20:23], a[200:203]
    buffer_load_dwordx4 v2, s[68:71], s78 offen offset:1024 lds
    v_mfma_f32_16x16x32_bf16 a[204:207], a[92:95], a[20:23], 0
    ds_read_b64_tr_b16 a[20:21], v12 offset:24576
    v_mfma_f32_16x16x32_bf16 a[204:207], a[76:79], a[16:19], a[204:207]
    ds_read_b64_tr_b16 a[22:23], v12 offset:25600
    v_mfma_f32_16x16x32_bf16 a[220:223], a[76:79], a[24:27], 0
    ds_read_b64_tr_b16 a[16:17], v12 offset:16384
    v_mfma_f32_16x16x32_bf16 a[220:223], a[92:95], a[28:31], a[220:223]
    ds_read_b64_tr_b16 a[18:19], v12 offset:17408
    buffer_load_dwordx4 v3, s[68:71], s78 offen offset:2048 lds
    v_mfma_f32_16x16x32_bf16 a[216:219], a[88:91], a[28:31], 0
    v_mfma_f32_16x16x32_bf16 a[216:219], a[72:75], a[24:27], a[216:219]
    v_mfma_f32_16x16x32_bf16 a[212:215], a[68:71], a[24:27], 0
    v_mfma_f32_16x16x32_bf16 a[212:215], a[84:87], a[28:31], a[212:215]
    buffer_load_dwordx4 v4, s[68:71], s78 offen offset:3072 lds
    v_mfma_f32_16x16x32_bf16 a[208:211], a[80:83], a[28:31], 0
    ds_read_b64_tr_b16 a[28:29], v13 offset:24576
    v_mfma_f32_16x16x32_bf16 a[208:211], a[64:67], a[24:27], a[208:211]
    ds_read_b64_tr_b16 a[30:31], v13 offset:25600
    ds_read_b64_tr_b16 a[24:25], v13 offset:16384
    ds_read_b64_tr_b16 a[26:27], v13 offset:17408
    s_waitcnt vmcnt(12) lgkmcnt(4)
    v_mfma_f32_16x16x32_bf16 v[64:67], a[96:99], a[0:3], v[64:67]
    v_mfma_f32_16x16x32_bf16 v[64:67], a[112:115], a[4:7], v[64:67]
    s_mov_b64 exec, 1
    buffer_store_dwordx2 a[248:249], off, s[20:23], s33 sc1
    s_mov_b64 exec, -1
    v_mfma_f32_16x16x32_bf16 v[68:71], a[116:119], a[4:7], v[68:71]
    v_mfma_f32_16x16x32_bf16 v[68:71], a[100:103], a[0:3], v[68:71]
    s_add_u32 s85, s85, 4096
    v_mfma_f32_16x16x32_bf16 v[72:75], a[104:107], a[0:3], v[72:75]
    buffer_load_dwordx4 a[144:147], v9, s[20:23], s85 offen offset:0 sc1
    v_mfma_f32_16x16x32_bf16 v[72:75], a[120:123], a[4:7], v[72:75]
    v_mfma_f32_16x16x32_bf16 v[76:79], a[124:127], a[4:7], v[76:79]
    ds_read_b64_tr_b16 a[4:5], v14 offset:24576
    v_mfma_f32_16x16x32_bf16 v[76:79], a[108:111], a[0:3], v[76:79]
    ds_read_b64_tr_b16 a[6:7], v14 offset:25600
    v_mfma_f32_16x16x32_bf16 v[92:95], a[108:111], a[8:11], v[92:95]
    ds_read_b64_tr_b16 a[0:1], v14 offset:16384
    buffer_load_dwordx4 a[148:151], v9, s[20:23], s85 offen offset:1024 sc1
    v_mfma_f32_16x16x32_bf16 v[92:95], a[124:127], a[12:15], v[92:95]
    ds_read_b64_tr_b16 a[2:3], v14 offset:17408
    v_mfma_f32_16x16x32_bf16 v[88:91], a[120:123], a[12:15], v[88:91]
    v_mfma_f32_16x16x32_bf16 v[88:91], a[104:107], a[8:11], v[88:91]
    buffer_load_dwordx4 a[152:155], v9, s[20:23], s85 offen offset:2048 sc1
    v_mfma_f32_16x16x32_bf16 v[84:87], a[100:103], a[8:11], v[84:87]
    v_mfma_f32_16x16x32_bf16 v[84:87], a[116:119], a[12:15], v[84:87]
    v_mfma_f32_16x16x32_bf16 v[80:83], a[112:115], a[12:15], v[80:83]
    ds_read_b64_tr_b16 a[12:13], v15 offset:24576
    v_mfma_f32_16x16x32_bf16 v[80:83], a[96:99], a[8:11], v[80:83]
    ds_read_b64_tr_b16 a[14:15], v15 offset:25600
    buffer_load_dwordx4 a[156:159], v9, s[20:23], s85 offen offset:3072 sc1
    v_mfma_f32_16x16x32_bf16 v[96:99], a[96:99], a[16:19], v[96:99]
    ds_read_b64_tr_b16 a[8:9], v15 offset:16384
    v_mfma_f32_16x16x32_bf16 v[96:99], a[112:115], a[20:23], v[96:99]
    ds_read_b64_tr_b16 a[10:11], v15 offset:17408
    s_add_u32 m0, s76, 53248
    v_mfma_f32_16x16x32_bf16 v[100:103], a[116:119], a[20:23], v[100:103]
    buffer_load_dwordx4 v5, s[68:71], s78 offen offset:0 lds
    v_mfma_f32_16x16x32_bf16 v[100:103], a[100:103], a[16:19], v[100:103]
    v_mfma_f32_16x16x32_bf16 v[104:107], a[104:107], a[16:19], v[104:107]
    v_mfma_f32_16x16x32_bf16 v[104:107], a[120:123], a[20:23], v[104:107]
    v_mfma_f32_16x16x32_bf16 v[108:111], a[124:127], a[20:23], v[108:111]
    ds_read_b64_tr_b16 a[20:21], v16 offset:24576
    buffer_load_dwordx4 v6, s[68:71], s78 offen offset:1024 lds
    v_mfma_f32_16x16x32_bf16 v[108:111], a[108:111], a[16:19], v[108:111]
    ds_read_b64_tr_b16 a[22:23], v16 offset:25600
    s_waitcnt lgkmcnt(4)
    v_mfma_f32_16x16x32_bf16 v[124:127], a[108:111], a[24:27], v[124:127]
    ds_read_b64_tr_b16 a[16:17], v16 offset:16384
    v_mfma_f32_16x16x32_bf16 v[124:127], a[124:127], a[28:31], v[124:127]
    ds_read_b64_tr_b16 a[18:19], v16 offset:17408
    buffer_load_dwordx4 v7, s[68:71], s78 offen offset:2048 lds
    v_mfma_f32_16x16x32_bf16 v[120:123], a[120:123], a[28:31], v[120:123]
    v_mfma_f32_16x16x32_bf16 v[120:123], a[104:107], a[24:27], v[120:123]
    v_mfma_f32_16x16x32_bf16 v[116:119], a[100:103], a[24:27], v[116:119]
    v_mfma_f32_16x16x32_bf16 v[116:119], a[116:119], a[28:31], v[116:119]
    buffer_load_dwordx4 v8, s[68:71], s78 offen offset:3072 lds
    v_mfma_f32_16x16x32_bf16 v[112:115], a[112:115], a[28:31], v[112:115]
    ds_read_b64_tr_b16 a[28:29], v17 offset:24576
    s_and_b32 s77, s32, 63
    s_lshl_b32 s77, s77, 17
    s_lshr_b32 s32, s32, 6
    v_mfma_f32_16x16x32_bf16 v[112:115], a[96:99], a[24:27], v[112:115]
    ds_read_b64_tr_b16 a[30:31], v17 offset:25600
    ds_read_b64_tr_b16 a[24:25], v17 offset:16384
    ds_read_b64_tr_b16 a[26:27], v17 offset:17408
    v_mfma_f32_16x16x32_bf16 a[160:163], a[96:99], a[0:3], a[160:163]
    v_mfma_f32_16x16x32_bf16 a[160:163], a[112:115], a[4:7], a[160:163]
    buffer_load_dwordx2 v[26:27], v60, s[20:23], s93 offen sc1
    v_mfma_f32_16x16x32_bf16 a[164:167], a[116:119], a[4:7], a[164:167]
    v_mfma_f32_16x16x32_bf16 a[164:167], a[100:103], a[0:3], a[164:167]
    s_add_u32 s85, s84, s83
    s_xor_b32 s83, s27, 24576
    v_mfma_f32_16x16x32_bf16 a[168:171], a[104:107], a[0:3], a[168:171]
    buffer_load_dwordx4 a[32:35], v9, s[20:23], s85 offen offset:0 sc1
    v_mfma_f32_16x16x32_bf16 a[168:171], a[120:123], a[4:7], a[168:171]
    v_mfma_f32_16x16x32_bf16 a[172:175], a[124:127], a[4:7], a[172:175]
    v_mfma_f32_16x16x32_bf16 a[172:175], a[108:111], a[0:3], a[172:175]
    s_waitcnt vmcnt(19)
    s_waitcnt lgkmcnt(0)
    s_barrier
    ds_read_b64_tr_b16 a[4:5], v10 offset:40960
    v_mfma_f32_16x16x32_bf16 a[188:191], a[108:111], a[8:11], a[188:191]
    ds_read_b64_tr_b16 a[6:7], v10 offset:41984
    buffer_load_dwordx4 a[36:39], v9, s[20:23], s85 offen offset:1024 sc1
    v_mfma_f32_16x16x32_bf16 a[188:191], a[124:127], a[12:15], a[188:191]
    ds_read_b64_tr_b16 a[0:1], v10 offset:32768
    v_mfma_f32_16x16x32_bf16 a[184:187], a[120:123], a[12:15], a[184:187]
    ds_read_b64_tr_b16 a[2:3], v10 offset:33792
    v_mfma_f32_16x16x32_bf16 a[184:187], a[104:107], a[8:11], a[184:187]
    buffer_load_dwordx4 a[40:43], v9, s[20:23], s85 offen offset:2048 sc1
    v_mfma_f32_16x16x32_bf16 a[180:183], a[100:103], a[8:11], a[180:183]
    v_mfma_f32_16x16x32_bf16 a[180:183], a[116:119], a[12:15], a[180:183]
    v_mfma_f32_16x16x32_bf16 a[176:179], a[112:115], a[12:15], a[176:179]
    ds_read_b64_tr_b16 a[12:13], v11 offset:40960
    v_mfma_f32_16x16x32_bf16 a[176:179], a[96:99], a[8:11], a[176:179]
    ds_read_b64_tr_b16 a[14:15], v11 offset:41984
    buffer_load_dwordx4 a[44:47], v9, s[20:23], s85 offen offset:3072 sc1
    v_mfma_f32_16x16x32_bf16 a[192:195], a[96:99], a[16:19], a[192:195]
    ds_read_b64_tr_b16 a[8:9], v11 offset:32768
    v_mfma_f32_16x16x32_bf16 a[192:195], a[112:115], a[20:23], a[192:195]
    ds_read_b64_tr_b16 a[10:11], v11 offset:33792
    s_add_u32 s78, s91, s16
    s_add_u32 m0, s76, 0
    v_mfma_f32_16x16x32_bf16 a[196:199], a[116:119], a[20:23], a[196:199]
    buffer_load_dwordx4 v32, s[8:11], s78 offen offset:0 lds
    v_mfma_f32_16x16x32_bf16 a[196:199], a[100:103], a[16:19], a[196:199]
    v_mfma_f32_16x16x32_bf16 a[200:203], a[104:107], a[16:19], a[200:203]
    v_mfma_f32_16x16x32_bf16 a[200:203], a[120:123], a[20:23], a[200:203]
    v_mfma_f32_16x16x32_bf16 a[204:207], a[124:127], a[20:23], a[204:207]
    ds_read_b64_tr_b16 a[20:21], v12 offset:40960
    buffer_load_dwordx4 v33, s[8:11], s78 offen offset:1024 lds
    v_mfma_f32_16x16x32_bf16 a[204:207], a[108:111], a[16:19], a[204:207]
    ds_read_b64_tr_b16 a[22:23], v12 offset:41984
    v_mfma_f32_16x16x32_bf16 a[220:223], a[108:111], a[24:27], a[220:223]
    ds_read_b64_tr_b16 a[16:17], v12 offset:32768
    v_mfma_f32_16x16x32_bf16 a[220:223], a[124:127], a[28:31], a[220:223]
    ds_read_b64_tr_b16 a[18:19], v12 offset:33792
    buffer_load_dwordx4 v34, s[8:11], s78 offen offset:2048 lds
    v_mfma_f32_16x16x32_bf16 a[216:219], a[120:123], a[28:31], a[216:219]
    v_mfma_f32_16x16x32_bf16 a[216:219], a[104:107], a[24:27], a[216:219]
    v_mfma_f32_16x16x32_bf16 a[212:215], a[100:103], a[24:27], a[212:215]
    v_mfma_f32_16x16x32_bf16 a[212:215], a[116:119], a[28:31], a[212:215]
    buffer_load_dwordx4 v35, s[8:11], s78 offen offset:3072 lds
    v_mfma_f32_16x16x32_bf16 a[208:211], a[112:115], a[28:31], a[208:211]
    ds_read_b64_tr_b16 a[28:29], v13 offset:40960
    v_mfma_f32_16x16x32_bf16 a[208:211], a[96:99], a[24:27], a[208:211]
    ds_read_b64_tr_b16 a[30:31], v13 offset:41984
    ds_read_b64_tr_b16 a[24:25], v13 offset:32768
    ds_read_b64_tr_b16 a[26:27], v13 offset:33792
    s_waitcnt vmcnt(13) lgkmcnt(4)
    v_mfma_f32_16x16x32_bf16 v[64:67], a[128:131], a[0:3], v[64:67]
    s_add_u32 s85, s85, 4096
    v_mfma_f32_16x16x32_bf16 v[64:67], a[144:147], a[4:7], v[64:67]
    buffer_load_dwordx4 a[48:51], v9, s[20:23], s85 offen offset:0 sc1
    v_mfma_f32_16x16x32_bf16 v[68:71], a[148:151], a[4:7], v[68:71]
    v_mfma_f32_16x16x32_bf16 v[68:71], a[132:135], a[0:3], v[68:71]
    v_mfma_f32_16x16x32_bf16 v[72:75], a[136:139], a[0:3], v[72:75]
    v_mfma_f32_16x16x32_bf16 v[72:75], a[152:155], a[4:7], v[72:75]
    buffer_load_dwordx4 a[52:55], v9, s[20:23], s85 offen offset:1024 sc1
    v_mfma_f32_16x16x32_bf16 v[76:79], a[156:159], a[4:7], v[76:79]
    ds_read_b64_tr_b16 a[4:5], v14 offset:40960
    v_mfma_f32_16x16x32_bf16 v[76:79], a[140:143], a[0:3], v[76:79]
    ds_read_b64_tr_b16 a[6:7], v14 offset:41984
    v_mfma_f32_16x16x32_bf16 v[92:95], a[140:143], a[8:11], v[92:95]
    ds_read_b64_tr_b16 a[0:1], v14 offset:32768
    v_mfma_f32_16x16x32_bf16 v[92:95], a[156:159], a[12:15], v[92:95]
    ds_read_b64_tr_b16 a[2:3], v14 offset:33792
    buffer_load_dwordx4 a[56:59], v9, s[20:23], s85 offen offset:2048 sc1
    v_mfma_f32_16x16x32_bf16 v[88:91], a[152:155], a[12:15], v[88:91]
    v_mfma_f32_16x16x32_bf16 v[88:91], a[136:139], a[8:11], v[88:91]
    v_mfma_f32_16x16x32_bf16 v[84:87], a[132:135], a[8:11], v[84:87]
    v_mfma_f32_16x16x32_bf16 v[84:87], a[148:151], a[12:15], v[84:87]
    buffer_load_dwordx4 a[60:63], v9, s[20:23], s85 offen offset:3072 sc1
    v_mfma_f32_16x16x32_bf16 v[80:83], a[144:147], a[12:15], v[80:83]
    ds_read_b64_tr_b16 a[12:13], v15 offset:40960
    v_mfma_f32_16x16x32_bf16 v[80:83], a[128:131], a[8:11], v[80:83]
    ds_read_b64_tr_b16 a[14:15], v15 offset:41984
    v_mfma_f32_16x16x32_bf16 v[96:99], a[128:131], a[16:19], v[96:99]
    ds_read_b64_tr_b16 a[8:9], v15 offset:32768
    s_mov_b32 s84, s92
    s_add_u32 m0, s76, 4096
    v_mfma_f32_16x16x32_bf16 v[96:99], a[144:147], a[20:23], v[96:99]
    ds_read_b64_tr_b16 a[10:11], v15 offset:33792
    buffer_load_dwordx4 v36, s[8:11], s78 offen offset:0 lds
    v_mfma_f32_16x16x32_bf16 v[100:103], a[148:151], a[20:23], v[100:103]
    v_mfma_f32_16x16x32_bf16 v[100:103], a[132:135], a[16:19], v[100:103]
    v_mfma_f32_16x16x32_bf16 v[104:107], a[136:139], a[16:19], v[104:107]
    v_mfma_f32_16x16x32_bf16 v[104:107], a[152:155], a[20:23], v[104:107]
    buffer_load_dwordx4 v37, s[8:11], s78 offen offset:1024 lds
    v_mfma_f32_16x16x32_bf16 v[108:111], a[156:159], a[20:23], v[108:111]
    ds_read_b64_tr_b16 a[20:21], v16 offset:40960
    v_mfma_f32_16x16x32_bf16 v[108:111], a[140:143], a[16:19], v[108:111]
    ds_read_b64_tr_b16 a[22:23], v16 offset:41984
    s_waitcnt lgkmcnt(4)
    v_mfma_f32_16x16x32_bf16 v[124:127], a[140:143], a[24:27], v[124:127]
    ds_read_b64_tr_b16 a[16:17], v16 offset:32768
    v_mfma_f32_16x16x32_bf16 v[124:127], a[156:159], a[28:31], v[124:127]
    ds_read_b64_tr_b16 a[18:19], v16 offset:33792
    buffer_load_dwordx4 v38, s[8:11], s78 offen offset:2048 lds
    v_mfma_f32_16x16x32_bf16 v[120:123], a[152:155], a[28:31], v[120:123]
    v_mfma_f32_16x16x32_bf16 v[120:123], a[136:139], a[24:27], v[120:123]
    v_mfma_f32_16x16x32_bf16 v[116:119], a[132:135], a[24:27], v[116:119]
    v_mfma_f32_16x16x32_bf16 v[116:119], a[148:151], a[28:31], v[116:119]
    buffer_load_dwordx4 v39, s[8:11], s78 offen offset:3072 lds
    v_mfma_f32_16x16x32_bf16 v[112:115], a[144:147], a[28:31], v[112:115]
    ds_read_b64_tr_b16 a[28:29], v17 offset:40960
    v_mfma_f32_16x16x32_bf16 v[112:115], a[128:131], a[24:27], v[112:115]
    ds_read_b64_tr_b16 a[30:31], v17 offset:41984
    ds_read_b64_tr_b16 a[24:25], v17 offset:32768
    ds_read_b64_tr_b16 a[26:27], v17 offset:33792
    v_mfma_f32_16x16x32_bf16 a[160:163], a[128:131], a[0:3], a[160:163]
    s_waitcnt vmcnt(16)
    s_mov_b32 s55, 0x40000
L_wcs:
    v_cmp_ne_u64 vcc, s[48:49], v[26:27]
    s_cbranch_vccnz L_k3_spin
L_gcs:
    s_add_u32 s85, s84, s80
    s_xor_b32 s80, s27, 0
    v_mfma_f32_16x16x32_bf16 a[160:163], a[144:147], a[4:7], a[160:163]
    buffer_load_dwordx4 a[64:67], v9, s[20:23], s85 offen offset:0 sc1
    v_mfma_f32_16x16x32_bf16 a[164:167], a[148:151], a[4:7], a[164:167]
    v_mfma_f32_16x16x32_bf16 a[164:167], a[132:135], a[0:3], a[164:167]
    v_mfma_f32_16x16x32_bf16 a[168:171], a[136:139], a[0:3], a[168:171]
    v_mfma_f32_16x16x32_bf16 a[168:171], a[152:155], a[4:7], a[168:171]
    buffer_load_dwordx4 a[68:71], v9, s[20:23], s85 offen offset:1024 sc1
    v_mfma_f32_16x16x32_bf16 a[172:175], a[156:159], a[4:7], a[172:175]
    v_mfma_f32_16x16x32_bf16 a[172:175], a[140:143], a[0:3], a[172:175]
    s_waitcnt lgkmcnt(0)
    s_barrier
    ds_read_b64_tr_b16 a[4:5], v10 offset:57344
    v_mfma_f32_16x16x32_bf16 a[188:191], a[140:143], a[8:11], a[188:191]
    ds_read_b64_tr_b16 a[6:7], v10 offset:58368
    v_mfma_f32_16x16x32_bf16 a[188:191], a[156:159], a[12:15], a[188:191]
    ds_read_b64_tr_b16 a[0:1], v10 offset:49152
    buffer_load_dwordx4 a[72:75], v9, s[20:23], s85 offen offset:2048 sc1
    v_mfma_f32_16x16x32_bf16 a[184:187], a[152:155], a[12:15], a[184:187]
    ds_read_b64_tr_b16 a[2:3], v10 offset:50176
    v_mfma_f32_16x16x32_bf16 a[184:187], a[136:139], a[8:11], a[184:187]
    v_mfma_f32_16x16x32_bf16 a[180:183], a[132:135], a[8:11], a[180:183]
    v_mfma_f32_16x16x32_bf16 a[180:183], a[148:151], a[12:15], a[180:183]
    buffer_load_dwordx4 a[76:79], v9, s[20:23], s85 offen offset:3072 sc1
    v_mfma_f32_16x16x32_bf16 a[176:179], a[144:147], a[12:15], a[176:179]
    ds_read_b64_tr_b16 a[12:13], v11 offset:57344
    v_mfma_f32_16x16x32_bf16 a[176:179], a[128:131], a[8:11], a[176:179]
    ds_read_b64_tr_b16 a[14:15], v11 offset:58368
    v_mfma_f32_16x16x32_bf16 a[192:195], a[128:131], a[16:19], a[192:195]
    ds_read_b64_tr_b16 a[8:9], v11 offset:49152
    s_add_u32 s78, s91, s17
    s_add_u32 m0, s76, 16384
    v_mfma_f32_16x16x32_bf16 a[192:195], a[144:147], a[20:23], a[192:195]
    ds_read_b64_tr_b16 a[10:11], v11 offset:50176
    buffer_load_dwordx4 v32, s[8:11], s78 offen offset:0 lds
    v_mfma_f32_16x16x32_bf16 a[196:199], a[148:151], a[20:23], a[196:199]
    v_mfma_f32_16x16x32_bf16 a[196:199], a[132:135], a[16:19], a[196:199]
    v_mfma_f32_16x16x32_bf16 a[200:203], a[136:139], a[16:19], a[200:203]
    v_mfma_f32_16x16x32_bf16 a[200:203], a[152:155], a[20:23], a[200:203]
    buffer_load_dwordx4 v33, s[8:11], s78 offen offset:1024 lds
    v_mfma_f32_16x16x32_bf16 a[204:207], a[156:159], a[20:23], a[204:207]
    ds_read_b64_tr_b16 a[20:21], v12 offset:57344
    v_mfma_f32_16x16x32_bf16 a[204:207], a[140:143], a[16:19], a[204:207]
    ds_read_b64_tr_b16 a[22:23], v12 offset:58368
    v_mfma_f32_16x16x32_bf16 a[220:223], a[140:143], a[24:27], a[220:223]
    ds_read_b64_tr_b16 a[16:17], v12 offset:49152
    v_mfma_f32_16x16x32_bf16 a[220:223], a[156:159], a[28:31], a[220:223]
    ds_read_b64_tr_b16 a[18:19], v12 offset:50176
    buffer_load_dwordx4 v34, s[8:11], s78 offen offset:2048 lds
    v_mfma_f32_16x16x32_bf16 a[216:219], a[152:155], a[28:31], a[216:219]
    v_mfma_f32_16x16x32_bf16 a[216:219], a[136:139], a[24:27], a[216:219]
    v_mfma_f32_16x16x32_bf16 a[212:215], a[132:135], a[24:27], a[212:215]
    v_mfma_f32_16x16x32_bf16 a[212:215], a[148:151], a[28:31], a[212:215]
    buffer_load_dwordx4 v35, s[8:11], s78 offen offset:3072 lds
    v_mfma_f32_16x16x32_bf16 a[208:211], a[144:147], a[28:31], a[208:211]
    ds_read_b64_tr_b16 a[28:29], v13 offset:57344
    v_mfma_f32_16x16x32_bf16 a[208:211], a[128:131], a[24:27], a[208:211]
    ds_read_b64_tr_b16 a[30:31], v13 offset:58368
    ds_read_b64_tr_b16 a[24:25], v13 offset:49152
    ds_read_b64_tr_b16 a[26:27], v13 offset:50176
    s_waitcnt vmcnt(12) lgkmcnt(4)
    v_mfma_f32_16x16x32_bf16 v[64:67], a[32:35], a[0:3], v[64:67]
    s_add_u32 s85, s85, 4096
    v_mfma_f32_16x16x32_bf16 v[64:67], a[48:51], a[4:7], v[64:67]
    buffer_load_dwordx4 a[80:83], v9, s[20:23], s85 offen offset:0 sc1
    v_mfma_f32_16x16x32_bf16 v[68:71], a[52:55], a[4:7], v[68:71]
    v_mfma_f32_16x16x32_bf16 v[68:71], a[36:39], a[0:3], v[68:71]
    v_mfma_f32_16x16x32_bf16 v[72:75], a[40:43], a[0:3], v[72:75]
    v_mfma_f32_16x16x32_bf16 v[72:75], a[56:59], a[4:7], v[72:75]
    buffer_load_dwordx4 a[84:87], v9, s[20:23], s85 offen offset:1024 sc1
    v_mfma_f32_16x16x32_bf16 v[76:79], a[60:63], a[4:7], v[76:79]
    ds_read_b64_tr_b16 a[4:5], v14 offset:57344
    v_mfma_f32_16x16x32_bf16 v[76:79], a[44:47], a[0:3], v[76:79]
    ds_read_b64_tr_b16 a[6:7], v14 offset:58368
    v_mfma_f32_16x16x32_bf16 v[92:95], a[44:47], a[8:11], v[92:95]
    ds_read_b64_tr_b16 a[0:1], v14 offset:49152
    v_mfma_f32_16x16x32_bf16 v[92:95], a[60:63], a[12:15], v[92:95]
    ds_read_b64_tr_b16 a[2:3], v14 offset:50176
    buffer_load_dwordx4 a[88:91], v9, s[20:23], s85 offen offset:2048 sc1
    v_mfma_f32_16x16x32_bf16 v[88:91], a[56:59], a[12:15], v[88:91]
    v_mfma_f32_16x16x32_bf16 v[88:91], a[40:43], a[8:11], v[88:91]
    v_mfma_f32_16x16x32_bf16 v[84:87], a[36:39], a[8:11], v[84:87]
    v_mfma_f32_16x16x32_bf16 v[84:87], a[52:55], a[12:15], v[84:87]
    buffer_load_dwordx4 a[92:95], v9, s[20:23], s85 offen offset:3072 sc1
    v_mfma_f32_16x16x32_bf16 v[80:83], a[48:51], a[12:15], v[80:83]
    ds_read_b64_tr_b16 a[12:13], v15 offset:57344
    v_mfma_f32_16x16x32_bf16 v[80:83], a[32:35], a[8:11], v[80:83]
    ds_read_b64_tr_b16 a[14:15], v15 offset:58368
    v_mfma_f32_16x16x32_bf16 v[96:99], a[32:35], a[16:19], v[96:99]
    ds_read_b64_tr_b16 a[8:9], v15 offset:49152
    s_add_u32 m0, s76, 20480
    v_mfma_f32_16x16x32_bf16 v[96:99], a[48:51], a[20:23], v[96:99]
    ds_read_b64_tr_b16 a[10:11], v15 offset:50176
    buffer_load_dwordx4 v36, s[8:11], s78 offen offset:0 lds
    v_mfma_f32_16x16x32_bf16 v[100:103], a[52:55], a[20:23], v[100:103]
    v_mfma_f32_16x16x32_bf16 v[100:103], a[36:39], a[16:19], v[100:103]
    v_mfma_f32_16x16x32_bf16 v[104:107], a[40:43], a[16:19], v[104:107]
    v_mfma_f32_16x16x32_bf16 v[104:107], a[56:59], a[20:23], v[104:107]
    buffer_load_dwordx4 v37, s[8:11], s78 offen offset:1024 lds
    v_mfma_f32_16x16x32_bf16 v[108:111], a[60:63], a[20:23], v[108:111]
    ds_read_b64_tr_b16 a[20:21], v16 offset:57344
    v_mfma_f32_16x16x32_bf16 v[108:111], a[44:47], a[16:19], v[108:111]
    ds_read_b64_tr_b16 a[22:23], v16 offset:58368
    s_waitcnt lgkmcnt(4)
    v_mfma_f32_16x16x32_bf16 v[124:127], a[44:47], a[24:27], v[124:127]
    ds_read_b64_tr_b16 a[16:17], v16 offset:49152
    v_mfma_f32_16x16x32_bf16 v[124:127], a[60:63], a[28:31], v[124:127]
    ds_read_b64_tr_b16 a[18:19], v16 offset:50176
    buffer_load_dwordx4 v38, s[8:11], s78 offen offset:2048 lds
    v_mfma_f32_16x16x32_bf16 v[120:123], a[56:59], a[28:31], v[120:123]
    v_mfma_f32_16x16x32_bf16 v[120:123], a[40:43], a[24:27], v[120:123]
    v_mfma_f32_16x16x32_bf16 v[116:119], a[36:39], a[24:27], v[116:119]
    v_mfma_f32_16x16x32_bf16 v[116:119], a[52:55], a[28:31], v[116:119]
    buffer_load_dwordx4 v39, s[8:11], s78 offen offset:3072 lds
    v_mfma_f32_16x16x32_bf16 v[112:115], a[48:51], a[28:31], v[112:115]
    ds_read_b64_tr_b16 a[28:29], v17 offset:57344
    v_mfma_f32_16x16x32_bf16 v[112:115], a[32:35], a[24:27], v[112:115]
    ds_read_b64_tr_b16 a[30:31], v17 offset:58368
    ds_read_b64_tr_b16 a[24:25], v17 offset:49152
    ds_read_b64_tr_b16 a[26:27], v17 offset:50176
    v_mfma_f32_16x16x32_bf16 a[160:163], a[32:35], a[0:3], a[160:163]
    s_add_u32 s85, s84, s81
    s_xor_b32 s81, s27, 8192
    v_mfma_f32_16x16x32_bf16 a[160:163], a[48:51], a[4:7], a[160:163]
    buffer_load_dwordx4 a[96:99], v9, s[20:23], s85 offen offset:0 sc1
    v_mfma_f32_16x16x32_bf16 a[164:167], a[52:55], a[4:7], a[164:167]
    v_mfma_f32_16x16x32_bf16 a[164:167], a[36:39], a[0:3], a[164:167]
    v_mfma_f32_16x16x32_bf16 a[168:171], a[40:43], a[0:3], a[168:171]
    v_mfma_f32_16x16x32_bf16 a[168:171], a[56:59], a[4:7], a[168:171]
    buffer_load_dwordx4 a[100:103], v9, s[20:23], s85 offen offset:1024 sc1
    v_mfma_f32_16x16x32_bf16 a[172:175], a[60:63], a[4:7], a[172:175]
    v_mfma_f32_16x16x32_bf16 a[172:175], a[44:47], a[0:3], a[172:175]
    s_waitcnt vmcnt(18)
    s_waitcnt lgkmcnt(0)
    s_barrier
    ds_read_b128 a[4:7], v41 offset:0
    v_mfma_f32_16x16x32_bf16 a[188:191], a[44:47], a[8:11], a[188:191]
    ds_read_b128 a[0:3], v40 offset:0
    v_mfma_f32_16x16x32_bf16 a[188:191], a[60:63], a[12:15], a[188:191]
    buffer_load_dwordx4 a[104:107], v9, s[20:23], s85 offen offset:2048 sc1
    v_mfma_f32_16x16x32_bf16 a[184:187], a[56:59], a[12:15], a[184:187]
    v_mfma_f32_16x16x32_bf16 a[184:187], a[40:43], a[8:11], a[184:187]
    v_mfma_f32_16x16x32_bf16 a[180:183], a[36:39], a[8:11], a[180:183]
    v_mfma_f32_16x16x32_bf16 a[180:183], a[52:55], a[12:15], a[180:183]
    buffer_load_dwordx4 a[108:111], v9, s[20:23], s85 offen offset:3072 sc1
    v_mfma_f32_16x16x32_bf16 a[176:179], a[48:51], a[12:15], a[176:179]
    ds_read_b128 a[12:15], v41 offset:2048
    v_mfma_f32_16x16x32_bf16 a[176:179], a[32:35], a[8:11], a[176:179]
    ds_read_b128 a[8:11], v40 offset:2048
    v_mfma_f32_16x16x32_bf16 a[192:195], a[32:35], a[16:19], a[192:195]
    s_add_u32 s78, s91, s18
    s_add_u32 m0, s76, 32768
    v_mfma_f32_16x16x32_bf16 a[192:195], a[48:51], a[20:23], a[192:195]
    buffer_load_dwordx4 v32, s[8:11], s78 offen offset:0 lds
    v_mfma_f32_16x16x32_bf16 a[196:199], a[52:55], a[20:23], a[196:199]
    v_mfma_f32_16x16x32_bf16 a[196:199], a[36:39], a[16:19], a[196:199]
    v_mfma_f32_16x16x32_bf16 a[200:203], a[40:43], a[16:19], a[200:203]
    v_mfma_f32_16x16x32_bf16 a[200:203], a[56:59], a[20:23], a[200:203]
    buffer_load_dwordx4 v33, s[8:11], s78 offen offset:1024 lds
    v_mfma_f32_16x16x32_bf16 a[204:207], a[60:63], a[20:23], a[204:207]
    ds_read_b128 a[20:23], v41 offset:4096
    v_mfma_f32_16x16x32_bf16 a[204:207], a[44:47], a[16:19], a[204:207]
    ds_read_b128 a[16:19], v40 offset:4096
    v_mfma_f32_16x16x32_bf16 a[220:223], a[44:47], a[24:27], a[220:223]
    v_mfma_f32_16x16x32_bf16 a[220:223], a[60:63], a[28:31], a[220:223]
    buffer_load_dwordx4 v34, s[8:11], s78 offen offset:2048 lds
    v_mfma_f32_16x16x32_bf16 a[216:219], a[56:59], a[28:31], a[216:219]
    v_mfma_f32_16x16x32_bf16 a[216:219], a[40:43], a[24:27], a[216:219]
    v_mfma_f32_16x16x32_bf16 a[212:215], a[36:39], a[24:27], a[212:215]
    v_mfma_f32_16x16x32_bf16 a[212:215], a[52:55], a[28:31], a[212:215]
    buffer_load_dwordx4 v35, s[8:11], s78 offen offset:3072 lds
    v_mfma_f32_16x16x32_bf16 a[208:211], a[48:51], a[28:31], a[208:211]
    ds_read_b128 a[28:31], v41 offset:6144
    v_mfma_f32_16x16x32_bf16 a[208:211], a[32:35], a[24:27], a[208:211]
    ds_read_b128 a[24:27], v40 offset:6144
    s_waitcnt vmcnt(12) lgkmcnt(4)
    v_mfma_f32_16x16x32_bf16 v[128:131], a[64:67], a[0:3], 0
    s_add_u32 s85, s85, 4096
    v_mfma_f32_16x16x32_bf16 v[128:131], a[80:83], a[4:7], v[128:131]
    buffer_load_dwordx4 a[112:115], v9, s[20:23], s85 offen offset:0 sc1
    v_mfma_f32_16x16x32_bf16 v[132:135], a[84:87], a[4:7], 0
    v_mfma_f32_16x16x32_bf16 v[132:135], a[68:71], a[0:3], v[132:135]
    v_mfma_f32_16x16x32_bf16 v[136:139], a[72:75], a[0:3], 0
    v_mfma_f32_16x16x32_bf16 v[136:139], a[88:91], a[4:7], v[136:139]
    buffer_load_dwordx4 a[116:119], v9, s[20:23], s85 offen offset:1024 sc1
    v_mfma_f32_16x16x32_bf16 v[140:143], a[92:95], a[4:7], 0
    ds_read_b128 a[4:7], v43 offset:0
    ds_write_b128 v20, a[160:163] offset:0
    v_mfma_f32_16x16x32_bf16 v[140:143], a[76:79], a[0:3], v[140:143]
    ds_read_b128 a[0:3], v42 offset:0
    v_mfma_f32_16x16x32_bf16 v[156:159], a[76:79], a[8:11], 0
    v_mfma_f32_16x16x32_bf16 v[156:159], a[92:95], a[12:15], v[156:159]
    buffer_load_dwordx4 a[120:123], v9, s[20:23], s85 offen offset:2048 sc1
    ds_write_b128 v20, a[164:167] offset:1024
    v_mfma_f32_16x16x32_bf16 v[152:155], a[88:91], a[12:15], 0
    v_mfma_f32_16x16x32_bf16 v[152:155], a[72:75], a[8:11], v[152:155]
    v_mfma_f32_16x16x32_bf16 v[148:151], a[68:71], a[8:11], 0
    ds_write_b128 v20, a[168:171] offset:2048
    v_mfma_f32_16x16x32_bf16 v[148:151], a[84:87], a[12:15], v[148:151]
    buffer_load_dwordx4 a[124:127], v9, s[20:23], s85 offen offset:3072 sc1
    v_mfma_f32_16x16x32_bf16 v[144:147], a[80:83], a[12:15], 0
    ds_read_b128 a[12:15], v43 offset:2048
    v_mfma_f32_16x16x32_bf16 v[144:147], a[64:67], a[8:11], v[144:147]
    ds_read_b128 a[8:11], v42 offset:2048
    ds_write_b128 v20, a[172:175] offset:3072
    s_waitcnt lgkmcnt(4)
    v_mfma_f32_16x16x32_bf16 v[160:163], a[64:67], a[16:19], 0
    s_add_u32 m0, s76, 36864
    v_mfma_f32_16x16x32_bf16 v[160:163], a[80:83], a[20:23], v[160:163]
    buffer_load_dwordx4 v36, s[8:11], s78 offen offset:0 lds
    v_mfma_f32_16x16x32_bf16 v[164:167], a[84:87], a[20:23], 0
    ds_write_b128 v20, a[176:179] offset:4096
    v_mfma_f32_16x16x32_bf16 v[164:167], a[68:71], a[16:19], v[164:167]
    v_mfma_f32_16x16x32_bf16 v[168:171], a[72:75], a[16:19], 0
    v_mfma_f32_16x16x32_bf16 v[168:171], a[88:91], a[20:23], v[168:171]
    buffer_load_dwordx4 v37, s[8:11], s78 offen offset:1024 lds
    ds_write_b128 v20, a[180:183] offset:5120
    v_mfma_f32_16x16x32_bf16 v[172:175], a[92:95], a[20:23], 0
    ds_read_b128 a[20:23], v43 offset:4096
    v_mfma_f32_16x16x32_bf16 v[172:175], a[76:79], a[16:19], v[172:175]
    ds_read_b128 a[16:19], v42 offset:4096
    v_mfma_f32_16x16x32_bf16 v[188:191], a[76:79], a[24:27], 0
    ds_write_b128 v20, a[184:187] offset:6144
    v_mfma_f32_16x16x32_bf16 v[188:191], a[92:95], a[28:31], v[188:191]
    buffer_load_dwordx4 v38, s[8:11], s78 offen offset:2048 lds
    v_mfma_f32_16x16x32_bf16 v[184:187], a[88:91], a[28:31], 0
    v_mfma_f32_16x16x32_bf16 v[184:187], a[72:75], a[24:27], v[184:187]
    ds_write_b128 v20, a[188:191] offset:7168
    v_mfma_f32_16x16x32_bf16 v[180:183], a[68:71], a[24:27], 0
    v_mfma_f32_16x16x32_bf16 v[180:183], a[84:87], a[28:31], v[180:183]
    buffer_load_dwordx4 v39, s[8:11], s78 offen offset:3072 lds
    v_mfma_f32_16x16x32_bf16 v[176:179], a[80:83], a[28:31], 0
    ds_read_b128 a[28:31], v43 offset:6144
    v_mfma_f32_16x16x32_bf16 v[176:179], a[64:67], a[24:27], v[176:179]
    ds_read_b128 a[24:27], v42 offset:6144
    v_mfma_f32_16x16x32_bf16 v[192:195], a[64:67], a[0:3], 0
    s_add_u32 s85, s84, s82
    s_xor_b32 s82, s27, 16384
    v_mfma_f32_16x16x32_bf16 v[192:195], a[80:83], a[4:7], v[192:195]
    buffer_load_dwordx4 a[128:131], v9, s[20:23], s85 offen offset:0 sc1
    v_mfma_f32_16x16x32_bf16 v[196:199], a[84:87], a[4:7], 0
    v_mfma_f32_16x16x32_bf16 v[196:199], a[68:71], a[0:3], v[196:199]
    v_mfma_f32_16x16x32_bf16 v[200:203], a[72:75], a[0:3], 0
    v_mfma_f32_16x16x32_bf16 v[200:203], a[88:91], a[4:7], v[200:203]
    buffer_load_dwordx4 a[132:135], v9, s[20:23], s85 offen offset:1024 sc1
    v_mfma_f32_16x16x32_bf16 v[204:207], a[92:95], a[4:7], 0
    v_mfma_f32_16x16x32_bf16 v[204:207], a[76:79], a[0:3], v[204:207]
    s_waitcnt vmcnt(18)
    s_waitcnt lgkmcnt(0)
    s_barrier
    ds_read_b128 a[4:7], v41 offset:16384
    v_mfma_f32_16x16x32_bf16 v[220:223], a[76:79], a[8:11], 0
    ds_read_b128 a[0:3], v40 offset:16384
    ds_read_b128 v[44:47], v21 offset:0
    v_mfma_f32_16x16x32_bf16 v[220:223], a[92:95], a[12:15], v[220:223]
    buffer_load_dwordx4 a[136:139], v9, s[20:23], s85 offen offset:2048 sc1
    ds_read_b128 v[48:51], v21 offset:1024
    v_mfma_f32_16x16x32_bf16 v[216:219], a[88:91], a[12:15], 0
    ds_read_b128 v[52:55], v21 offset:2048
    v_mfma_f32_16x16x32_bf16 v[216:219], a[72:75], a[8:11], v[216:219]
    ds_read_b128 v[56:59], v21 offset:3072
    v_mfma_f32_16x16x32_bf16 v[212:215], a[68:71], a[8:11], 0
    v_mfma_f32_16x16x32_bf16 v[212:215], a[84:87], a[12:15], v[212:215]
    buffer_load_dwordx4 a[140:143], v9, s[20:23], s85 offen offset:3072 sc1
    v_mfma_f32_16x16x32_bf16 v[208:211], a[80:83], a[12:15], 0
    ds_read_b128 a[12:15], v41 offset:18432
    v_mfma_f32_16x16x32_bf16 v[208:211], a[64:67], a[8:11], v[208:211]
    ds_read_b128 a[8:11], v40 offset:18432
    v_mfma_f32_16x16x32_bf16 v[224:227], a[64:67], a[16:19], 0
    s_add_u32 s78, s91, s19
    s_add_u32 m0, s76, 49152
    v_mfma_f32_16x16x32_bf16 v[224:227], a[80:83], a[20:23], v[224:227]
    buffer_load_dwordx4 v32, s[8:11], s78 offen offset:0 lds
    s_waitcnt lgkmcnt(4)
    v_add_f32 v64, v64, v44
    v_add_f32 v65, v65, v45
    v_add_f32 v66, v66, v46
    v_add_f32_e64 v67, v67, v47
    v_mfma_f32_16x16x32_bf16 v[228:231], a[84:87], a[20:23], 0
    v_mfma_f32_16x16x32_bf16 v[228:231], a[68:71], a[16:19], v[228:231]
    v_mfma_f32_16x16x32_bf16 v[232:235], a[72:75], a[16:19], 0
    v_add_f32 v68, v68, v48
    v_add_f32 v69, v69, v49
    v_add_f32 v70, v70, v50
    v_add_f32 v71, v71, v51
    v_mfma_f32_16x16x32_bf16 v[232:235], a[88:91], a[20:23], v[232:235]
    buffer_load_dwordx4 v33, s[8:11], s78 offen offset:1024 lds
    v_mfma_f32_16x16x32_bf16 v[236:239], a[92:95], a[20:23], 0
    ds_read_b128 a[20:23], v41 offset:20480
    v_mfma_f32_16x16x32_bf16 v[236:239], a[76:79], a[16:19], v[236:239]
    ds_read_b128 a[16:19], v40 offset:20480
    s_waitcnt lgkmcnt(4)
    v_add_f32 v72, v72, v52
    v_add_f32 v73, v73, v53
    v_add_f32 v74, v74, v54
    v_add_f32_e64 v75, v75, v55
    v_mfma_f32_16x16x32_bf16 v[252:255], a[76:79], a[24:27], 0
    v_mfma_f32_16x16x32_bf16 v[252:255], a[92:95], a[28:31], v[252:255]
    buffer_load_dwordx4 v34, s[8:11], s78 offen offset:2048 lds
    v_mfma_f32_16x16x32_bf16 v[248:251], a[88:91], a[28:31], 0
    v_add_f32 v76, v76, v56
    v_add_f32 v77, v77, v57
    v_add_f32 v78, v78, v58
    v_add_f32 v79, v79, v59
    v_mfma_f32_16x16x32_bf16 v[248:251], a[72:75], a[24:27], v[248:251]
    v_mfma_f32_16x16x32_bf16 v[244:247], a[68:71], a[24:27], 0
    v_mfma_f32_16x16x32_bf16 v[244:247], a[84:87], a[28:31], v[244:247]
    buffer_load_dwordx4 v35, s[8:11], s78 offen offset:3072 lds
    v_mfma_f32_16x16x32_bf16 v[240:243], a[80:83], a[28:31], 0
    ds_read_b128 a[28:31], v41 offset:22528
    v_mfma_f32_16x16x32_bf16 v[240:243], a[64:67], a[24:27], v[240:243]
    ds_read_b128 a[24:27], v40 offset:22528
    s_waitcnt vmcnt(12)
    v_mfma_f32_16x16x32_bf16 v[128:131], a[96:99], a[0:3], v[128:131]
    s_xor_b32 s93, s93, 128
    v_mfma_f32_16x16x32_bf16 v[128:131], a[112:115], a[4:7], v[128:131]
    buffer_load_dwordx2 v[26:27], v60, s[20:23], s93 offen sc1
    ds_read_b128 v[44:47], v21 offset:4096
    v_mfma_f32_16x16x32_bf16 v[132:135], a[116:119], a[4:7], v[132:135]
    ds_read_b128 v[48:51], v21 offset:5120
    v_mfma_f32_16x16x32_bf16 v[132:135], a[100:103], a[0:3], v[132:135]
    s_add_u32 s85, s85, 4096
    ds_read_b128 v[52:55], v21 offset:6144
    v_mfma_f32_16x16x32_bf16 v[136:139], a[104:107], a[0:3], v[136:139]
    buffer_load_dwordx4 a[144:147], v9, s[20:23], s85 offen offset:0 sc1
    ds_read_b128 v[56:59], v21 offset:7168
    v_mfma_f32_16x16x32_bf16 v[136:139], a[120:123], a[4:7], v[136:139]
    v_mfma_f32_16x16x32_bf16 v[140:143], a[124:127], a[4:7], v[140:143]
    ds_read_b128 a[4:7], v43 offset:16384
    v_mfma_f32_16x16x32_bf16 v[140:143], a[108:111], a[0:3], v[140:143]
    ds_read_b128 a[0:3], v42 offset:16384
    s_waitcnt lgkmcnt(4)
    v_mfma_f32_16x16x32_bf16 v[156:159], a[108:111], a[8:11], v[156:159]
    buffer_load_dwordx4 a[148:151], v9, s[20:23], s85 offen offset:1024 sc1
    v_mfma_f32_16x16x32_bf16 v[156:159], a[124:127], a[12:15], v[156:159]
    v_mfma_f32_16x16x32_bf16 v[152:155], a[120:123], a[12:15], v[152:155]
    v_add_f32 v80, v80, v44
    v_add_f32 v81, v81, v45
    v_add_f32 v82, v82, v46
    v_add_f32 v83, v83, v47
    v_mfma_f32_16x16x32_bf16 v[152:155], a[104:107], a[8:11], v[152:155]
    buffer_load_dwordx4 a[152:155], v9, s[20:23], s85 offen offset:2048 sc1
    v_mfma_f32_16x16x32_bf16 v[148:151], a[100:103], a[8:11], v[148:151]
    v_mfma_f32_16x16x32_bf16 v[148:151], a[116:119], a[12:15], v[148:151]
    v_mfma_f32_16x16x32_bf16 v[144:147], a[112:115], a[12:15], v[144:147]
    ds_read_b128 a[12:15], v43 offset:18432
    v_add_f32 v84, v84, v48
    v_add_f32 v85, v85, v49
    v_add_f32 v86, v86, v50
    v_add_f32 v87, v87, v51
    v_mfma_f32_16x16x32_bf16 v[144:147], a[96:99], a[8:11], v[144:147]
    ds_read_b128 a[8:11], v42 offset:18432
    buffer_load_dwordx4 a[156:159], v9, s[20:23], s85 offen offset:3072 sc1
    v_mfma_f32_16x16x32_bf16 v[160:163], a[96:99], a[16:19], v[160:163]
    v_mfma_f32_16x16x32_bf16 v[160:163], a[112:115], a[20:23], v[160:163]
    s_add_u32 m0, s76, 53248
    v_mfma_f32_16x16x32_bf16 v[164:167], a[116:119], a[20:23], v[164:167]
    buffer_load_dwordx4 v36, s[8:11], s78 offen offset:0 lds
    s_waitcnt lgkmcnt(4)
    v_add_f32 v88, v88, v52
    v_add_f32 v89, v89, v53
    v_add_f32 v90, v90, v54
    v_add_f32_e64 v91, v91, v55
    v_mfma_f32_16x16x32_bf16 v[164:167], a[100:103], a[16:19], v[164:167]
    v_mfma_f32_16x16x32_bf16 v[168:171], a[104:107], a[16:19], v[168:171]
    v_mfma_f32_16x16x32_bf16 v[168:171], a[120:123], a[20:23], v[168:171]
    v_mfma_f32_16x16x32_bf16 v[172:175], a[124:127], a[20:23], v[172:175]
    ds_read_b128 a[20:23], v43 offset:20480
    buffer_load_dwordx4 v37, s[8:11], s78 offen offset:1024 lds
    v_add_f32 v92, v92, v56
    v_add_f32 v93, v93, v57
    v_add_f32 v94, v94, v58
    v_add_f32 v95, v95, v59
    v_mfma_f32_16x16x32_bf16 v[172:175], a[108:111], a[16:19], v[172:175]
    ds_read_b128 a[16:19], v42 offset:20480
    v_mfma_f32_16x16x32_bf16 v[188:191], a[108:111], a[24:27], v[188:191]
    v_mfma_f32_16x16x32_bf16 v[188:191], a[124:127], a[28:31], v[188:191]
    buffer_load_dwordx4 v38, s[8:11], s78 offen offset:2048 lds
    v_mfma_f32_16x16x32_bf16 v[184:187], a[120:123], a[28:31], v[184:187]
    v_mfma_f32_16x16x32_bf16 v[184:187], a[104:107], a[24:27], v[184:187]
    v_mfma_f32_16x16x32_bf16 v[180:183], a[100:103], a[24:27], v[180:183]
    v_mfma_f32_16x16x32_bf16 v[180:183], a[116:119], a[28:31], v[180:183]
    buffer_load_dwordx4 v39, s[8:11], s78 offen offset:3072 lds
    v_mfma_f32_16x16x32_bf16 v[176:179], a[112:115], a[28:31], v[176:179]
    ds_read_b128 a[28:31], v43 offset:22528
    s_add_u32 s91, s91, 512
    v_mfma_f32_16x16x32_bf16 v[176:179], a[96:99], a[24:27], v[176:179]
    ds_read_b128 a[24:27], v42 offset:22528
    s_waitcnt lgkmcnt(4)
    v_mfma_f32_16x16x32_bf16 v[192:195], a[96:99], a[0:3], v[192:195]
    s_add_u32 s85, s84, s83
    s_xor_b32 s83, s27, 24576
    v_mfma_f32_16x16x32_bf16 v[192:195], a[112:115], a[4:7], v[192:195]
    buffer_load_dwordx4 a[32:35], v9, s[20:23], s85 offen offset:0 sc1
    v_mfma_f32_16x16x32_bf16 v[196:199], a[116:119], a[4:7], v[196:199]
    v_mfma_f32_16x16x32_bf16 v[196:199], a[100:103], a[0:3], v[196:199]
    v_mfma_f32_16x16x32_bf16 v[200:203], a[104:107], a[0:3], v[200:203]
    v_mfma_f32_16x16x32_bf16 v[200:203], a[120:123], a[4:7], v[200:203]
    buffer_load_dwordx4 a[36:39], v9, s[20:23], s85 offen offset:1024 sc1
    v_mfma_f32_16x16x32_bf16 v[204:207], a[124:127], a[4:7], v[204:207]
    v_mfma_f32_16x16x32_bf16 v[204:207], a[108:111], a[0:3], v[204:207]
    s_waitcnt vmcnt(19)
    s_waitcnt lgkmcnt(0)
    s_barrier
    ds_read_b128 a[4:7], v41 offset:32768
    v_mfma_f32_16x16x32_bf16 v[220:223], a[108:111], a[8:11], v[220:223]
    ds_read_b128 a[0:3], v40 offset:32768
    v_mfma_f32_16x16x32_bf16 v[220:223], a[124:127], a[12:15], v[220:223]
    buffer_load_dwordx4 a[40:43], v9, s[20:23], s85 offen offset:2048 sc1
    v_mfma_f32_16x16x32_bf16 v[216:219], a[120:123], a[12:15], v[216:219]
    v_mfma_f32_16x16x32_bf16 v[216:219], a[104:107], a[8:11], v[216:219]
    v_mfma_f32_16x16x32_bf16 v[212:215], a[100:103], a[8:11], v[212:215]
    v_mfma_f32_16x16x32_bf16 v[212:215], a[116:119], a[12:15], v[212:215]
    buffer_load_dwordx4 a[44:47], v9, s[20:23], s85 offen offset:3072 sc1
    v_mfma_f32_16x16x32_bf16 v[208:211], a[112:115], a[12:15], v[208:211]
    ds_read_b128 a[12:15], v41 offset:34816
    v_mfma_f32_16x16x32_bf16 v[208:211], a[96:99], a[8:11], v[208:211]
    ds_read_b128 a[8:11], v40 offset:34816
    v_mfma_f32_16x16x32_bf16 v[224:227], a[96:99], a[16:19], v[224:227]
    s_add_u32 s78, s91, s16
    s_add_u32 m0, s76, 0
    v_mfma_f32_16x16x32_bf16 v[224:227], a[112:115], a[20:23], v[224:227]
    buffer_load_dwordx4 v32, s[8:11], s78 offen offset:0 lds
    v_mfma_f32_16x16x32_bf16 v[228:231], a[116:119], a[20:23], v[228:231]
    v_mfma_f32_16x16x32_bf16 v[228:231], a[100:103], a[16:19], v[228:231]
    v_mfma_f32_16x16x32_bf16 v[232:235], a[104:107], a[16:19], v[232:235]
    v_mfma_f32_16x16x32_bf16 v[232:235], a[120:123], a[20:23], v[232:235]
    buffer_load_dwordx4 v33, s[8:11], s78 offen offset:1024 lds
    v_mfma_f32_16x16x32_bf16 v[236:239], a[124:127], a[20:23], v[236:239]
    ds_read_b128 a[20:23], v41 offset:36864
    v_mfma_f32_16x16x32_bf16 v[236:239], a[108:111], a[16:19], v[236:239]
    ds_read_b128 a[16:19], v40 offset:36864
    v_mfma_f32_16x16x32_bf16 v[252:255], a[108:111], a[24:27], v[252:255]
    v_mfma_f32_16x16x32_bf16 v[252:255], a[124:127], a[28:31], v[252:255]
    buffer_load_dwordx4 v34, s[8:11], s78 offen offset:2048 lds
    v_mfma_f32_16x16x32_bf16 v[248:251], a[120:123], a[28:31], v[248:251]
    v_mfma_f32_16x16x32_bf16 v[248:251], a[104:107], a[24:27], v[248:251]
    v_mfma_f32_16x16x32_bf16 v[244:247], a[100:103], a[24:27], v[244:247]
    v_mfma_f32_16x16x32_bf16 v[244:247], a[116:119], a[28:31], v[244:247]
    buffer_load_dwordx4 v35, s[8:11], s78 offen offset:3072 lds
    v_mfma_f32_16x16x32_bf16 v[240:243], a[112:115], a[28:31], v[240:243]
    ds_read_b128 a[28:31], v41 offset:38912
    v_mfma_f32_16x16x32_bf16 v[240:243], a[96:99], a[24:27], v[240:243]
    ds_read_b128 a[24:27], v40 offset:38912
    s_waitcnt vmcnt(12) lgkmcnt(4)
    v_mfma_f32_16x16x32_bf16 v[128:131], a[128:131], a[0:3], v[128:131]
    s_mov_b32 s55, 0x40000
L_wcs2:
    v_cmp_ne_u64 vcc, s[48:49], v[26:27]
    s_cbranch_vccnz L_k3_spin2
L_gcs2:
    s_add_u32 s85, s85, 4096
    v_mfma_f32_16x16x32_bf16 v[128:131], a[144:147], a[4:7], v[128:131]
    buffer_load_dwordx4 a[48:51], v9, s[20:23], s85 offen offset:0 sc1
    v_mfma_f32_16x16x32_bf16 v[132:135], a[148:151], a[4:7], v[132:135]
    v_mfma_f32_16x16x32_bf16 v[132:135], a[132:135], a[0:3], v[132:135]
    buffer_load_dwordx4 a[52:55], v9, s[20:23], s85 offen offset:1024 sc1
    v_mfma_f32_16x16x32_bf16 v[136:139], a[136:139], a[0:3], v[136:139]
    v_mfma_f32_16x16x32_bf16 v[136:139], a[152:155], a[4:7], v[136:139]
    v_mfma_f32_16x16x32_bf16 v[140:143], a[156:159], a[4:7], v[140:143]
    ds_read_b128 a[4:7], v43 offset:32768
    buffer_load_dwordx4 a[56:59], v9, s[20:23], s85 offen offset:2048 sc1
    ds_write_b128 v20, a[192:195] offset:0
    v_mfma_f32_16x16x32_bf16 v[140:143], a[140:143], a[0:3], v[140:143]
    ds_read_b128 a[0:3], v42 offset:32768
    v_mfma_f32_16x16x32_bf16 v[156:159], a[140:143], a[8:11], v[156:159]
    v_mfma_f32_16x16x32_bf16 v[156:159], a[156:159], a[12:15], v[156:159]
    buffer_load_dwordx4 a[60:63], v9, s[20:23], s85 offen offset:3072 sc1
    ds_write_b128 v20, a[196:199] offset:1024
    v_mfma_f32_16x16x32_bf16 v[152:155], a[152:155], a[12:15], v[152:155]
    s_add_u32 s84, s84, 32768
    s_add_u32 s85, s84, s80
    s_xor_b32 s80, s27, 0
    v_mfma_f32_16x16x32_bf16 v[152:155], a[136:139], a[8:11], v[152:155]
    buffer_load_dwordx4 a[64:67], v9, s[20:23], s85 offen offset:0 sc1
    v_mfma_f32_16x16x32_bf16 v[148:151], a[132:135], a[8:11], v[148:151]
    ds_write_b128 v20, a[200:203] offset:2048
    v_mfma_f32_16x16x32_bf16 v[148:151], a[148:151], a[12:15], v[148:151]
    v_mfma_f32_16x16x32_bf16 v[144:147], a[144:147], a[12:15], v[144:147]
    ds_read_b128 a[12:15], v43 offset:34816
    buffer_load_dwordx4 a[68:71], v9, s[20:23], s85 offen offset:1024 sc1
    v_mfma_f32_16x16x32_bf16 v[144:147], a[128:131], a[8:11], v[144:147]
    ds_read_b128 a[8:11], v42 offset:34816
    ds_write_b128 v20, a[204:207] offset:3072
    s_waitcnt lgkmcnt(4)
    v_mfma_f32_16x16x32_bf16 v[160:163], a[128:131], a[16:19], v[160:163]
    v_mfma_f32_16x16x32_bf16 v[160:163], a[144:147], a[20:23], v[160:163]
    buffer_load_dwordx4 a[72:75], v9, s[20:23], s85 offen offset:2048 sc1
    v_mfma_f32_16x16x32_bf16 v[164:167], a[148:151], a[20:23], v[164:167]
    ds_write_b128 v20, a[208:211] offset:4096
    v_mfma_f32_16x16x32_bf16 v[164:167], a[132:135], a[16:19], v[164:167]
    buffer_load_dwordx4 a[76:79], v9, s[20:23], s85 offen offset:3072 sc1
    v_mfma_f32_16x16x32_bf16 v[168:171], a[136:139], a[16:19], v[168:171]
    v_mfma_f32_16x16x32_bf16 v[168:171], a[152:155], a[20:23], v[168:171]
    s_add_u32 m0, s76, 4096
    ds_write_b128 v20, a[212:215] offset:5120
    v_mfma_f32_16x16x32_bf16 v[172:175], a[156:159], a[20:23], v[172:175]
    ds_read_b128 a[20:23], v43 offset:36864
    buffer_load_dwordx4 v36, s[8:11], s78 offen offset:0 lds
    v_mfma_f32_16x16x32_bf16 v[172:175], a[140:143], a[16:19], v[172:175]
    ds_read_b128 a[16:19], v42 offset:36864
    v_mfma_f32_16x16x32_bf16 v[188:191], a[140:143], a[24:27], v[188:191]
    ds_write_b128 v20, a[216:219] offset:6144
    v_mfma_f32_16x16x32_bf16 v[188:191], a[156:159], a[28:31], v[188:191]
    buffer_load_dwordx4 v37, s[8:11], s78 offen offset:1024 lds
    v_mfma_f32_16x16x32_bf16 v[184:187], a[152:155], a[28:31], v[184:187]
    v_mfma_f32_16x16x32_bf16 v[184:187], a[136:139], a[24:27], v[184:187]
    buffer_load_dwordx4 v38, s[8:11], s78 offen offset:2048 lds
    ds_write_b128 v20, a[220:223] offset:7168
    v_mfma_f32_16x16x32_bf16 v[180:183], a[132:135], a[24:27], v[180:183]
    v_mfma_f32_16x16x32_bf16 v[180:183], a[148:151], a[28:31], v[180:183]
    v_mfma_f32_16x16x32_bf16 v[176:179], a[144:147], a[28:31], v[176:179]
    ds_read_b128 a[28:31], v43 offset:38912
    buffer_load_dwordx4 v39, s[8:11], s78 offen offset:3072 lds
    v_mfma_f32_16x16x32_bf16 v[176:179], a[128:131], a[24:27], v[176:179]
    ds_read_b128 a[24:27], v42 offset:38912
    v_mfma_f32_16x16x32_bf16 v[192:195], a[128:131], a[0:3], v[192:195]
    s_add_u32 s85, s85, 4096
    v_mfma_f32_16x16x32_bf16 v[192:195], a[144:147], a[4:7], v[192:195]
    buffer_load_dwordx4 a[80:83], v9, s[20:23], s85 offen offset:0 sc1
    v_mfma_f32_16x16x32_bf16 v[196:199], a[148:151], a[4:7], v[196:199]
    v_mfma_f32_16x16x32_bf16 v[196:199], a[132:135], a[0:3], v[196:199]
    buffer_load_dwordx4 a[84:87], v9, s[20:23], s85 offen offset:1024 sc1
    v_mfma_f32_16x16x32_bf16 v[200:203], a[136:139], a[0:3], v[200:203]
    v_mfma_f32_16x16x32_bf16 v[200:203], a[152:155], a[4:7], v[200:203]
    v_mfma_f32_16x16x32_bf16 v[204:207], a[156:159], a[4:7], v[204:207]
    buffer_load_dwordx4 a[88:91], v9, s[20:23], s85 offen offset:2048 sc1
    v_mfma_f32_16x16x32_bf16 v[204:207], a[140:143], a[0:3], v[204:207]
    s_waitcnt vmcnt(23)
    s_waitcnt lgkmcnt(0)
    s_barrier
    ds_read_b128 a[4:7], v41 offset:49152
    v_mfma_f32_16x16x32_bf16 v[220:223], a[140:143], a[8:11], v[220:223]
    ds_read_b128 a[0:3], v40 offset:49152
    ds_read_b128 v[44:47], v21 offset:0
    v_mfma_f32_16x16x32_bf16 v[220:223], a[156:159], a[12:15], v[220:223]
    buffer_load_dwordx4 a[92:95], v9, s[20:23], s85 offen offset:3072 sc1
    ds_read_b128 v[48:51], v21 offset:1024
    v_mfma_f32_16x16x32_bf16 v[216:219], a[152:155], a[12:15], v[216:219]
    s_add_u32 s85, s84, s81
    s_xor_b32 s81, s27, 8192
    ds_read_b128 v[52:55], v21 offset:2048
    v_mfma_f32_16x16x32_bf16 v[216:219], a[136:139], a[8:11], v[216:219]
    buffer_load_dwordx4 a[96:99], v9, s[20:23], s85 offen offset:0 sc1
    ds_read_b128 v[56:59], v21 offset:3072
    v_mfma_f32_16x16x32_bf16 v[212:215], a[132:135], a[8:11], v[212:215]
    v_mfma_f32_16x16x32_bf16 v[212:215], a[148:151], a[12:15], v[212:215]
    v_mfma_f32_16x16x32_bf16 v[208:211], a[144:147], a[12:15], v[208:211]
    ds_read_b128 a[12:15], v41 offset:51200
    buffer_load_dwordx4 a[100:103], v9, s[20:23], s85 offen offset:1024 sc1
    v_mfma_f32_16x16x32_bf16 v[208:211], a[128:131], a[8:11], v[208:211]
    ds_read_b128 a[8:11], v40 offset:51200
    v_mfma_f32_16x16x32_bf16 v[224:227], a[128:131], a[16:19], v[224:227]
    v_mfma_f32_16x16x32_bf16 v[224:227], a[144:147], a[20:23], v[224:227]
    buffer_load_dwordx4 a[104:107], v9, s[20:23], s85 offen offset:2048 sc1
    s_waitcnt lgkmcnt(4)
    v_add_f32 v96, v96, v44
    v_add_f32 v97, v97, v45
    v_add_f32 v98, v98, v46
    v_add_f32 v99, v99, v47
    v_mfma_f32_16x16x32_bf16 v[228:231], a[148:151], a[20:23], v[228:231]
    v_mfma_f32_16x16x32_bf16 v[228:231], a[132:135], a[16:19], v[228:231]
    buffer_load_dwordx4 a[108:111], v9, s[20:23], s85 offen offset:3072 sc1
    v_mfma_f32_16x16x32_bf16 v[232:235], a[136:139], a[16:19], v[232:235]
    v_add_f32 v100, v100, v48
    v_add_f32 v101, v101, v49
    v_add_f32 v102, v102, v50
    v_add_f32 v103, v103, v51
    v_mfma_f32_16x16x32_bf16 v[232:235], a[152:155], a[20:23], v[232:235]
    s_add_u32 s78, s91, s17
    s_add_u32 m0, s76, 16384
    v_mfma_f32_16x16x32_bf16 v[236:239], a[156:159], a[20:23], v[236:239]
    ds_read_b128 a[20:23], v41 offset:53248
    buffer_load_dwordx4 v32, s[8:11], s78 offen offset:0 lds
    v_mfma_f32_16x16x32_bf16 v[236:239], a[140:143], a[16:19], v[236:239]
    ds_read_b128 a[16:19], v40 offset:53248
    s_waitcnt lgkmcnt(4)
    v_add_f32 v104, v104, v52
    v_add_f32 v105, v105, v53
    v_add_f32 v106, v106, v54
    v_add_f32 v107, v107, v55
    v_mfma_f32_16x16x32_bf16 v[252:255], a[140:143], a[24:27], v[252:255]
    v_mfma_f32_16x16x32_bf16 v[252:255], a[156:159], a[28:31], v[252:255]
    buffer_load_dwordx4 v33, s[8:11], s78 offen offset:1024 lds
    v_mfma_f32_16x16x32_bf16 v[248:251], a[152:155], a[28:31], v[248:251]
    v_add_f32 v108, v108, v56
    v_add_f32 v109, v109, v57
    v_add_f32 v110, v110, v58
    v_add_f32 v111, v111, v59
    v_mfma_f32_16x16x32_bf16 v[248:251], a[136:139], a[24:27], v[248:251]
    buffer_load_dwordx4 v34, s[8:11], s78 offen offset:2048 lds
    v_mfma_f32_16x16x32_bf16 v[244:247], a[132:135], a[24:27], v[244:247]
    v_mfma_f32_16x16x32_bf16 v[244:247], a[148:151], a[28:31], v[244:247]
    v_mfma_f32_16x16x32_bf16 v[240:243], a[144:147], a[28:31], v[240:243]
    ds_read_b128 a[28:31], v41 offset:55296
    buffer_load_dwordx4 v35, s[8:11], s78 offen offset:3072 lds
    v_mfma_f32_16x16x32_bf16 v[240:243], a[128:131], a[24:27], v[240:243]
    ds_read_b128 a[24:27], v40 offset:55296
    s_waitcnt vmcnt(20)
    v_mfma_f32_16x16x32_bf16 v[128:131], a[32:35], a[0:3], v[128:131]
    s_add_u32 s85, s85, 4096
    v_mfma_f32_16x16x32_bf16 v[128:131], a[48:51], a[4:7], v[128:131]
    buffer_load_dwordx4 a[112:115], v9, s[20:23], s85 offen offset:0 sc1
    ds_read_b128 v[44:47], v21 offset:4096
    v_mfma_f32_16x16x32_bf16 v[132:135], a[52:55], a[4:7], v[132:135]
    ds_read_b128 v[48:51], v21 offset:5120
    v_mfma_f32_16x16x32_bf16 v[132:135], a[36:39], a[0:3], v[132:135]
    buffer_load_dwordx4 a[116:119], v9, s[20:23], s85 offen offset:1024 sc1
    ds_read_b128 v[52:55], v21 offset:6144
    v_mfma_f32_16x16x32_bf16 v[136:139], a[40:43], a[0:3], v[136:139]
    ds_read_b128 v[56:59], v21 offset:7168
    v_mfma_f32_16x16x32_bf16 v[136:139], a[56:59], a[4:7], v[136:139]
    v_mfma_f32_16x16x32_bf16 v[140:143], a[60:63], a[4:7], v[140:143]
    ds_read_b128 a[4:7], v43 offset:49152
    buffer_load_dwordx4 a[120:123], v9, s[20:23], s85 offen offset:2048 sc1
    v_mfma_f32_16x16x32_bf16 v[140:143], a[44:47], a[0:3], v[140:143]
    ds_read_b128 a[0:3], v42 offset:49152
    s_waitcnt lgkmcnt(4)
    v_mfma_f32_16x16x32_bf16 v[156:159], a[44:47], a[8:11], v[156:159]
    v_mfma_f32_16x16x32_bf16 v[156:159], a[60:63], a[12:15], v[156:159]
    buffer_load_dwordx4 a[124:127], v9, s[20:23], s85 offen offset:3072 sc1
    v_mfma_f32_16x16x32_bf16 v[152:155], a[56:59], a[12:15], v[152:155]
    s_add_u32 s85, s84, s82
    s_xor_b32 s82, s27, 16384
    v_add_f32 v112, v112, v44
    v_add_f32 v113, v113, v45
    v_add_f32 v114, v114, v46
    v_add_f32_e64 v115, v115, v47
    v_mfma_f32_16x16x32_bf16 v[152:155], a[40:43], a[8:11], v[152:155]
    buffer_load_dwordx4 a[128:131], v9, s[20:23], s85 offen offset:0 sc1
    v_mfma_f32_16x16x32_bf16 v[148:151], a[36:39], a[8:11], v[148:151]
    v_mfma_f32_16x16x32_bf16 v[148:151], a[52:55], a[12:15], v[148:151]
    v_mfma_f32_16x16x32_bf16 v[144:147], a[48:51], a[12:15], v[144:147]
    ds_read_b128 a[12:15], v43 offset:51200
    buffer_load_dwordx4 a[132:135], v9, s[20:23], s85 offen offset:1024 sc1
    v_add_f32 v116, v116, v48
    v_add_f32 v117, v117, v49
    v_add_f32 v118, v118, v50
    v_add_f32 v119, v119, v51
    v_mfma_f32_16x16x32_bf16 v[144:147], a[32:35], a[8:11], v[144:147]
    ds_read_b128 a[8:11], v42 offset:51200
    v_mfma_f32_16x16x32_bf16 v[160:163], a[32:35], a[16:19], v[160:163]
    v_mfma_f32_16x16x32_bf16 v[160:163], a[48:51], a[20:23], v[160:163]
    buffer_load_dwordx4 a[136:139], v9, s[20:23], s85 offen offset:2048 sc1
    v_mfma_f32_16x16x32_bf16 v[164:167], a[52:55], a[20:23], v[164:167]
    s_waitcnt lgkmcnt(4)
    v_add_f32 v120, v120, v52
    v_add_f32 v121, v121, v53
    v_add_f32 v122, v122, v54
    v_add_f32_e64 v123, v123, v55
    v_mfma_f32_16x16x32_bf16 v[164:167], a[36:39], a[16:19], v[164:167]
    buffer_load_dwordx4 a[140:143], v9, s[20:23], s85 offen offset:3072 sc1
    v_mfma_f32_16x16x32_bf16 v[168:171], a[40:43], a[16:19], v[168:171]
    v_mfma_f32_16x16x32_bf16 v[168:171], a[56:59], a[20:23], v[168:171]
    s_add_u32 m0, s76, 20480
    v_mfma_f32_16x16x32_bf16 v[172:175], a[60:63], a[20:23], v[172:175]
    ds_read_b128 a[20:23], v43 offset:53248
    buffer_load_dwordx4 v36, s[8:11], s78 offen offset:0 lds
    v_add_f32 v124, v124, v56
    v_add_f32 v125, v125, v57
    v_add_f32 v126, v126, v58
    v_add_f32 v127, v127, v59
    v_mfma_f32_16x16x32_bf16 v[172:175], a[44:47], a[16:19], v[172:175]
    ds_read_b128 a[16:19], v42 offset:53248
    v_mfma_f32_16x16x32_bf16 v[188:191], a[44:47], a[24:27], v[188:191]
    v_mfma_f32_16x16x32_bf16 v[188:191], a[60:63], a[28:31], v[188:191]
    buffer_load_dwordx4 v37, s[8:11], s78 offen offset:1024 lds
    v_mfma_f32_16x16x32_bf16 v[184:187], a[56:59], a[28:31], v[184:187]
    v_mfma_f32_16x16x32_bf16 v[184:187], a[40:43], a[24:27], v[184:187]
    buffer_load_dwordx4 v38, s[8:11], s78 offen offset:2048 lds
    v_mfma_f32_16x16x32_bf16 v[180:183], a[36:39], a[24:27], v[180:183]
    v_mfma_f32_16x16x32_bf16 v[180:183], a[52:55], a[28:31], v[180:183]
    v_mfma_f32_16x16x32_bf16 v[176:179], a[48:51], a[28:31], v[176:179]
    ds_read_b128 a[28:31], v43 offset:55296
    buffer_load_dwordx4 v39, s[8:11], s78 offen offset:3072 lds
    v_mfma_f32_16x16x32_bf16 v[176:179], a[32:35], a[24:27], v[176:179]
    ds_read_b128 a[24:27], v42 offset:55296
    s_waitcnt lgkmcnt(4)
    v_mfma_f32_16x16x32_bf16 v[192:195], a[32:35], a[0:3], v[192:195]
    v_mfma_f32_16x16x32_bf16 v[192:195], a[48:51], a[4:7], v[192:195]
    buffer_store_dwordx4 v[64:67], v9, s[20:23], s66 offen offset:0 sc1
    v_mfma_f32_16x16x32_bf16 v[196:199], a[52:55], a[4:7], v[196:199]
    v_mfma_f32_16x16x32_bf16 v[196:199], a[36:39], a[0:3], v[196:199]
    buffer_store_dwordx4 v[68:71], v9, s[20:23], s66 offen offset:1024 sc1
    v_mfma_f32_16x16x32_bf16 v[200:203], a[40:43], a[0:3], v[200:203]
    v_mfma_f32_16x16x32_bf16 v[200:203], a[56:59], a[4:7], v[200:203]
    v_mfma_f32_16x16x32_bf16 v[204:207], a[60:63], a[4:7], v[204:207]
    buffer_store_dwordx4 v[72:75], v9, s[20:23], s66 offen offset:2048 sc1
    v_mfma_f32_16x16x32_bf16 v[204:207], a[44:47], a[0:3], v[204:207]
    s_waitcnt vmcnt(27)
    s_waitcnt lgkmcnt(0)
    s_barrier
    ds_read_b128 a[4:7], v41 offset:0
    v_mfma_f32_16x16x32_bf16 v[220:223], a[44:47], a[8:11], v[220:223]
    ds_read_b128 a[0:3], v40 offset:0
    v_mfma_f32_16x16x32_bf16 v[220:223], a[60:63], a[12:15], v[220:223]
    buffer_store_dwordx4 v[76:79], v9, s[20:23], s66 offen offset:3072 sc1
    v_mfma_f32_16x16x32_bf16 v[216:219], a[56:59], a[12:15], v[216:219]
    s_add_u32 s66, s66, 4096
    v_mfma_f32_16x16x32_bf16 v[216:219], a[40:43], a[8:11], v[216:219]
    buffer_store_dwordx4 v[80:83], v9, s[20:23], s66 offen offset:0 sc1
    v_mfma_f32_16x16x32_bf16 v[212:215], a[36:39], a[8:11], v[212:215]
    v_mfma_f32_16x16x32_bf16 v[212:215], a[52:55], a[12:15], v[212:215]
    v_mfma_f32_16x16x32_bf16 v[208:211], a[48:51], a[12:15], v[208:211]
    ds_read_b128 a[12:15], v41 offset:2048
    buffer_store_dwordx4 v[84:87], v9, s[20:23], s66 offen offset:1024 sc1
    v_mfma_f32_16x16x32_bf16 v[208:211], a[32:35], a[8:11], v[208:211]
    ds_read_b128 a[8:11], v40 offset:2048
    v_mfma_f32_16x16x32_bf16 v[224:227], a[32:35], a[16:19], v[224:227]
    v_mfma_f32_16x16x32_bf16 v[224:227], a[48:51], a[20:23], v[224:227]
    buffer_store_dwordx4 v[88:91], v9, s[20:23], s66 offen offset:2048 sc1
    v_mfma_f32_16x16x32_bf16 v[228:231], a[52:55], a[20:23], v[228:231]
    v_mfma_f32_16x16x32_bf16 v[228:231], a[36:39], a[16:19], v[228:231]
    buffer_store_dwordx4 v[92:95], v9, s[20:23], s66 offen offset:3072 sc1
    v_mfma_f32_16x16x32_bf16 v[232:235], a[40:43], a[16:19], v[232:235]
    v_mfma_f32_16x16x32_bf16 v[232:235], a[56:59], a[20:23], v[232:235]
    s_add_u32 s78, s91, s18
    s_add_u32 m0, s76, 32768
    v_mfma_f32_16x16x32_bf16 v[236:239], a[60:63], a[20:23], v[236:239]
    ds_read_b128 a[20:23], v41 offset:4096
    buffer_load_dwordx4 v32, s[8:11], s78 offen offset:0 lds
    v_mfma_f32_16x16x32_bf16 v[236:239], a[44:47], a[16:19], v[236:239]
    ds_read_b128 a[16:19], v40 offset:4096
    v_mfma_f32_16x16x32_bf16 v[252:255], a[44:47], a[24:27], v[252:255]
    v_mfma_f32_16x16x32_bf16 v[252:255], a[60:63], a[28:31], v[252:255]
    buffer_load_dwordx4 v33, s[8:11], s78 offen offset:1024 lds
    v_mfma_f32_16x16x32_bf16 v[248:251], a[56:59], a[28:31], v[248:251]
    v_mfma_f32_16x16x32_bf16 v[248:251], a[40:43], a[24:27], v[248:251]
    buffer_load_dwordx4 v34, s[8:11], s78 offen offset:2048 lds
    v_mfma_f32_16x16x32_bf16 v[244:247], a[36:39], a[24:27], v[244:247]
    v_mfma_f32_16x16x32_bf16 v[244:247], a[52:55], a[28:31], v[244:247]
    v_mfma_f32_16x16x32_bf16 v[240:243], a[48:51], a[28:31], v[240:243]
    ds_read_b128 a[28:31], v41 offset:6144
    buffer_load_dwordx4 v35, s[8:11], s78 offen offset:3072 lds
    v_mfma_f32_16x16x32_bf16 v[240:243], a[32:35], a[24:27], v[240:243]
    ds_read_b128 a[24:27], v40 offset:6144
    s_waitcnt vmcnt(32) lgkmcnt(4)
    v_mfma_f32_16x16x32_bf16 v[128:131], a[64:67], a[0:3], v[128:131]
    s_add_u32 m0, s76, 36864
    v_mfma_f32_16x16x32_bf16 v[128:131], a[80:83], a[4:7], v[128:131]
    buffer_load_dwordx4 v36, s[8:11], s78 offen offset:0 lds
    v_mfma_f32_16x16x32_bf16 v[132:135], a[84:87], a[4:7], v[132:135]
    v_mfma_f32_16x16x32_bf16 v[132:135], a[68:71], a[0:3], v[132:135]
    v_mfma_f32_16x16x32_bf16 v[136:139], a[72:75], a[0:3], v[136:139]
    v_mfma_f32_16x16x32_bf16 v[136:139], a[88:91], a[4:7], v[136:139]
    v_mfma_f32_16x16x32_bf16 v[140:143], a[92:95], a[4:7], v[140:143]
    ds_read_b128 a[4:7], v43 offset:0
    v_mfma_f32_16x16x32_bf16 v[140:143], a[76:79], a[0:3], v[140:143]
    ds_read_b128 a[0:3], v42 offset:0
    v_mfma_f32_16x16x32_bf16 v[156:159], a[76:79], a[8:11], v[156:159]
    v_mfma_f32_16x16x32_bf16 v[156:159], a[92:95], a[12:15], v[156:159]
    buffer_load_dwordx4 v37, s[8:11], s78 offen offset:1024 lds
    v_mfma_f32_16x16x32_bf16 v[152:155], a[88:91], a[12:15], v[152:155]
    v_mfma_f32_16x16x32_bf16 v[152:155], a[72:75], a[8:11], v[152:155]
    v_mfma_f32_16x16x32_bf16 v[148:151], a[68:71], a[8:11], v[148:151]
    v_mfma_f32_16x16x32_bf16 v[148:151], a[84:87], a[12:15], v[148:151]
    v_mfma_f32_16x16x32_bf16 v[144:147], a[80:83], a[12:15], v[144:147]
    ds_read_b128 a[12:15], v43 offset:2048
    v_mfma_f32_16x16x32_bf16 v[144:147], a[64:67], a[8:11], v[144:147]
    ds_read_b128 a[8:11], v42 offset:2048
    s_waitcnt lgkmcnt(4)
    v_mfma_f32_16x16x32_bf16 v[160:163], a[64:67], a[16:19], v[160:163]
    v_mfma_f32_16x16x32_bf16 v[160:163], a[80:83], a[20:23], v[160:163]
    buffer_load_dwordx4 v38, s[8:11], s78 offen offset:2048 lds
    v_mfma_f32_16x16x32_bf16 v[164:167], a[84:87], a[20:23], v[164:167]
    v_mfma_f32_16x16x32_bf16 v[164:167], a[68:71], a[16:19], v[164:167]
    v_mfma_f32_16x16x32_bf16 v[168:171], a[72:75], a[16:19], v[168:171]
    v_mfma_f32_16x16x32_bf16 v[168:171], a[88:91], a[20:23], v[168:171]
    v_mfma_f32_16x16x32_bf16 v[172:175], a[92:95], a[20:23], v[172:175]
    ds_read_b128 a[20:23], v43 offset:4096
    v_mfma_f32_16x16x32_bf16 v[172:175], a[76:79], a[16:19], v[172:175]
    ds_read_b128 a[16:19], v42 offset:4096
    v_mfma_f32_16x16x32_bf16 v[188:191], a[76:79], a[24:27], v[188:191]
    v_mfma_f32_16x16x32_bf16 v[188:191], a[92:95], a[28:31], v[188:191]
    buffer_load_dwordx4 v39, s[8:11], s78 offen offset:3072 lds
    v_mfma_f32_16x16x32_bf16 v[184:187], a[88:91], a[28:31], v[184:187]
    v_mfma_f32_16x16x32_bf16 v[184:187], a[72:75], a[24:27], v[184:187]
    v_mfma_f32_16x16x32_bf16 v[180:183], a[68:71], a[24:27], v[180:183]
    v_mfma_f32_16x16x32_bf16 v[180:183], a[84:87], a[28:31], v[180:183]
    v_mfma_f32_16x16x32_bf16 v[176:179], a[80:83], a[28:31], v[176:179]
    ds_read_b128 a[28:31], v43 offset:6144
    v_mfma_f32_16x16x32_bf16 v[176:179], a[64:67], a[24:27], v[176:179]
    ds_read_b128 a[24:27], v42 offset:6144
    s_waitcnt lgkmcnt(4)
    v_mfma_f32_16x16x32_bf16 v[192:195], a[64:67], a[0:3], v[192:195]
    s_add_u32 s78, s91, s19
    s_add_u32 m0, s76, 49152
    v_mfma_f32_16x16x32_bf16 v[192:195], a[80:83], a[4:7], v[192:195]
    buffer_load_dwordx4 v32, s[8:11], s78 offen offset:0 lds
    v_mfma_f32_16x16x32_bf16 v[196:199], a[84:87], a[4:7], v[196:199]
    v_mfma_f32_16x16x32_bf16 v[196:199], a[68:71], a[0:3], v[196:199]
    v_mfma_f32_16x16x32_bf16 v[200:203], a[72:75], a[0:3], v[200:203]
    v_mfma_f32_16x16x32_bf16 v[200:203], a[88:91], a[4:7], v[200:203]
    v_mfma_f32_16x16x32_bf16 v[204:207], a[92:95], a[4:7], v[204:207]
    v_mfma_f32_16x16x32_bf16 v[204:207], a[76:79], a[0:3], v[204:207]
    s_waitcnt vmcnt(17)
    s_waitcnt lgkmcnt(0)
    s_barrier
    ds_read_b128 a[4:7], v41 offset:16384
    v_mfma_f32_16x16x32_bf16 v[220:223], a[76:79], a[8:11], v[220:223]
    ds_read_b128 a[0:3], v40 offset:16384
    v_mfma_f32_16x16x32_bf16 v[220:223], a[92:95], a[12:15], v[220:223]
    buffer_load_dwordx4 v33, s[8:11], s78 offen offset:1024 lds
    v_mfma_f32_16x16x32_bf16 v[216:219], a[88:91], a[12:15], v[216:219]
    v_mfma_f32_16x16x32_bf16 v[216:219], a[72:75], a[8:11], v[216:219]
    v_mfma_f32_16x16x32_bf16 v[212:215], a[68:71], a[8:11], v[212:215]
    v_mfma_f32_16x16x32_bf16 v[212:215], a[84:87], a[12:15], v[212:215]
    v_mfma_f32_16x16x32_bf16 v[208:211], a[80:83], a[12:15], v[208:211]
    ds_read_b128 a[12:15], v41 offset:18432
    v_mfma_f32_16x16x32_bf16 v[208:211], a[64:67], a[8:11], v[208:211]
    ds_read_b128 a[8:11], v40 offset:18432
    v_mfma_f32_16x16x32_bf16 v[224:227], a[64:67], a[16:19], v[224:227]
    v_mfma_f32_16x16x32_bf16 v[224:227], a[80:83], a[20:23], v[224:227]
    buffer_load_dwordx4 v34, s[8:11], s78 offen offset:2048 lds
    v_mfma_f32_16x16x32_bf16 v[228:231], a[84:87], a[20:23], v[228:231]
    v_mfma_f32_16x16x32_bf16 v[228:231], a[68:71], a[16:19], v[228:231]
    v_mfma_f32_16x16x32_bf16 v[232:235], a[72:75], a[16:19], v[232:235]
    v_mfma_f32_16x16x32_bf16 v[232:235], a[88:91], a[20:23], v[232:235]
    v_mfma_f32_16x16x32_bf16 v[236:239], a[92:95], a[20:23], v[236:239]
    ds_read_b128 a[20:23], v41 offset:20480
    v_mfma_f32_16x16x32_bf16 v[236:239], a[76:79], a[16:19], v[236:239]
    ds_read_b128 a[16:19], v40 offset:20480
    v_mfma_f32_16x16x32_bf16 v[252:255], a[76:79], a[24:27], v[252:255]
    v_mfma_f32_16x16x32_bf16 v[252:255], a[92:95], a[28:31], v[252:255]
    buffer_load_dwordx4 v35, s[8:11], s78 offen offset:3072 lds
    v_mfma_f32_16x16x32_bf16 v[248:251], a[88:91], a[28:31], v[248:251]
    v_mfma_f32_16x16x32_bf16 v[248:251], a[72:75], a[24:27], v[248:251]
    v_mfma_f32_16x16x32_bf16 v[244:247], a[68:71], a[24:27], v[244:247]
    v_mfma_f32_16x16x32_bf16 v[244:247], a[84:87], a[28:31], v[244:247]
    v_mfma_f32_16x16x32_bf16 v[240:243], a[80:83], a[28:31], v[240:243]
    ds_read_b128 a[28:31], v41 offset:22528
    v_mfma_f32_16x16x32_bf16 v[240:243], a[64:67], a[24:27], v[240:243]
    ds_read_b128 a[24:27], v40 offset:22528
    s_waitcnt lgkmcnt(4)
    v_mfma_f32_16x16x32_bf16 v[128:131], a[96:99], a[0:3], v[128:131]
    s_add_u32 s85, s85, 4096
    v_mfma_f32_16x16x32_bf16 v[128:131], a[112:115], a[4:7], v[128:131]
    buffer_load_dwordx4 a[144:147], v9, s[20:23], s85 offen offset:0 sc1
    v_mfma_f32_16x16x32_bf16 v[132:135], a[116:119], a[4:7], v[132:135]
    v_mfma_f32_16x16x32_bf16 v[132:135], a[100:103], a[0:3], v[132:135]
    v_mfma_f32_16x16x32_bf16 v[136:139], a[104:107], a[0:3], v[136:139]
    v_mfma_f32_16x16x32_bf16 v[136:139], a[120:123], a[4:7], v[136:139]
    buffer_load_dwordx4 a[148:151], v9, s[20:23], s85 offen offset:1024 sc1
    v_mfma_f32_16x16x32_bf16 v[140:143], a[124:127], a[4:7], v[140:143]
    ds_read_b128 a[4:7], v43 offset:16384
    v_mfma_f32_16x16x32_bf16 v[140:143], a[108:111], a[0:3], v[140:143]
    ds_read_b128 a[0:3], v42 offset:16384
    v_mfma_f32_16x16x32_bf16 v[156:159], a[108:111], a[8:11], v[156:159]
    v_mfma_f32_16x16x32_bf16 v[156:159], a[124:127], a[12:15], v[156:159]
    buffer_load_dwordx4 a[152:155], v9, s[20:23], s85 offen offset:2048 sc1
    v_mfma_f32_16x16x32_bf16 v[152:155], a[120:123], a[12:15], v[152:155]
    v_mfma_f32_16x16x32_bf16 v[152:155], a[104:107], a[8:11], v[152:155]
    v_mfma_f32_16x16x32_bf16 v[148:151], a[100:103], a[8:11], v[148:151]
    v_mfma_f32_16x16x32_bf16 v[148:151], a[116:119], a[12:15], v[148:151]
    buffer_load_dwordx4 a[156:159], v9, s[20:23], s85 offen offset:3072 sc1
    v_mfma_f32_16x16x32_bf16 v[144:147], a[112:115], a[12:15], v[144:147]
    ds_read_b128 a[12:15], v43 offset:18432
    v_mfma_f32_16x16x32_bf16 v[144:147], a[96:99], a[8:11], v[144:147]
    ds_read_b128 a[8:11], v42 offset:18432
    s_waitcnt lgkmcnt(4)
    v_mfma_f32_16x16x32_bf16 v[160:163], a[96:99], a[16:19], v[160:163]
    s_add_u32 m0, s76, 53248
    v_mfma_f32_16x16x32_bf16 v[160:163], a[112:115], a[20:23], v[160:163]
    buffer_load_dwordx4 v36, s[8:11], s78 offen offset:0 lds
    v_mfma_f32_16x16x32_bf16 v[164:167], a[116:119], a[20:23], v[164:167]
    v_mfma_f32_16x16x32_bf16 v[164:167], a[100:103], a[16:19], v[164:167]
    v_mfma_f32_16x16x32_bf16 v[168:171], a[104:107], a[16:19], v[168:171]
    v_mfma_f32_16x16x32_bf16 v[168:171], a[120:123], a[20:23], v[168:171]
    buffer_load_dwordx4 v37, s[8:11], s78 offen offset:1024 lds
    v_mfma_f32_16x16x32_bf16 v[172:175], a[124:127], a[20:23], v[172:175]
    ds_read_b128 a[20:23], v43 offset:20480
    v_mfma_f32_16x16x32_bf16 v[172:175], a[108:111], a[16:19], v[172:175]
    ds_read_b128 a[16:19], v42 offset:20480
    v_mfma_f32_16x16x32_bf16 v[188:191], a[108:111], a[24:27], v[188:191]
    v_mfma_f32_16x16x32_bf16 v[188:191], a[124:127], a[28:31], v[188:191]
    buffer_load_dwordx4 v38, s[8:11], s78 offen offset:2048 lds
    v_mfma_f32_16x16x32_bf16 v[184:187], a[120:123], a[28:31], v[184:187]
    v_mfma_f32_16x16x32_bf16 v[184:187], a[104:107], a[24:27], v[184:187]
    v_mfma_f32_16x16x32_bf16 v[180:183], a[100:103], a[24:27], v[180:183]
    v_mfma_f32_16x16x32_bf16 v[180:183], a[116:119], a[28:31], v[180:183]
    buffer_load_dwordx4 v39, s[8:11], s78 offen offset:3072 lds
    v_mfma_f32_16x16x32_bf16 v[176:179], a[112:115], a[28:31], v[176:179]
    ds_read_b128 a[28:31], v43 offset:22528
    s_add_u32 s91, s91, 512
    v_mfma_f32_16x16x32_bf16 v[176:179], a[96:99], a[24:27], v[176:179]
    ds_read_b128 a[24:27], v42 offset:22528
    s_waitcnt lgkmcnt(4)
    v_mfma_f32_16x16x32_bf16 v[192:195], a[96:99], a[0:3], v[192:195]
    s_add_u32 s85, s84, s83
    s_xor_b32 s83, s27, 24576
    v_mfma_f32_16x16x32_bf16 v[192:195], a[112:115], a[4:7], v[192:195]
    buffer_load_dwordx4 a[32:35], v9, s[20:23], s85 offen offset:0 sc1
    v_mfma_f32_16x16x32_bf16 v[196:199], a[116:119], a[4:7], v[196:199]
    v_mfma_f32_16x16x32_bf16 v[196:199], a[100:103], a[0:3], v[196:199]
    v_mfma_f32_16x16x32_bf16 v[200:203], a[104:107], a[0:3], v[200:203]
    v_mfma_f32_16x16x32_bf16 v[200:203], a[120:123], a[4:7], v[200:203]
    buffer_load_dwordx4 a[36:39], v9, s[20:23], s85 offen offset:1024 sc1
    v_mfma_f32_16x16x32_bf16 v[204:207], a[124:127], a[4:7], v[204:207]
    v_mfma_f32_16x16x32_bf16 v[204:207], a[108:111], a[0:3], v[204:207]
    s_waitcnt vmcnt(14)
    s_waitcnt lgkmcnt(0)
    s_barrier
    ds_read_b128 a[4:7], v41 offset:32768
    v_mfma_f32_16x16x32_bf16 v[220:223], a[108:111], a[8:11], v[220:223]
    ds_read_b128 a[0:3], v40 offset:32768
    v_mfma_f32_16x16x32_bf16 v[220:223], a[124:127], a[12:15], v[220:223]
    buffer_load_dwordx4 a[40:43], v9, s[20:23], s85 offen offset:2048 sc1
    v_mfma_f32_16x16x32_bf16 v[216:219], a[120:123], a[12:15], v[216:219]
    v_mfma_f32_16x16x32_bf16 v[216:219], a[104:107], a[8:11], v[216:219]
    v_mfma_f32_16x16x32_bf16 v[212:215], a[100:103], a[8:11], v[212:215]
    v_mfma_f32_16x16x32_bf16 v[212:215], a[116:119], a[12:15], v[212:215]
    buffer_load_dwordx4 a[44:47], v9, s[20:23], s85 offen offset:3072 sc1
    v_mfma_f32_16x16x32_bf16 v[208:211], a[112:115], a[12:15], v[208:211]
    ds_read_b128 a[12:15], v41 offset:34816
    v_mfma_f32_16x16x32_bf16 v[208:211], a[96:99], a[8:11], v[208:211]
    ds_read_b128 a[8:11], v40 offset:34816
    v_mfma_f32_16x16x32_bf16 v[224:227], a[96:99], a[16:19], v[224:227]
    s_add_u32 s78, s91, s16
    s_add_u32 m0, s76, 0
    v_mfma_f32_16x16x32_bf16 v[224:227], a[112:115], a[20:23], v[224:227]
    buffer_load_dwordx4 v32, s[8:11], s78 offen offset:0 lds
    v_mfma_f32_16x16x32_bf16 v[228:231], a[116:119], a[20:23], v[228:231]
    v_mfma_f32_16x16x32_bf16 v[228:231], a[100:103], a[16:19], v[228:231]
    v_mfma_f32_16x16x32_bf16 v[232:235], a[104:107], a[16:19], v[232:235]
    v_mfma_f32_16x16x32_bf16 v[232:235], a[120:123], a[20:23], v[232:235]
    buffer_load_dwordx4 v33, s[8:11], s78 offen offset:1024 lds
    v_mfma_f32_16x16x32_bf16 v[236:239], a[124:127], a[20:23], v[236:239]
    ds_read_b128 a[20:23], v41 offset:36864
    v_mfma_f32_16x16x32_bf16 v[236:239], a[108:111], a[16:19], v[236:239]
    ds_read_b128 a[16:19], v40 offset:36864
    v_mfma_f32_16x16x32_bf16 v[252:255], a[108:111], a[24:27], v[252:255]
    v_mfma_f32_16x16x32_bf16 v[252:255], a[124:127], a[28:31], v[252:255]
    buffer_load_dwordx4 v34, s[8:11], s78 offen offset:2048 lds
    v_mfma_f32_16x16x32_bf16 v[248:251], a[120:123], a[28:31], v[248:251]
    v_mfma_f32_16x16x32_bf16 v[248:251], a[104:107], a[24:27], v[248:251]
    v_mfma_f32_16x16x32_bf16 v[244:247], a[100:103], a[24:27], v[244:247]
    v_mfma_f32_16x16x32_bf16 v[244:247], a[116:119], a[28:31], v[244:247]
    buffer_load_dwordx4 v35, s[8:11], s78 offen offset:3072 lds
    v_mfma_f32_16x16x32_bf16 v[240:243], a[112:115], a[28:31], v[240:243]
    ds_read_b128 a[28:31], v41 offset:38912
    v_mfma_f32_16x16x32_bf16 v[240:243], a[96:99], a[24:27], v[240:243]
    ds_read_b128 a[24:27], v40 offset:38912
    s_waitcnt vmcnt(12) lgkmcnt(4)
    v_mfma_f32_16x16x32_bf16 v[128:131], a[128:131], a[0:3], v[128:131]
    s_add_u32 s85, s85, 4096
    v_mfma_f32_16x16x32_bf16 v[128:131], a[144:147], a[4:7], v[128:131]
    buffer_load_dwordx4 a[48:51], v9, s[20:23], s85 offen offset:0 sc1
    v_mfma_f32_16x16x32_bf16 v[132:135], a[148:151], a[4:7], v[132:135]
    v_mfma_f32_16x16x32_bf16 v[132:135], a[132:135], a[0:3], v[132:135]
    v_mfma_f32_16x16x32_bf16 v[136:139], a[136:139], a[0:3], v[136:139]
    v_mfma_f32_16x16x32_bf16 v[136:139], a[152:155], a[4:7], v[136:139]
    buffer_load_dwordx4 a[52:55], v9, s[20:23], s85 offen offset:1024 sc1
    v_mfma_f32_16x16x32_bf16 v[140:143], a[156:159], a[4:7], v[140:143]
    ds_read_b128 a[4:7], v43 offset:32768
    v_mfma_f32_16x16x32_bf16 v[140:143], a[140:143], a[0:3], v[140:143]
    ds_read_b128 a[0:3], v42 offset:32768
    v_mfma_f32_16x16x32_bf16 v[156:159], a[140:143], a[8:11], v[156:159]
    v_mfma_f32_16x16x32_bf16 v[156:159], a[156:159], a[12:15], v[156:159]
    buffer_load_dwordx4 a[56:59], v9, s[20:23], s85 offen offset:2048 sc1
    v_mfma_f32_16x16x32_bf16 v[152:155], a[152:155], a[12:15], v[152:155]
    v_mfma_f32_16x16x32_bf16 v[152:155], a[136:139], a[8:11], v[152:155]
    v_mfma_f32_16x16x32_bf16 v[148:151], a[132:135], a[8:11], v[148:151]
    v_mfma_f32_16x16x32_bf16 v[148:151], a[148:151], a[12:15], v[148:151]
    buffer_load_dwordx4 a[60:63], v9, s[20:23], s85 offen offset:3072 sc1
    v_mfma_f32_16x16x32_bf16 v[144:147], a[144:147], a[12:15], v[144:147]
    ds_read_b128 a[12:15], v43 offset:34816
    v_mfma_f32_16x16x32_bf16 v[144:147], a[128:131], a[8:11], v[144:147]
    ds_read_b128 a[8:11], v42 offset:34816
    s_waitcnt lgkmcnt(4)
    v_mfma_f32_16x16x32_bf16 v[160:163], a[128:131], a[16:19], v[160:163]
    s_add_u32 s84, s84, 32768
    s_add_u32 m0, s76, 4096
    v_mfma_f32_16x16x32_bf16 v[160:163], a[144:147], a[20:23], v[160:163]
    buffer_load_dwordx4 v36, s[8:11], s78 offen offset:0 lds
    v_mfma_f32_16x16x32_bf16 v[164:167], a[148:151], a[20:23], v[164:167]
    v_mfma_f32_16x16x32_bf16 v[164:167], a[132:135], a[16:19], v[164:167]
    v_mfma_f32_16x16x32_bf16 v[168:171], a[136:139], a[16:19], v[168:171]
    v_mfma_f32_16x16x32_bf16 v[168:171], a[152:155], a[20:23], v[168:171]
    buffer_load_dwordx4 v37, s[8:11], s78 offen offset:1024 lds
    v_mfma_f32_16x16x32_bf16 v[172:175], a[156:159], a[20:23], v[172:175]
    ds_read_b128 a[20:23], v43 offset:36864
    v_mfma_f32_16x16x32_bf16 v[172:175], a[140:143], a[16:19], v[172:175]
    ds_read_b128 a[16:19], v42 offset:36864
    v_mfma_f32_16x16x32_bf16 v[188:191], a[140:143], a[24:27], v[188:191]
    v_mfma_f32_16x16x32_bf16 v[188:191], a[156:159], a[28:31], v[188:191]
    buffer_load_dwordx4 v38, s[8:11], s78 offen offset:2048 lds
    v_mfma_f32_16x16x32_bf16 v[184:187], a[152:155], a[28:31], v[184:187]
    v_mfma_f32_16x16x32_bf16 v[184:187], a[136:139], a[24:27], v[184:187]
    v_mfma_f32_16x16x32_bf16 v[180:183], a[132:135], a[24:27], v[180:183]
    v_mfma_f32_16x16x32_bf16 v[180:183], a[148:151], a[28:31], v[180:183]
    buffer_load_dwordx4 v39, s[8:11], s78 offen offset:3072 lds
    v_mfma_f32_16x16x32_bf16 v[176:179], a[144:147], a[28:31], v[176:179]
    ds_read_b128 a[28:31], v43 offset:38912
    v_mfma_f32_16x16x32_bf16 v[176:179], a[128:131], a[24:27], v[176:179]
    ds_read_b128 a[24:27], v42 offset:38912
    s_waitcnt lgkmcnt(4)
    v_mfma_f32_16x16x32_bf16 v[192:195], a[128:131], a[0:3], v[192:195]
    s_add_u32 s85, s84, s80
    s_xor_b32 s80, s27, 0
    v_mfma_f32_16x16x32_bf16 v[192:195], a[144:147], a[4:7], v[192:195]
    buffer_load_dwordx4 a[64:67], v9, s[20:23], s85 offen offset:0 sc1
    v_mfma_f32_16x16x32_bf16 v[196:199], a[148:151], a[4:7], v[196:199]
    v_mfma_f32_16x16x32_bf16 v[196:199], a[132:135], a[0:3], v[196:199]
    v_mfma_f32_16x16x32_bf16 v[200:203], a[136:139], a[0:3], v[200:203]
    v_mfma_f32_16x16x32_bf16 v[200:203], a[152:155], a[4:7], v[200:203]
    buffer_load_dwordx4 a[68:71], v9, s[20:23], s85 offen offset:1024 sc1
    v_mfma_f32_16x16x32_bf16 v[204:207], a[156:159], a[4:7], v[204:207]
    v_mfma_f32_16x16x32_bf16 v[204:207], a[140:143], a[0:3], v[204:207]
    s_waitcnt vmcnt(18)
    s_waitcnt lgkmcnt(0)
    s_barrier
    s_cmp_eq_u32 s26, 0
    s_cbranch_scc1 L_k3_sig
L_k3_sigret:
    ds_read_b128 a[4:7], v41 offset:49152
    v_mfma_f32_16x16x32_bf16 v[220:223], a[140:143], a[8:11], v[220:223]
    ds_read_b128 a[0:3], v40 offset:49152
    v_mfma_f32_16x16x32_bf16 v[220:223], a[156:159], a[12:15], v[220:223]
    buffer_load_dwordx4 a[72:75], v9, s[20:23], s85 offen offset:2048 sc1
    v_mfma_f32_16x16x32_bf16 v[216:219], a[152:155], a[12:15], v[216:219]
    v_mfma_f32_16x16x32_bf16 v[216:219], a[136:139], a[8:11], v[216:219]
    v_mfma_f32_16x16x32_bf16 v[212:215], a[132:135], a[8:11], v[212:215]
    v_mfma_f32_16x16x32_bf16 v[212:215], a[148:151], a[12:15], v[212:215]
    buffer_load_dwordx4 a[76:79], v9, s[20:23], s85 offen offset:3072 sc1
    v_mfma_f32_16x16x32_bf16 v[208:211], a[144:147], a[12:15], v[208:211]
    ds_read_b128 a[12:15], v41 offset:51200
    v_mfma_f32_16x16x32_bf16 v[208:211], a[128:131], a[8:11], v[208:211]
    ds_read_b128 a[8:11], v40 offset:51200
    v_mfma_f32_16x16x32_bf16 v[224:227], a[128:131], a[16:19], v[224:227]
    s_add_u32 s78, s91, s17
    s_add_u32 m0, s76, 16384
    v_mfma_f32_16x16x32_bf16 v[224:227], a[144:147], a[20:23], v[224:227]
    buffer_load_dwordx4 v32, s[8:11], s78 offen offset:0 lds
    v_mfma_f32_16x16x32_bf16 v[228:231], a[148:151], a[20:23], v[228:231]
    v_mfma_f32_16x16x32_bf16 v[228:231], a[132:135], a[16:19], v[228:231]
    v_mfma_f32_16x16x32_bf16 v[232:235], a[136:139], a[16:19], v[232:235]
    v_mfma_f32_16x16x32_bf16 v[232:235], a[152:155], a[20:23], v[232:235]
    buffer_load_dwordx4 v33, s[8:11], s78 offen offset:1024 lds
    v_mfma_f32_16x16x32_bf16 v[236:239], a[156:159], a[20:23], v[236:239]
    ds_read_b128 a[20:23], v41 offset:53248
    v_mfma_f32_16x16x32_bf16 v[236:239], a[140:143], a[16:19], v[236:239]
    ds_read_b128 a[16:19], v40 offset:53248
    v_mfma_f32_16x16x32_bf16 v[252:255], a[140:143], a[24:27], v[252:255]
    v_mfma_f32_16x16x32_bf16 v[252:255], a[156:159], a[28:31], v[252:255]
    buffer_load_dwordx4 v34, s[8:11], s78 offen offset:2048 lds
    v_mfma_f32_16x16x32_bf16 v[248:251], a[152:155], a[28:31], v[248:251]
    v_mfma_f32_16x16x32_bf16 v[248:251], a[136:139], a[24:27], v[248:251]
    v_mfma_f32_16x16x32_bf16 v[244:247], a[132:135], a[24:27], v[244:247]
    v_mfma_f32_16x16x32_bf16 v[244:247], a[148:151], a[28:31], v[244:247]
    buffer_load_dwordx4 v35, s[8:11], s78 offen offset:3072 lds
    v_mfma_f32_16x16x32_bf16 v[240:243], a[144:147], a[28:31], v[240:243]
    ds_read_b128 a[28:31], v41 offset:55296
    v_mfma_f32_16x16x32_bf16 v[240:243], a[128:131], a[24:27], v[240:243]
    ds_read_b128 a[24:27], v40 offset:55296
    s_waitcnt vmcnt(12) lgkmcnt(4)
    v_mfma_f32_16x16x32_bf16 v[128:131], a[32:35], a[0:3], v[128:131]
    s_add_u32 s85, s85, 4096
    v_mfma_f32_16x16x32_bf16 v[128:131], a[48:51], a[4:7], v[128:131]
    buffer_load_dwordx4 a[80:83], v9, s[20:23], s85 offen offset:0 sc1
    v_mfma_f32_16x16x32_bf16 v[132:135], a[52:55], a[4:7], v[132:135]
    v_mfma_f32_16x16x32_bf16 v[132:135], a[36:39], a[0:3], v[132:135]
    v_mfma_f32_16x16x32_bf16 v[136:139], a[40:43], a[0:3], v[136:139]
    v_mfma_f32_16x16x32_bf16 v[136:139], a[56:59], a[4:7], v[136:139]
    buffer_load_dwordx4 a[84:87], v9, s[20:23], s85 offen offset:1024 sc1
    v_mfma_f32_16x16x32_bf16 v[140:143], a[60:63], a[4:7], v[140:143]
    ds_read_b128 a[4:7], v43 offset:49152
    v_mfma_f32_16x16x32_bf16 v[140:143], a[44:47], a[0:3], v[140:143]
    ds_read_b128 a[0:3], v42 offset:49152
    v_mfma_f32_16x16x32_bf16 v[156:159], a[44:47], a[8:11], v[156:159]
    v_mfma_f32_16x16x32_bf16 v[156:159], a[60:63], a[12:15], v[156:159]
    buffer_load_dwordx4 a[88:91], v9, s[20:23], s85 offen offset:2048 sc1
    v_mfma_f32_16x16x32_bf16 v[152:155], a[56:59], a[12:15], v[152:155]
    v_mfma_f32_16x16x32_bf16 v[152:155], a[40:43], a[8:11], v[152:155]
    v_mfma_f32_16x16x32_bf16 v[148:151], a[36:39], a[8:11], v[148:151]
    v_mfma_f32_16x16x32_bf16 v[148:151], a[52:55], a[12:15], v[148:151]
    buffer_load_dwordx4 a[92:95], v9, s[20:23], s85 offen offset:3072 sc1
    v_mfma_f32_16x16x32_bf16 v[144:147], a[48:51], a[12:15], v[144:147]
    ds_read_b128 a[12:15], v43 offset:51200
    v_mfma_f32_16x16x32_bf16 v[144:147], a[32:35], a[8:11], v[144:147]
    ds_read_b128 a[8:11], v42 offset:51200
    s_waitcnt lgkmcnt(4)
    v_mfma_f32_16x16x32_bf16 v[160:163], a[32:35], a[16:19], v[160:163]
    s_add_u32 m0, s76, 20480
    v_mfma_f32_16x16x32_bf16 v[160:163], a[48:51], a[20:23], v[160:163]
    buffer_load_dwordx4 v36, s[8:11], s78 offen offset:0 lds
    v_mfma_f32_16x16x32_bf16 v[164:167], a[52:55], a[20:23], v[164:167]
    v_mfma_f32_16x16x32_bf16 v[164:167], a[36:39], a[16:19], v[164:167]
    v_mfma_f32_16x16x32_bf16 v[168:171], a[40:43], a[16:19], v[168:171]
    v_mfma_f32_16x16x32_bf16 v[168:171], a[56:59], a[20:23], v[168:171]
    buffer_load_dwordx4 v37, s[8:11], s78 offen offset:1024 lds
    v_mfma_f32_16x16x32_bf16 v[172:175], a[60:63], a[20:23], v[172:175]
    ds_read_b128 a[20:23], v43 offset:53248
    v_mfma_f32_16x16x32_bf16 v[172:175], a[44:47], a[16:19], v[172:175]
    ds_read_b128 a[16:19], v42 offset:53248
    v_mfma_f32_16x16x32_bf16 v[188:191], a[44:47], a[24:27], v[188:191]
    v_mfma_f32_16x16x32_bf16 v[188:191], a[60:63], a[28:31], v[188:191]
    buffer_load_dwordx4 v38, s[8:11], s78 offen offset:2048 lds
    v_mfma_f32_16x16x32_bf16 v[184:187], a[56:59], a[28:31], v[184:187]
    v_mfma_f32_16x16x32_bf16 v[184:187], a[40:43], a[24:27], v[184:187]
    v_mfma_f32_16x16x32_bf16 v[180:183], a[36:39], a[24:27], v[180:183]
    v_mfma_f32_16x16x32_bf16 v[180:183], a[52:55], a[28:31], v[180:183]
    buffer_load_dwordx4 v39, s[8:11], s78 offen offset:3072 lds
    v_mfma_f32_16x16x32_bf16 v[176:179], a[48:51], a[28:31], v[176:179]
    ds_read_b128 a[28:31], v43 offset:55296
    v_mfma_f32_16x16x32_bf16 v[176:179], a[32:35], a[24:27], v[176:179]
    ds_read_b128 a[24:27], v42 offset:55296
    s_waitcnt lgkmcnt(4)
    v_mfma_f32_16x16x32_bf16 v[192:195], a[32:35], a[0:3], v[192:195]
    s_add_u32 s85, s84, s81
    s_xor_b32 s81, s27, 8192
    v_mfma_f32_16x16x32_bf16 v[192:195], a[48:51], a[4:7], v[192:195]
    buffer_load_dwordx4 a[96:99], v9, s[20:23], s85 offen offset:0 sc1
    v_mfma_f32_16x16x32_bf16 v[196:199], a[52:55], a[4:7], v[196:199]
    v_mfma_f32_16x16x32_bf16 v[196:199], a[36:39], a[0:3], v[196:199]
    v_mfma_f32_16x16x32_bf16 v[200:203], a[40:43], a[0:3], v[200:203]
    v_mfma_f32_16x16x32_bf16 v[200:203], a[56:59], a[4:7], v[200:203]
    buffer_load_dwordx4 a[100:103], v9, s[20:23], s85 offen offset:1024 sc1
    v_mfma_f32_16x16x32_bf16 v[204:207], a[60:63], a[4:7], v[204:207]
    v_mfma_f32_16x16x32_bf16 v[204:207], a[44:47], a[0:3], v[204:207]
    s_waitcnt vmcnt(18)
    s_waitcnt lgkmcnt(0)
    s_barrier
    ds_read_b128 a[4:7], v41 offset:0
    v_mfma_f32_16x16x32_bf16 v[220:223], a[44:47], a[8:11], v[220:223]
    ds_read_b128 a[0:3], v40 offset:0
    v_mfma_f32_16x16x32_bf16 v[220:223], a[60:63], a[12:15], v[220:223]
    buffer_load_dwordx4 a[104:107], v9, s[20:23], s85 offen offset:2048 sc1
    v_mfma_f32_16x16x32_bf16 v[216:219], a[56:59], a[12:15], v[216:219]
    v_mfma_f32_16x16x32_bf16 v[216:219], a[40:43], a[8:11], v[216:219]
    v_mfma_f32_16x16x32_bf16 v[212:215], a[36:39], a[8:11], v[212:215]
    v_mfma_f32_16x16x32_bf16 v[212:215], a[52:55], a[12:15], v[212:215]
    buffer_load_dwordx4 a[108:111], v9, s[20:23], s85 offen offset:3072 sc1
    v_mfma_f32_16x16x32_bf16 v[208:211], a[48:51], a[12:15], v[208:211]
    ds_read_b128 a[12:15], v41 offset:2048
    v_mfma_f32_16x16x32_bf16 v[208:211], a[32:35], a[8:11], v[208:211]
    ds_read_b128 a[8:11], v40 offset:2048
    v_mfma_f32_16x16x32_bf16 v[224:227], a[32:35], a[16:19], v[224:227]
    s_add_u32 s78, s91, s18
    s_add_u32 m0, s76, 32768
    v_mfma_f32_16x16x32_bf16 v[224:227], a[48:51], a[20:23], v[224:227]
    buffer_load_dwordx4 v32, s[8:11], s78 offen offset:0 lds
    v_mfma_f32_16x16x32_bf16 v[228:231], a[52:55], a[20:23], v[228:231]
    v_mfma_f32_16x16x32_bf16 v[228:231], a[36:39], a[16:19], v[228:231]
    v_mfma_f32_16x16x32_bf16 v[232:235], a[40:43], a[16:19], v[232:235]
    v_mfma_f32_16x16x32_bf16 v[232:235], a[56:59], a[20:23], v[232:235]
    buffer_load_dwordx4 v33, s[8:11], s78 offen offset:1024 lds
    v_mfma_f32_16x16x32_bf16 v[236:239], a[60:63], a[20:23], v[236:239]
    ds_read_b128 a[20:23], v41 offset:4096
    v_mfma_f32_16x16x32_bf16 v[236:239], a[44:47], a[16:19], v[236:239]
    ds_read_b128 a[16:19], v40 offset:4096
    v_mfma_f32_16x16x32_bf16 v[252:255], a[44:47], a[24:27], v[252:255]
    v_mfma_f32_16x16x32_bf16 v[252:255], a[60:63], a[28:31], v[252:255]
    buffer_load_dwordx4 v34, s[8:11], s78 offen offset:2048 lds
    v_mfma_f32_16x16x32_bf16 v[248:251], a[56:59], a[28:31], v[248:251]
    v_mfma_f32_16x16x32_bf16 v[248:251], a[40:43], a[24:27], v[248:251]
    v_mfma_f32_16x16x32_bf16 v[244:247], a[36:39], a[24:27], v[244:247]
    v_mfma_f32_16x16x32_bf16 v[244:247], a[52:55], a[28:31], v[244:247]
    buffer_load_dwordx4 v35, s[8:11], s78 offen offset:3072 lds
    v_mfma_f32_16x16x32_bf16 v[240:243], a[48:51], a[28:31], v[240:243]
    ds_read_b128 a[28:31], v41 offset:6144
    v_mfma_f32_16x16x32_bf16 v[240:243], a[32:35], a[24:27], v[240:243]
    ds_read_b128 a[24:27], v40 offset:6144
    s_getpc_b64 s[58:59]
L_pc3ssm:
    s_add_u32 s58, s58, L_k3_lastssm-L_pc3ssm
    s_addc_u32 s59, s59, 0
    v_lshlrev_b32_e64 v19, 6, v0
    v_min_u32 v19, 0+L_k3_stopssm-L_k3_lastssm-4, v19
    global_load_dword a238, v19, s[58:59]
    s_waitcnt vmcnt(12) lgkmcnt(4)
    v_mfma_f32_16x16x32_bf16 v[128:131], a[64:67], a[0:3], v[128:131]
    s_add_u32 s85, s85, 4096
    v_mfma_f32_16x16x32_bf16 v[128:131], a[80:83], a[4:7], v[128:131]
    buffer_load_dwordx4 a[112:115], v9, s[20:23], s85 offen offset:0 sc1
    v_mfma_f32_16x16x32_bf16 v[132:135], a[84:87], a[4:7], v[132:135]
    v_mfma_f32_16x16x32_bf16 v[132:135], a[68:71], a[0:3], v[132:135]
    v_mfma_f32_16x16x32_bf16 v[136:139], a[72:75], a[0:3], v[136:139]
    v_mfma_f32_16x16x32_bf16 v[136:139], a[88:91], a[4:7], v[136:139]
    buffer_load_dwordx4 a[116:119], v9, s[20:23], s85 offen offset:1024 sc1
    v_mfma_f32_16x16x32_bf16 v[140:143], a[92:95], a[4:7], v[140:143]
    ds_read_b128 a[4:7], v43 offset:0
    v_mfma_f32_16x16x32_bf16 v[140:143], a[76:79], a[0:3], v[140:143]
    ds_read_b128 a[0:3], v42 offset:0
    v_mfma_f32_16x16x32_bf16 v[156:159], a[76:79], a[8:11], v[156:159]
    v_mfma_f32_16x16x32_bf16 v[156:159], a[92:95], a[12:15], v[156:159]
    buffer_load_dwordx4 a[120:123], v9, s[20:23], s85 offen offset:2048 sc1
    v_mfma_f32_16x16x32_bf16 v[152:155], a[88:91], a[12:15], v[152:155]
    v_mfma_f32_16x16x32_bf16 v[152:155], a[72:75], a[8:11], v[152:155]
    v_mfma_f32_16x16x32_bf16 v[148:151], a[68:71], a[8:11], v[148:151]
    v_mfma_f32_16x16x32_bf16 v[148:151], a[84:87], a[12:15], v[148:151]
    buffer_load_dwordx4 a[124:127], v9, s[20:23], s85 offen offset:3072 sc1
    v_mfma_f32_16x16x32_bf16 v[144:147], a[80:83], a[12:15], v[144:147]
    ds_read_b128 a[12:15], v43 offset:2048
    v_mfma_f32_16x16x32_bf16 v[144:147], a[64:67], a[8:11], v[144:147]
    ds_read_b128 a[8:11], v42 offset:2048
    s_waitcnt lgkmcnt(4)
    v_mfma_f32_16x16x32_bf16 v[160:163], a[64:67], a[16:19], v[160:163]
    s_add_u32 m0, s76, 36864
    v_mfma_f32_16x16x32_bf16 v[160:163], a[80:83], a[20:23], v[160:163]
    buffer_load_dwordx4 v36, s[8:11], s78 offen offset:0 lds
    v_mfma_f32_16x16x32_bf16 v[164:167], a[84:87], a[20:23], v[164:167]
    v_mfma_f32_16x16x32_bf16 v[164:167], a[68:71], a[16:19], v[164:167]
    v_mfma_f32_16x16x32_bf16 v[168:171], a[72:75], a[16:19], v[168:171]
    v_mfma_f32_16x16x32_bf16 v[168:171], a[88:91], a[20:23], v[168:171]
    buffer_load_dwordx4 v37, s[8:11], s78 offen offset:1024 lds
    v_mfma_f32_16x16x32_bf16 v[172:175], a[92:95], a[20:23], v[172:175]
    ds_read_b128 a[20:23], v43 offset:4096
    v_mfma_f32_16x16x32_bf16 v[172:175], a[76:79], a[16:19], v[172:175]
    ds_read_b128 a[16:19], v42 offset:4096
    v_mfma_f32_16x16x32_bf16 v[188:191], a[76:79], a[24:27], v[188:191]
    v_mfma_f32_16x16x32_bf16 v[188:191], a[92:95], a[28:31], v[188:191]
    buffer_load_dwordx4 v38, s[8:11], s78 offen offset:2048 lds
    v_mfma_f32_16x16x32_bf16 v[184:187], a[88:91], a[28:31], v[184:187]
    v_mfma_f32_16x16x32_bf16 v[184:187], a[72:75], a[24:27], v[184:187]
    v_mfma_f32_16x16x32_bf16 v[180:183], a[68:71], a[24:27], v[180:183]
    v_mfma_f32_16x16x32_bf16 v[180:183], a[84:87], a[28:31], v[180:183]
    buffer_load_dwordx4 v39, s[8:11], s78 offen offset:3072 lds
    v_mfma_f32_16x16x32_bf16 v[176:179], a[80:83], a[28:31], v[176:179]
    ds_read_b128 a[28:31], v43 offset:6144
    v_mfma_f32_16x16x32_bf16 v[176:179], a[64:67], a[24:27], v[176:179]
    ds_read_b128 a[24:27], v42 offset:6144
    s_waitcnt lgkmcnt(4)
    v_mfma_f32_16x16x32_bf16 v[192:195], a[64:67], a[0:3], v[192:195]
    s_add_u32 s85, s84, s82
    s_xor_b32 s82, s27, 16384
    v_mfma_f32_16x16x32_bf16 v[192:195], a[80:83], a[4:7], v[192:195]
    buffer_load_dwordx4 a[128:131], v9, s[20:23], s85 offen offset:0 sc1
    v_mfma_f32_16x16x32_bf16 v[196:199], a[84:87], a[4:7], v[196:199]
    v_mfma_f32_16x16x32_bf16 v[196:199], a[68:71], a[0:3], v[196:199]
    v_mfma_f32_16x16x32_bf16 v[200:203], a[72:75], a[0:3], v[200:203]
    v_mfma_f32_16x16x32_bf16 v[200:203], a[88:91], a[4:7], v[200:203]
    buffer_load_dwordx4 a[132:135], v9, s[20:23], s85 offen offset:1024 sc1
    v_mfma_f32_16x16x32_bf16 v[204:207], a[92:95], a[4:7], v[204:207]
    v_mfma_f32_16x16x32_bf16 v[204:207], a[76:79], a[0:3], v[204:207]
    s_waitcnt vmcnt(18)
    s_waitcnt lgkmcnt(0)
    s_barrier
    ds_read_b128 a[4:7], v41 offset:16384
    v_mfma_f32_16x16x32_bf16 v[220:223], a[76:79], a[8:11], v[220:223]
    ds_read_b128 a[0:3], v40 offset:16384
    v_mfma_f32_16x16x32_bf16 v[220:223], a[92:95], a[12:15], v[220:223]
    buffer_load_dwordx4 a[136:139], v9, s[20:23], s85 offen offset:2048 sc1
    v_mfma_f32_16x16x32_bf16 v[216:219], a[88:91], a[12:15], v[216:219]
    v_mfma_f32_16x16x32_bf16 v[216:219], a[72:75], a[8:11], v[216:219]
    v_mfma_f32_16x16x32_bf16 v[212:215], a[68:71], a[8:11], v[212:215]
    v_mfma_f32_16x16x32_bf16 v[212:215], a[84:87], a[12:15], v[212:215]
    buffer_load_dwordx4 a[140:143], v9, s[20:23], s85 offen offset:3072 sc1
    v_mfma_f32_16x16x32_bf16 v[208:211], a[80:83], a[12:15], v[208:211]
    ds_read_b128 a[12:15], v41 offset:18432
    v_mfma_f32_16x16x32_bf16 v[208:211], a[64:67], a[8:11], v[208:211]
    ds_read_b128 a[8:11], v40 offset:18432
    v_mfma_f32_16x16x32_bf16 v[224:227], a[64:67], a[16:19], v[224:227]
    s_add_u32 s78, s91, s19
    s_add_u32 m0, s76, 49152
    v_mfma_f32_16x16x32_bf16 v[224:227], a[80:83], a[20:23], v[224:227]
    buffer_load_dwordx4 v32, s[8:11], s78 offen offset:0 lds
    v_mfma_f32_16x16x32_bf16 v[228:231], a[84:87], a[20:23], v[228:231]
    v_mfma_f32_16x16x32_bf16 v[228:231], a[68:71], a[16:19], v[228:231]
    v_mfma_f32_16x16x32_bf16 v[232:235], a[72:75], a[16:19], v[232:235]
    v_mfma_f32_16x16x32_bf16 v[232:235], a[88:91], a[20:23], v[232:235]
    buffer_load_dwordx4 v33, s[8:11], s78 offen offset:1024 lds
    v_mfma_f32_16x16x32_bf16 v[236:239], a[92:95], a[20:23], v[236:239]
    ds_read_b128 a[20:23], v41 offset:20480
    v_mfma_f32_16x16x32_bf16 v[236:239], a[76:79], a[16:19], v[236:239]
    ds_read_b128 a[16:19], v40 offset:20480
    v_mfma_f32_16x16x32_bf16 v[252:255], a[76:79], a[24:27], v[252:255]
    v_mfma_f32_16x16x32_bf16 v[252:255], a[92:95], a[28:31], v[252:255]
    buffer_load_dwordx4 v34, s[8:11], s78 offen offset:2048 lds
    v_mfma_f32_16x16x32_bf16 v[248:251], a[88:91], a[28:31], v[248:251]
    v_mfma_f32_16x16x32_bf16 v[248:251], a[72:75], a[24:27], v[248:251]
    v_mfma_f32_16x16x32_bf16 v[244:247], a[68:71], a[24:27], v[244:247]
    v_mfma_f32_16x16x32_bf16 v[244:247], a[84:87], a[28:31], v[244:247]
    buffer_load_dwordx4 v35, s[8:11], s78 offen offset:3072 lds
    v_mfma_f32_16x16x32_bf16 v[240:243], a[80:83], a[28:31], v[240:243]
    ds_read_b128 a[28:31], v41 offset:22528
    v_mfma_f32_16x16x32_bf16 v[240:243], a[64:67], a[24:27], v[240:243]
    ds_read_b128 a[24:27], v40 offset:22528
    s_waitcnt vmcnt(12) lgkmcnt(4)
    v_mfma_f32_16x16x32_bf16 v[128:131], a[96:99], a[0:3], v[128:131]
    s_add_u32 s85, s85, 4096
    v_mfma_f32_16x16x32_bf16 v[128:131], a[112:115], a[4:7], v[128:131]
    buffer_load_dwordx4 a[144:147], v9, s[20:23], s85 offen offset:0 sc1
    v_mfma_f32_16x16x32_bf16 v[132:135], a[116:119], a[4:7], v[132:135]
    v_mfma_f32_16x16x32_bf16 v[132:135], a[100:103], a[0:3], v[132:135]
    v_mfma_f32_16x16x32_bf16 v[136:139], a[104:107], a[0:3], v[136:139]
    v_mfma_f32_16x16x32_bf16 v[136:139], a[120:123], a[4:7], v[136:139]
    buffer_load_dwordx4 a[148:151], v9, s[20:23], s85 offen offset:1024 sc1
    v_mfma_f32_16x16x32_bf16 v[140:143], a[124:127], a[4:7], v[140:143]
    ds_read_b128 a[4:7], v43 offset:16384
    v_mfma_f32_16x16x32_bf16 v[140:143], a[108:111], a[0:3], v[140:143]
    ds_read_b128 a[0:3], v42 offset:16384
    v_mfma_f32_16x16x32_bf16 v[156:159], a[108:111], a[8:11], v[156:159]
    v_mfma_f32_16x16x32_bf16 v[156:159], a[124:127], a[12:15], v[156:159]
    buffer_load_dwordx4 a[152:155], v9, s[20:23], s85 offen offset:2048 sc1
    v_mfma_f32_16x16x32_bf16 v[152:155], a[120:123], a[12:15], v[152:155]
    v_mfma_f32_16x16x32_bf16 v[152:155], a[104:107], a[8:11], v[152:155]
    v_mfma_f32_16x16x32_bf16 v[148:151], a[100:103], a[8:11], v[148:151]
    v_mfma_f32_16x16x32_bf16 v[148:151], a[116:119], a[12:15], v[148:151]
    buffer_load_dwordx4 a[156:159], v9, s[20:23], s85 offen offset:3072 sc1
    v_mfma_f32_16x16x32_bf16 v[144:147], a[112:115], a[12:15], v[144:147]
    ds_read_b128 a[12:15], v43 offset:18432
    v_mfma_f32_16x16x32_bf16 v[144:147], a[96:99], a[8:11], v[144:147]
    ds_read_b128 a[8:11], v42 offset:18432
    s_waitcnt lgkmcnt(4)
    v_mfma_f32_16x16x32_bf16 v[160:163], a[96:99], a[16:19], v[160:163]
    s_add_u32 m0, s76, 53248
    v_mfma_f32_16x16x32_bf16 v[160:163], a[112:115], a[20:23], v[160:163]
    buffer_load_dwordx4 v36, s[8:11], s78 offen offset:0 lds
    v_mfma_f32_16x16x32_bf16 v[164:167], a[116:119], a[20:23], v[164:167]
    v_mfma_f32_16x16x32_bf16 v[164:167], a[100:103], a[16:19], v[164:167]
    v_mfma_f32_16x16x32_bf16 v[168:171], a[104:107], a[16:19], v[168:171]
    v_mfma_f32_16x16x32_bf16 v[168:171], a[120:123], a[20:23], v[168:171]
    buffer_load_dwordx4 v37, s[8:11], s78 offen offset:1024 lds
    v_mfma_f32_16x16x32_bf16 v[172:175], a[124:127], a[20:23], v[172:175]
    ds_read_b128 a[20:23], v43 offset:20480
    v_mfma_f32_16x16x32_bf16 v[172:175], a[108:111], a[16:19], v[172:175]
    ds_read_b128 a[16:19], v42 offset:20480
    v_mfma_f32_16x16x32_bf16 v[188:191], a[108:111], a[24:27], v[188:191]
    v_mfma_f32_16x16x32_bf16 v[188:191], a[124:127], a[28:31], v[188:191]
    buffer_load_dwordx4 v38, s[8:11], s78 offen offset:2048 lds
    v_mfma_f32_16x16x32_bf16 v[184:187], a[120:123], a[28:31], v[184:187]
    v_mfma_f32_16x16x32_bf16 v[184:187], a[104:107], a[24:27], v[184:187]
    v_mfma_f32_16x16x32_bf16 v[180:183], a[100:103], a[24:27], v[180:183]
    v_mfma_f32_16x16x32_bf16 v[180:183], a[116:119], a[28:31], v[180:183]
    buffer_load_dwordx4 v39, s[8:11], s78 offen offset:3072 lds
    v_mfma_f32_16x16x32_bf16 v[176:179], a[112:115], a[28:31], v[176:179]
    ds_read_b128 a[28:31], v43 offset:22528
    s_add_u32 s91, s91, 512
    v_mfma_f32_16x16x32_bf16 v[176:179], a[96:99], a[24:27], v[176:179]
    ds_read_b128 a[24:27], v42 offset:22528
    s_waitcnt lgkmcnt(4)
    v_mfma_f32_16x16x32_bf16 v[192:195], a[96:99], a[0:3], v[192:195]
    s_add_u32 s85, s84, s83
    s_xor_b32 s83, s27, 24576
    v_mfma_f32_16x16x32_bf16 v[192:195], a[112:115], a[4:7], v[192:195]
    buffer_load_dwordx4 a[32:35], v9, s[20:23], s85 offen offset:0 sc1
    v_mfma_f32_16x16x32_bf16 v[196:199], a[116:119], a[4:7], v[196:199]
    v_mfma_f32_16x16x32_bf16 v[196:199], a[100:103], a[0:3], v[196:199]
    v_mfma_f32_16x16x32_bf16 v[200:203], a[104:107], a[0:3], v[200:203]
    v_mfma_f32_16x16x32_bf16 v[200:203], a[120:123], a[4:7], v[200:203]
    buffer_load_dwordx4 a[36:39], v9, s[20:23], s85 offen offset:1024 sc1
    v_mfma_f32_16x16x32_bf16 v[204:207], a[124:127], a[4:7], v[204:207]
    v_mfma_f32_16x16x32_bf16 v[204:207], a[108:111], a[0:3], v[204:207]
    s_waitcnt vmcnt(18)
    s_waitcnt lgkmcnt(0)
    s_barrier
    ds_read_b128 a[4:7], v41 offset:32768
    v_mfma_f32_16x16x32_bf16 v[220:223], a[108:111], a[8:11], v[220:223]
    ds_read_b128 a[0:3], v40 offset:32768
    v_mfma_f32_16x16x32_bf16 v[220:223], a[124:127], a[12:15], v[220:223]
    buffer_load_dwordx4 a[40:43], v9, s[20:23], s85 offen offset:2048 sc1
    v_mfma_f32_16x16x32_bf16 v[216:219], a[120:123], a[12:15], v[216:219]
    v_mfma_f32_16x16x32_bf16 v[216:219], a[104:107], a[8:11], v[216:219]
    v_mfma_f32_16x16x32_bf16 v[212:215], a[100:103], a[8:11], v[212:215]
    v_mfma_f32_16x16x32_bf16 v[212:215], a[116:119], a[12:15], v[212:215]
    buffer_load_dwordx4 a[44:47], v9, s[20:23], s85 offen offset:3072 sc1
    v_mfma_f32_16x16x32_bf16 v[208:211], a[112:115], a[12:15], v[208:211]
    ds_read_b128 a[12:15], v41 offset:34816
    v_mfma_f32_16x16x32_bf16 v[208:211], a[96:99], a[8:11], v[208:211]
    ds_read_b128 a[8:11], v40 offset:34816
    v_mfma_f32_16x16x32_bf16 v[224:227], a[96:99], a[16:19], v[224:227]
    s_add_u32 s78, s91, s16
    s_add_u32 m0, s76, 0
    v_mfma_f32_16x16x32_bf16 v[224:227], a[112:115], a[20:23], v[224:227]
    buffer_load_dwordx4 v32, s[8:11], s78 offen offset:0 lds
    v_mfma_f32_16x16x32_bf16 v[228:231], a[116:119], a[20:23], v[228:231]
    v_mfma_f32_16x16x32_bf16 v[228:231], a[100:103], a[16:19], v[228:231]
    v_mfma_f32_16x16x32_bf16 v[232:235], a[104:107], a[16:19], v[232:235]
    v_mfma_f32_16x16x32_bf16 v[232:235], a[120:123], a[20:23], v[232:235]
    buffer_load_dwordx4 v33, s[8:11], s78 offen offset:1024 lds
    v_mfma_f32_16x16x32_bf16 v[236:239], a[124:127], a[20:23], v[236:239]
    ds_read_b128 a[20:23], v41 offset:36864
    v_mfma_f32_16x16x32_bf16 v[236:239], a[108:111], a[16:19], v[236:239]
    ds_read_b128 a[16:19], v40 offset:36864
    v_mfma_f32_16x16x32_bf16 v[252:255], a[108:111], a[24:27], v[252:255]
    v_mfma_f32_16x16x32_bf16 v[252:255], a[124:127], a[28:31], v[252:255]
    buffer_load_dwordx4 v34, s[8:11], s78 offen offset:2048 lds
    v_mfma_f32_16x16x32_bf16 v[248:251], a[120:123], a[28:31], v[248:251]
    v_mfma_f32_16x16x32_bf16 v[248:251], a[104:107], a[24:27], v[248:251]
    v_mfma_f32_16x16x32_bf16 v[244:247], a[100:103], a[24:27], v[244:247]
    v_mfma_f32_16x16x32_bf16 v[244:247], a[116:119], a[28:31], v[244:247]
    buffer_load_dwordx4 v35, s[8:11], s78 offen offset:3072 lds
    v_mfma_f32_16x16x32_bf16 v[240:243], a[112:115], a[28:31], v[240:243]
    ds_read_b128 a[28:31], v41 offset:38912
    v_mfma_f32_16x16x32_bf16 v[240:243], a[96:99], a[24:27], v[240:243]
    ds_read_b128 a[24:27], v40 offset:38912
    s_waitcnt vmcnt(12) lgkmcnt(4)
    v_mfma_f32_16x16x32_bf16 v[128:131], a[128:131], a[0:3], v[128:131]
    s_add_u32 s85, s85, 4096
    v_mfma_f32_16x16x32_bf16 v[128:131], a[144:147], a[4:7], v[128:131]
    buffer_load_dwordx4 a[48:51], v9, s[20:23], s85 offen offset:0 sc1
    v_mfma_f32_16x16x32_bf16 v[132:135], a[148:151], a[4:7], v[132:135]
    v_mfma_f32_16x16x32_bf16 v[132:135], a[132:135], a[0:3], v[132:135]
    v_mfma_f32_16x16x32_bf16 v[136:139], a[136:139], a[0:3], v[136:139]
    v_mfma_f32_16x16x32_bf16 v[136:139], a[152:155], a[4:7], v[136:139]
    buffer_load_dwordx4 a[52:55], v9, s[20:23], s85 offen offset:1024 sc1
    v_mfma_f32_16x16x32_bf16 v[140:143], a[156:159], a[4:7], v[140:143]
    ds_read_b128 a[4:7], v43 offset:32768
    v_mfma_f32_16x16x32_bf16 v[140:143], a[140:143], a[0:3], v[140:143]
    ds_read_b128 a[0:3], v42 offset:32768
    v_mfma_f32_16x16x32_bf16 v[156:159], a[140:143], a[8:11], v[156:159]
    v_mfma_f32_16x16x32_bf16 v[156:159], a[156:159], a[12:15], v[156:159]
    buffer_load_dwordx4 a[56:59], v9, s[20:23], s85 offen offset:2048 sc1
    v_mfma_f32_16x16x32_bf16 v[152:155], a[152:155], a[12:15], v[152:155]
    v_mfma_f32_16x16x32_bf16 v[152:155], a[136:139], a[8:11], v[152:155]
    v_mfma_f32_16x16x32_bf16 v[148:151], a[132:135], a[8:11], v[148:151]
    v_mfma_f32_16x16x32_bf16 v[148:151], a[148:151], a[12:15], v[148:151]
    buffer_load_dwordx4 a[60:63], v9, s[20:23], s85 offen offset:3072 sc1
    v_mfma_f32_16x16x32_bf16 v[144:147], a[144:147], a[12:15], v[144:147]
    ds_read_b128 a[12:15], v43 offset:34816
    v_mfma_f32_16x16x32_bf16 v[144:147], a[128:131], a[8:11], v[144:147]
    ds_read_b128 a[8:11], v42 offset:34816
    s_waitcnt lgkmcnt(4)
    v_mfma_f32_16x16x32_bf16 v[160:163], a[128:131], a[16:19], v[160:163]
    s_add_u32 s84, s84, 32768
    s_add_u32 m0, s76, 4096
    v_mfma_f32_16x16x32_bf16 v[160:163], a[144:147], a[20:23], v[160:163]
    buffer_load_dwordx4 v36, s[8:11], s78 offen offset:0 lds
    v_mfma_f32_16x16x32_bf16 v[164:167], a[148:151], a[20:23], v[164:167]
    v_mfma_f32_16x16x32_bf16 v[164:167], a[132:135], a[16:19], v[164:167]
    v_mfma_f32_16x16x32_bf16 v[168:171], a[136:139], a[16:19], v[168:171]
    v_mfma_f32_16x16x32_bf16 v[168:171], a[152:155], a[20:23], v[168:171]
    buffer_load_dwordx4 v37, s[8:11], s78 offen offset:1024 lds
    v_mfma_f32_16x16x32_bf16 v[172:175], a[156:159], a[20:23], v[172:175]
    ds_read_b128 a[20:23], v43 offset:36864
    v_mfma_f32_16x16x32_bf16 v[172:175], a[140:143], a[16:19], v[172:175]
    ds_read_b128 a[16:19], v42 offset:36864
    v_mfma_f32_16x16x32_bf16 v[188:191], a[140:143], a[24:27], v[188:191]
    v_mfma_f32_16x16x32_bf16 v[188:191], a[156:159], a[28:31], v[188:191]
    buffer_load_dwordx4 v38, s[8:11], s78 offen offset:2048 lds
    v_mfma_f32_16x16x32_bf16 v[184:187], a[152:155], a[28:31], v[184:187]
    v_mfma_f32_16x16x32_bf16 v[184:187], a[136:139], a[24:27], v[184:187]
    v_mfma_f32_16x16x32_bf16 v[180:183], a[132:135], a[24:27], v[180:183]
    v_mfma_f32_16x16x32_bf16 v[180:183], a[148:151], a[28:31], v[180:183]
    buffer_load_dwordx4 v39, s[8:11], s78 offen offset:3072 lds
    v_mfma_f32_16x16x32_bf16 v[176:179], a[144:147], a[28:31], v[176:179]
    ds_read_b128 a[28:31], v43 offset:38912
    v_mfma_f32_16x16x32_bf16 v[176:179], a[128:131], a[24:27], v[176:179]
    ds_read_b128 a[24:27], v42 offset:38912
    s_waitcnt lgkmcnt(4)
    v_mfma_f32_16x16x32_bf16 v[192:195], a[128:131], a[0:3], v[192:195]
    s_add_u32 s85, s84, s80
    s_xor_b32 s80, s27, 0
    v_mfma_f32_16x16x32_bf16 v[192:195], a[144:147], a[4:7], v[192:195]
    buffer_load_dwordx4 a[64:67], v9, s[20:23], s85 offen offset:0 sc1
    v_mfma_f32_16x16x32_bf16 v[196:199], a[148:151], a[4:7], v[196:199]
    v_mfma_f32_16x16x32_bf16 v[196:199], a[132:135], a[0:3], v[196:199]
    v_mfma_f32_16x16x32_bf16 v[200:203], a[136:139], a[0:3], v[200:203]
    v_mfma_f32_16x16x32_bf16 v[200:203], a[152:155], a[4:7], v[200:203]
    buffer_load_dwordx4 a[68:71], v9, s[20:23], s85 offen offset:1024 sc1
    v_mfma_f32_16x16x32_bf16 v[204:207], a[156:159], a[4:7], v[204:207]
    v_mfma_f32_16x16x32_bf16 v[204:207], a[140:143], a[0:3], v[204:207]
    s_waitcnt vmcnt(18)
    s_waitcnt lgkmcnt(0)
    s_barrier
    ds_read_b128 a[4:7], v41 offset:49152
    v_mfma_f32_16x16x32_bf16 v[220:223], a[140:143], a[8:11], v[220:223]
    ds_read_b128 a[0:3], v40 offset:49152
    v_mfma_f32_16x16x32_bf16 v[220:223], a[156:159], a[12:15], v[220:223]
    buffer_load_dwordx4 a[72:75], v9, s[20:23], s85 offen offset:2048 sc1
    v_mfma_f32_16x16x32_bf16 v[216:219], a[152:155], a[12:15], v[216:219]
    v_mfma_f32_16x16x32_bf16 v[216:219], a[136:139], a[8:11], v[216:219]
    v_mfma_f32_16x16x32_bf16 v[212:215], a[132:135], a[8:11], v[212:215]
    v_mfma_f32_16x16x32_bf16 v[212:215], a[148:151], a[12:15], v[212:215]
    buffer_load_dwordx4 a[76:79], v9, s[20:23], s85 offen offset:3072 sc1
    v_mfma_f32_16x16x32_bf16 v[208:211], a[144:147], a[12:15], v[208:211]
    ds_read_b128 a[12:15], v41 offset:51200
    v_mfma_f32_16x16x32_bf16 v[208:211], a[128:131], a[8:11], v[208:211]
    ds_read_b128 a[8:11], v40 offset:51200
    v_mfma_f32_16x16x32_bf16 v[224:227], a[128:131], a[16:19], v[224:227]
    s_add_u32 s78, s91, s17
    s_add_u32 m0, s76, 16384
    v_mfma_f32_16x16x32_bf16 v[224:227], a[144:147], a[20:23], v[224:227]
    buffer_load_dwordx4 v32, s[8:11], s78 offen offset:0 lds
    v_mfma_f32_16x16x32_bf16 v[228:231], a[148:151], a[20:23], v[228:231]
    v_mfma_f32_16x16x32_bf16 v[228:231], a[132:135], a[16:19], v[228:231]
    v_mfma_f32_16x16x32_bf16 v[232:235], a[136:139], a[16:19], v[232:235]
    v_mfma_f32_16x16x32_bf16 v[232:235], a[152:155], a[20:23], v[232:235]
    buffer_load_dwordx4 v33, s[8:11], s78 offen offset:1024 lds
    v_mfma_f32_16x16x32_bf16 v[236:239], a[156:159], a[20:23], v[236:239]
    ds_read_b128 a[20:23], v41 offset:53248
    v_mfma_f32_16x16x32_bf16 v[236:239], a[140:143], a[16:19], v[236:239]
    ds_read_b128 a[16:19], v40 offset:53248
    v_mfma_f32_16x16x32_bf16 v[252:255], a[140:143], a[24:27], v[252:255]
    v_mfma_f32_16x16x32_bf16 v[252:255], a[156:159], a[28:31], v[252:255]
    buffer_load_dwordx4 v34, s[8:11], s78 offen offset:2048 lds
    v_mfma_f32_16x16x32_bf16 v[248:251], a[152:155], a[28:31], v[248:251]
    v_mfma_f32_16x16x32_bf16 v[248:251], a[136:139], a[24:27], v[248:251]
    v_mfma_f32_16x16x32_bf16 v[244:247], a[132:135], a[24:27], v[244:247]
    v_mfma_f32_16x16x32_bf16 v[244:247], a[148:151], a[28:31], v[244:247]
    buffer_load_dwordx4 v35, s[8:11], s78 offen offset:3072 lds
    v_mfma_f32_16x16x32_bf16 v[240:243], a[144:147], a[28:31], v[240:243]
    ds_read_b128 a[28:31], v41 offset:55296
    v_mfma_f32_16x16x32_bf16 v[240:243], a[128:131], a[24:27], v[240:243]
    ds_read_b128 a[24:27], v40 offset:55296
    s_waitcnt vmcnt(12) lgkmcnt(4)
    v_mfma_f32_16x16x32_bf16 v[128:131], a[32:35], a[0:3], v[128:131]
    s_add_u32 s85, s85, 4096
    v_mfma_f32_16x16x32_bf16 v[128:131], a[48:51], a[4:7], v[128:131]
    buffer_load_dwordx4 a[80:83], v9, s[20:23], s85 offen offset:0 sc1
    v_mfma_f32_16x16x32_bf16 v[132:135], a[52:55], a[4:7], v[132:135]
    v_mfma_f32_16x16x32_bf16 v[132:135], a[36:39], a[0:3], v[132:135]
    v_mfma_f32_16x16x32_bf16 v[136:139], a[40:43], a[0:3], v[136:139]
    v_mfma_f32_16x16x32_bf16 v[136:139], a[56:59], a[4:7], v[136:139]
    buffer_load_dwordx4 a[84:87], v9, s[20:23], s85 offen offset:1024 sc1
    v_mfma_f32_16x16x32_bf16 v[140:143], a[60:63], a[4:7], v[140:143]
    ds_read_b128 a[4:7], v43 offset:49152
    v_mfma_f32_16x16x32_bf16 v[140:143], a[44:47], a[0:3], v[140:143]
    ds_read_b128 a[0:3], v42 offset:49152
    v_mfma_f32_16x16x32_bf16 v[156:159], a[44:47], a[8:11], v[156:159]
    v_mfma_f32_16x16x32_bf16 v[156:159], a[60:63], a[12:15], v[156:159]
    buffer_load_dwordx4 a[88:91], v9, s[20:23], s85 offen offset:2048 sc1
    v_mfma_f32_16x16x32_bf16 v[152:155], a[56:59], a[12:15], v[152:155]
    v_mfma_f32_16x16x32_bf16 v[152:155], a[40:43], a[8:11], v[152:155]
    v_mfma_f32_16x16x32_bf16 v[148:151], a[36:39], a[8:11], v[148:151]
    v_mfma_f32_16x16x32_bf16 v[148:151], a[52:55], a[12:15], v[148:151]
    buffer_load_dwordx4 a[92:95], v9, s[20:23], s85 offen offset:3072 sc1
    v_mfma_f32_16x16x32_bf16 v[144:147], a[48:51], a[12:15], v[144:147]
    ds_read_b128 a[12:15], v43 offset:51200
    v_mfma_f32_16x16x32_bf16 v[144:147], a[32:35], a[8:11], v[144:147]
    ds_read_b128 a[8:11], v42 offset:51200
    s_waitcnt lgkmcnt(4)
    v_mfma_f32_16x16x32_bf16 v[160:163], a[32:35], a[16:19], v[160:163]
    s_add_u32 m0, s76, 20480
    v_mfma_f32_16x16x32_bf16 v[160:163], a[48:51], a[20:23], v[160:163]
    buffer_load_dwordx4 v36, s[8:11], s78 offen offset:0 lds
    v_mfma_f32_16x16x32_bf16 v[164:167], a[52:55], a[20:23], v[164:167]
    v_mfma_f32_16x16x32_bf16 v[164:167], a[36:39], a[16:19], v[164:167]
    v_mfma_f32_16x16x32_bf16 v[168:171], a[40:43], a[16:19], v[168:171]
    v_mfma_f32_16x16x32_bf16 v[168:171], a[56:59], a[20:23], v[168:171]
    buffer_load_dwordx4 v37, s[8:11], s78 offen offset:1024 lds
    v_mfma_f32_16x16x32_bf16 v[172:175], a[60:63], a[20:23], v[172:175]
    ds_read_b128 a[20:23], v43 offset:53248
    v_mfma_f32_16x16x32_bf16 v[172:175], a[44:47], a[16:19], v[172:175]
    ds_read_b128 a[16:19], v42 offset:53248
    v_mfma_f32_16x16x32_bf16 v[188:191], a[44:47], a[24:27], v[188:191]
    v_mfma_f32_16x16x32_bf16 v[188:191], a[60:63], a[28:31], v[188:191]
    buffer_load_dwordx4 v38, s[8:11], s78 offen offset:2048 lds
    v_mfma_f32_16x16x32_bf16 v[184:187], a[56:59], a[28:31], v[184:187]
    v_mfma_f32_16x16x32_bf16 v[184:187], a[40:43], a[24:27], v[184:187]
    v_mfma_f32_16x16x32_bf16 v[180:183], a[36:39], a[24:27], v[180:183]
    v_mfma_f32_16x16x32_bf16 v[180:183], a[52:55], a[28:31], v[180:183]
    buffer_load_dwordx4 v39, s[8:11], s78 offen offset:3072 lds
    v_mfma_f32_16x16x32_bf16 v[176:179], a[48:51], a[28:31], v[176:179]
    ds_read_b128 a[28:31], v43 offset:55296
    v_mfma_f32_16x16x32_bf16 v[176:179], a[32:35], a[24:27], v[176:179]
    ds_read_b128 a[24:27], v42 offset:55296
    s_waitcnt lgkmcnt(4)
    v_mfma_f32_16x16x32_bf16 v[192:195], a[32:35], a[0:3], v[192:195]
    s_add_u32 s85, s84, s81
    s_xor_b32 s81, s27, 8192
    v_mfma_f32_16x16x32_bf16 v[192:195], a[48:51], a[4:7], v[192:195]
    buffer_load_dwordx4 a[96:99], v9, s[20:23], s85 offen offset:0 sc1
    v_mfma_f32_16x16x32_bf16 v[196:199], a[52:55], a[4:7], v[196:199]
    v_mfma_f32_16x16x32_bf16 v[196:199], a[36:39], a[0:3], v[196:199]
    v_mfma_f32_16x16x32_bf16 v[200:203], a[40:43], a[0:3], v[200:203]
    v_mfma_f32_16x16x32_bf16 v[200:203], a[56:59], a[4:7], v[200:203]
    buffer_load_dwordx4 a[100:103], v9, s[20:23], s85 offen offset:1024 sc1
    v_mfma_f32_16x16x32_bf16 v[204:207], a[60:63], a[4:7], v[204:207]
    v_mfma_f32_16x16x32_bf16 v[204:207], a[44:47], a[0:3], v[204:207]
    s_waitcnt vmcnt(18)
    s_waitcnt lgkmcnt(0)
    s_barrier
    ds_read_b128 a[4:7], v41 offset:0
    v_mfma_f32_16x16x32_bf16 v[220:223], a[44:47], a[8:11], v[220:223]
    ds_read_b128 a[0:3], v40 offset:0
    v_mfma_f32_16x16x32_bf16 v[220:223], a[60:63], a[12:15], v[220:223]
    buffer_load_dwordx4 a[104:107], v9, s[20:23], s85 offen offset:2048 sc1
    v_mfma_f32_16x16x32_bf16 v[216:219], a[56:59], a[12:15], v[216:219]
    v_mfma_f32_16x16x32_bf16 v[216:219], a[40:43], a[8:11], v[216:219]
    v_mfma_f32_16x16x32_bf16 v[212:215], a[36:39], a[8:11], v[212:215]
    v_mfma_f32_16x16x32_bf16 v[212:215], a[52:55], a[12:15], v[212:215]
    buffer_load_dwordx4 a[108:111], v9, s[20:23], s85 offen offset:3072 sc1
    v_mfma_f32_16x16x32_bf16 v[208:211], a[48:51], a[12:15], v[208:211]
    ds_read_b128 a[12:15], v41 offset:2048
    v_mfma_f32_16x16x32_bf16 v[208:211], a[32:35], a[8:11], v[208:211]
    ds_read_b128 a[8:11], v40 offset:2048
    v_mfma_f32_16x16x32_bf16 v[224:227], a[32:35], a[16:19], v[224:227]
    s_add_u32 s78, s91, s18
    s_add_u32 m0, s76, 32768
    v_mfma_f32_16x16x32_bf16 v[224:227], a[48:51], a[20:23], v[224:227]
    buffer_load_dwordx4 v32, s[8:11], s78 offen offset:0 lds
    v_mfma_f32_16x16x32_bf16 v[228:231], a[52:55], a[20:23], v[228:231]
    v_mfma_f32_16x16x32_bf16 v[228:231], a[36:39], a[16:19], v[228:231]
    v_mfma_f32_16x16x32_bf16 v[232:235], a[40:43], a[16:19], v[232:235]
    v_mfma_f32_16x16x32_bf16 v[232:235], a[56:59], a[20:23], v[232:235]
    buffer_load_dwordx4 v33, s[8:11], s78 offen offset:1024 lds
    v_mfma_f32_16x16x32_bf16 v[236:239], a[60:63], a[20:23], v[236:239]
    ds_read_b128 a[20:23], v41 offset:4096
    v_mfma_f32_16x16x32_bf16 v[236:239], a[44:47], a[16:19], v[236:239]
    ds_read_b128 a[16:19], v40 offset:4096
    v_mfma_f32_16x16x32_bf16 v[252:255], a[44:47], a[24:27], v[252:255]
    v_mfma_f32_16x16x32_bf16 v[252:255], a[60:63], a[28:31], v[252:255]
    buffer_load_dwordx4 v34, s[8:11], s78 offen offset:2048 lds
    v_mfma_f32_16x16x32_bf16 v[248:251], a[56:59], a[28:31], v[248:251]
    v_mfma_f32_16x16x32_bf16 v[248:251], a[40:43], a[24:27], v[248:251]
    v_mfma_f32_16x16x32_bf16 v[244:247], a[36:39], a[24:27], v[244:247]
    v_mfma_f32_16x16x32_bf16 v[244:247], a[52:55], a[28:31], v[244:247]
    buffer_load_dwordx4 v35, s[8:11], s78 offen offset:3072 lds
    v_mfma_f32_16x16x32_bf16 v[240:243], a[48:51], a[28:31], v[240:243]
    ds_read_b128 a[28:31], v41 offset:6144
    v_mfma_f32_16x16x32_bf16 v[240:243], a[32:35], a[24:27], v[240:243]
    ds_read_b128 a[24:27], v40 offset:6144
L_k3_lastssm:
    s_lshl_b32 s3, s26, 15
    s_add_u32 s86, s86, s3
    s_add_u32 s86, s86, 131072
    s_xor_b32 s67, s86, 128
    s_add_u32 s42, s87, 8192
    s_add_u32 s43, s87, 4096
    s_add_u32 s54, s42, 4096
    s_cmp_eq_u32 s62, 0
    s_cselect_b32 s40, 2.0, -2.0
    s_mov_b32 s41, s40
    s_and_b32 s3, s39, 2047
    v_and_b32 v30, 15, v18
    v_lshl_add_u32 v30, v30, 1, s3
    v_add_u32_e64 v20, s76, v9
    v_xor_b32 v21, 0x10000, v20
    s_waitcnt vmcnt(12) lgkmcnt(4)
    v_mfma_f32_16x16x32_bf16 v[128:131], a[64:67], a[0:3], v[128:131]
    s_add_u32 s85, s85, 4096
    v_mfma_f32_16x16x32_bf16 v[128:131], a[80:83], a[4:7], v[128:131]
    ds_read_b128 a[16:19], v42 offset:0
    buffer_load_dwordx4 a[112:115], v9, s[20:23], s85 offen offset:0 sc1
    v_mfma_f32_16x16x32_bf16 v[132:135], a[84:87], a[4:7], v[132:135]
    v_mfma_f32_16x16x32_bf16 v[132:135], a[68:71], a[0:3], v[132:135]
    ds_read_b128 a[20:23], v43 offset:0
    buffer_load_dwordx4 a[116:119], v9, s[20:23], s85 offen offset:1024 sc1
    v_mfma_f32_16x16x32_bf16 v[136:139], a[72:75], a[0:3], v[136:139]
    v_mfma_f32_16x16x32_bf16 v[136:139], a[88:91], a[4:7], v[136:139]
    ds_read_b128 a[24:27], v42 offset:2048
    buffer_load_dwordx4 a[120:123], v9, s[20:23], s85 offen offset:2048 sc1
    v_mfma_f32_16x16x32_bf16 v[140:143], a[92:95], a[4:7], v[140:143]
    buffer_load_dwordx4 a[124:127], v9, s[20:23], s85 offen offset:3072 sc1
    v_mfma_f32_16x16x32_bf16 v[140:143], a[76:79], a[0:3], v[140:143]
    ds_read_b128 a[28:31], v43 offset:2048
    v_mfma_f32_16x16x32_bf16 v[156:159], a[76:79], a[8:11], v[156:159]
    s_add_u32 m0, s76, 36864
    v_mfma_f32_16x16x32_bf16 v[156:159], a[92:95], a[12:15], v[156:159]
    v_mfma_f32_16x16x32_bf16 v[152:155], a[88:91], a[12:15], v[152:155]
    buffer_load_dwordx4 v36, s[8:11], s78 offen offset:0 lds
    v_mfma_f32_16x16x32_bf16 v[152:155], a[72:75], a[8:11], v[152:155]
    buffer_load_dwordx4 v37, s[8:11], s78 offen offset:1024 lds
    v_mfma_f32_16x16x32_bf16 v[148:151], a[68:71], a[8:11], v[148:151]
    v_mfma_f32_16x16x32_bf16 v[148:151], a[84:87], a[12:15], v[148:151]
    buffer_load_dwordx4 v38, s[8:11], s78 offen offset:2048 lds
    v_mfma_f32_16x16x32_bf16 v[144:147], a[80:83], a[12:15], v[144:147]
    v_mfma_f32_16x16x32_bf16 v[144:147], a[64:67], a[8:11], v[144:147]
    s_waitcnt lgkmcnt(3)
    v_mfma_f32_16x16x32_bf16 v[192:195], a[64:67], a[16:19], v[192:195]
    s_waitcnt vmcnt(15)
    s_waitcnt lgkmcnt(0)
    s_barrier
    buffer_load_dwordx4 v39, s[8:11], s78 offen offset:3072 lds
    v_mfma_f32_16x16x32_bf16 v[192:195], a[80:83], a[20:23], v[192:195]
    ds_read_b128 a[0:3], v40 offset:16384
    s_add_u32 s85, s84, s82
    s_xor_b32 s82, s27, 16384
    v_mfma_f32_16x16x32_bf16 v[196:199], a[84:87], a[20:23], v[196:199]
    v_mfma_f32_16x16x32_bf16 v[196:199], a[68:71], a[16:19], v[196:199]
    ds_read_b128 a[4:7], v41 offset:16384
    buffer_load_dwordx4 a[128:131], v9, s[20:23], s85 offen offset:0 sc1
    v_mfma_f32_16x16x32_bf16 v[200:203], a[72:75], a[16:19], v[200:203]
    v_mfma_f32_16x16x32_bf16 v[200:203], a[88:91], a[20:23], v[200:203]
    ds_read_b128 a[8:11], v40 offset:18432
    buffer_load_dwordx4 a[132:135], v9, s[20:23], s85 offen offset:1024 sc1
    v_mfma_f32_16x16x32_bf16 v[204:207], a[92:95], a[20:23], v[204:207]
    buffer_load_dwordx4 a[136:139], v9, s[20:23], s85 offen offset:2048 sc1
    v_mfma_f32_16x16x32_bf16 v[204:207], a[76:79], a[16:19], v[204:207]
    ds_read_b128 a[12:15], v41 offset:18432
    v_mfma_f32_16x16x32_bf16 v[220:223], a[76:79], a[24:27], v[220:223]
    buffer_load_dwordx4 a[140:143], v9, s[20:23], s85 offen offset:3072 sc1
    v_mfma_f32_16x16x32_bf16 v[220:223], a[92:95], a[28:31], v[220:223]
    v_mfma_f32_16x16x32_bf16 v[216:219], a[88:91], a[28:31], v[216:219]
    s_add_u32 s85, s85, 4096
    v_mfma_f32_16x16x32_bf16 v[216:219], a[72:75], a[24:27], v[216:219]
    buffer_load_dwordx4 a[144:147], v9, s[20:23], s85 offen offset:0 sc1
    v_mfma_f32_16x16x32_bf16 v[212:215], a[68:71], a[24:27], v[212:215]
    v_mfma_f32_16x16x32_bf16 v[212:215], a[84:87], a[28:31], v[212:215]
    buffer_load_dwordx4 a[148:151], v9, s[20:23], s85 offen offset:1024 sc1
    v_mfma_f32_16x16x32_bf16 v[208:211], a[80:83], a[28:31], v[208:211]
    v_mfma_f32_16x16x32_bf16 v[208:211], a[64:67], a[24:27], v[208:211]
    s_waitcnt vmcnt(10) lgkmcnt(3)
    v_mfma_f32_16x16x32_bf16 v[128:131], a[96:99], a[0:3], v[128:131]
    buffer_load_dwordx4 a[152:155], v9, s[20:23], s85 offen offset:2048 sc1
    s_waitcnt lgkmcnt(2)
    v_mfma_f32_16x16x32_bf16 v[128:131], a[112:115], a[4:7], v[128:131]
    ds_read_b128 a[16:19], v42 offset:16384
    buffer_load_dwordx4 a[156:159], v9, s[20:23], s85 offen offset:3072 sc1
    v_mfma_f32_16x16x32_bf16 v[132:135], a[116:119], a[4:7], v[132:135]
    v_mfma_f32_16x16x32_bf16 v[132:135], a[100:103], a[0:3], v[132:135]
    ds_read_b128 a[20:23], v43 offset:16384
    s_add_u32 s78, s91, s19
    v_mfma_f32_16x16x32_bf16 v[136:139], a[104:107], a[0:3], v[136:139]
    s_add_u32 m0, s76, 49152
    v_mfma_f32_16x16x32_bf16 v[136:139], a[120:123], a[4:7], v[136:139]
    ds_read_b128 a[24:27], v42 offset:18432
    v_mfma_f32_16x16x32_bf16 v[140:143], a[124:127], a[4:7], v[140:143]
    buffer_load_dwordx4 v32, s[8:11], s78 offen offset:0 lds
    v_mfma_f32_16x16x32_bf16 v[140:143], a[108:111], a[0:3], v[140:143]
    ds_read_b128 a[28:31], v43 offset:18432
    buffer_load_dwordx4 v33, s[8:11], s78 offen offset:1024 lds
    s_waitcnt lgkmcnt(4)
    v_mfma_f32_16x16x32_bf16 v[156:159], a[108:111], a[8:11], v[156:159]
    v_mfma_f32_16x16x32_bf16 v[156:159], a[124:127], a[12:15], v[156:159]
    buffer_load_dwordx4 v34, s[8:11], s78 offen offset:2048 lds
    v_mfma_f32_16x16x32_bf16 v[152:155], a[120:123], a[12:15], v[152:155]
    buffer_load_dwordx4 v35, s[8:11], s78 offen offset:3072 lds
    v_mfma_f32_16x16x32_bf16 v[152:155], a[104:107], a[8:11], v[152:155]
    v_mfma_f32_16x16x32_bf16 v[148:151], a[100:103], a[8:11], v[148:151]
    s_add_u32 m0, s76, 53248
    v_mfma_f32_16x16x32_bf16 v[148:151], a[116:119], a[12:15], v[148:151]
    buffer_load_dwordx4 v36, s[8:11], s78 offen offset:0 lds
    v_mfma_f32_16x16x32_bf16 v[144:147], a[112:115], a[12:15], v[144:147]
    v_mfma_f32_16x16x32_bf16 v[144:147], a[96:99], a[8:11], v[144:147]
    s_waitcnt lgkmcnt(3)
    v_mfma_f32_16x16x32_bf16 v[192:195], a[96:99], a[16:19], v[192:195]
    s_waitcnt vmcnt(13)
    s_waitcnt lgkmcnt(0)
    s_barrier
    buffer_load_dwordx4 v37, s[8:11], s78 offen offset:1024 lds
    v_mfma_f32_16x16x32_bf16 v[192:195], a[112:115], a[20:23], v[192:195]
    ds_read_b128 a[0:3], v40 offset:32768
    buffer_load_dwordx4 v38, s[8:11], s78 offen offset:2048 lds
    v_mfma_f32_16x16x32_bf16 v[196:199], a[116:119], a[20:23], v[196:199]
    v_mfma_f32_16x16x32_bf16 v[196:199], a[100:103], a[16:19], v[196:199]
    ds_read_b128 a[4:7], v41 offset:32768
    buffer_load_dwordx4 v39, s[8:11], s78 offen offset:3072 lds
    v_mfma_f32_16x16x32_bf16 v[200:203], a[104:107], a[16:19], v[200:203]
    v_mfma_f32_16x16x32_bf16 v[200:203], a[120:123], a[20:23], v[200:203]
    ds_read_b128 a[8:11], v40 offset:34816
    s_add_u32 s91, s91, 512
    v_mfma_f32_16x16x32_bf16 v[204:207], a[124:127], a[20:23], v[204:207]
    s_add_u32 s85, s84, s83
    s_xor_b32 s83, s27, 24576
    v_mfma_f32_16x16x32_bf16 v[204:207], a[108:111], a[16:19], v[204:207]
    ds_read_b128 a[12:15], v41 offset:34816
    v_mfma_f32_16x16x32_bf16 v[220:223], a[108:111], a[24:27], v[220:223]
    buffer_load_dwordx4 a[32:35], v9, s[20:23], s85 offen offset:0 sc1
    v_mfma_f32_16x16x32_bf16 v[220:223], a[124:127], a[28:31], v[220:223]
    v_mfma_f32_16x16x32_bf16 v[216:219], a[120:123], a[28:31], v[216:219]
    buffer_load_dwordx4 a[36:39], v9, s[20:23], s85 offen offset:1024 sc1
    v_mfma_f32_16x16x32_bf16 v[216:219], a[104:107], a[24:27], v[216:219]
    buffer_load_dwordx4 a[40:43], v9, s[20:23], s85 offen offset:2048 sc1
    v_mfma_f32_16x16x32_bf16 v[212:215], a[100:103], a[24:27], v[212:215]
    v_mfma_f32_16x16x32_bf16 v[212:215], a[116:119], a[28:31], v[212:215]
    buffer_load_dwordx4 a[44:47], v9, s[20:23], s85 offen offset:3072 sc1
    v_mfma_f32_16x16x32_bf16 v[208:211], a[112:115], a[28:31], v[208:211]
    v_mfma_f32_16x16x32_bf16 v[208:211], a[96:99], a[24:27], v[208:211]
    s_waitcnt vmcnt(12) lgkmcnt(3)
    v_mfma_f32_16x16x32_bf16 v[128:131], a[128:131], a[0:3], v[128:131]
    s_add_u32 s85, s85, 4096
    s_waitcnt lgkmcnt(2)
    v_mfma_f32_16x16x32_bf16 v[128:131], a[144:147], a[4:7], v[128:131]
    ds_read_b128 a[16:19], v42 offset:32768
    buffer_load_dwordx4 a[48:51], v9, s[20:23], s85 offen offset:0 sc1
    v_mfma_f32_16x16x32_bf16 v[132:135], a[148:151], a[4:7], v[132:135]
    buffer_load_dwordx4 a[52:55], v9, s[20:23], s85 offen offset:1024 sc1
    v_mfma_f32_16x16x32_bf16 v[132:135], a[132:135], a[0:3], v[132:135]
    ds_read_b128 a[20:23], v43 offset:32768
    buffer_load_dwordx4 a[56:59], v9, s[20:23], s85 offen offset:2048 sc1
    v_mfma_f32_16x16x32_bf16 v[136:139], a[136:139], a[0:3], v[136:139]
    v_mfma_f32_16x16x32_bf16 v[136:139], a[152:155], a[4:7], v[136:139]
    ds_read_b128 a[24:27], v42 offset:34816
    buffer_load_dwordx4 a[60:63], v9, s[20:23], s85 offen offset:3072 sc1
    v_mfma_f32_16x16x32_bf16 v[140:143], a[156:159], a[4:7], v[140:143]
    s_add_u32 s84, s84, 32768
    v_mfma_f32_16x16x32_bf16 v[140:143], a[140:143], a[0:3], v[140:143]
    ds_read_b128 a[28:31], v43 offset:34816
    s_add_u32 m0, s89, 0
    s_add_u32 s3, s39, 0
    s_waitcnt lgkmcnt(4)
    v_mfma_f32_16x16x32_bf16 v[156:159], a[140:143], a[8:11], v[156:159]
    buffer_load_dwordx4 v24, s[12:15], s3 offen lds
    v_mfma_f32_16x16x32_bf16 v[156:159], a[156:159], a[12:15], v[156:159]
    v_mfma_f32_16x16x32_bf16 v[152:155], a[152:155], a[12:15], v[152:155]
    s_add_u32 m0, s89, 1024
    s_add_u32 s3, s39, 32768
    v_mfma_f32_16x16x32_bf16 v[152:155], a[136:139], a[8:11], v[152:155]
    buffer_load_dwordx4 v24, s[12:15], s3 offen lds
    v_mfma_f32_16x16x32_bf16 v[148:151], a[132:135], a[8:11], v[148:151]
    s_add_u32 m0, s89, 2048
    s_add_u32 s3, s39, 65536
    v_mfma_f32_16x16x32_bf16 v[148:151], a[148:151], a[12:15], v[148:151]
    buffer_load_dwordx4 v24, s[12:15], s3 offen lds
    v_mfma_f32_16x16x32_bf16 v[144:147], a[144:147], a[12:15], v[144:147]
    v_mfma_f32_16x16x32_bf16 v[144:147], a[128:131], a[8:11], v[144:147]
    s_waitcnt lgkmcnt(3)
    v_mfma_f32_16x16x32_bf16 v[192:195], a[128:131], a[16:19], v[192:195]
    s_waitcnt vmcnt(11)
    s_waitcnt lgkmcnt(0)
    s_barrier
    s_add_u32 m0, s89, 3072
    s_add_u32 s3, s39, 98304
    v_mfma_f32_16x16x32_bf16 v[192:195], a[144:147], a[20:23], v[192:195]
    ds_read_b128 a[0:3], v40 offset:49152
    v_mfma_f32_16x16x32_bf16 v[196:199], a[148:151], a[20:23], v[196:199]
    buffer_load_dwordx4 v24, s[12:15], s3 offen lds
    v_mfma_f32_16x16x32_bf16 v[196:199], a[132:135], a[16:19], v[196:199]
    ds_read_b128 a[4:7], v41 offset:49152
    v_mfma_f32_16x16x32_bf16 v[200:203], a[136:139], a[16:19], v[200:203]
    v_mfma_f32_16x16x32_bf16 v[200:203], a[152:155], a[20:23], v[200:203]
    ds_read_b128 a[8:11], v40 offset:51200
    s_add_u32 m0, s89, 4096
    v_mfma_f32_16x16x32_bf16 v[204:207], a[156:159], a[20:23], v[204:207]
    v_mfma_f32_16x16x32_bf16 v[204:207], a[140:143], a[16:19], v[204:207]
    ds_read_b128 a[12:15], v41 offset:51200
    buffer_load_dwordx4 v9, s[20:23], s88 offen offset:0 sc1 lds
    v_mfma_f32_16x16x32_bf16 v[220:223], a[140:143], a[24:27], v[220:223]
    v_mfma_f32_16x16x32_bf16 v[220:223], a[156:159], a[28:31], v[220:223]
    v_mfma_f32_16x16x32_bf16 v[216:219], a[152:155], a[28:31], v[216:219]
    buffer_load_dwordx4 v9, s[20:23], s88 offen offset:1024 sc1 lds
    v_mfma_f32_16x16x32_bf16 v[216:219], a[136:139], a[24:27], v[216:219]
    v_mfma_f32_16x16x32_bf16 v[212:215], a[132:135], a[24:27], v[212:215]
    buffer_load_dwordx4 v9, s[20:23], s88 offen offset:2048 sc1 lds
    v_mfma_f32_16x16x32_bf16 v[212:215], a[148:151], a[28:31], v[212:215]
    v_mfma_f32_16x16x32_bf16 v[208:211], a[144:147], a[28:31], v[208:211]
    v_mfma_f32_16x16x32_bf16 v[208:211], a[128:131], a[24:27], v[208:211]
    s_waitcnt vmcnt(7) lgkmcnt(3)
    v_mfma_f32_16x16x32_bf16 v[128:131], a[32:35], a[0:3], v[128:131]
    buffer_load_dwordx4 v9, s[20:23], s88 offen offset:3072 sc1 lds
    s_waitcnt lgkmcnt(2)
    v_mfma_f32_16x16x32_bf16 v[128:131], a[48:51], a[4:7], v[128:131]
    ds_read_b128 a[16:19], v42 offset:49152
    v_mfma_f32_16x16x32_bf16 v[132:135], a[52:55], a[4:7], v[132:135]
    v_mfma_f32_16x16x32_bf16 v[132:135], a[36:39], a[0:3], v[132:135]
    ds_read_b128 a[20:23], v43 offset:49152
    v_mfma_f32_16x16x32_bf16 v[136:139], a[40:43], a[0:3], v[136:139]
    v_mfma_f32_16x16x32_bf16 v[136:139], a[56:59], a[4:7], v[136:139]
    ds_read_b128 a[24:27], v42 offset:51200
    global_load_ushort v28, v30, s[44:45] offset:0
    v_mfma_f32_16x16x32_bf16 v[140:143], a[60:63], a[4:7], v[140:143]
    v_mfma_f32_16x16x32_bf16 v[140:143], a[44:47], a[0:3], v[140:143]
    ds_read_b128 a[28:31], v43 offset:51200
    s_waitcnt lgkmcnt(4)
    v_mfma_f32_16x16x32_bf16 v[156:159], a[44:47], a[8:11], v[156:159]
    v_mfma_f32_16x16x32_bf16 v[156:159], a[60:63], a[12:15], v[156:159]
    v_mfma_f32_16x16x32_bf16 v[152:155], a[56:59], a[12:15], v[152:155]
    global_load_ushort v29, v30, s[44:45] offset:32
    v_mfma_f32_16x16x32_bf16 v[152:155], a[40:43], a[8:11], v[152:155]
    v_mfma_f32_16x16x32_bf16 v[148:151], a[36:39], a[8:11], v[148:151]
    v_mfma_f32_16x16x32_bf16 v[148:151], a[52:55], a[12:15], v[148:151]
    v_mfma_f32_16x16x32_bf16 v[144:147], a[48:51], a[12:15], v[144:147]
    v_mfma_f32_16x16x32_bf16 v[144:147], a[32:35], a[8:11], v[144:147]
    s_waitcnt lgkmcnt(3)
    v_mfma_f32_16x16x32_bf16 v[192:195], a[32:35], a[16:19], v[192:195]
    s_waitcnt lgkmcnt(2)
    v_mfma_f32_16x16x32_bf16 v[192:195], a[48:51], a[20:23], v[192:195]
    ds_read_b128 a[0:3], v40 offset:4096
    v_mfma_f32_16x16x32_bf16 v[196:199], a[52:55], a[20:23], v[196:199]
    v_mfma_f32_16x16x32_bf16 v[196:199], a[36:39], a[16:19], v[196:199]
    ds_read_b128 a[4:7], v41 offset:4096
    v_mfma_f32_16x16x32_bf16 v[200:203], a[40:43], a[16:19], v[200:203]
    v_mfma_f32_16x16x32_bf16 v[200:203], a[56:59], a[20:23], v[200:203]
    ds_read_b128 a[8:11], v40 offset:6144
    v_mfma_f32_16x16x32_bf16 v[204:207], a[60:63], a[20:23], v[204:207]
    v_mfma_f32_16x16x32_bf16 v[204:207], a[44:47], a[16:19], v[204:207]
    ds_read_b128 a[12:15], v41 offset:6144
    s_waitcnt lgkmcnt(4)
    v_mfma_f32_16x16x32_bf16 v[220:223], a[44:47], a[24:27], v[220:223]
    v_mfma_f32_16x16x32_bf16 v[220:223], a[60:63], a[28:31], v[220:223]
    v_mfma_f32_16x16x32_bf16 v[216:219], a[56:59], a[28:31], v[216:219]
    v_mfma_f32_16x16x32_bf16 v[216:219], a[40:43], a[24:27], v[216:219]
    v_mfma_f32_16x16x32_bf16 v[212:215], a[36:39], a[24:27], v[212:215]
    v_mfma_f32_16x16x32_bf16 v[212:215], a[52:55], a[28:31], v[212:215]
    v_mfma_f32_16x16x32_bf16 v[208:211], a[48:51], a[28:31], v[208:211]
    v_mfma_f32_16x16x32_bf16 v[208:211], a[32:35], a[24:27], v[208:211]
    s_waitcnt lgkmcnt(3)
    v_mfma_f32_16x16x32_bf16 v[160:163], a[64:67], a[0:3], v[160:163]
    s_waitcnt lgkmcnt(2)
    v_mfma_f32_16x16x32_bf16 v[160:163], a[80:83], a[4:7], v[160:163]
    ds_read_b128 a[16:19], v42 offset:4096
    v_mfma_f32_16x16x32_bf16 v[164:167], a[84:87], a[4:7], v[164:167]
    v_mfma_f32_16x16x32_bf16 v[164:167], a[68:71], a[0:3], v[164:167]
    ds_read_b128 a[20:23], v43 offset:4096
    v_mfma_f32_16x16x32_bf16 v[168:171], a[72:75], a[0:3], v[168:171]
    v_mfma_f32_16x16x32_bf16 v[168:171], a[88:91], a[4:7], v[168:171]
    ds_read_b128 a[24:27], v42 offset:6144
    v_mfma_f32_16x16x32_bf16 v[172:175], a[92:95], a[4:7], v[172:175]
    v_mfma_f32_16x16x32_bf16 v[172:175], a[76:79], a[0:3], v[172:175]
    ds_read_b128 a[28:31], v43 offset:6144
    s_waitcnt lgkmcnt(4)
    v_mfma_f32_16x16x32_bf16 v[188:191], a[76:79], a[8:11], v[188:191]
    v_mfma_f32_16x16x32_bf16 v[188:191], a[92:95], a[12:15], v[188:191]
    v_mfma_f32_16x16x32_bf16 v[184:187], a[88:91], a[12:15], v[184:187]
    v_mfma_f32_16x16x32_bf16 v[184:187], a[72:75], a[8:11], v[184:187]
    v_mfma_f32_16x16x32_bf16 v[180:183], a[68:71], a[8:11], v[180:183]
    v_mfma_f32_16x16x32_bf16 v[180:183], a[84:87], a[12:15], v[180:183]
    v_mfma_f32_16x16x32_bf16 v[176:179], a[80:83], a[12:15], v[176:179]
    v_mfma_f32_16x16x32_bf16 v[176:179], a[64:67], a[8:11], v[176:179]
    s_waitcnt lgkmcnt(3)
    v_mfma_f32_16x16x32_bf16 v[224:227], a[64:67], a[16:19], v[224:227]
    s_waitcnt lgkmcnt(2)
    v_mfma_f32_16x16x32_bf16 v[224:227], a[80:83], a[20:23], v[224:227]
    ds_read_b128 a[0:3], v40 offset:20480
    s_waitcnt lgkmcnt(0)
    s_barrier
    v_mfma_f32_16x16x32_bf16 v[228:231], a[84:87], a[20:23], v[228:231]
    ds_write_b128 v20, v[192:195] offset:0
    v_mfma_f32_16x16x32_bf16 v[228:231], a[68:71], a[16:19], v[228:231]
    ds_read_b128 a[4:7], v41 offset:20480
    v_mfma_f32_16x16x32_bf16 v[232:235], a[72:75], a[16:19], v[232:235]
    ds_write_b128 v20, v[196:199] offset:1024
    v_mfma_f32_16x16x32_bf16 v[232:235], a[88:91], a[20:23], v[232:235]
    ds_read_b128 a[8:11], v40 offset:22528
    v_mfma_f32_16x16x32_bf16 v[236:239], a[92:95], a[20:23], v[236:239]
    ds_write_b128 v20, v[200:203] offset:2048
    v_mfma_f32_16x16x32_bf16 v[236:239], a[76:79], a[16:19], v[236:239]
    ds_read_b128 a[12:15], v41 offset:22528
    v_mfma_f32_16x16x32_bf16 v[252:255], a[76:79], a[24:27], v[252:255]
    ds_write_b128 v20, v[204:207] offset:3072
    v_mfma_f32_16x16x32_bf16 v[252:255], a[92:95], a[28:31], v[252:255]
    v_mfma_f32_16x16x32_bf16 v[248:251], a[88:91], a[28:31], v[248:251]
    ds_write_b128 v20, v[208:211] offset:4096
    v_mfma_f32_16x16x32_bf16 v[248:251], a[72:75], a[24:27], v[248:251]
    v_mfma_f32_16x16x32_bf16 v[244:247], a[68:71], a[24:27], v[244:247]
    ds_write_b128 v20, v[212:215] offset:5120
    v_mfma_f32_16x16x32_bf16 v[244:247], a[84:87], a[28:31], v[244:247]
    v_mfma_f32_16x16x32_bf16 v[240:243], a[80:83], a[28:31], v[240:243]
    ds_write_b128 v20, v[216:219] offset:6144
    v_mfma_f32_16x16x32_bf16 v[240:243], a[64:67], a[24:27], v[240:243]
    v_mfma_f32_16x16x32_bf16 v[160:163], a[96:99], a[0:3], v[160:163]
    ds_write_b128 v20, v[220:223] offset:7168
    s_waitcnt lgkmcnt(4)
    v_mfma_f32_16x16x32_bf16 v[160:163], a[112:115], a[4:7], v[160:163]
    ds_read_b128 a[16:19], v42 offset:20480
    v_mfma_f32_16x16x32_bf16 v[164:167], a[116:119], a[4:7], v[164:167]
    v_mfma_f32_16x16x32_bf16 v[164:167], a[100:103], a[0:3], v[164:167]
    ds_read_b128 a[20:23], v43 offset:20480
    v_mfma_f32_16x16x32_bf16 v[168:171], a[104:107], a[0:3], v[168:171]
    s_waitcnt lgkmcnt(0)
    s_barrier
    v_mfma_f32_16x16x32_bf16 v[168:171], a[120:123], a[4:7], v[168:171]
    ds_read_b128 a[24:27], v42 offset:22528
    ds_read_b128 v[192:195], v21 offset:0
    v_mfma_f32_16x16x32_bf16 v[172:175], a[124:127], a[4:7], v[172:175]
    ds_read_b128 v[196:199], v21 offset:1024
    v_mfma_f32_16x16x32_bf16 v[172:175], a[108:111], a[0:3], v[172:175]
    ds_read_b128 a[28:31], v43 offset:22528
    ds_read_b128 v[200:203], v21 offset:2048
    v_mfma_f32_16x16x32_bf16 v[188:191], a[108:111], a[8:11], v[188:191]
    ds_read_b128 v[204:207], v21 offset:3072
    v_mfma_f32_16x16x32_bf16 v[188:191], a[124:127], a[12:15], v[188:191]
    ds_read_b128 v[208:211], v21 offset:4096
    v_mfma_f32_16x16x32_bf16 v[184:187], a[120:123], a[12:15], v[184:187]
    ds_read_b128 v[212:215], v21 offset:5120
    v_mfma_f32_16x16x32_bf16 v[184:187], a[104:107], a[8:11], v[184:187]
    ds_read_b128 v[216:219], v21 offset:6144
    v_mfma_f32_16x16x32_bf16 v[180:183], a[100:103], a[8:11], v[180:183]
    ds_read_b128 v[220:223], v21 offset:7168
    v_mfma_f32_16x16x32_bf16 v[180:183], a[116:119], a[12:15], v[180:183]
    v_mfma_f32_16x16x32_bf16 v[176:179], a[112:115], a[12:15], v[176:179]
    v_mfma_f32_16x16x32_bf16 v[176:179], a[96:99], a[8:11], v[176:179]
    v_mfma_f32_16x16x32_bf16 v[224:227], a[96:99], a[16:19], v[224:227]
    s_waitcnt lgkmcnt(4)
    v_sub_f32 v128, v128, v192
    v_sub_f32 v129, v129, v193
    v_sub_f32 v130, v130, v194
    v_sub_f32 v131, v131, v195
    v_mul_f32 v128, s40, v128
    v_mul_f32 v129, s40, v129
    v_mul_f32 v130, s40, v130
    v_mul_f32_e64 v131, s40, v131
    v_mfma_f32_16x16x32_bf16 v[224:227], a[112:115], a[20:23], v[224:227]
    ds_read_b128 a[0:3], v40 offset:36864
    buffer_store_dwordx4 v[128:131], v9, s[20:23], s87 offen offset:0 sc1
    v_mfma_f32_16x16x32_bf16 v[228:231], a[116:119], a[20:23], v[228:231]
    v_mfma_f32_16x16x32_bf16 v[228:231], a[100:103], a[16:19], v[228:231]
    ds_read_b128 a[4:7], v41 offset:36864
    v_sub_f32 v132, v132, v196
    v_sub_f32 v133, v133, v197
    v_sub_f32 v134, v134, v198
    v_sub_f32 v135, v135, v199
    v_mul_f32 v132, s40, v132
    v_mul_f32 v133, s40, v133
    v_mul_f32 v134, s40, v134
    v_mul_f32 v135, s40, v135
    v_mfma_f32_16x16x32_bf16 v[232:235], a[104:107], a[16:19], v[232:235]
    buffer_store_dwordx4 v[132:135], v9, s[20:23], s87 offen offset:1024 sc1
    v_mfma_f32_16x16x32_bf16 v[232:235], a[120:123], a[20:23], v[232:235]
    ds_read_b128 a[8:11], v40 offset:38912
    v_mfma_f32_16x16x32_bf16 v[236:239], a[124:127], a[20:23], v[236:239]
    v_sub_f32 v136, v136, v200
    v_sub_f32 v137, v137, v201
    v_sub_f32 v138, v138, v202
    v_sub_f32 v139, v139, v203
    v_mul_f32 v136, s40, v136
    v_mul_f32 v137, s40, v137
    v_mul_f32 v138, s40, v138
    v_mul_f32 v139, s40, v139
    v_mfma_f32_16x16x32_bf16 v[236:239], a[108:111], a[16:19], v[236:239]
    ds_read_b128 a[12:15], v41 offset:38912
    buffer_store_dwordx4 v[136:139], v9, s[20:23], s87 offen offset:2048 sc1
    v_mfma_f32_16x16x32_bf16 v[252:255], a[108:111], a[24:27], v[252:255]
    v_mfma_f32_16x16x32_bf16 v[252:255], a[124:127], a[28:31], v[252:255]
    v_sub_f32 v140, v140, v204
    v_sub_f32 v141, v141, v205
    v_sub_f32 v142, v142, v206
    v_sub_f32 v143, v143, v207
    v_mul_f32 v140, s40, v140
    v_mul_f32 v141, s40, v141
    v_mul_f32 v142, s40, v142
    v_mul_f32 v143, s40, v143
    v_mfma_f32_16x16x32_bf16 v[248:251], a[120:123], a[28:31], v[248:251]
    buffer_store_dwordx4 v[140:143], v9, s[20:23], s87 offen offset:3072 sc1
    v_mfma_f32_16x16x32_bf16 v[248:251], a[104:107], a[24:27], v[248:251]
    v_mfma_f32_16x16x32_bf16 v[244:247], a[100:103], a[24:27], v[244:247]
    s_waitcnt lgkmcnt(4)
    v_sub_f32 v144, v144, v208
    v_sub_f32 v145, v145, v209
    v_sub_f32 v146, v146, v210
    v_sub_f32 v147, v147, v211
    v_mul_f32 v144, s40, v144
    v_mul_f32 v145, s40, v145
    v_mul_f32 v146, s40, v146
    v_mul_f32_e64 v147, s40, v147
    v_mfma_f32_16x16x32_bf16 v[244:247], a[116:119], a[28:31], v[244:247]
    buffer_store_dwordx4 v[144:147], v9, s[20:23], s43 offen offset:0 sc1
    v_mfma_f32_16x16x32_bf16 v[240:243], a[112:115], a[28:31], v[240:243]
    v_mfma_f32_16x16x32_bf16 v[240:243], a[96:99], a[24:27], v[240:243]
    v_sub_f32 v148, v148, v212
    v_sub_f32 v149, v149, v213
    v_sub_f32 v150, v150, v214
    v_sub_f32 v151, v151, v215
    v_mul_f32 v148, s40, v148
    v_mul_f32 v149, s40, v149
    v_mul_f32 v150, s40, v150
    v_mul_f32_e64 v151, s40, v151
    s_waitcnt lgkmcnt(3)
    v_mfma_f32_16x16x32_bf16 v[160:163], a[128:131], a[0:3], v[160:163]
    buffer_store_dwordx4 v[148:151], v9, s[20:23], s43 offen offset:1024 sc1
    s_waitcnt lgkmcnt(2)
    v_mfma_f32_16x16x32_bf16 v[160:163], a[144:147], a[4:7], v[160:163]
    ds_read_b128 a[16:19], v42 offset:36864
    v_mfma_f32_16x16x32_bf16 v[164:167], a[148:151], a[4:7], v[164:167]
    v_sub_f32 v152, v152, v216
    v_sub_f32 v153, v153, v217
    v_sub_f32 v154, v154, v218
    v_sub_f32 v155, v155, v219
    v_mul_f32 v152, s40, v152
    v_mul_f32 v153, s40, v153
    v_mul_f32 v154, s40, v154
    v_mul_f32_e64 v155, s40, v155
    v_mfma_f32_16x16x32_bf16 v[164:167], a[132:135], a[0:3], v[164:167]
    ds_read_b128 a[20:23], v43 offset:36864
    buffer_store_dwordx4 v[152:155], v9, s[20:23], s43 offen offset:2048 sc1
    v_mfma_f32_16x16x32_bf16 v[168:171], a[136:139], a[0:3], v[168:171]
    v_mfma_f32_16x16x32_bf16 v[168:171], a[152:155], a[4:7], v[168:171]
    ds_read_b128 a[24:27], v42 offset:38912
    v_sub_f32 v156, v156, v220
    v_sub_f32 v157, v157, v221
    v_sub_f32 v158, v158, v222
    v_sub_f32 v159, v159, v223
    v_mul_f32 v156, s40, v156
    v_mul_f32 v157, s40, v157
    v_mul_f32 v158, s40, v158
    v_mul_f32 v159, s40, v159
    v_mfma_f32_16x16x32_bf16 v[172:175], a[156:159], a[4:7], v[172:175]
    buffer_store_dwordx4 v[156:159], v9, s[20:23], s43 offen offset:3072 sc1
    v_mfma_f32_16x16x32_bf16 v[172:175], a[140:143], a[0:3], v[172:175]
    ds_read_b128 a[28:31], v43 offset:38912
    s_waitcnt lgkmcnt(4)
    v_mfma_f32_16x16x32_bf16 v[188:191], a[140:143], a[8:11], v[188:191]
    s_waitcnt lgkmcnt(0)
    s_barrier
    v_mfma_f32_16x16x32_bf16 v[188:191], a[156:159], a[12:15], v[188:191]
    v_mfma_f32_16x16x32_bf16 v[184:187], a[152:155], a[12:15], v[184:187]
    s_waitcnt vmcnt(10)
    ds_read_b64_tr_b16 v[48:49], v22 offset:4096
    v_mfma_f32_16x16x32_bf16 v[184:187], a[136:139], a[8:11], v[184:187]
    ds_read_b64_tr_b16 v[50:51], v22 offset:5120
    v_mfma_f32_16x16x32_bf16 v[180:183], a[132:135], a[8:11], v[180:183]
    ds_read_b64_tr_b16 v[52:53], v22 offset:6144
    v_mfma_f32_16x16x32_bf16 v[180:183], a[148:151], a[12:15], v[180:183]
    ds_read_b64_tr_b16 v[54:55], v22 offset:7168
    v_mfma_f32_16x16x32_bf16 v[176:179], a[144:147], a[12:15], v[176:179]
    ds_read_b64_tr_b16 v[56:57], v22 offset:4608
    v_mfma_f32_16x16x32_bf16 v[176:179], a[128:131], a[8:11], v[176:179]
    ds_read_b64_tr_b16 v[58:59], v22 offset:5632
    v_mfma_f32_16x16x32_bf16 v[224:227], a[128:131], a[16:19], v[224:227]
    ds_read_b64_tr_b16 v[60:61], v22 offset:6656
    v_mfma_f32_16x16x32_bf16 v[224:227], a[144:147], a[20:23], v[224:227]
    ds_read_b128 a[0:3], v40 offset:53248
    ds_read_b64_tr_b16 v[62:63], v22 offset:7680
    v_mfma_f32_16x16x32_bf16 v[228:231], a[148:151], a[20:23], v[228:231]
    v_mfma_f32_16x16x32_bf16 v[228:231], a[132:135], a[16:19], v[228:231]
    ds_read_b128 a[4:7], v41 offset:53248
    v_mfma_f32_16x16x32_bf16 v[232:235], a[136:139], a[16:19], v[232:235]
    v_mfma_f32_16x16x32_bf16 v[232:235], a[152:155], a[20:23], v[232:235]
    ds_read_b128 a[8:11], v40 offset:55296
    v_mfma_f32_16x16x32_bf16 v[236:239], a[156:159], a[20:23], v[236:239]
    v_mfma_f32_16x16x32_bf16 v[236:239], a[140:143], a[16:19], v[236:239]
    ds_read_b128 a[12:15], v41 offset:55296
    v_mfma_f32_16x16x32_bf16 v[252:255], a[140:143], a[24:27], v[252:255]
    v_mfma_f32_16x16x32_bf16 v[252:255], a[156:159], a[28:31], v[252:255]
    v_mfma_f32_16x16x32_bf16 v[248:251], a[152:155], a[28:31], v[248:251]
    v_mfma_f32_16x16x32_bf16 v[248:251], a[136:139], a[24:27], v[248:251]
    v_mfma_f32_16x16x32_bf16 v[244:247], a[132:135], a[24:27], v[244:247]
    v_mfma_f32_16x16x32_bf16 v[244:247], a[148:151], a[28:31], v[244:247]
    v_mfma_f32_16x16x32_bf16 v[240:243], a[144:147], a[28:31], v[240:243]
    v_mfma_f32_16x16x32_bf16 v[240:243], a[128:131], a[24:27], v[240:243]
    s_waitcnt lgkmcnt(4)
    v_mfma_f32_16x16x32_bf16 v[160:163], a[32:35], a[0:3], v[160:163]
    s_waitcnt lgkmcnt(2)
    v_mfma_f32_16x16x32_bf16 v[160:163], a[48:51], a[4:7], v[160:163]
    ds_read_b128 a[16:19], v42 offset:53248
    v_mfma_f32_16x16x32_bf16 v[164:167], a[52:55], a[4:7], v[164:167]
    v_mfma_f32_16x16x32_bf16 v[164:167], a[36:39], a[0:3], v[164:167]
    ds_read_b128 a[20:23], v43 offset:53248
    v_mfma_f32_16x16x32_bf16 v[168:171], a[40:43], a[0:3], v[168:171]
    v_mfma_f32_16x16x32_bf16 v[168:171], a[56:59], a[4:7], v[168:171]
    ds_read_b128 a[24:27], v42 offset:55296
    v_mfma_f32_16x16x32_bf16 v[172:175], a[60:63], a[4:7], v[172:175]
    v_mfma_f32_16x16x32_bf16 v[172:175], a[44:47], a[0:3], v[172:175]
    ds_read_b128 a[28:31], v43 offset:55296
    s_waitcnt lgkmcnt(4)
    v_mfma_f32_16x16x32_bf16 v[188:191], a[44:47], a[8:11], v[188:191]
    v_mfma_f32_16x16x32_bf16 v[188:191], a[60:63], a[12:15], v[188:191]
    v_mfma_f32_16x16x32_bf16 v[184:187], a[56:59], a[12:15], v[184:187]
    v_mfma_f32_16x16x32_bf16 v[184:187], a[40:43], a[8:11], v[184:187]
    v_mfma_f32_16x16x32_bf16 v[180:183], a[36:39], a[8:11], v[180:183]
    v_mfma_f32_16x16x32_bf16 v[180:183], a[52:55], a[12:15], v[180:183]
    v_mfma_f32_16x16x32_bf16 v[176:179], a[48:51], a[12:15], v[176:179]
    v_mfma_f32_16x16x32_bf16 v[176:179], a[32:35], a[8:11], v[176:179]
    s_waitcnt lgkmcnt(3)
    v_mfma_f32_16x16x32_bf16 v[224:227], a[32:35], a[16:19], v[224:227]
    s_waitcnt lgkmcnt(2)
    v_mfma_f32_16x16x32_bf16 v[224:227], a[48:51], a[20:23], v[224:227]
    ds_read_b64_tr_b16 v[32:33], v25 offset:0
    v_mfma_f32_16x16x32_bf16 v[228:231], a[52:55], a[20:23], v[228:231]
    ds_read_b64_tr_b16 v[34:35], v25 offset:256
    v_mfma_f32_16x16x32_bf16 v[228:231], a[36:39], a[16:19], v[228:231]
    ds_read_b64_tr_b16 v[36:37], v25 offset:512
    v_mfma_f32_16x16x32_bf16 v[232:235], a[40:43], a[16:19], v[232:235]
    ds_read_b64_tr_b16 v[38:39], v25 offset:768
    v_mfma_f32_16x16x32_bf16 v[232:235], a[56:59], a[20:23], v[232:235]
    ds_read_b64_tr_b16 v[40:41], v25 offset:32
    v_mfma_f32_16x16x32_bf16 v[236:239], a[60:63], a[20:23], v[236:239]
    ds_read_b64_tr_b16 v[42:43], v25 offset:288
    v_mfma_f32_16x16x32_bf16 v[236:239], a[44:47], a[16:19], v[236:239]
    ds_read_b64_tr_b16 v[44:45], v25 offset:544
    s_waitcnt lgkmcnt(4)
    v_mfma_f32_16x16x32_bf16 v[252:255], a[44:47], a[24:27], v[252:255]
    ds_read_b64_tr_b16 v[46:47], v25 offset:800
    v_mfma_f32_16x16x32_bf16 v[252:255], a[60:63], a[28:31], v[252:255]
    v_mfma_f32_16x16x32_bf16 v[248:251], a[56:59], a[28:31], v[248:251]
    v_mfma_f32_16x16x32_bf16 v[248:251], a[40:43], a[24:27], v[248:251]
    v_mfma_f32_16x16x32_bf16 v[244:247], a[36:39], a[24:27], v[244:247]
    v_mfma_f32_16x16x32_bf16 v[244:247], a[52:55], a[28:31], v[244:247]
    v_mfma_f32_16x16x32_bf16 v[240:243], a[48:51], a[28:31], v[240:243]
    v_mfma_f32_16x16x32_bf16 v[240:243], a[32:35], a[24:27], v[240:243]
L_k3_epissm:
    v_add_u32 v2, 16384, v20
    v_add_u32 v3, 16384, v21
    s_mov_b32 s12, s46
    s_mov_b32 s13, s47
    s_mov_b32 s14, 8388608
    s_mov_b32 s15, 0x00020000
    s_lshl_b32 s60, s39, 1
    s_mov_b32 s4, 0xbfb8aa3b
    s_mov_b32 s5, s4
    ds_write_b128 v2, v[224:227] offset:0
    ds_write_b128 v2, v[228:231] offset:1024
    ds_write_b128 v2, v[232:235] offset:2048
    ds_write_b128 v2, v[236:239] offset:3072
    ds_write_b128 v2, v[240:243] offset:4096
    ds_write_b128 v2, v[244:247] offset:5120
    ds_write_b128 v2, v[248:251] offset:6144
    ds_write_b128 v2, v[252:255] offset:7168
    s_waitcnt vmcnt(0)
    buffer_store_dwordx2 a[248:249], off, s[20:23], s86 sc1
    s_waitcnt lgkmcnt(0)
    s_barrier
    ds_read_b128 v[224:227], v3 offset:0
    ds_read_b128 v[228:231], v3 offset:1024
    ds_read_b128 v[232:235], v3 offset:2048
    ds_read_b128 v[236:239], v3 offset:3072
    ds_read_b128 v[240:243], v3 offset:4096
    ds_read_b128 v[244:247], v3 offset:5120
    ds_read_b128 v[248:251], v3 offset:6144
    ds_read_b128 v[252:255], v3 offset:7168
    s_add_u32 s68, s60, 0
    s_add_u32 s69, s60, 4096
    s_add_u32 s70, s60, 8192
    s_add_u32 s71, s60, 12288
    s_add_u32 s72, s60, 16384
    s_add_u32 s73, s60, 20480
    s_add_u32 s74, s60, 24576
    s_add_u32 s75, s60, 28672
    s_add_u32 s76, s60, 32768
    s_add_u32 s77, s60, 36864
    s_add_u32 s78, s60, 40960
    s_add_u32 s79, s60, 45056
    s_add_u32 s80, s60, 49152
    s_add_u32 s81, s60, 53248
    s_add_u32 s82, s60, 57344
    s_add_u32 s83, s60, 61440
    v_lshlrev_b32 v10, 16, v28
    v_lshlrev_b32 v12, 16, v29
    v_lshlrev_b32_e64 v128, 16, v48
    v_and_b32 v129, 0xffff0000, v48
    v_lshlrev_b32_e64 v130, 16, v49
    v_and_b32 v131, 0xffff0000, v49
    v_pk_mul_f32 v[128:129], v[128:129], v[10:11] op_sel_hi:[1,0]
    v_pk_mul_f32 v[130:131], v[130:131], v[10:11] op_sel_hi:[1,0]
    v_cvt_pk_bf16_f32 v48, v128, v129
    v_cvt_pk_bf16_f32 v49, v130, v131
    v_lshlrev_b32_e64 v128, 16, v48
    v_and_b32 v129, 0xffff0000, v48
    v_lshlrev_b32_e64 v130, 16, v49
    v_and_b32 v131, 0xffff0000, v49
    v_lshlrev_b32_e64 v192, 16, v32
    v_and_b32 v193, 0xffff0000, v32
    v_lshlrev_b32_e64 v194, 16, v33
    v_and_b32 v195, 0xffff0000, v33
    v_lshlrev_b32_e64 v132, 16, v50
    v_and_b32 v133, 0xffff0000, v50
    v_lshlrev_b32_e64 v134, 16, v51
    v_and_b32 v135, 0xffff0000, v51
    v_pk_mul_f32 v[132:133], v[132:133], v[10:11] op_sel_hi:[1,0]
    v_pk_mul_f32 v[134:135], v[134:135], v[10:11] op_sel_hi:[1,0]
    v_cvt_pk_bf16_f32 v50, v132, v133
    v_cvt_pk_bf16_f32 v51, v134, v135
    v_lshlrev_b32_e64 v132, 16, v50
    v_and_b32 v133, 0xffff0000, v50
    v_lshlrev_b32_e64 v134, 16, v51
    v_and_b32 v135, 0xffff0000, v51
    v_lshlrev_b32_e64 v196, 16, v34
    v_and_b32 v197, 0xffff0000, v34
    v_lshlrev_b32_e64 v198, 16, v35
    v_and_b32 v199, 0xffff0000, v35
    v_lshlrev_b32_e64 v136, 16, v52
    v_and_b32 v137, 0xffff0000, v52
    v_lshlrev_b32_e64 v138, 16, v53
    v_and_b32 v139, 0xffff0000, v53
    v_pk_mul_f32 v[136:137], v[136:137], v[10:11] op_sel_hi:[1,0]
    v_pk_mul_f32 v[138:139], v[138:139], v[10:11] op_sel_hi:[1,0]
    v_cvt_pk_bf16_f32 v52, v136, v137
    v_cvt_pk_bf16_f32 v53, v138, v139
    v_lshlrev_b32_e64 v136, 16, v52
    v_and_b32 v137, 0xffff0000, v52
    v_lshlrev_b32_e64 v138, 16, v53
    v_and_b32 v139, 0xffff0000, v53
    v_lshlrev_b32_e64 v200, 16, v36
    v_and_b32 v201, 0xffff0000, v36
    v_lshlrev_b32_e64 v202, 16, v37
    v_and_b32 v203, 0xffff0000, v37
    v_lshlrev_b32_e64 v140, 16, v54
    v_and_b32 v141, 0xffff0000, v54
    v_lshlrev_b32_e64 v142, 16, v55
    v_and_b32 v143, 0xffff0000, v55
    v_pk_mul_f32 v[140:141], v[140:141], v[10:11] op_sel_hi:[1,0]
    v_pk_mul_f32 v[142:143], v[142:143], v[10:11] op_sel_hi:[1,0]
    v_cvt_pk_bf16_f32 v54, v140, v141
    v_cvt_pk_bf16_f32 v55, v142, v143
    v_lshlrev_b32_e64 v140, 16, v54
    v_and_b32 v141, 0xffff0000, v54
    v_lshlrev_b32_e64 v142, 16, v55
    v_and_b32 v143, 0xffff0000, v55
    v_lshlrev_b32_e64 v204, 16, v38
    v_and_b32 v205, 0xffff0000, v38
    v_lshlrev_b32_e64 v206, 16, v39
    v_and_b32 v207, 0xffff0000, v39
    buffer_load_dwordx2 v[26:27], off, s[20:23], s67 sc1
    v_lshlrev_b32_e64 v144, 16, v56
    v_and_b32 v145, 0xffff0000, v56
    v_lshlrev_b32_e64 v146, 16, v57
    v_and_b32 v147, 0xffff0000, v57
    v_pk_mul_f32 v[144:145], v[144:145], v[12:13] op_sel_hi:[1,0]
    v_pk_mul_f32 v[146:147], v[146:147], v[12:13] op_sel_hi:[1,0]
    v_cvt_pk_bf16_f32 v56, v144, v145
    v_cvt_pk_bf16_f32 v57, v146, v147
    v_lshlrev_b32_e64 v144, 16, v56
    v_and_b32 v145, 0xffff0000, v56
    v_lshlrev_b32_e64 v146, 16, v57
    v_and_b32 v147, 0xffff0000, v57
    v_lshlrev_b32_e64 v208, 16, v40
    v_and_b32 v209, 0xffff0000, v40
    v_lshlrev_b32_e64 v210, 16, v41
    v_and_b32 v211, 0xffff0000, v41
    v_lshlrev_b32_e64 v148, 16, v58
    v_and_b32 v149, 0xffff0000, v58
    v_lshlrev_b32_e64 v150, 16, v59
    v_and_b32 v151, 0xffff0000, v59
    v_pk_mul_f32 v[148:149], v[148:149], v[12:13] op_sel_hi:[1,0]
    v_pk_mul_f32 v[150:151], v[150:151], v[12:13] op_sel_hi:[1,0]
    v_cvt_pk_bf16_f32 v58, v148, v149
    v_cvt_pk_bf16_f32 v59, v150, v151
    v_lshlrev_b32_e64 v148, 16, v58
    v_and_b32 v149, 0xffff0000, v58
    v_lshlrev_b32_e64 v150, 16, v59
    v_and_b32 v151, 0xffff0000, v59
    v_lshlrev_b32_e64 v212, 16, v42
    v_and_b32 v213, 0xffff0000, v42
    v_lshlrev_b32_e64 v214, 16, v43
    v_and_b32 v215, 0xffff0000, v43
    v_lshlrev_b32_e64 v152, 16, v60
    v_and_b32 v153, 0xffff0000, v60
    v_lshlrev_b32_e64 v154, 16, v61
    v_and_b32 v155, 0xffff0000, v61
    v_pk_mul_f32 v[152:153], v[152:153], v[12:13] op_sel_hi:[1,0]
    v_pk_mul_f32 v[154:155], v[154:155], v[12:13] op_sel_hi:[1,0]
    v_cvt_pk_bf16_f32 v60, v152, v153
    v_cvt_pk_bf16_f32 v61, v154, v155
    v_lshlrev_b32_e64 v152, 16, v60
    v_and_b32 v153, 0xffff0000, v60
    v_lshlrev_b32_e64 v154, 16, v61
    v_and_b32 v155, 0xffff0000, v61
    v_lshlrev_b32_e64 v216, 16, v44
    v_and_b32 v217, 0xffff0000, v44
    v_lshlrev_b32_e64 v218, 16, v45
    v_and_b32 v219, 0xffff0000, v45
    v_lshlrev_b32_e64 v156, 16, v62
    v_and_b32 v157, 0xffff0000, v62
    v_lshlrev_b32_e64 v158, 16, v63
    v_and_b32 v159, 0xffff0000, v63
    v_pk_mul_f32 v[156:157], v[156:157], v[12:13] op_sel_hi:[1,0]
    v_pk_mul_f32 v[158:159], v[158:159], v[12:13] op_sel_hi:[1,0]
    v_cvt_pk_bf16_f32 v62, v156, v157
    v_cvt_pk_bf16_f32 v63, v158, v159
    v_lshlrev_b32_e64 v156, 16, v62
    v_and_b32 v157, 0xffff0000, v62
    v_lshlrev_b32_e64 v158, 16, v63
    v_and_b32 v159, 0xffff0000, v63
    v_lshlrev_b32_e64 v220, 16, v46
    v_and_b32 v221, 0xffff0000, v46
    v_lshlrev_b32_e64 v222, 16, v47
    v_and_b32 v223, 0xffff0000, v47
    s_waitcnt lgkmcnt(0)
    v_pk_add_f32 v[160:161], v[160:161], v[224:225] neg_lo:[0,1] neg_hi:[0,1]
    v_pk_add_f32 v[162:163], v[162:163], v[226:227] neg_lo:[0,1] neg_hi:[0,1]
    v_pk_mul_f32 v[160:161], v[160:161], s[40:41]
    v_pk_mul_f32 v[162:163], v[162:163], s[40:41]
    v_pk_add_f32 v[160:161], v[160:161], v[128:129]
    v_pk_add_f32 v[162:163], v[162:163], v[130:131]
    v_pk_add_f32 v[164:165], v[164:165], v[228:229] neg_lo:[0,1] neg_hi:[0,1]
    v_pk_add_f32 v[166:167], v[166:167], v[230:231] neg_lo:[0,1] neg_hi:[0,1]
    v_pk_mul_f32 v[164:165], v[164:165], s[40:41]
    v_pk_mul_f32 v[166:167], v[166:167], s[40:41]
    v_pk_add_f32 v[164:165], v[164:165], v[132:133]
    v_pk_add_f32 v[166:167], v[166:167], v[134:135]
    v_pk_add_f32 v[168:169], v[168:169], v[232:233] neg_lo:[0,1] neg_hi:[0,1]
    v_pk_add_f32 v[170:171], v[170:171], v[234:235] neg_lo:[0,1] neg_hi:[0,1]
    v_pk_mul_f32 v[168:169], v[168:169], s[40:41]
    v_pk_mul_f32 v[170:171], v[170:171], s[40:41]
    v_pk_add_f32 v[168:169], v[168:169], v[136:137]
    v_pk_add_f32 v[170:171], v[170:171], v[138:139]
    v_pk_add_f32 v[172:173], v[172:173], v[236:237] neg_lo:[0,1] neg_hi:[0,1]
    v_pk_add_f32 v[174:175], v[174:175], v[238:239] neg_lo:[0,1] neg_hi:[0,1]
    v_pk_mul_f32 v[172:173], v[172:173], s[40:41]
    v_pk_mul_f32 v[174:175], v[174:175], s[40:41]
    v_pk_add_f32 v[172:173], v[172:173], v[140:141]
    v_pk_add_f32 v[174:175], v[174:175], v[142:143]
    v_pk_add_f32 v[176:177], v[176:177], v[240:241] neg_lo:[0,1] neg_hi:[0,1]
    v_pk_add_f32 v[178:179], v[178:179], v[242:243] neg_lo:[0,1] neg_hi:[0,1]
    v_pk_mul_f32 v[176:177], v[176:177], s[40:41]
    v_pk_mul_f32 v[178:179], v[178:179], s[40:41]
    v_pk_add_f32 v[176:177], v[176:177], v[144:145]
    v_pk_add_f32 v[178:179], v[178:179], v[146:147]
    v_pk_add_f32 v[180:181], v[180:181], v[244:245] neg_lo:[0,1] neg_hi:[0,1]
    v_pk_add_f32 v[182:183], v[182:183], v[246:247] neg_lo:[0,1] neg_hi:[0,1]
    v_pk_mul_f32 v[180:181], v[180:181], s[40:41]
    v_pk_mul_f32 v[182:183], v[182:183], s[40:41]
    v_pk_add_f32 v[180:181], v[180:181], v[148:149]
    v_pk_add_f32 v[182:183], v[182:183], v[150:151]
    v_pk_add_f32 v[184:185], v[184:185], v[248:249] neg_lo:[0,1] neg_hi:[0,1]
    v_pk_add_f32 v[186:187], v[186:187], v[250:251] neg_lo:[0,1] neg_hi:[0,1]
    v_pk_mul_f32 v[184:185], v[184:185], s[40:41]
    v_pk_mul_f32 v[186:187], v[186:187], s[40:41]
    v_pk_add_f32 v[184:185], v[184:185], v[152:153]
    v_pk_add_f32 v[186:187], v[186:187], v[154:155]
    v_pk_add_f32 v[188:189], v[188:189], v[252:253] neg_lo:[0,1] neg_hi:[0,1]
    v_pk_add_f32 v[190:191], v[190:191], v[254:255] neg_lo:[0,1] neg_hi:[0,1]
    v_pk_mul_f32 v[188:189], v[188:189], s[40:41]
    v_pk_mul_f32 v[190:191], v[190:191], s[40:41]
    v_pk_add_f32 v[188:189], v[188:189], v[156:157]
    v_pk_add_f32 v[190:191], v[190:191], v[158:159]
    s_mov_b32 s55, 0x40000
    s_waitcnt vmcnt(0)
L_wrssm:
    v_cmp_ne_u64 vcc, s[48:49], v[26:27]
    s_cbranch_vccz L_grssm
    s_sleep 1
    buffer_load_dwordx2 v[26:27], off, s[20:23], s67 sc1
    s_waitcnt vmcnt(0)
    s_sub_u32 s55, s55, 1
    s_cmp_lg_u32 s55, 0
    s_cbranch_scc1 L_wrssm
L_grssm:
    buffer_load_dwordx4 v[64:67], v9, s[20:23], s42 offen offset:0 sc1
    buffer_load_dwordx4 v[68:71], v9, s[20:23], s42 offen offset:1024 sc1
    buffer_load_dwordx4 v[72:75], v9, s[20:23], s42 offen offset:2048 sc1
    buffer_load_dwordx4 v[76:79], v9, s[20:23], s42 offen offset:3072 sc1
    buffer_load_dwordx4 v[80:83], v9, s[20:23], s54 offen offset:0 sc1
    buffer_load_dwordx4 v[84:87], v9, s[20:23], s54 offen offset:1024 sc1
    buffer_load_dwordx4 v[88:91], v9, s[20:23], s54 offen offset:2048 sc1
    buffer_load_dwordx4 v[92:95], v9, s[20:23], s54 offen offset:3072 sc1
    s_waitcnt vmcnt(7)
    v_pk_add_f32 v[64:65], v[64:65], v[96:97]
    v_pk_add_f32 v[66:67], v[66:67], v[98:99]
    v_pk_mul_f32 v[224:225], v[64:65], s[4:5]
    v_pk_mul_f32 v[226:227], v[66:67], s[4:5]
    v_exp_f32 v224, v224
    v_exp_f32 v225, v225
    v_exp_f32 v226, v226
    v_exp_f32_e64 v227, v227
    s_nop 0
    v_pk_add_f32 v[224:225], v[224:225], 1.0 op_sel_hi:[1,0]
    v_pk_add_f32 v[226:227], v[226:227], 1.0 op_sel_hi:[1,0]
    v_rcp_f32 v224, v224
    v_rcp_f32 v225, v225
    v_rcp_f32 v226, v226
    v_rcp_f32_e64 v227, v227
    s_nop 0
    v_pk_mul_f32 v[64:65], v[64:65], v[224:225]
    v_pk_mul_f32 v[66:67], v[66:67], v[226:227]
    v_pk_fma_f32 v[192:193], v[160:161], v[64:65], v[192:193]
    v_pk_fma_f32 v[194:195], v[162:163], v[66:67], v[194:195]
    s_waitcnt vmcnt(6)
    v_pk_add_f32 v[68:69], v[68:69], v[100:101]
    v_pk_add_f32 v[70:71], v[70:71], v[102:103]
    v_pk_mul_f32 v[228:229], v[68:69], s[4:5]
    v_pk_mul_f32 v[230:231], v[70:71], s[4:5]
    buffer_store_dword v192, v23, s[12:15], s68 offen offset:0 sc1
    v_exp_f32 v228, v228
    v_exp_f32 v229, v229
    v_exp_f32 v230, v230
    v_exp_f32 v231, v231
    s_nop 0
    buffer_store_dword v193, v23, s[12:15], s69 offen offset:0 sc1
    v_pk_add_f32 v[228:229], v[228:229], 1.0 op_sel_hi:[1,0]
    v_pk_add_f32 v[230:231], v[230:231], 1.0 op_sel_hi:[1,0]
    v_rcp_f32 v228, v228
    v_rcp_f32 v229, v229
    v_rcp_f32_e64 v230, v230
    buffer_store_dword v194, v23, s[12:15], s70 offen offset:0 sc1
    v_rcp_f32 v231, v231
    s_nop 0
    v_pk_mul_f32 v[68:69], v[68:69], v[228:229]
    v_pk_mul_f32 v[70:71], v[70:71], v[230:231]
    v_pk_fma_f32 v[196:197], v[164:165], v[68:69], v[196:197]
    buffer_store_dword v195, v23, s[12:15], s71 offen offset:0 sc1
    v_pk_fma_f32 v[198:199], v[166:167], v[70:71], v[198:199]
    s_waitcnt vmcnt(9)
    v_pk_add_f32 v[72:73], v[72:73], v[104:105]
    v_pk_add_f32 v[74:75], v[74:75], v[106:107]
    v_pk_mul_f32 v[232:233], v[72:73], s[4:5]
    v_pk_mul_f32 v[234:235], v[74:75], s[4:5]
    buffer_store_dword v196, v23, s[12:15], s72 offen offset:0 sc1
    v_exp_f32 v232, v232
    v_exp_f32 v233, v233
    v_exp_f32 v234, v234
    v_exp_f32 v235, v235
    s_nop 0
    buffer_store_dword v197, v23, s[12:15], s73 offen offset:0 sc1
    v_pk_add_f32 v[232:233], v[232:233], 1.0 op_sel_hi:[1,0]
    v_pk_add_f32 v[234:235], v[234:235], 1.0 op_sel_hi:[1,0]
    v_rcp_f32 v232, v232
    v_rcp_f32 v233, v233
    v_rcp_f32_e64 v234, v234
    buffer_store_dword v198, v23, s[12:15], s74 offen offset:0 sc1
    v_rcp_f32 v235, v235
    s_nop 0
    v_pk_mul_f32 v[72:73], v[72:73], v[232:233]
    v_pk_mul_f32 v[74:75], v[74:75], v[234:235]
    v_pk_fma_f32 v[200:201], v[168:169], v[72:73], v[200:201]
    buffer_store_dword v199, v23, s[12:15], s75 offen offset:0 sc1
    v_pk_fma_f32 v[202:203], v[170:171], v[74:75], v[202:203]
    s_waitcnt vmcnt(12)
    v_pk_add_f32 v[76:77], v[76:77], v[108:109]
    v_pk_add_f32 v[78:79], v[78:79], v[110:111]
    v_pk_mul_f32 v[236:237], v[76:77], s[4:5]
    v_pk_mul_f32 v[238:239], v[78:79], s[4:5]
    buffer_store_dword v200, v23, s[12:15], s76 offen offset:0 sc1
    v_exp_f32 v236, v236
    v_exp_f32 v237, v237
    v_exp_f32 v238, v238
    v_exp_f32 v239, v239
    s_nop 0
    buffer_store_dword v201, v23, s[12:15], s77 offen offset:0 sc1
    v_pk_add_f32 v[236:237], v[236:237], 1.0 op_sel_hi:[1,0]
    v_pk_add_f32 v[238:239], v[238:239], 1.0 op_sel_hi:[1,0]
    v_rcp_f32 v236, v236
    v_rcp_f32 v237, v237
    v_rcp_f32_e64 v238, v238
    buffer_store_dword v202, v23, s[12:15], s78 offen offset:0 sc1
    v_rcp_f32 v239, v239
    s_nop 0
    v_pk_mul_f32 v[76:77], v[76:77], v[236:237]
    v_pk_mul_f32 v[78:79], v[78:79], v[238:239]
    v_pk_fma_f32 v[204:205], v[172:173], v[76:77], v[204:205]
    buffer_store_dword v203, v23, s[12:15], s79 offen offset:0 sc1
    v_pk_fma_f32 v[206:207], v[174:175], v[78:79], v[206:207]
    s_waitcnt vmcnt(15)
    v_pk_add_f32 v[80:81], v[80:81], v[112:113]
    v_pk_add_f32 v[82:83], v[82:83], v[114:115]
    v_pk_mul_f32 v[240:241], v[80:81], s[4:5]
    v_pk_mul_f32 v[242:243], v[82:83], s[4:5]
    buffer_store_dword v204, v23, s[12:15], s80 offen offset:0 sc1
    v_exp_f32 v240, v240
    v_exp_f32 v241, v241
    v_exp_f32 v242, v242
    v_exp_f32 v243, v243
    s_nop 0
    buffer_store_dword v205, v23, s[12:15], s81 offen offset:0 sc1
    v_pk_add_f32 v[240:241], v[240:241], 1.0 op_sel_hi:[1,0]
    v_pk_add_f32 v[242:243], v[242:243], 1.0 op_sel_hi:[1,0]
    v_rcp_f32 v240, v240
    v_rcp_f32 v241, v241
    v_rcp_f32_e64 v242, v242
    buffer_store_dword v206, v23, s[12:15], s82 offen offset:0 sc1
    v_rcp_f32 v243, v243
    s_nop 0
    v_pk_mul_f32 v[80:81], v[80:81], v[240:241]
    v_pk_mul_f32 v[82:83], v[82:83], v[242:243]
    v_pk_fma_f32 v[208:209], v[176:177], v[80:81], v[208:209]
    buffer_store_dword v207, v23, s[12:15], s83 offen offset:0 sc1
    v_pk_fma_f32 v[210:211], v[178:179], v[82:83], v[210:211]
    s_waitcnt vmcnt(18)
    v_pk_add_f32 v[84:85], v[84:85], v[116:117]
    v_pk_add_f32 v[86:87], v[86:87], v[118:119]
    v_pk_mul_f32 v[244:245], v[84:85], s[4:5]
    v_pk_mul_f32 v[246:247], v[86:87], s[4:5]
    buffer_store_dword v208, v23, s[12:15], s68 offen offset:64 sc1
    v_exp_f32 v244, v244
    v_exp_f32 v245, v245
    v_exp_f32 v246, v246
    v_exp_f32 v247, v247
    s_nop 0
    buffer_store_dword v209, v23, s[12:15], s69 offen offset:64 sc1
    v_pk_add_f32 v[244:245], v[244:245], 1.0 op_sel_hi:[1,0]
    v_pk_add_f32 v[246:247], v[246:247], 1.0 op_sel_hi:[1,0]
    v_rcp_f32 v244, v244
    v_rcp_f32 v245, v245
    v_rcp_f32_e64 v246, v246
    buffer_store_dword v210, v23, s[12:15], s70 offen offset:64 sc1
    v_rcp_f32 v247, v247
    s_nop 0
    v_pk_mul_f32 v[84:85], v[84:85], v[244:245]
    v_pk_mul_f32 v[86:87], v[86:87], v[246:247]
    v_pk_fma_f32 v[212:213], v[180:181], v[84:85], v[212:213]
    buffer_store_dword v211, v23, s[12:15], s71 offen offset:64 sc1
    v_pk_fma_f32 v[214:215], v[182:183], v[86:87], v[214:215]
    s_waitcnt vmcnt(21)
    v_pk_add_f32 v[88:89], v[88:89], v[120:121]
    v_pk_add_f32 v[90:91], v[90:91], v[122:123]
    v_pk_mul_f32 v[248:249], v[88:89], s[4:5]
    v_pk_mul_f32 v[250:251], v[90:91], s[4:5]
    buffer_store_dword v212, v23, s[12:15], s72 offen offset:64 sc1
    v_exp_f32 v248, v248
    v_exp_f32 v249, v249
    v_exp_f32 v250, v250
    v_exp_f32 v251, v251
    s_nop 0
    buffer_store_dword v213, v23, s[12:15], s73 offen offset:64 sc1
    v_pk_add_f32 v[248:249], v[248:249], 1.0 op_sel_hi:[1,0]
    v_pk_add_f32 v[250:251], v[250:251], 1.0 op_sel_hi:[1,0]
    v_rcp_f32 v248, v248
    v_rcp_f32 v249, v249
    v_rcp_f32_e64 v250, v250
    buffer_store_dword v214, v23, s[12:15], s74 offen offset:64 sc1
    v_rcp_f32 v251, v251
    s_nop 0
    v_pk_mul_f32 v[88:89], v[88:89], v[248:249]
    v_pk_mul_f32 v[90:91], v[90:91], v[250:251]
    v_pk_fma_f32 v[216:217], v[184:185], v[88:89], v[216:217]
    buffer_store_dword v215, v23, s[12:15], s75 offen offset:64 sc1
    v_pk_fma_f32 v[218:219], v[186:187], v[90:91], v[218:219]
    s_waitcnt vmcnt(24)
    v_pk_add_f32 v[92:93], v[92:93], v[124:125]
    v_pk_add_f32 v[94:95], v[94:95], v[126:127]
    v_pk_mul_f32 v[252:253], v[92:93], s[4:5]
    v_pk_mul_f32 v[254:255], v[94:95], s[4:5]
    buffer_store_dword v216, v23, s[12:15], s76 offen offset:64 sc1
    v_exp_f32 v252, v252
    v_exp_f32 v253, v253
    v_exp_f32 v254, v254
    v_exp_f32 v255, v255
    s_nop 0
    buffer_store_dword v217, v23, s[12:15], s77 offen offset:64 sc1
    v_pk_add_f32 v[252:253], v[252:253], 1.0 op_sel_hi:[1,0]
    v_pk_add_f32 v[254:255], v[254:255], 1.0 op_sel_hi:[1,0]
    v_rcp_f32 v252, v252
    v_rcp_f32 v253, v253
    v_rcp_f32_e64 v254, v254
    buffer_store_dword v218, v23, s[12:15], s78 offen offset:64 sc1
    v_rcp_f32 v255, v255
    s_nop 0
    v_pk_mul_f32 v[92:93], v[92:93], v[252:253]
    v_pk_mul_f32 v[94:95], v[94:95], v[254:255]
    v_pk_fma_f32 v[220:221], v[188:189], v[92:93], v[220:221]
    buffer_store_dword v219, v23, s[12:15], s79 offen offset:64 sc1
    v_pk_fma_f32 v[222:223], v[190:191], v[94:95], v[222:223]
    buffer_store_dword v220, v23, s[12:15], s80 offen offset:64 sc1
    buffer_store_dword v221, v23, s[12:15], s81 offen offset:64 sc1
    buffer_store_dword v222, v23, s[12:15], s82 offen offset:64 sc1
    buffer_store_dword v223, v23, s[12:15], s83 offen offset:64 sc1
    s_endpgm
L_k3_stopssm:
L_k3_spin2:
    s_sleep 1
    buffer_load_dwordx2 v[26:27], v60, s[20:23], s93 offen sc1
    s_waitcnt vmcnt(0)
    s_sub_u32 s55, s55, 1
    s_cmp_lg_u32 s55, 0
    s_cbranch_scc1 L_wcs2
    s_branch L_gcs2
L_k3_sig:
    s_cmp_lg_u32 s26, 0
    s_cbranch_scc1 L_sigpf
    s_mov_b32 s3, s67
    s_mov_b64 exec, 1
    buffer_store_dwordx2 a[248:249], off, s[20:23], s3 sc1
    s_mov_b64 exec, -1
L_sigpf:
    s_branch L_k3_sigret
L_k3_spin:
    s_sleep 1
    buffer_load_dwordx2 v[26:27], v60, s[20:23], s93 offen sc1
    s_waitcnt vmcnt(0)
    s_sub_u32 s55, s55, 1
    s_cmp_lg_u32 s55, 0
    s_cbranch_scc1 L_wcs
    s_branch L_gcs
L_end:
    s_endpgm
L_text_end:
.section .rodata,"a"
.p2align 6
.amdhsa_kernel recurrent_scan__ssm_conv_s5__glu_gated_geglu__prompt_kernel
  .amdhsa_next_free_vgpr 512
  .amdhsa_next_free_sgpr 102
  .amdhsa_accum_offset 256
  .amdhsa_group_segment_fixed_size 0
  .amdhsa_kernarg_size 128
  .amdhsa_user_sgpr_count 2
  .amdhsa_user_sgpr_kernarg_segment_ptr 1
  .amdhsa_system_sgpr_workgroup_id_x 1
  .amdhsa_float_denorm_mode_32 3
.end_amdhsa_kernel
```
